```python
import torch

def _softmax(x, axis=-1):
    return torch.softmax(x, dim=axis)
def _gelu(x):
    return torch.nn.functional.gelu(x, approximate="tanh")
def _silu(x):
    return torch.nn.functional.silu(x)
def _sigmoid(x):
    return torch.sigmoid(x)
def _layernorm(x, axis=-1, eps=1e-5):
    m = x.mean(dim=axis, keepdim=True)
    v = x.var(dim=axis, keepdim=True, unbiased=False)
    return (x - m) / torch.sqrt(v + eps)
def _scatter_add(tgt, idx, src, axis=0):
    return tgt.clone().index_add_(axis, idx, src)
def _segment_sum(src, seg, n):
    out = torch.zeros((n,) + src.shape[1:], dtype=src.dtype)
    return out.index_add_(0, seg, src)
def _pad(x, pw):
    flat = tuple(v for pair in reversed(pw) for v in pair)
    return torch.nn.functional.pad(x, flat)

kernel_name = 'standalone__modern_conv_block_slak__vision'

def setup_inputs():

    _w = (lambda a: (lambda t: t.to(torch.bfloat16) if t.is_floating_point() else t)(torch.as_tensor(a)))
    H = W = 384
    C = 384
    K = 1
    return {
        "x": _w((lambda *s: torch.randn(*s, dtype=torch.bfloat16) * 0.05)(1, H, W, C)),
        "dw": _w((lambda *s: torch.randn(*s, dtype=torch.bfloat16) * 0.05)(K, K, C)),
        "w1": _w((lambda *s: torch.randn(*s, dtype=torch.bfloat16) * 0.05)(C, 4 * C)),
        "w2": _w((lambda *s: torch.randn(*s, dtype=torch.bfloat16) * 0.05)(4 * C, C)),
        "grn_g": _w((lambda *s: torch.randn(*s, dtype=torch.bfloat16) * 0.05)(4 * C)),
        "grn_b": _w((lambda *s: torch.randn(*s, dtype=torch.bfloat16) * 0.05)(4 * C)),
    }

def reference(x, dw, w1, w2, grn_g, grn_b):
    B, H, W, C = x.shape
    K = dw.shape[0]
    pad = K // 2
    xp = _pad(x, ((0,0),(pad,pad),(pad,pad),(0,0)))
    out = torch.zeros_like(x)
    for i in range(K):
        for j in range(K):
            out = out + xp[:, i:i+H, j:j+W, :] * dw[i, j][None, None, None, :]
    h = _layernorm(out, axis=-1)
    h = _gelu(h @ w1)
    gx = torch.sqrt((h * h).sum(axis=(1, 2), keepdims=True) + 1e-6)
    nx = gx / (gx.mean(axis=-1, keepdims=True) + 1e-6)
    h = grn_g[None, None, None, :] * (h * nx) + grn_b[None, None, None, :] + h
    return x + h @ w2
```

```asm
; @launch kernel=prep_kernel grid=(336,1,1) block=(256,1,1) lds=0
; @launch kernel=ln_gemm1_kernel grid=(256,1,1) block=(512,1,1) lds=163840
; @launch kernel=grn_kernel grid=(145,1,1) block=(512,1,1) lds=8192
; @launch kernel=gemm2_kernel grid=(256,1,1) block=(256,1,1) lds=159744
.amdgcn_target "amdgcn-amd-amdhsa--gfx950"
.text
.globl prep_kernel
.p2align 8
.type prep_kernel,@function
prep_kernel:
    s_cmp_ge_u32 s2, 336
    s_cbranch_scc1 L_k0_end
    s_load_dwordx16 s[64:79], s[0:1], 0
    s_load_dwordx2 s[80:81], s[0:1], 64
    s_cmp_ge_u32 s2, 288
    s_cbranch_scc1 L_k0_bias
    v_lshrrev_b32 v1, 6, v0
    v_and_b32 v2, 15, v0
    v_readfirstlane_b32 s3, v1
    v_bfe_u32 v3, v0, 4, 2
    s_lshl_b32 s4, s2, 2
    s_add_u32 s4, s4, s3
    s_mul_i32 s5, s4, 43691
    s_lshr_b32 s5, s5, 19
    s_mul_i32 s6, s5, 12
    s_sub_u32 s6, s4, s6
    s_mul_i32 s7, s6, 98304
    s_lshl_b32 s5, s5, 5
    s_add_u32 s7, s7, s5
    v_mul_u32_u24 v4, 24576, v3
    v_lshl_add_u32 v4, v2, 1, v4
    s_waitcnt lgkmcnt(0)
    s_mov_b32 s8, s68
    s_and_b32 s9, s69, 0xffff
    s_mov_b32 s10, 0x120000
    s_mov_b32 s11, 0x20000
    s_add_u32 s12, s80, 0x14400000
    s_addc_u32 s13, s81, 0
    s_and_b32 s13, s13, 0xffff
    s_mov_b32 s14, 0x120000
    s_mov_b32 s15, 0x20000
    buffer_load_ushort v8, v4, s[8:11], s7 offen
    s_add_u32 s7, s7, 3072
    buffer_load_ushort v9, v4, s[8:11], s7 offen
    s_add_u32 s7, s7, 3072
    buffer_load_ushort v10, v4, s[8:11], s7 offen
    s_add_u32 s7, s7, 3072
    buffer_load_ushort v11, v4, s[8:11], s7 offen
    s_add_u32 s7, s7, 3072
    buffer_load_ushort v12, v4, s[8:11], s7 offen
    s_add_u32 s7, s7, 3072
    buffer_load_ushort v13, v4, s[8:11], s7 offen
    s_add_u32 s7, s7, 3072
    buffer_load_ushort v14, v4, s[8:11], s7 offen
    s_add_u32 s7, s7, 3072
    buffer_load_ushort v15, v4, s[8:11], s7 offen
    v_and_b32 v5, 63, v0
    v_lshlrev_b32 v5, 4, v5
    s_lshl_b32 s4, s4, 10
    s_waitcnt vmcnt(0)
    v_lshl_or_b32 v16, v9, 16, v8
    v_lshl_or_b32 v17, v11, 16, v10
    v_lshl_or_b32 v18, v13, 16, v12
    v_lshl_or_b32 v19, v15, 16, v14
    buffer_store_dwordx4 v[16:19], v5, s[12:15], s4 offen
    s_endpgm
L_k0_bias:
    s_sub_u32 s3, s2, 288
    s_waitcnt lgkmcnt(0)
    s_mov_b32 s8, s70
    s_and_b32 s9, s71, 0xffff
    s_mov_b32 s10, 0x120000
    s_mov_b32 s11, 0x20000
    s_add_u32 s12, s80, 0x14640000
    s_addc_u32 s13, s81, 0
    s_and_b32 s13, s13, 0xffff
    s_mov_b32 s14, 0xc000
    s_mov_b32 s15, 0x20000
    s_add_u32 s16, s80, 0x1464c000
    s_addc_u32 s17, s81, 0
    s_and_b32 s17, s17, 0xffff
    s_mov_b32 s18, 0x12000
    s_mov_b32 s19, 0x20000
    s_lshl_b32 s4, s3, 6
    s_add_u32 s20, s74, s4
    s_addc_u32 s21, s75, 0
    s_load_dwordx16 s[32:47], s[20:21], 0
    v_lshlrev_b32 v1, 2, v0
    v_mov_b32 v2, 0
    s_mul_i32 s5, s3, 1024
    buffer_store_dword v2, v1, s[12:15], s5 offen offset:0
    v_cmp_gt_u32 vcc, 192, v0
    s_and_saveexec_b64 s[22:23], vcc
    s_cbranch_execz L_k0_end
    s_mul_i32 s6, s3, 24576
    buffer_load_dword v8, v1, s[8:11], s6 offen offset:0
    buffer_load_dword v9, v1, s[8:11], s6 offen offset:768
    buffer_load_dword v10, v1, s[8:11], s6 offen offset:1536
    buffer_load_dword v11, v1, s[8:11], s6 offen offset:2304
    s_add_u32 s6, s6, 3072
    buffer_load_dword v12, v1, s[8:11], s6 offen offset:0
    buffer_load_dword v13, v1, s[8:11], s6 offen offset:768
    buffer_load_dword v14, v1, s[8:11], s6 offen offset:1536
    buffer_load_dword v15, v1, s[8:11], s6 offen offset:2304
    s_add_u32 s6, s6, 3072
    buffer_load_dword v16, v1, s[8:11], s6 offen offset:0
    buffer_load_dword v17, v1, s[8:11], s6 offen offset:768
    buffer_load_dword v18, v1, s[8:11], s6 offen offset:1536
    buffer_load_dword v19, v1, s[8:11], s6 offen offset:2304
    s_add_u32 s6, s6, 3072
    buffer_load_dword v20, v1, s[8:11], s6 offen offset:0
    buffer_load_dword v21, v1, s[8:11], s6 offen offset:768
    buffer_load_dword v22, v1, s[8:11], s6 offen offset:1536
    buffer_load_dword v23, v1, s[8:11], s6 offen offset:2304
    s_add_u32 s6, s6, 3072
    buffer_load_dword v24, v1, s[8:11], s6 offen offset:0
    buffer_load_dword v25, v1, s[8:11], s6 offen offset:768
    buffer_load_dword v26, v1, s[8:11], s6 offen offset:1536
    buffer_load_dword v27, v1, s[8:11], s6 offen offset:2304
    s_add_u32 s6, s6, 3072
    buffer_load_dword v28, v1, s[8:11], s6 offen offset:0
    buffer_load_dword v29, v1, s[8:11], s6 offen offset:768
    buffer_load_dword v30, v1, s[8:11], s6 offen offset:1536
    buffer_load_dword v31, v1, s[8:11], s6 offen offset:2304
    s_add_u32 s6, s6, 3072
    buffer_load_dword v32, v1, s[8:11], s6 offen offset:0
    buffer_load_dword v33, v1, s[8:11], s6 offen offset:768
    buffer_load_dword v34, v1, s[8:11], s6 offen offset:1536
    buffer_load_dword v35, v1, s[8:11], s6 offen offset:2304
    s_add_u32 s6, s6, 3072
    buffer_load_dword v36, v1, s[8:11], s6 offen offset:0
    buffer_load_dword v37, v1, s[8:11], s6 offen offset:768
    buffer_load_dword v38, v1, s[8:11], s6 offen offset:1536
    buffer_load_dword v39, v1, s[8:11], s6 offen offset:2304
    v_mov_b32 v4, 0
    v_mov_b32 v5, 0
    s_waitcnt lgkmcnt(0)
    s_waitcnt vmcnt(31)
    s_lshl_b32 s7, s32, 16
    v_lshlrev_b32 v6, 16, v8
    v_and_b32 v7, 0xffff0000, v8
    v_fmac_f32 v4, s7, v6
    v_fmac_f32 v5, s7, v7
    s_waitcnt vmcnt(30)
    s_and_b32 s7, s32, 0xffff0000
    v_lshlrev_b32 v6, 16, v9
    v_and_b32 v7, 0xffff0000, v9
    v_fmac_f32 v4, s7, v6
    v_fmac_f32 v5, s7, v7
    s_waitcnt vmcnt(29)
    s_lshl_b32 s7, s33, 16
    v_lshlrev_b32 v6, 16, v10
    v_and_b32 v7, 0xffff0000, v10
    v_fmac_f32 v4, s7, v6
    v_fmac_f32 v5, s7, v7
    s_waitcnt vmcnt(28)
    s_and_b32 s7, s33, 0xffff0000
    v_lshlrev_b32 v6, 16, v11
    v_and_b32 v7, 0xffff0000, v11
    v_fmac_f32 v4, s7, v6
    v_fmac_f32 v5, s7, v7
    s_waitcnt vmcnt(27)
    s_lshl_b32 s7, s34, 16
    v_lshlrev_b32 v6, 16, v12
    v_and_b32 v7, 0xffff0000, v12
    v_fmac_f32 v4, s7, v6
    v_fmac_f32 v5, s7, v7
    s_waitcnt vmcnt(26)
    s_and_b32 s7, s34, 0xffff0000
    v_lshlrev_b32 v6, 16, v13
    v_and_b32 v7, 0xffff0000, v13
    v_fmac_f32 v4, s7, v6
    v_fmac_f32 v5, s7, v7
    s_waitcnt vmcnt(25)
    s_lshl_b32 s7, s35, 16
    v_lshlrev_b32 v6, 16, v14
    v_and_b32 v7, 0xffff0000, v14
    v_fmac_f32 v4, s7, v6
    v_fmac_f32 v5, s7, v7
    s_waitcnt vmcnt(24)
    s_and_b32 s7, s35, 0xffff0000
    v_lshlrev_b32 v6, 16, v15
    v_and_b32 v7, 0xffff0000, v15
    v_fmac_f32 v4, s7, v6
    v_fmac_f32 v5, s7, v7
    s_waitcnt vmcnt(23)
    s_lshl_b32 s7, s36, 16
    v_lshlrev_b32 v6, 16, v16
    v_and_b32 v7, 0xffff0000, v16
    v_fmac_f32 v4, s7, v6
    v_fmac_f32 v5, s7, v7
    s_waitcnt vmcnt(22)
    s_and_b32 s7, s36, 0xffff0000
    v_lshlrev_b32 v6, 16, v17
    v_and_b32 v7, 0xffff0000, v17
    v_fmac_f32 v4, s7, v6
    v_fmac_f32 v5, s7, v7
    s_waitcnt vmcnt(21)
    s_lshl_b32 s7, s37, 16
    v_lshlrev_b32 v6, 16, v18
    v_and_b32 v7, 0xffff0000, v18
    v_fmac_f32 v4, s7, v6
    v_fmac_f32 v5, s7, v7
    s_waitcnt vmcnt(20)
    s_and_b32 s7, s37, 0xffff0000
    v_lshlrev_b32 v6, 16, v19
    v_and_b32 v7, 0xffff0000, v19
    v_fmac_f32 v4, s7, v6
    v_fmac_f32 v5, s7, v7
    s_waitcnt vmcnt(19)
    s_lshl_b32 s7, s38, 16
    v_lshlrev_b32 v6, 16, v20
    v_and_b32 v7, 0xffff0000, v20
    v_fmac_f32 v4, s7, v6
    v_fmac_f32 v5, s7, v7
    s_waitcnt vmcnt(18)
    s_and_b32 s7, s38, 0xffff0000
    v_lshlrev_b32 v6, 16, v21
    v_and_b32 v7, 0xffff0000, v21
    v_fmac_f32 v4, s7, v6
    v_fmac_f32 v5, s7, v7
    s_waitcnt vmcnt(17)
    s_lshl_b32 s7, s39, 16
    v_lshlrev_b32 v6, 16, v22
    v_and_b32 v7, 0xffff0000, v22
    v_fmac_f32 v4, s7, v6
    v_fmac_f32 v5, s7, v7
    s_waitcnt vmcnt(16)
    s_and_b32 s7, s39, 0xffff0000
    v_lshlrev_b32 v6, 16, v23
    v_and_b32 v7, 0xffff0000, v23
    v_fmac_f32 v4, s7, v6
    v_fmac_f32 v5, s7, v7
    s_waitcnt vmcnt(15)
    s_lshl_b32 s7, s40, 16
    v_lshlrev_b32 v6, 16, v24
    v_and_b32 v7, 0xffff0000, v24
    v_fmac_f32 v4, s7, v6
    v_fmac_f32 v5, s7, v7
    s_waitcnt vmcnt(14)
    s_and_b32 s7, s40, 0xffff0000
    v_lshlrev_b32 v6, 16, v25
    v_and_b32 v7, 0xffff0000, v25
    v_fmac_f32 v4, s7, v6
    v_fmac_f32 v5, s7, v7
    s_waitcnt vmcnt(13)
    s_lshl_b32 s7, s41, 16
    v_lshlrev_b32 v6, 16, v26
    v_and_b32 v7, 0xffff0000, v26
    v_fmac_f32 v4, s7, v6
    v_fmac_f32 v5, s7, v7
    s_waitcnt vmcnt(12)
    s_and_b32 s7, s41, 0xffff0000
    v_lshlrev_b32 v6, 16, v27
    v_and_b32 v7, 0xffff0000, v27
    v_fmac_f32 v4, s7, v6
    v_fmac_f32 v5, s7, v7
    s_waitcnt vmcnt(11)
    s_lshl_b32 s7, s42, 16
    v_lshlrev_b32 v6, 16, v28
    v_and_b32 v7, 0xffff0000, v28
    v_fmac_f32 v4, s7, v6
    v_fmac_f32 v5, s7, v7
    s_waitcnt vmcnt(10)
    s_and_b32 s7, s42, 0xffff0000
    v_lshlrev_b32 v6, 16, v29
    v_and_b32 v7, 0xffff0000, v29
    v_fmac_f32 v4, s7, v6
    v_fmac_f32 v5, s7, v7
    s_waitcnt vmcnt(9)
    s_lshl_b32 s7, s43, 16
    v_lshlrev_b32 v6, 16, v30
    v_and_b32 v7, 0xffff0000, v30
    v_fmac_f32 v4, s7, v6
    v_fmac_f32 v5, s7, v7
    s_waitcnt vmcnt(8)
    s_and_b32 s7, s43, 0xffff0000
    v_lshlrev_b32 v6, 16, v31
    v_and_b32 v7, 0xffff0000, v31
    v_fmac_f32 v4, s7, v6
    v_fmac_f32 v5, s7, v7
    s_waitcnt vmcnt(7)
    s_lshl_b32 s7, s44, 16
    v_lshlrev_b32 v6, 16, v32
    v_and_b32 v7, 0xffff0000, v32
    v_fmac_f32 v4, s7, v6
    v_fmac_f32 v5, s7, v7
    s_waitcnt vmcnt(6)
    s_and_b32 s7, s44, 0xffff0000
    v_lshlrev_b32 v6, 16, v33
    v_and_b32 v7, 0xffff0000, v33
    v_fmac_f32 v4, s7, v6
    v_fmac_f32 v5, s7, v7
    s_waitcnt vmcnt(5)
    s_lshl_b32 s7, s45, 16
    v_lshlrev_b32 v6, 16, v34
    v_and_b32 v7, 0xffff0000, v34
    v_fmac_f32 v4, s7, v6
    v_fmac_f32 v5, s7, v7
    s_waitcnt vmcnt(4)
    s_and_b32 s7, s45, 0xffff0000
    v_lshlrev_b32 v6, 16, v35
    v_and_b32 v7, 0xffff0000, v35
    v_fmac_f32 v4, s7, v6
    v_fmac_f32 v5, s7, v7
    s_waitcnt vmcnt(3)
    s_lshl_b32 s7, s46, 16
    v_lshlrev_b32 v6, 16, v36
    v_and_b32 v7, 0xffff0000, v36
    v_fmac_f32 v4, s7, v6
    v_fmac_f32 v5, s7, v7
    s_waitcnt vmcnt(2)
    s_and_b32 s7, s46, 0xffff0000
    v_lshlrev_b32 v6, 16, v37
    v_and_b32 v7, 0xffff0000, v37
    v_fmac_f32 v4, s7, v6
    v_fmac_f32 v5, s7, v7
    s_waitcnt vmcnt(1)
    s_lshl_b32 s7, s47, 16
    v_lshlrev_b32 v6, 16, v38
    v_and_b32 v7, 0xffff0000, v38
    v_fmac_f32 v4, s7, v6
    v_fmac_f32 v5, s7, v7
    s_waitcnt vmcnt(0)
    s_and_b32 s7, s47, 0xffff0000
    v_lshlrev_b32 v6, 16, v39
    v_and_b32 v7, 0xffff0000, v39
    v_fmac_f32 v4, s7, v6
    v_fmac_f32 v5, s7, v7
    v_lshlrev_b32 v1, 3, v0
    s_mul_i32 s6, s3, 1536
    buffer_store_dwordx2 v[4:5], v1, s[16:19], s6 offen
L_k0_end:
    s_endpgm
.globl ln_gemm1_kernel
.p2align 8
.type ln_gemm1_kernel,@function
ln_gemm1_kernel:
    s_cmp_ge_u32 s2, 256
    s_cbranch_scc1 L_k1_end
    s_load_dwordx16 s[64:79], s[0:1], 0
    s_load_dwordx2 s[80:81], s[0:1], 64
    v_lshrrev_b32 v16, 6, v0
    v_and_b32 v17, 63, v0
    v_readfirstlane_b32 s3, v16
    v_and_b32 v18, 15, v0
    v_bfe_u32 v19, v0, 4, 2
    v_lshlrev_b32 v1, 4, v17
    v_mul_u32_u24 v5, 768, v19
    v_lshl_add_u32 v5, v18, 4, v5
    s_and_b32 s46, s3, 3
    s_lshr_b32 s48, s3, 2
    s_lshr_b32 s27, s2, 3
    s_mul_i32 s29, s27, 3
    s_lshr_b32 s29, s29, 4
    s_lshl_b32 s49, s29, 3
    s_add_u32 s29, s2, 512
    s_add_u32 s30, s2, 256
    s_add_u32 s34, s2, 0
    s_cmp_eq_u32 s48, 0
    s_cselect_b32 s35, s29, s30
    s_mov_b32 s33, 5
    s_mov_b32 s36, 12
    s_mov_b32 s42, 1
    s_mov_b32 s24, s49
    s_mul_i32 s39, s46, 3072
    s_lshr_b32 s27, s46, 1
    s_mul_i32 s27, s27, 73728
    s_and_b32 s28, s46, 1
    s_mul_i32 s28, s28, 9216
    s_add_u32 s40, s27, s28
    s_mul_i32 s47, s3, 3072
    s_add_u32 s38, s47, 1179648
    s_mul_i32 s6, s49, 24576
    s_add_u32 s6, s6, s47
    s_waitcnt lgkmcnt(0)
    s_mov_b32 s8, s64
    s_and_b32 s9, s65, 0xffff
    s_mov_b32 s10, 0x6c00000
    s_mov_b32 s11, 0x20000
    s_mov_b32 s28, s66
    s_and_b32 s29, s67, 0xffff
    s_mov_b32 s30, 0x300
    s_mov_b32 s31, 0x20000
    s_add_u32 s12, s80, 0x14400000
    s_addc_u32 s13, s81, 0
    s_and_b32 s13, s13, 0xffff
    s_mov_b32 s14, 0x120000
    s_mov_b32 s15, 0x20000
    s_cmp_eq_u32 s48, 0
    s_cbranch_scc0 L_k1_nox
    s_mul_i32 s26, s34, 147456
    s_add_u32 s26, s26, s40
    v_and_b32 v10, 0xf0, v1
    buffer_load_dwordx4 v[48:51], v10, s[28:31], 0 offen offset:0
    buffer_load_dwordx4 v[52:55], v10, s[28:31], 0 offen offset:256
    buffer_load_dwordx4 v[12:15], v10, s[28:31], 0 offen offset:512
    s_add_u32 s27, s26, 0
    buffer_load_dwordx4 v[112:115], v5, s[8:11], s27 offen offset:0
    buffer_load_dwordx4 v[128:131], v5, s[8:11], s27 offen offset:256
    buffer_load_dwordx4 v[144:147], v5, s[8:11], s27 offen offset:512
    s_add_u32 s27, s26, 18432
    buffer_load_dwordx4 v[116:119], v5, s[8:11], s27 offen offset:0
    buffer_load_dwordx4 v[132:135], v5, s[8:11], s27 offen offset:256
    buffer_load_dwordx4 v[148:151], v5, s[8:11], s27 offen offset:512
    s_add_u32 s27, s26, 36864
    buffer_load_dwordx4 v[120:123], v5, s[8:11], s27 offen offset:0
    buffer_load_dwordx4 v[136:139], v5, s[8:11], s27 offen offset:256
    buffer_load_dwordx4 v[152:155], v5, s[8:11], s27 offen offset:512
    s_add_u32 s27, s26, 55296
    buffer_load_dwordx4 v[124:127], v5, s[8:11], s27 offen offset:0
    buffer_load_dwordx4 v[140:143], v5, s[8:11], s27 offen offset:256
    buffer_load_dwordx4 v[156:159], v5, s[8:11], s27 offen offset:512
    s_add_u32 s27, s26, 3072
    buffer_load_dwordx4 v[160:163], v5, s[8:11], s27 offen offset:0
    buffer_load_dwordx4 v[176:179], v5, s[8:11], s27 offen offset:256
    buffer_load_dwordx4 v[192:195], v5, s[8:11], s27 offen offset:512
    s_add_u32 s27, s26, 21504
    buffer_load_dwordx4 v[164:167], v5, s[8:11], s27 offen offset:0
    buffer_load_dwordx4 v[180:183], v5, s[8:11], s27 offen offset:256
    buffer_load_dwordx4 v[196:199], v5, s[8:11], s27 offen offset:512
    s_add_u32 s27, s26, 39936
    buffer_load_dwordx4 v[168:171], v5, s[8:11], s27 offen offset:0
    buffer_load_dwordx4 v[184:187], v5, s[8:11], s27 offen offset:256
    buffer_load_dwordx4 v[200:203], v5, s[8:11], s27 offen offset:512
    s_add_u32 s27, s26, 58368
    buffer_load_dwordx4 v[172:175], v5, s[8:11], s27 offen offset:0
    buffer_load_dwordx4 v[188:191], v5, s[8:11], s27 offen offset:256
    buffer_load_dwordx4 v[204:207], v5, s[8:11], s27 offen offset:512
    s_add_u32 s6, s6, 98304
L_k1_nox:
    s_mov_b32 s16, s80
    s_and_b32 s17, s81, 0xffff
    s_mov_b32 s18, 0x14400000
    s_mov_b32 s19, 0x20000
    s_mov_b32 s52, s76
    s_and_b32 s53, s77, 0xffff
    s_mov_b32 s54, 0x6c00000
    s_mov_b32 s55, 0x20000
    s_add_u32 s20, s80, 0x14640000
    s_addc_u32 s21, s81, 0
    s_and_b32 s21, s21, 0xffff
    s_mov_b32 s22, 0xc000
    s_mov_b32 s23, 0x20000
    v_add_u32 v2, 49152, v1
    s_lshl_b32 s27, s48, 13
    s_add_u32 s27, s27, 98304
    v_lshl_add_u32 v20, v17, 2, s27
    s_lshl_b32 s27, s46, 8
    v_add_u32 v3, s27, v20
    s_lshl_b32 s27, s46, 10
    s_add_u32 s27, s27, 4096
    v_add_u32 v6, s27, v20
    v_and_b32 v7, 31, v17
    v_lshlrev_b32 v7, 2, v7
    s_lshr_b32 s50, s2, 3
    s_and_b32 s50, s50, 7
    s_mul_i32 s50, s50, 6144
    s_lshl_b32 s27, s46, 7
    s_add_u32 s50, s50, s27
    s_mov_b32 s45, 0x40000000
    v_lshrrev_b32 v20, 2, v18
    v_lshlrev_b32 v4, 8, v20
    v_lshl_add_u32 v4, v19, 6, v4
    v_and_b32 v20, 3, v18
    v_lshl_add_u32 v4, v20, 4, v4
    s_mov_b32 s25, 0xc4eac4ea
    s_mov_b32 s51, 0xffff0000
    s_lshl_b32 s4, s39, 2
    s_add_u32 s4, s4, 114688
    s_mov_b32 s5, 1
L_k1_ln:
    s_cmp_ge_u32 s24, 48
    s_cselect_b32 s27, 48, 0
    s_sub_u32 s24, s24, s27
    s_mul_i32 s27, s34, 12
    s_lshr_b32 s43, s24, 2
    s_add_u32 s27, s27, s43
    s_mul_i32 s7, s27, 36864
    s_add_u32 s7, s7, s39
    s_mul_i32 s32, s27, 12288
    s_add_u32 s32, s32, s39
    v_lshrrev_b32 v64, 4, v1
    v_and_b32 v65, 15, v64
    v_lshrrev_b32 v66, 4, v64
    v_xor_b32 v67, v65, v66
    v_lshlrev_b32 v67, 4, v67
    s_mov_b32 s27, s4
    v_lshl_add_u32 v68, v66, 8, v67
    v_lshl_add_u32 v69, v65, 8, v67
    v_xor_b32 v56, 0, v68
    v_xor_b32 v60, 0, v69
    v_xor_b32 v57, 64, v68
    v_xor_b32 v61, 64, v69
    v_xor_b32 v58, 128, v68
    v_xor_b32 v62, 128, v69
    v_xor_b32 v59, 192, v68
    v_xor_b32 v63, 192, v69
    v_add_u32 v56, s27, v56
    v_add_u32 v60, s27, v60
    v_add_u32 v57, s27, v57
    v_add_u32 v61, s27, v61
    v_add_u32 v58, s27, v58
    v_add_u32 v62, s27, v62
    v_add_u32 v59, s27, v59
    v_add_u32 v63, s27, v63
    s_and_b32 s27, s42, s48
    s_cbranch_scc0 L_k1_lnj
    s_barrier
    ds_read_b128 v[112:115], v60 offset:0
    ds_read_b128 v[116:119], v61 offset:0
    ds_read_b128 v[120:123], v62 offset:0
    ds_read_b128 v[124:127], v63 offset:0
    ds_read_b128 v[128:131], v60 offset:4096
    ds_read_b128 v[132:135], v61 offset:4096
    ds_read_b128 v[136:139], v62 offset:4096
    ds_read_b128 v[140:143], v63 offset:4096
    ds_read_b128 v[144:147], v60 offset:8192
    ds_read_b128 v[148:151], v61 offset:8192
    ds_read_b128 v[152:155], v62 offset:8192
    ds_read_b128 v[156:159], v63 offset:8192
    s_waitcnt lgkmcnt(0)
    s_barrier
    s_add_u32 m0, s39, 0
    s_sub_u32 s27, s6, 12288
    buffer_load_dwordx4 v1, s[12:15], s27 offen offset:0 lds
    buffer_load_dwordx4 v1, s[12:15], s27 offen offset:1024 lds
    buffer_load_dwordx4 v1, s[12:15], s27 offen offset:2048 lds
    s_add_u32 m0, s47, 0
    s_nop 0
    buffer_load_dwordx4 v1, s[12:15], s6 offen offset:0 lds
    buffer_load_dwordx4 v1, s[12:15], s6 offen offset:1024 lds
    buffer_load_dwordx4 v1, s[12:15], s6 offen offset:2048 lds
    s_add_u32 s6, s6, 24576
    s_add_u32 m0, s39, 24576
    s_sub_u32 s27, s6, 12288
    buffer_load_dwordx4 v1, s[12:15], s27 offen offset:0 lds
    buffer_load_dwordx4 v1, s[12:15], s27 offen offset:1024 lds
    buffer_load_dwordx4 v1, s[12:15], s27 offen offset:2048 lds
    s_add_u32 m0, s47, 24576
    s_nop 0
    buffer_load_dwordx4 v1, s[12:15], s6 offen offset:0 lds
    buffer_load_dwordx4 v1, s[12:15], s6 offen offset:1024 lds
    buffer_load_dwordx4 v1, s[12:15], s6 offen offset:2048 lds
    s_add_u32 s6, s6, 24576
    s_barrier
    ds_read_b128 v[160:163], v60 offset:0
    ds_read_b128 v[164:167], v61 offset:0
    ds_read_b128 v[168:171], v62 offset:0
    ds_read_b128 v[172:175], v63 offset:0
    ds_read_b128 v[176:179], v60 offset:4096
    ds_read_b128 v[180:183], v61 offset:4096
    ds_read_b128 v[184:187], v62 offset:4096
    ds_read_b128 v[188:191], v63 offset:4096
    ds_read_b128 v[192:195], v60 offset:8192
    ds_read_b128 v[196:199], v61 offset:8192
    ds_read_b128 v[200:203], v62 offset:8192
    ds_read_b128 v[204:207], v63 offset:8192
    s_waitcnt lgkmcnt(0)
    s_barrier
    s_add_u32 m0, s39, 49152
    s_sub_u32 s27, s6, 12288
    buffer_load_dwordx4 v1, s[12:15], s27 offen offset:0 lds
    buffer_load_dwordx4 v1, s[12:15], s27 offen offset:1024 lds
    buffer_load_dwordx4 v1, s[12:15], s27 offen offset:2048 lds
    s_add_u32 m0, s47, 49152
    s_nop 0
    buffer_load_dwordx4 v1, s[12:15], s6 offen offset:0 lds
    buffer_load_dwordx4 v1, s[12:15], s6 offen offset:1024 lds
    buffer_load_dwordx4 v1, s[12:15], s6 offen offset:2048 lds
    s_add_u32 s6, s6, 24576
    s_add_u32 m0, s39, 73728
    s_sub_u32 s27, s6, 12288
    buffer_load_dwordx4 v1, s[12:15], s27 offen offset:0 lds
    buffer_load_dwordx4 v1, s[12:15], s27 offen offset:1024 lds
    buffer_load_dwordx4 v1, s[12:15], s27 offen offset:2048 lds
    s_add_u32 m0, s47, 73728
    s_nop 0
    buffer_load_dwordx4 v1, s[12:15], s6 offen offset:0 lds
    buffer_load_dwordx4 v1, s[12:15], s6 offen offset:1024 lds
    buffer_load_dwordx4 v1, s[12:15], s6 offen offset:2048 lds
    s_add_u32 s6, s6, 24576
    s_cmp_ge_u32 s6, s38
    s_cselect_b32 s6, s47, s6
    s_waitcnt vmcnt(0)
    s_barrier
    ds_read_b128 v[208:211], v60 offset:0
    ds_read_b128 v[212:215], v61 offset:0
    ds_read_b128 v[216:219], v62 offset:0
    ds_read_b128 v[220:223], v63 offset:0
    ds_read_b128 v[224:227], v60 offset:4096
    ds_read_b128 v[228:231], v61 offset:4096
    ds_read_b128 v[232:235], v62 offset:4096
    ds_read_b128 v[236:239], v63 offset:4096
    ds_read_b128 v[240:243], v60 offset:8192
    ds_read_b128 v[244:247], v61 offset:8192
    ds_read_b128 v[248:251], v62 offset:8192
    ds_read_b128 v[252:255], v63 offset:8192
    s_waitcnt lgkmcnt(0)
    s_add_u32 s27, s2, 512
    s_mul_i32 s26, s27, 147456
    s_add_u32 s26, s26, s40
    s_add_u32 s27, s26, 0
    s_add_u32 m0, s4, 0
    s_nop 0
    buffer_load_dwordx4 v5, s[8:11], s27 offen offset:0 lds
    s_add_u32 m0, s4, 3840
    s_nop 0
    buffer_load_dwordx4 v5, s[8:11], s27 offen offset:256 lds
    s_add_u32 m0, s4, 7680
    s_nop 0
    buffer_load_dwordx4 v5, s[8:11], s27 offen offset:512 lds
    s_add_u32 s27, s26, 18432
    s_add_u32 m0, s4, 1024
    s_nop 0
    buffer_load_dwordx4 v5, s[8:11], s27 offen offset:0 lds
    s_add_u32 m0, s4, 4864
    s_nop 0
    buffer_load_dwordx4 v5, s[8:11], s27 offen offset:256 lds
    s_add_u32 m0, s4, 8704
    s_nop 0
    buffer_load_dwordx4 v5, s[8:11], s27 offen offset:512 lds
    s_add_u32 s27, s26, 36864
    s_add_u32 m0, s4, 2048
    s_nop 0
    buffer_load_dwordx4 v5, s[8:11], s27 offen offset:0 lds
    s_add_u32 m0, s4, 5888
    s_nop 0
    buffer_load_dwordx4 v5, s[8:11], s27 offen offset:256 lds
    s_add_u32 m0, s4, 9728
    s_nop 0
    buffer_load_dwordx4 v5, s[8:11], s27 offen offset:512 lds
    s_add_u32 s27, s26, 55296
    s_add_u32 m0, s4, 3072
    s_nop 0
    buffer_load_dwordx4 v5, s[8:11], s27 offen offset:0 lds
    s_add_u32 m0, s4, 6912
    s_nop 0
    buffer_load_dwordx4 v5, s[8:11], s27 offen offset:256 lds
    s_add_u32 m0, s4, 10752
    s_nop 0
    buffer_load_dwordx4 v5, s[8:11], s27 offen offset:512 lds
    s_branch L_k1_dstart2
L_k1_lnj:
    s_cmp_eq_u32 s42, 1
    s_cbranch_scc1 L_k1_sa0
    s_waitcnt vmcnt(15)
    s_barrier
    s_add_u32 m0, s47, 0
    s_nop 0
    buffer_load_dwordx4 v1, s[12:15], s6 offen offset:0 lds
    buffer_load_dwordx4 v1, s[12:15], s6 offen offset:1024 lds
    buffer_load_dwordx4 v1, s[12:15], s6 offen offset:2048 lds
    s_add_u32 s6, s6, 24576
    s_waitcnt vmcnt(3) lgkmcnt(0)
    s_branch L_k1_sc0
L_k1_sa0:
    s_waitcnt vmcnt(12)
L_k1_sc0:
    v_and_b32 v16, 0xffff, v48
    v_and_b32 v17, 0xffff0000, v48
    v_and_b32 v18, 0xffff, v49
    v_and_b32 v19, 0xffff0000, v49
    v_and_b32 v20, 0xffff, v50
    v_and_b32 v21, 0xffff0000, v50
    v_and_b32 v22, 0xffff, v51
    v_and_b32 v23, 0xffff0000, v51
    v_and_b32 v24, 0xffff, v52
    v_and_b32 v25, 0xffff0000, v52
    v_and_b32 v26, 0xffff, v53
    v_and_b32 v27, 0xffff0000, v53
    v_and_b32 v28, 0xffff, v54
    v_and_b32 v29, 0xffff0000, v54
    v_and_b32 v30, 0xffff, v55
    v_and_b32 v31, 0xffff0000, v55
    v_and_b32 v32, 0xffff, v12
    v_and_b32 v33, 0xffff0000, v12
    v_and_b32 v34, 0xffff, v13
    v_and_b32 v35, 0xffff0000, v13
    v_and_b32 v36, 0xffff, v14
    v_and_b32 v37, 0xffff0000, v14
    v_and_b32 v38, 0xffff, v15
    v_and_b32 v39, 0xffff0000, v15
    s_cmp_eq_u32 s42, 1
    s_cbranch_scc1 L_k1_e00a
    s_add_u32 s27, s26, 3072
    buffer_load_dwordx4 v[160:163], v5, s[8:11], s27 offen offset:0
    buffer_load_dwordx4 v[176:179], v5, s[8:11], s27 offen offset:256
    buffer_load_dwordx4 v[192:195], v5, s[8:11], s27 offen offset:512
    s_branch L_k1_e00b
L_k1_e00a:
    s_add_u32 s27, s26, 6144
    buffer_load_dwordx4 v[208:211], v5, s[8:11], s27 offen offset:0
    buffer_load_dwordx4 v[224:227], v5, s[8:11], s27 offen offset:256
    buffer_load_dwordx4 v[240:243], v5, s[8:11], s27 offen offset:512
L_k1_e00b:
    v_dot2_f32_bf16 v40, v112, v48, 0
    v_dot2_f32_bf16 v40, v113, v49, v40
    v_dot2_f32_bf16 v40, v114, v50, v40
    v_dot2_f32_bf16 v40, v115, v51, v40
    v_dot2_f32_bf16 v64, v112, v16, 0
    v_dot2_f32_bf16 v65, v113, v18, 0
    v_dot2_f32_bf16 v66, v114, v20, 0
    v_dot2_f32_bf16 v67, v115, v22, 0
    v_dot2_f32_bf16 v112, v112, v17, 0
    v_dot2_f32_bf16 v113, v113, v19, 0
    v_dot2_f32_bf16 v114, v114, v21, 0
    v_dot2_f32_bf16 v115, v115, v23, 0
    v_pk_mul_f32 v[10:11], v[64:65], v[64:65]
    v_pk_fma_f32 v[10:11], v[66:67], v[66:67], v[10:11]
    v_pk_fma_f32 v[10:11], v[112:113], v[112:113], v[10:11]
    v_pk_fma_f32 v[10:11], v[114:115], v[114:115], v[10:11]
    v_dot2_f32_bf16 v40, v128, v52, v40
    v_dot2_f32_bf16 v40, v129, v53, v40
    v_dot2_f32_bf16 v40, v130, v54, v40
    v_dot2_f32_bf16 v40, v131, v55, v40
    v_dot2_f32_bf16 v80, v128, v24, 0
    v_dot2_f32_bf16 v81, v129, v26, 0
    v_dot2_f32_bf16 v82, v130, v28, 0
    v_dot2_f32_bf16 v83, v131, v30, 0
    v_dot2_f32_bf16 v128, v128, v25, 0
    v_dot2_f32_bf16 v129, v129, v27, 0
    v_dot2_f32_bf16 v130, v130, v29, 0
    v_dot2_f32_bf16 v131, v131, v31, 0
    v_pk_fma_f32 v[10:11], v[80:81], v[80:81], v[10:11]
    v_pk_fma_f32 v[10:11], v[82:83], v[82:83], v[10:11]
    v_pk_fma_f32 v[10:11], v[128:129], v[128:129], v[10:11]
    v_pk_fma_f32 v[10:11], v[130:131], v[130:131], v[10:11]
    v_dot2_f32_bf16 v40, v144, v12, v40
    v_dot2_f32_bf16 v40, v145, v13, v40
    v_dot2_f32_bf16 v40, v146, v14, v40
    v_dot2_f32_bf16 v40, v147, v15, v40
    v_dot2_f32_bf16 v96, v144, v32, 0
    v_dot2_f32_bf16 v97, v145, v34, 0
    v_dot2_f32_bf16 v98, v146, v36, 0
    v_dot2_f32_bf16 v99, v147, v38, 0
    v_dot2_f32_bf16 v144, v144, v33, 0
    v_dot2_f32_bf16 v145, v145, v35, 0
    v_dot2_f32_bf16 v146, v146, v37, 0
    v_dot2_f32_bf16 v147, v147, v39, 0
    v_pk_fma_f32 v[10:11], v[96:97], v[96:97], v[10:11]
    v_pk_fma_f32 v[10:11], v[98:99], v[98:99], v[10:11]
    v_pk_fma_f32 v[10:11], v[144:145], v[144:145], v[10:11]
    v_pk_fma_f32 v[10:11], v[146:147], v[146:147], v[10:11]
    v_add_f32 v44, v10, v11
    s_cmp_eq_u32 s42, 1
    s_cbranch_scc1 L_k1_e01a
    s_add_u32 s27, s26, 21504
    buffer_load_dwordx4 v[164:167], v5, s[8:11], s27 offen offset:0
    buffer_load_dwordx4 v[180:183], v5, s[8:11], s27 offen offset:256
    buffer_load_dwordx4 v[196:199], v5, s[8:11], s27 offen offset:512
    s_branch L_k1_e01b
L_k1_e01a:
    s_add_u32 s27, s26, 24576
    buffer_load_dwordx4 v[212:215], v5, s[8:11], s27 offen offset:0
    buffer_load_dwordx4 v[228:231], v5, s[8:11], s27 offen offset:256
    buffer_load_dwordx4 v[244:247], v5, s[8:11], s27 offen offset:512
L_k1_e01b:
    v_dot2_f32_bf16 v41, v116, v48, 0
    v_dot2_f32_bf16 v41, v117, v49, v41
    v_dot2_f32_bf16 v41, v118, v50, v41
    v_dot2_f32_bf16 v41, v119, v51, v41
    v_dot2_f32_bf16 v68, v116, v16, 0
    v_dot2_f32_bf16 v69, v117, v18, 0
    v_dot2_f32_bf16 v70, v118, v20, 0
    v_dot2_f32_bf16 v71, v119, v22, 0
    v_dot2_f32_bf16 v116, v116, v17, 0
    v_dot2_f32_bf16 v117, v117, v19, 0
    v_dot2_f32_bf16 v118, v118, v21, 0
    v_dot2_f32_bf16 v119, v119, v23, 0
    v_pk_mul_f32 v[10:11], v[68:69], v[68:69]
    v_pk_fma_f32 v[10:11], v[70:71], v[70:71], v[10:11]
    v_pk_fma_f32 v[10:11], v[116:117], v[116:117], v[10:11]
    v_pk_fma_f32 v[10:11], v[118:119], v[118:119], v[10:11]
    v_dot2_f32_bf16 v41, v132, v52, v41
    v_dot2_f32_bf16 v41, v133, v53, v41
    v_dot2_f32_bf16 v41, v134, v54, v41
    v_dot2_f32_bf16 v41, v135, v55, v41
    v_dot2_f32_bf16 v84, v132, v24, 0
    v_dot2_f32_bf16 v85, v133, v26, 0
    v_dot2_f32_bf16 v86, v134, v28, 0
    v_dot2_f32_bf16 v87, v135, v30, 0
    v_dot2_f32_bf16 v132, v132, v25, 0
    v_dot2_f32_bf16 v133, v133, v27, 0
    v_dot2_f32_bf16 v134, v134, v29, 0
    v_dot2_f32_bf16 v135, v135, v31, 0
    v_pk_fma_f32 v[10:11], v[84:85], v[84:85], v[10:11]
    v_pk_fma_f32 v[10:11], v[86:87], v[86:87], v[10:11]
    v_pk_fma_f32 v[10:11], v[132:133], v[132:133], v[10:11]
    v_pk_fma_f32 v[10:11], v[134:135], v[134:135], v[10:11]
    v_dot2_f32_bf16 v41, v148, v12, v41
    v_dot2_f32_bf16 v41, v149, v13, v41
    v_dot2_f32_bf16 v41, v150, v14, v41
    v_dot2_f32_bf16 v41, v151, v15, v41
    v_dot2_f32_bf16 v100, v148, v32, 0
    v_dot2_f32_bf16 v101, v149, v34, 0
    v_dot2_f32_bf16 v102, v150, v36, 0
    v_dot2_f32_bf16 v103, v151, v38, 0
    v_dot2_f32_bf16 v148, v148, v33, 0
    v_dot2_f32_bf16 v149, v149, v35, 0
    v_dot2_f32_bf16 v150, v150, v37, 0
    v_dot2_f32_bf16 v151, v151, v39, 0
    v_pk_fma_f32 v[10:11], v[100:101], v[100:101], v[10:11]
    v_pk_fma_f32 v[10:11], v[102:103], v[102:103], v[10:11]
    v_pk_fma_f32 v[10:11], v[148:149], v[148:149], v[10:11]
    v_pk_fma_f32 v[10:11], v[150:151], v[150:151], v[10:11]
    v_add_f32 v45, v10, v11
    s_cmp_eq_u32 s42, 1
    s_cbranch_scc1 L_k1_e02a
    s_add_u32 s27, s26, 39936
    buffer_load_dwordx4 v[168:171], v5, s[8:11], s27 offen offset:0
    buffer_load_dwordx4 v[184:187], v5, s[8:11], s27 offen offset:256
    buffer_load_dwordx4 v[200:203], v5, s[8:11], s27 offen offset:512
    s_branch L_k1_e02b
L_k1_e02a:
    s_add_u32 s27, s26, 43008
    buffer_load_dwordx4 v[216:219], v5, s[8:11], s27 offen offset:0
    buffer_load_dwordx4 v[232:235], v5, s[8:11], s27 offen offset:256
    buffer_load_dwordx4 v[248:251], v5, s[8:11], s27 offen offset:512
L_k1_e02b:
    v_dot2_f32_bf16 v42, v120, v48, 0
    v_dot2_f32_bf16 v42, v121, v49, v42
    v_dot2_f32_bf16 v42, v122, v50, v42
    v_dot2_f32_bf16 v42, v123, v51, v42
    v_dot2_f32_bf16 v72, v120, v16, 0
    v_dot2_f32_bf16 v73, v121, v18, 0
    v_dot2_f32_bf16 v74, v122, v20, 0
    v_dot2_f32_bf16 v75, v123, v22, 0
    v_dot2_f32_bf16 v120, v120, v17, 0
    v_dot2_f32_bf16 v121, v121, v19, 0
    v_dot2_f32_bf16 v122, v122, v21, 0
    v_dot2_f32_bf16 v123, v123, v23, 0
    v_pk_mul_f32 v[10:11], v[72:73], v[72:73]
    v_pk_fma_f32 v[10:11], v[74:75], v[74:75], v[10:11]
    v_pk_fma_f32 v[10:11], v[120:121], v[120:121], v[10:11]
    v_pk_fma_f32 v[10:11], v[122:123], v[122:123], v[10:11]
    v_dot2_f32_bf16 v42, v136, v52, v42
    v_dot2_f32_bf16 v42, v137, v53, v42
    v_dot2_f32_bf16 v42, v138, v54, v42
    v_dot2_f32_bf16 v42, v139, v55, v42
    v_dot2_f32_bf16 v88, v136, v24, 0
    v_dot2_f32_bf16 v89, v137, v26, 0
    v_dot2_f32_bf16 v90, v138, v28, 0
    v_dot2_f32_bf16 v91, v139, v30, 0
    v_dot2_f32_bf16 v136, v136, v25, 0
    v_dot2_f32_bf16 v137, v137, v27, 0
    v_dot2_f32_bf16 v138, v138, v29, 0
    v_dot2_f32_bf16 v139, v139, v31, 0
    v_pk_fma_f32 v[10:11], v[88:89], v[88:89], v[10:11]
    v_pk_fma_f32 v[10:11], v[90:91], v[90:91], v[10:11]
    v_pk_fma_f32 v[10:11], v[136:137], v[136:137], v[10:11]
    v_pk_fma_f32 v[10:11], v[138:139], v[138:139], v[10:11]
    v_dot2_f32_bf16 v42, v152, v12, v42
    v_dot2_f32_bf16 v42, v153, v13, v42
    v_dot2_f32_bf16 v42, v154, v14, v42
    v_dot2_f32_bf16 v42, v155, v15, v42
    v_dot2_f32_bf16 v104, v152, v32, 0
    v_dot2_f32_bf16 v105, v153, v34, 0
    v_dot2_f32_bf16 v106, v154, v36, 0
    v_dot2_f32_bf16 v107, v155, v38, 0
    v_dot2_f32_bf16 v152, v152, v33, 0
    v_dot2_f32_bf16 v153, v153, v35, 0
    v_dot2_f32_bf16 v154, v154, v37, 0
    v_dot2_f32_bf16 v155, v155, v39, 0
    v_pk_fma_f32 v[10:11], v[104:105], v[104:105], v[10:11]
    v_pk_fma_f32 v[10:11], v[106:107], v[106:107], v[10:11]
    v_pk_fma_f32 v[10:11], v[152:153], v[152:153], v[10:11]
    v_pk_fma_f32 v[10:11], v[154:155], v[154:155], v[10:11]
    v_add_f32 v46, v10, v11
    s_cmp_eq_u32 s42, 1
    s_cbranch_scc1 L_k1_e03a
    s_add_u32 s27, s26, 58368
    buffer_load_dwordx4 v[172:175], v5, s[8:11], s27 offen offset:0
    buffer_load_dwordx4 v[188:191], v5, s[8:11], s27 offen offset:256
    buffer_load_dwordx4 v[204:207], v5, s[8:11], s27 offen offset:512
    s_branch L_k1_e03b
L_k1_e03a:
    s_add_u32 s27, s26, 61440
    buffer_load_dwordx4 v[220:223], v5, s[8:11], s27 offen offset:0
    buffer_load_dwordx4 v[236:239], v5, s[8:11], s27 offen offset:256
    buffer_load_dwordx4 v[252:255], v5, s[8:11], s27 offen offset:512
L_k1_e03b:
    v_dot2_f32_bf16 v43, v124, v48, 0
    v_dot2_f32_bf16 v43, v125, v49, v43
    v_dot2_f32_bf16 v43, v126, v50, v43
    v_dot2_f32_bf16 v43, v127, v51, v43
    v_dot2_f32_bf16 v76, v124, v16, 0
    v_dot2_f32_bf16 v77, v125, v18, 0
    v_dot2_f32_bf16 v78, v126, v20, 0
    v_dot2_f32_bf16 v79, v127, v22, 0
    v_dot2_f32_bf16 v124, v124, v17, 0
    v_dot2_f32_bf16 v125, v125, v19, 0
    v_dot2_f32_bf16 v126, v126, v21, 0
    v_dot2_f32_bf16 v127, v127, v23, 0
    v_pk_mul_f32 v[10:11], v[76:77], v[76:77]
    v_pk_fma_f32 v[10:11], v[78:79], v[78:79], v[10:11]
    v_pk_fma_f32 v[10:11], v[124:125], v[124:125], v[10:11]
    v_pk_fma_f32 v[10:11], v[126:127], v[126:127], v[10:11]
    v_dot2_f32_bf16 v43, v140, v52, v43
    v_dot2_f32_bf16 v43, v141, v53, v43
    v_dot2_f32_bf16 v43, v142, v54, v43
    v_dot2_f32_bf16 v43, v143, v55, v43
    v_dot2_f32_bf16 v92, v140, v24, 0
    v_dot2_f32_bf16 v93, v141, v26, 0
    v_dot2_f32_bf16 v94, v142, v28, 0
    v_dot2_f32_bf16 v95, v143, v30, 0
    v_dot2_f32_bf16 v140, v140, v25, 0
    v_dot2_f32_bf16 v141, v141, v27, 0
    v_dot2_f32_bf16 v142, v142, v29, 0
    v_dot2_f32_bf16 v143, v143, v31, 0
    v_pk_fma_f32 v[10:11], v[92:93], v[92:93], v[10:11]
    v_pk_fma_f32 v[10:11], v[94:95], v[94:95], v[10:11]
    v_pk_fma_f32 v[10:11], v[140:141], v[140:141], v[10:11]
    v_pk_fma_f32 v[10:11], v[142:143], v[142:143], v[10:11]
    v_dot2_f32_bf16 v43, v156, v12, v43
    v_dot2_f32_bf16 v43, v157, v13, v43
    v_dot2_f32_bf16 v43, v158, v14, v43
    v_dot2_f32_bf16 v43, v159, v15, v43
    v_dot2_f32_bf16 v108, v156, v32, 0
    v_dot2_f32_bf16 v109, v157, v34, 0
    v_dot2_f32_bf16 v110, v158, v36, 0
    v_dot2_f32_bf16 v111, v159, v38, 0
    v_dot2_f32_bf16 v156, v156, v33, 0
    v_dot2_f32_bf16 v157, v157, v35, 0
    v_dot2_f32_bf16 v158, v158, v37, 0
    v_dot2_f32_bf16 v159, v159, v39, 0
    v_pk_fma_f32 v[10:11], v[108:109], v[108:109], v[10:11]
    v_pk_fma_f32 v[10:11], v[110:111], v[110:111], v[10:11]
    v_pk_fma_f32 v[10:11], v[156:157], v[156:157], v[10:11]
    v_pk_fma_f32 v[10:11], v[158:159], v[158:159], v[10:11]
    v_add_f32 v47, v10, v11
    s_nop 1
    v_add_f32_dpp v40, v40, v40 row_ror:8 row_mask:0xf bank_mask:0xf
    v_add_f32_dpp v41, v41, v41 row_ror:8 row_mask:0xf bank_mask:0xf
    v_add_f32_dpp v42, v42, v42 row_ror:8 row_mask:0xf bank_mask:0xf
    v_add_f32_dpp v43, v43, v43 row_ror:8 row_mask:0xf bank_mask:0xf
    v_add_f32_dpp v44, v44, v44 row_ror:8 row_mask:0xf bank_mask:0xf
    v_add_f32_dpp v45, v45, v45 row_ror:8 row_mask:0xf bank_mask:0xf
    v_add_f32_dpp v46, v46, v46 row_ror:8 row_mask:0xf bank_mask:0xf
    v_add_f32_dpp v47, v47, v47 row_ror:8 row_mask:0xf bank_mask:0xf
    v_add_f32_dpp v40, v40, v40 row_ror:4 row_mask:0xf bank_mask:0xf
    v_add_f32_dpp v41, v41, v41 row_ror:4 row_mask:0xf bank_mask:0xf
    v_add_f32_dpp v42, v42, v42 row_ror:4 row_mask:0xf bank_mask:0xf
    v_add_f32_dpp v43, v43, v43 row_ror:4 row_mask:0xf bank_mask:0xf
    v_add_f32_dpp v44, v44, v44 row_ror:4 row_mask:0xf bank_mask:0xf
    v_add_f32_dpp v45, v45, v45 row_ror:4 row_mask:0xf bank_mask:0xf
    v_add_f32_dpp v46, v46, v46 row_ror:4 row_mask:0xf bank_mask:0xf
    v_add_f32_dpp v47, v47, v47 row_ror:4 row_mask:0xf bank_mask:0xf
    v_add_f32_dpp v40, v40, v40 row_ror:2 row_mask:0xf bank_mask:0xf
    v_add_f32_dpp v41, v41, v41 row_ror:2 row_mask:0xf bank_mask:0xf
    v_add_f32_dpp v42, v42, v42 row_ror:2 row_mask:0xf bank_mask:0xf
    v_add_f32_dpp v43, v43, v43 row_ror:2 row_mask:0xf bank_mask:0xf
    v_add_f32_dpp v44, v44, v44 row_ror:2 row_mask:0xf bank_mask:0xf
    v_add_f32_dpp v45, v45, v45 row_ror:2 row_mask:0xf bank_mask:0xf
    v_add_f32_dpp v46, v46, v46 row_ror:2 row_mask:0xf bank_mask:0xf
    v_add_f32_dpp v47, v47, v47 row_ror:2 row_mask:0xf bank_mask:0xf
    v_add_f32_dpp v40, v40, v40 row_ror:1 row_mask:0xf bank_mask:0xf
    v_add_f32_dpp v41, v41, v41 row_ror:1 row_mask:0xf bank_mask:0xf
    v_add_f32_dpp v42, v42, v42 row_ror:1 row_mask:0xf bank_mask:0xf
    v_add_f32_dpp v43, v43, v43 row_ror:1 row_mask:0xf bank_mask:0xf
    v_add_f32_dpp v44, v44, v44 row_ror:1 row_mask:0xf bank_mask:0xf
    v_add_f32_dpp v45, v45, v45 row_ror:1 row_mask:0xf bank_mask:0xf
    v_add_f32_dpp v46, v46, v46 row_ror:1 row_mask:0xf bank_mask:0xf
    v_add_f32_dpp v47, v47, v47 row_ror:1 row_mask:0xf bank_mask:0xf
    v_mul_f32 v40, 0x3b2aaaab, v40
    v_mul_f32 v41, 0x3b2aaaab, v41
    v_mul_f32 v42, 0x3b2aaaab, v42
    v_mul_f32 v43, 0x3b2aaaab, v43
    v_mul_f32 v44, 0x3b2aaaab, v44
    v_mul_f32 v45, 0x3b2aaaab, v45
    v_mul_f32 v46, 0x3b2aaaab, v46
    v_mul_f32 v47, 0x3b2aaaab, v47
    v_fma_f32 v44, -v40, v40, v44
    v_fma_f32 v45, -v41, v41, v45
    v_fma_f32 v46, -v42, v42, v46
    v_fma_f32 v47, -v43, v43, v47
    v_max_f32 v44, 0, v44
    v_max_f32 v45, 0, v45
    v_max_f32 v46, 0, v46
    v_max_f32 v47, 0, v47
    v_add_f32 v44, 0x3727c5ac, v44
    v_add_f32 v45, 0x3727c5ac, v45
    v_add_f32 v46, 0x3727c5ac, v46
    v_add_f32 v47, 0x3727c5ac, v47
    v_rsq_f32 v44, v44
    v_rsq_f32 v45, v45
    v_rsq_f32 v46, v46
    v_rsq_f32 v47, v47
    v_mul_f32 v44, 0x3eefde6e, v44
    v_mul_f32 v45, 0x3eefde6e, v45
    v_mul_f32 v46, 0x3eefde6e, v46
    v_mul_f32 v47, 0x3eefde6e, v47
    v_mul_f32 v40, v40, v44
    v_mul_f32 v41, v41, v45
    v_mul_f32 v42, v42, v46
    v_mul_f32 v43, v43, v47
    v_pk_fma_f32 v[64:65], v[64:65], v[44:45], v[40:41] op_sel:[0,0,0] op_sel_hi:[1,0,0] neg_lo:[0,0,1] neg_hi:[0,0,1]
    v_pk_fma_f32 v[112:113], v[112:113], v[44:45], v[40:41] op_sel:[0,0,0] op_sel_hi:[1,0,0] neg_lo:[0,0,1] neg_hi:[0,0,1]
    v_pk_fma_f32 v[66:67], v[66:67], v[44:45], v[40:41] op_sel:[0,0,0] op_sel_hi:[1,0,0] neg_lo:[0,0,1] neg_hi:[0,0,1]
    v_pk_fma_f32 v[114:115], v[114:115], v[44:45], v[40:41] op_sel:[0,0,0] op_sel_hi:[1,0,0] neg_lo:[0,0,1] neg_hi:[0,0,1]
    v_cvt_pk_bf16_f32 v112, v64, v112
    v_cvt_pk_bf16_f32 v113, v65, v113
    v_cvt_pk_bf16_f32 v114, v66, v114
    v_cvt_pk_bf16_f32 v115, v67, v115
    ds_write_b128 v56, v[112:115] offset:0
    v_pk_fma_f32 v[68:69], v[68:69], v[44:45], v[40:41] op_sel:[0,1,1] op_sel_hi:[1,1,1] neg_lo:[0,0,1] neg_hi:[0,0,1]
    v_pk_fma_f32 v[116:117], v[116:117], v[44:45], v[40:41] op_sel:[0,1,1] op_sel_hi:[1,1,1] neg_lo:[0,0,1] neg_hi:[0,0,1]
    v_pk_fma_f32 v[70:71], v[70:71], v[44:45], v[40:41] op_sel:[0,1,1] op_sel_hi:[1,1,1] neg_lo:[0,0,1] neg_hi:[0,0,1]
    v_pk_fma_f32 v[118:119], v[118:119], v[44:45], v[40:41] op_sel:[0,1,1] op_sel_hi:[1,1,1] neg_lo:[0,0,1] neg_hi:[0,0,1]
    v_cvt_pk_bf16_f32 v116, v68, v116
    v_cvt_pk_bf16_f32 v117, v69, v117
    v_cvt_pk_bf16_f32 v118, v70, v118
    v_cvt_pk_bf16_f32 v119, v71, v119
    ds_write_b128 v57, v[116:119] offset:1024
    v_pk_fma_f32 v[72:73], v[72:73], v[46:47], v[42:43] op_sel:[0,0,0] op_sel_hi:[1,0,0] neg_lo:[0,0,1] neg_hi:[0,0,1]
    v_pk_fma_f32 v[120:121], v[120:121], v[46:47], v[42:43] op_sel:[0,0,0] op_sel_hi:[1,0,0] neg_lo:[0,0,1] neg_hi:[0,0,1]
    v_pk_fma_f32 v[74:75], v[74:75], v[46:47], v[42:43] op_sel:[0,0,0] op_sel_hi:[1,0,0] neg_lo:[0,0,1] neg_hi:[0,0,1]
    v_pk_fma_f32 v[122:123], v[122:123], v[46:47], v[42:43] op_sel:[0,0,0] op_sel_hi:[1,0,0] neg_lo:[0,0,1] neg_hi:[0,0,1]
    v_cvt_pk_bf16_f32 v120, v72, v120
    v_cvt_pk_bf16_f32 v121, v73, v121
    v_cvt_pk_bf16_f32 v122, v74, v122
    v_cvt_pk_bf16_f32 v123, v75, v123
    ds_write_b128 v58, v[120:123] offset:2048
    v_pk_fma_f32 v[76:77], v[76:77], v[46:47], v[42:43] op_sel:[0,1,1] op_sel_hi:[1,1,1] neg_lo:[0,0,1] neg_hi:[0,0,1]
    v_pk_fma_f32 v[124:125], v[124:125], v[46:47], v[42:43] op_sel:[0,1,1] op_sel_hi:[1,1,1] neg_lo:[0,0,1] neg_hi:[0,0,1]
    v_pk_fma_f32 v[78:79], v[78:79], v[46:47], v[42:43] op_sel:[0,1,1] op_sel_hi:[1,1,1] neg_lo:[0,0,1] neg_hi:[0,0,1]
    v_pk_fma_f32 v[126:127], v[126:127], v[46:47], v[42:43] op_sel:[0,1,1] op_sel_hi:[1,1,1] neg_lo:[0,0,1] neg_hi:[0,0,1]
    v_cvt_pk_bf16_f32 v124, v76, v124
    v_cvt_pk_bf16_f32 v125, v77, v125
    v_cvt_pk_bf16_f32 v126, v78, v126
    v_cvt_pk_bf16_f32 v127, v79, v127
    ds_write_b128 v59, v[124:127] offset:3072
    ds_read_b128 v[112:115], v60 offset:0
    ds_read_b128 v[116:119], v61 offset:0
    ds_read_b128 v[120:123], v62 offset:0
    ds_read_b128 v[124:127], v63 offset:0
    v_pk_fma_f32 v[80:81], v[80:81], v[44:45], v[40:41] op_sel:[0,0,0] op_sel_hi:[1,0,0] neg_lo:[0,0,1] neg_hi:[0,0,1]
    v_pk_fma_f32 v[128:129], v[128:129], v[44:45], v[40:41] op_sel:[0,0,0] op_sel_hi:[1,0,0] neg_lo:[0,0,1] neg_hi:[0,0,1]
    v_pk_fma_f32 v[82:83], v[82:83], v[44:45], v[40:41] op_sel:[0,0,0] op_sel_hi:[1,0,0] neg_lo:[0,0,1] neg_hi:[0,0,1]
    v_pk_fma_f32 v[130:131], v[130:131], v[44:45], v[40:41] op_sel:[0,0,0] op_sel_hi:[1,0,0] neg_lo:[0,0,1] neg_hi:[0,0,1]
    v_cvt_pk_bf16_f32 v128, v80, v128
    v_cvt_pk_bf16_f32 v129, v81, v129
    v_cvt_pk_bf16_f32 v130, v82, v130
    v_cvt_pk_bf16_f32 v131, v83, v131
    ds_write_b128 v56, v[128:131] offset:4096
    v_pk_fma_f32 v[84:85], v[84:85], v[44:45], v[40:41] op_sel:[0,1,1] op_sel_hi:[1,1,1] neg_lo:[0,0,1] neg_hi:[0,0,1]
    v_pk_fma_f32 v[132:133], v[132:133], v[44:45], v[40:41] op_sel:[0,1,1] op_sel_hi:[1,1,1] neg_lo:[0,0,1] neg_hi:[0,0,1]
    v_pk_fma_f32 v[86:87], v[86:87], v[44:45], v[40:41] op_sel:[0,1,1] op_sel_hi:[1,1,1] neg_lo:[0,0,1] neg_hi:[0,0,1]
    v_pk_fma_f32 v[134:135], v[134:135], v[44:45], v[40:41] op_sel:[0,1,1] op_sel_hi:[1,1,1] neg_lo:[0,0,1] neg_hi:[0,0,1]
    v_cvt_pk_bf16_f32 v132, v84, v132
    v_cvt_pk_bf16_f32 v133, v85, v133
    v_cvt_pk_bf16_f32 v134, v86, v134
    v_cvt_pk_bf16_f32 v135, v87, v135
    ds_write_b128 v57, v[132:135] offset:5120
    v_pk_fma_f32 v[88:89], v[88:89], v[46:47], v[42:43] op_sel:[0,0,0] op_sel_hi:[1,0,0] neg_lo:[0,0,1] neg_hi:[0,0,1]
    v_pk_fma_f32 v[136:137], v[136:137], v[46:47], v[42:43] op_sel:[0,0,0] op_sel_hi:[1,0,0] neg_lo:[0,0,1] neg_hi:[0,0,1]
    v_pk_fma_f32 v[90:91], v[90:91], v[46:47], v[42:43] op_sel:[0,0,0] op_sel_hi:[1,0,0] neg_lo:[0,0,1] neg_hi:[0,0,1]
    v_pk_fma_f32 v[138:139], v[138:139], v[46:47], v[42:43] op_sel:[0,0,0] op_sel_hi:[1,0,0] neg_lo:[0,0,1] neg_hi:[0,0,1]
    v_cvt_pk_bf16_f32 v136, v88, v136
    v_cvt_pk_bf16_f32 v137, v89, v137
    v_cvt_pk_bf16_f32 v138, v90, v138
    v_cvt_pk_bf16_f32 v139, v91, v139
    ds_write_b128 v58, v[136:139] offset:6144
    v_pk_fma_f32 v[92:93], v[92:93], v[46:47], v[42:43] op_sel:[0,1,1] op_sel_hi:[1,1,1] neg_lo:[0,0,1] neg_hi:[0,0,1]
    v_pk_fma_f32 v[140:141], v[140:141], v[46:47], v[42:43] op_sel:[0,1,1] op_sel_hi:[1,1,1] neg_lo:[0,0,1] neg_hi:[0,0,1]
    v_pk_fma_f32 v[94:95], v[94:95], v[46:47], v[42:43] op_sel:[0,1,1] op_sel_hi:[1,1,1] neg_lo:[0,0,1] neg_hi:[0,0,1]
    v_pk_fma_f32 v[142:143], v[142:143], v[46:47], v[42:43] op_sel:[0,1,1] op_sel_hi:[1,1,1] neg_lo:[0,0,1] neg_hi:[0,0,1]
    v_cvt_pk_bf16_f32 v140, v92, v140
    v_cvt_pk_bf16_f32 v141, v93, v141
    v_cvt_pk_bf16_f32 v142, v94, v142
    v_cvt_pk_bf16_f32 v143, v95, v143
    ds_write_b128 v59, v[140:143] offset:7168
    ds_read_b128 v[128:131], v60 offset:4096
    ds_read_b128 v[132:135], v61 offset:4096
    ds_read_b128 v[136:139], v62 offset:4096
    ds_read_b128 v[140:143], v63 offset:4096
    v_pk_fma_f32 v[96:97], v[96:97], v[44:45], v[40:41] op_sel:[0,0,0] op_sel_hi:[1,0,0] neg_lo:[0,0,1] neg_hi:[0,0,1]
    v_pk_fma_f32 v[144:145], v[144:145], v[44:45], v[40:41] op_sel:[0,0,0] op_sel_hi:[1,0,0] neg_lo:[0,0,1] neg_hi:[0,0,1]
    v_pk_fma_f32 v[98:99], v[98:99], v[44:45], v[40:41] op_sel:[0,0,0] op_sel_hi:[1,0,0] neg_lo:[0,0,1] neg_hi:[0,0,1]
    v_pk_fma_f32 v[146:147], v[146:147], v[44:45], v[40:41] op_sel:[0,0,0] op_sel_hi:[1,0,0] neg_lo:[0,0,1] neg_hi:[0,0,1]
    v_cvt_pk_bf16_f32 v144, v96, v144
    v_cvt_pk_bf16_f32 v145, v97, v145
    v_cvt_pk_bf16_f32 v146, v98, v146
    v_cvt_pk_bf16_f32 v147, v99, v147
    ds_write_b128 v56, v[144:147] offset:8192
    v_pk_fma_f32 v[100:101], v[100:101], v[44:45], v[40:41] op_sel:[0,1,1] op_sel_hi:[1,1,1] neg_lo:[0,0,1] neg_hi:[0,0,1]
    v_pk_fma_f32 v[148:149], v[148:149], v[44:45], v[40:41] op_sel:[0,1,1] op_sel_hi:[1,1,1] neg_lo:[0,0,1] neg_hi:[0,0,1]
    v_pk_fma_f32 v[102:103], v[102:103], v[44:45], v[40:41] op_sel:[0,1,1] op_sel_hi:[1,1,1] neg_lo:[0,0,1] neg_hi:[0,0,1]
    v_pk_fma_f32 v[150:151], v[150:151], v[44:45], v[40:41] op_sel:[0,1,1] op_sel_hi:[1,1,1] neg_lo:[0,0,1] neg_hi:[0,0,1]
    v_cvt_pk_bf16_f32 v148, v100, v148
    v_cvt_pk_bf16_f32 v149, v101, v149
    v_cvt_pk_bf16_f32 v150, v102, v150
    v_cvt_pk_bf16_f32 v151, v103, v151
    ds_write_b128 v57, v[148:151] offset:9216
    v_pk_fma_f32 v[104:105], v[104:105], v[46:47], v[42:43] op_sel:[0,0,0] op_sel_hi:[1,0,0] neg_lo:[0,0,1] neg_hi:[0,0,1]
    v_pk_fma_f32 v[152:153], v[152:153], v[46:47], v[42:43] op_sel:[0,0,0] op_sel_hi:[1,0,0] neg_lo:[0,0,1] neg_hi:[0,0,1]
    v_pk_fma_f32 v[106:107], v[106:107], v[46:47], v[42:43] op_sel:[0,0,0] op_sel_hi:[1,0,0] neg_lo:[0,0,1] neg_hi:[0,0,1]
    v_pk_fma_f32 v[154:155], v[154:155], v[46:47], v[42:43] op_sel:[0,0,0] op_sel_hi:[1,0,0] neg_lo:[0,0,1] neg_hi:[0,0,1]
    v_cvt_pk_bf16_f32 v152, v104, v152
    v_cvt_pk_bf16_f32 v153, v105, v153
    v_cvt_pk_bf16_f32 v154, v106, v154
    v_cvt_pk_bf16_f32 v155, v107, v155
    ds_write_b128 v58, v[152:155] offset:10240
    v_pk_fma_f32 v[108:109], v[108:109], v[46:47], v[42:43] op_sel:[0,1,1] op_sel_hi:[1,1,1] neg_lo:[0,0,1] neg_hi:[0,0,1]
    v_pk_fma_f32 v[156:157], v[156:157], v[46:47], v[42:43] op_sel:[0,1,1] op_sel_hi:[1,1,1] neg_lo:[0,0,1] neg_hi:[0,0,1]
    v_pk_fma_f32 v[110:111], v[110:111], v[46:47], v[42:43] op_sel:[0,1,1] op_sel_hi:[1,1,1] neg_lo:[0,0,1] neg_hi:[0,0,1]
    v_pk_fma_f32 v[158:159], v[158:159], v[46:47], v[42:43] op_sel:[0,1,1] op_sel_hi:[1,1,1] neg_lo:[0,0,1] neg_hi:[0,0,1]
    v_cvt_pk_bf16_f32 v156, v108, v156
    v_cvt_pk_bf16_f32 v157, v109, v157
    v_cvt_pk_bf16_f32 v158, v110, v158
    v_cvt_pk_bf16_f32 v159, v111, v159
    ds_write_b128 v59, v[156:159] offset:11264
    ds_read_b128 v[144:147], v60 offset:8192
    ds_read_b128 v[148:151], v61 offset:8192
    ds_read_b128 v[152:155], v62 offset:8192
    ds_read_b128 v[156:159], v63 offset:8192
    s_cmp_eq_u32 s42, 1
    s_cbranch_scc1 L_k1_sa1
    s_barrier
    s_add_u32 m0, s47, 24576
    s_nop 0
    buffer_load_dwordx4 v1, s[12:15], s6 offen offset:0 lds
    buffer_load_dwordx4 v1, s[12:15], s6 offen offset:1024 lds
    buffer_load_dwordx4 v1, s[12:15], s6 offen offset:2048 lds
    s_add_u32 s6, s6, 24576
    s_waitcnt vmcnt(3) lgkmcnt(0)
    s_branch L_k1_sc1
L_k1_sa1:
    s_waitcnt lgkmcnt(0)
    s_barrier
    s_waitcnt vmcnt(12)
L_k1_sc1:
    s_cmp_eq_u32 s42, 1
    s_cbranch_scc1 L_k1_e10a
    s_add_u32 s27, s26, 6144
    buffer_load_dwordx4 v[208:211], v5, s[8:11], s27 offen offset:0
    buffer_load_dwordx4 v[224:227], v5, s[8:11], s27 offen offset:256
    buffer_load_dwordx4 v[240:243], v5, s[8:11], s27 offen offset:512
L_k1_e10a:
    v_dot2_f32_bf16 v40, v160, v48, 0
    v_dot2_f32_bf16 v40, v161, v49, v40
    v_dot2_f32_bf16 v40, v162, v50, v40
    v_dot2_f32_bf16 v40, v163, v51, v40
    v_dot2_f32_bf16 v64, v160, v16, 0
    v_dot2_f32_bf16 v65, v161, v18, 0
    v_dot2_f32_bf16 v66, v162, v20, 0
    v_dot2_f32_bf16 v67, v163, v22, 0
    v_dot2_f32_bf16 v160, v160, v17, 0
    v_dot2_f32_bf16 v161, v161, v19, 0
    v_dot2_f32_bf16 v162, v162, v21, 0
    v_dot2_f32_bf16 v163, v163, v23, 0
    v_pk_mul_f32 v[10:11], v[64:65], v[64:65]
    v_pk_fma_f32 v[10:11], v[66:67], v[66:67], v[10:11]
    v_pk_fma_f32 v[10:11], v[160:161], v[160:161], v[10:11]
    v_pk_fma_f32 v[10:11], v[162:163], v[162:163], v[10:11]
    v_dot2_f32_bf16 v40, v176, v52, v40
    v_dot2_f32_bf16 v40, v177, v53, v40
    v_dot2_f32_bf16 v40, v178, v54, v40
    v_dot2_f32_bf16 v40, v179, v55, v40
    v_dot2_f32_bf16 v80, v176, v24, 0
    v_dot2_f32_bf16 v81, v177, v26, 0
    v_dot2_f32_bf16 v82, v178, v28, 0
    v_dot2_f32_bf16 v83, v179, v30, 0
    v_dot2_f32_bf16 v176, v176, v25, 0
    v_dot2_f32_bf16 v177, v177, v27, 0
    v_dot2_f32_bf16 v178, v178, v29, 0
    v_dot2_f32_bf16 v179, v179, v31, 0
    v_pk_fma_f32 v[10:11], v[80:81], v[80:81], v[10:11]
    v_pk_fma_f32 v[10:11], v[82:83], v[82:83], v[10:11]
    v_pk_fma_f32 v[10:11], v[176:177], v[176:177], v[10:11]
    v_pk_fma_f32 v[10:11], v[178:179], v[178:179], v[10:11]
    v_dot2_f32_bf16 v40, v192, v12, v40
    v_dot2_f32_bf16 v40, v193, v13, v40
    v_dot2_f32_bf16 v40, v194, v14, v40
    v_dot2_f32_bf16 v40, v195, v15, v40
    v_dot2_f32_bf16 v96, v192, v32, 0
    v_dot2_f32_bf16 v97, v193, v34, 0
    v_dot2_f32_bf16 v98, v194, v36, 0
    v_dot2_f32_bf16 v99, v195, v38, 0
    v_dot2_f32_bf16 v192, v192, v33, 0
    v_dot2_f32_bf16 v193, v193, v35, 0
    v_dot2_f32_bf16 v194, v194, v37, 0
    v_dot2_f32_bf16 v195, v195, v39, 0
    v_pk_fma_f32 v[10:11], v[96:97], v[96:97], v[10:11]
    v_pk_fma_f32 v[10:11], v[98:99], v[98:99], v[10:11]
    v_pk_fma_f32 v[10:11], v[192:193], v[192:193], v[10:11]
    v_pk_fma_f32 v[10:11], v[194:195], v[194:195], v[10:11]
    v_add_f32 v44, v10, v11
    s_cmp_eq_u32 s42, 1
    s_cbranch_scc1 L_k1_e11a
    s_add_u32 s27, s26, 24576
    buffer_load_dwordx4 v[212:215], v5, s[8:11], s27 offen offset:0
    buffer_load_dwordx4 v[228:231], v5, s[8:11], s27 offen offset:256
    buffer_load_dwordx4 v[244:247], v5, s[8:11], s27 offen offset:512
L_k1_e11a:
    v_dot2_f32_bf16 v41, v164, v48, 0
    v_dot2_f32_bf16 v41, v165, v49, v41
    v_dot2_f32_bf16 v41, v166, v50, v41
    v_dot2_f32_bf16 v41, v167, v51, v41
    v_dot2_f32_bf16 v68, v164, v16, 0
    v_dot2_f32_bf16 v69, v165, v18, 0
    v_dot2_f32_bf16 v70, v166, v20, 0
    v_dot2_f32_bf16 v71, v167, v22, 0
    v_dot2_f32_bf16 v164, v164, v17, 0
    v_dot2_f32_bf16 v165, v165, v19, 0
    v_dot2_f32_bf16 v166, v166, v21, 0
    v_dot2_f32_bf16 v167, v167, v23, 0
    v_pk_mul_f32 v[10:11], v[68:69], v[68:69]
    v_pk_fma_f32 v[10:11], v[70:71], v[70:71], v[10:11]
    v_pk_fma_f32 v[10:11], v[164:165], v[164:165], v[10:11]
    v_pk_fma_f32 v[10:11], v[166:167], v[166:167], v[10:11]
    v_dot2_f32_bf16 v41, v180, v52, v41
    v_dot2_f32_bf16 v41, v181, v53, v41
    v_dot2_f32_bf16 v41, v182, v54, v41
    v_dot2_f32_bf16 v41, v183, v55, v41
    v_dot2_f32_bf16 v84, v180, v24, 0
    v_dot2_f32_bf16 v85, v181, v26, 0
    v_dot2_f32_bf16 v86, v182, v28, 0
    v_dot2_f32_bf16 v87, v183, v30, 0
    v_dot2_f32_bf16 v180, v180, v25, 0
    v_dot2_f32_bf16 v181, v181, v27, 0
    v_dot2_f32_bf16 v182, v182, v29, 0
    v_dot2_f32_bf16 v183, v183, v31, 0
    v_pk_fma_f32 v[10:11], v[84:85], v[84:85], v[10:11]
    v_pk_fma_f32 v[10:11], v[86:87], v[86:87], v[10:11]
    v_pk_fma_f32 v[10:11], v[180:181], v[180:181], v[10:11]
    v_pk_fma_f32 v[10:11], v[182:183], v[182:183], v[10:11]
    v_dot2_f32_bf16 v41, v196, v12, v41
    v_dot2_f32_bf16 v41, v197, v13, v41
    v_dot2_f32_bf16 v41, v198, v14, v41
    v_dot2_f32_bf16 v41, v199, v15, v41
    v_dot2_f32_bf16 v100, v196, v32, 0
    v_dot2_f32_bf16 v101, v197, v34, 0
    v_dot2_f32_bf16 v102, v198, v36, 0
    v_dot2_f32_bf16 v103, v199, v38, 0
    v_dot2_f32_bf16 v196, v196, v33, 0
    v_dot2_f32_bf16 v197, v197, v35, 0
    v_dot2_f32_bf16 v198, v198, v37, 0
    v_dot2_f32_bf16 v199, v199, v39, 0
    v_pk_fma_f32 v[10:11], v[100:101], v[100:101], v[10:11]
    v_pk_fma_f32 v[10:11], v[102:103], v[102:103], v[10:11]
    v_pk_fma_f32 v[10:11], v[196:197], v[196:197], v[10:11]
    v_pk_fma_f32 v[10:11], v[198:199], v[198:199], v[10:11]
    v_add_f32 v45, v10, v11
    s_cmp_eq_u32 s42, 1
    s_cbranch_scc1 L_k1_e12a
    s_add_u32 s27, s26, 43008
    buffer_load_dwordx4 v[216:219], v5, s[8:11], s27 offen offset:0
    buffer_load_dwordx4 v[232:235], v5, s[8:11], s27 offen offset:256
    buffer_load_dwordx4 v[248:251], v5, s[8:11], s27 offen offset:512
L_k1_e12a:
    v_dot2_f32_bf16 v42, v168, v48, 0
    v_dot2_f32_bf16 v42, v169, v49, v42
    v_dot2_f32_bf16 v42, v170, v50, v42
    v_dot2_f32_bf16 v42, v171, v51, v42
    v_dot2_f32_bf16 v72, v168, v16, 0
    v_dot2_f32_bf16 v73, v169, v18, 0
    v_dot2_f32_bf16 v74, v170, v20, 0
    v_dot2_f32_bf16 v75, v171, v22, 0
    v_dot2_f32_bf16 v168, v168, v17, 0
    v_dot2_f32_bf16 v169, v169, v19, 0
    v_dot2_f32_bf16 v170, v170, v21, 0
    v_dot2_f32_bf16 v171, v171, v23, 0
    v_pk_mul_f32 v[10:11], v[72:73], v[72:73]
    v_pk_fma_f32 v[10:11], v[74:75], v[74:75], v[10:11]
    v_pk_fma_f32 v[10:11], v[168:169], v[168:169], v[10:11]
    v_pk_fma_f32 v[10:11], v[170:171], v[170:171], v[10:11]
    v_dot2_f32_bf16 v42, v184, v52, v42
    v_dot2_f32_bf16 v42, v185, v53, v42
    v_dot2_f32_bf16 v42, v186, v54, v42
    v_dot2_f32_bf16 v42, v187, v55, v42
    v_dot2_f32_bf16 v88, v184, v24, 0
    v_dot2_f32_bf16 v89, v185, v26, 0
    v_dot2_f32_bf16 v90, v186, v28, 0
    v_dot2_f32_bf16 v91, v187, v30, 0
    v_dot2_f32_bf16 v184, v184, v25, 0
    v_dot2_f32_bf16 v185, v185, v27, 0
    v_dot2_f32_bf16 v186, v186, v29, 0
    v_dot2_f32_bf16 v187, v187, v31, 0
    v_pk_fma_f32 v[10:11], v[88:89], v[88:89], v[10:11]
    v_pk_fma_f32 v[10:11], v[90:91], v[90:91], v[10:11]
    v_pk_fma_f32 v[10:11], v[184:185], v[184:185], v[10:11]
    v_pk_fma_f32 v[10:11], v[186:187], v[186:187], v[10:11]
    v_dot2_f32_bf16 v42, v200, v12, v42
    v_dot2_f32_bf16 v42, v201, v13, v42
    v_dot2_f32_bf16 v42, v202, v14, v42
    v_dot2_f32_bf16 v42, v203, v15, v42
    v_dot2_f32_bf16 v104, v200, v32, 0
    v_dot2_f32_bf16 v105, v201, v34, 0
    v_dot2_f32_bf16 v106, v202, v36, 0
    v_dot2_f32_bf16 v107, v203, v38, 0
    v_dot2_f32_bf16 v200, v200, v33, 0
    v_dot2_f32_bf16 v201, v201, v35, 0
    v_dot2_f32_bf16 v202, v202, v37, 0
    v_dot2_f32_bf16 v203, v203, v39, 0
    v_pk_fma_f32 v[10:11], v[104:105], v[104:105], v[10:11]
    v_pk_fma_f32 v[10:11], v[106:107], v[106:107], v[10:11]
    v_pk_fma_f32 v[10:11], v[200:201], v[200:201], v[10:11]
    v_pk_fma_f32 v[10:11], v[202:203], v[202:203], v[10:11]
    v_add_f32 v46, v10, v11
    s_cmp_eq_u32 s42, 1
    s_cbranch_scc1 L_k1_e13a
    s_add_u32 s27, s26, 61440
    buffer_load_dwordx4 v[220:223], v5, s[8:11], s27 offen offset:0
    buffer_load_dwordx4 v[236:239], v5, s[8:11], s27 offen offset:256
    buffer_load_dwordx4 v[252:255], v5, s[8:11], s27 offen offset:512
L_k1_e13a:
    v_dot2_f32_bf16 v43, v172, v48, 0
    v_dot2_f32_bf16 v43, v173, v49, v43
    v_dot2_f32_bf16 v43, v174, v50, v43
    v_dot2_f32_bf16 v43, v175, v51, v43
    v_dot2_f32_bf16 v76, v172, v16, 0
    v_dot2_f32_bf16 v77, v173, v18, 0
    v_dot2_f32_bf16 v78, v174, v20, 0
    v_dot2_f32_bf16 v79, v175, v22, 0
    v_dot2_f32_bf16 v172, v172, v17, 0
    v_dot2_f32_bf16 v173, v173, v19, 0
    v_dot2_f32_bf16 v174, v174, v21, 0
    v_dot2_f32_bf16 v175, v175, v23, 0
    v_pk_mul_f32 v[10:11], v[76:77], v[76:77]
    v_pk_fma_f32 v[10:11], v[78:79], v[78:79], v[10:11]
    v_pk_fma_f32 v[10:11], v[172:173], v[172:173], v[10:11]
    v_pk_fma_f32 v[10:11], v[174:175], v[174:175], v[10:11]
    v_dot2_f32_bf16 v43, v188, v52, v43
    v_dot2_f32_bf16 v43, v189, v53, v43
    v_dot2_f32_bf16 v43, v190, v54, v43
    v_dot2_f32_bf16 v43, v191, v55, v43
    v_dot2_f32_bf16 v92, v188, v24, 0
    v_dot2_f32_bf16 v93, v189, v26, 0
    v_dot2_f32_bf16 v94, v190, v28, 0
    v_dot2_f32_bf16 v95, v191, v30, 0
    v_dot2_f32_bf16 v188, v188, v25, 0
    v_dot2_f32_bf16 v189, v189, v27, 0
    v_dot2_f32_bf16 v190, v190, v29, 0
    v_dot2_f32_bf16 v191, v191, v31, 0
    v_pk_fma_f32 v[10:11], v[92:93], v[92:93], v[10:11]
    v_pk_fma_f32 v[10:11], v[94:95], v[94:95], v[10:11]
    v_pk_fma_f32 v[10:11], v[188:189], v[188:189], v[10:11]
    v_pk_fma_f32 v[10:11], v[190:191], v[190:191], v[10:11]
    v_dot2_f32_bf16 v43, v204, v12, v43
    v_dot2_f32_bf16 v43, v205, v13, v43
    v_dot2_f32_bf16 v43, v206, v14, v43
    v_dot2_f32_bf16 v43, v207, v15, v43
    v_dot2_f32_bf16 v108, v204, v32, 0
    v_dot2_f32_bf16 v109, v205, v34, 0
    v_dot2_f32_bf16 v110, v206, v36, 0
    v_dot2_f32_bf16 v111, v207, v38, 0
    v_dot2_f32_bf16 v204, v204, v33, 0
    v_dot2_f32_bf16 v205, v205, v35, 0
    v_dot2_f32_bf16 v206, v206, v37, 0
    v_dot2_f32_bf16 v207, v207, v39, 0
    v_pk_fma_f32 v[10:11], v[108:109], v[108:109], v[10:11]
    v_pk_fma_f32 v[10:11], v[110:111], v[110:111], v[10:11]
    v_pk_fma_f32 v[10:11], v[204:205], v[204:205], v[10:11]
    v_pk_fma_f32 v[10:11], v[206:207], v[206:207], v[10:11]
    v_add_f32 v47, v10, v11
    s_cmp_eq_u32 s42, 1
    s_cbranch_scc0 L_k1_sy1
    s_barrier
L_k1_sy1:
    s_nop 1
    v_add_f32_dpp v40, v40, v40 row_ror:8 row_mask:0xf bank_mask:0xf
    v_add_f32_dpp v41, v41, v41 row_ror:8 row_mask:0xf bank_mask:0xf
    v_add_f32_dpp v42, v42, v42 row_ror:8 row_mask:0xf bank_mask:0xf
    v_add_f32_dpp v43, v43, v43 row_ror:8 row_mask:0xf bank_mask:0xf
    v_add_f32_dpp v44, v44, v44 row_ror:8 row_mask:0xf bank_mask:0xf
    v_add_f32_dpp v45, v45, v45 row_ror:8 row_mask:0xf bank_mask:0xf
    v_add_f32_dpp v46, v46, v46 row_ror:8 row_mask:0xf bank_mask:0xf
    v_add_f32_dpp v47, v47, v47 row_ror:8 row_mask:0xf bank_mask:0xf
    v_add_f32_dpp v40, v40, v40 row_ror:4 row_mask:0xf bank_mask:0xf
    v_add_f32_dpp v41, v41, v41 row_ror:4 row_mask:0xf bank_mask:0xf
    v_add_f32_dpp v42, v42, v42 row_ror:4 row_mask:0xf bank_mask:0xf
    v_add_f32_dpp v43, v43, v43 row_ror:4 row_mask:0xf bank_mask:0xf
    v_add_f32_dpp v44, v44, v44 row_ror:4 row_mask:0xf bank_mask:0xf
    v_add_f32_dpp v45, v45, v45 row_ror:4 row_mask:0xf bank_mask:0xf
    v_add_f32_dpp v46, v46, v46 row_ror:4 row_mask:0xf bank_mask:0xf
    v_add_f32_dpp v47, v47, v47 row_ror:4 row_mask:0xf bank_mask:0xf
    v_add_f32_dpp v40, v40, v40 row_ror:2 row_mask:0xf bank_mask:0xf
    v_add_f32_dpp v41, v41, v41 row_ror:2 row_mask:0xf bank_mask:0xf
    v_add_f32_dpp v42, v42, v42 row_ror:2 row_mask:0xf bank_mask:0xf
    v_add_f32_dpp v43, v43, v43 row_ror:2 row_mask:0xf bank_mask:0xf
    v_add_f32_dpp v44, v44, v44 row_ror:2 row_mask:0xf bank_mask:0xf
    v_add_f32_dpp v45, v45, v45 row_ror:2 row_mask:0xf bank_mask:0xf
    v_add_f32_dpp v46, v46, v46 row_ror:2 row_mask:0xf bank_mask:0xf
    v_add_f32_dpp v47, v47, v47 row_ror:2 row_mask:0xf bank_mask:0xf
    v_add_f32_dpp v40, v40, v40 row_ror:1 row_mask:0xf bank_mask:0xf
    v_add_f32_dpp v41, v41, v41 row_ror:1 row_mask:0xf bank_mask:0xf
    v_add_f32_dpp v42, v42, v42 row_ror:1 row_mask:0xf bank_mask:0xf
    v_add_f32_dpp v43, v43, v43 row_ror:1 row_mask:0xf bank_mask:0xf
    v_add_f32_dpp v44, v44, v44 row_ror:1 row_mask:0xf bank_mask:0xf
    v_add_f32_dpp v45, v45, v45 row_ror:1 row_mask:0xf bank_mask:0xf
    v_add_f32_dpp v46, v46, v46 row_ror:1 row_mask:0xf bank_mask:0xf
    v_add_f32_dpp v47, v47, v47 row_ror:1 row_mask:0xf bank_mask:0xf
    v_mul_f32 v40, 0x3b2aaaab, v40
    v_mul_f32 v41, 0x3b2aaaab, v41
    v_mul_f32 v42, 0x3b2aaaab, v42
    v_mul_f32 v43, 0x3b2aaaab, v43
    v_mul_f32 v44, 0x3b2aaaab, v44
    v_mul_f32 v45, 0x3b2aaaab, v45
    v_mul_f32 v46, 0x3b2aaaab, v46
    v_mul_f32 v47, 0x3b2aaaab, v47
    v_fma_f32 v44, -v40, v40, v44
    v_fma_f32 v45, -v41, v41, v45
    v_fma_f32 v46, -v42, v42, v46
    v_fma_f32 v47, -v43, v43, v47
    v_max_f32 v44, 0, v44
    v_max_f32 v45, 0, v45
    v_max_f32 v46, 0, v46
    v_max_f32 v47, 0, v47
    v_add_f32 v44, 0x3727c5ac, v44
    v_add_f32 v45, 0x3727c5ac, v45
    v_add_f32 v46, 0x3727c5ac, v46
    v_add_f32 v47, 0x3727c5ac, v47
    v_rsq_f32 v44, v44
    v_rsq_f32 v45, v45
    v_rsq_f32 v46, v46
    v_rsq_f32 v47, v47
    v_mul_f32 v44, 0x3eefde6e, v44
    v_mul_f32 v45, 0x3eefde6e, v45
    v_mul_f32 v46, 0x3eefde6e, v46
    v_mul_f32 v47, 0x3eefde6e, v47
    v_mul_f32 v40, v40, v44
    v_mul_f32 v41, v41, v45
    v_mul_f32 v42, v42, v46
    v_mul_f32 v43, v43, v47
    v_pk_fma_f32 v[64:65], v[64:65], v[44:45], v[40:41] op_sel:[0,0,0] op_sel_hi:[1,0,0] neg_lo:[0,0,1] neg_hi:[0,0,1]
    v_pk_fma_f32 v[160:161], v[160:161], v[44:45], v[40:41] op_sel:[0,0,0] op_sel_hi:[1,0,0] neg_lo:[0,0,1] neg_hi:[0,0,1]
    v_pk_fma_f32 v[66:67], v[66:67], v[44:45], v[40:41] op_sel:[0,0,0] op_sel_hi:[1,0,0] neg_lo:[0,0,1] neg_hi:[0,0,1]
    v_pk_fma_f32 v[162:163], v[162:163], v[44:45], v[40:41] op_sel:[0,0,0] op_sel_hi:[1,0,0] neg_lo:[0,0,1] neg_hi:[0,0,1]
    v_cvt_pk_bf16_f32 v160, v64, v160
    v_cvt_pk_bf16_f32 v161, v65, v161
    v_cvt_pk_bf16_f32 v162, v66, v162
    v_cvt_pk_bf16_f32 v163, v67, v163
    ds_write_b128 v56, v[160:163] offset:0
    v_pk_fma_f32 v[68:69], v[68:69], v[44:45], v[40:41] op_sel:[0,1,1] op_sel_hi:[1,1,1] neg_lo:[0,0,1] neg_hi:[0,0,1]
    v_pk_fma_f32 v[164:165], v[164:165], v[44:45], v[40:41] op_sel:[0,1,1] op_sel_hi:[1,1,1] neg_lo:[0,0,1] neg_hi:[0,0,1]
    v_pk_fma_f32 v[70:71], v[70:71], v[44:45], v[40:41] op_sel:[0,1,1] op_sel_hi:[1,1,1] neg_lo:[0,0,1] neg_hi:[0,0,1]
    v_pk_fma_f32 v[166:167], v[166:167], v[44:45], v[40:41] op_sel:[0,1,1] op_sel_hi:[1,1,1] neg_lo:[0,0,1] neg_hi:[0,0,1]
    v_cvt_pk_bf16_f32 v164, v68, v164
    v_cvt_pk_bf16_f32 v165, v69, v165
    v_cvt_pk_bf16_f32 v166, v70, v166
    v_cvt_pk_bf16_f32 v167, v71, v167
    ds_write_b128 v57, v[164:167] offset:1024
    v_pk_fma_f32 v[72:73], v[72:73], v[46:47], v[42:43] op_sel:[0,0,0] op_sel_hi:[1,0,0] neg_lo:[0,0,1] neg_hi:[0,0,1]
    v_pk_fma_f32 v[168:169], v[168:169], v[46:47], v[42:43] op_sel:[0,0,0] op_sel_hi:[1,0,0] neg_lo:[0,0,1] neg_hi:[0,0,1]
    v_pk_fma_f32 v[74:75], v[74:75], v[46:47], v[42:43] op_sel:[0,0,0] op_sel_hi:[1,0,0] neg_lo:[0,0,1] neg_hi:[0,0,1]
    v_pk_fma_f32 v[170:171], v[170:171], v[46:47], v[42:43] op_sel:[0,0,0] op_sel_hi:[1,0,0] neg_lo:[0,0,1] neg_hi:[0,0,1]
    v_cvt_pk_bf16_f32 v168, v72, v168
    v_cvt_pk_bf16_f32 v169, v73, v169
    v_cvt_pk_bf16_f32 v170, v74, v170
    v_cvt_pk_bf16_f32 v171, v75, v171
    ds_write_b128 v58, v[168:171] offset:2048
    v_pk_fma_f32 v[76:77], v[76:77], v[46:47], v[42:43] op_sel:[0,1,1] op_sel_hi:[1,1,1] neg_lo:[0,0,1] neg_hi:[0,0,1]
    v_pk_fma_f32 v[172:173], v[172:173], v[46:47], v[42:43] op_sel:[0,1,1] op_sel_hi:[1,1,1] neg_lo:[0,0,1] neg_hi:[0,0,1]
    v_pk_fma_f32 v[78:79], v[78:79], v[46:47], v[42:43] op_sel:[0,1,1] op_sel_hi:[1,1,1] neg_lo:[0,0,1] neg_hi:[0,0,1]
    v_pk_fma_f32 v[174:175], v[174:175], v[46:47], v[42:43] op_sel:[0,1,1] op_sel_hi:[1,1,1] neg_lo:[0,0,1] neg_hi:[0,0,1]
    v_cvt_pk_bf16_f32 v172, v76, v172
    v_cvt_pk_bf16_f32 v173, v77, v173
    v_cvt_pk_bf16_f32 v174, v78, v174
    v_cvt_pk_bf16_f32 v175, v79, v175
    ds_write_b128 v59, v[172:175] offset:3072
    ds_read_b128 v[160:163], v60 offset:0
    ds_read_b128 v[164:167], v61 offset:0
    ds_read_b128 v[168:171], v62 offset:0
    ds_read_b128 v[172:175], v63 offset:0
    v_pk_fma_f32 v[80:81], v[80:81], v[44:45], v[40:41] op_sel:[0,0,0] op_sel_hi:[1,0,0] neg_lo:[0,0,1] neg_hi:[0,0,1]
    v_pk_fma_f32 v[176:177], v[176:177], v[44:45], v[40:41] op_sel:[0,0,0] op_sel_hi:[1,0,0] neg_lo:[0,0,1] neg_hi:[0,0,1]
    v_pk_fma_f32 v[82:83], v[82:83], v[44:45], v[40:41] op_sel:[0,0,0] op_sel_hi:[1,0,0] neg_lo:[0,0,1] neg_hi:[0,0,1]
    v_pk_fma_f32 v[178:179], v[178:179], v[44:45], v[40:41] op_sel:[0,0,0] op_sel_hi:[1,0,0] neg_lo:[0,0,1] neg_hi:[0,0,1]
    v_cvt_pk_bf16_f32 v176, v80, v176
    v_cvt_pk_bf16_f32 v177, v81, v177
    v_cvt_pk_bf16_f32 v178, v82, v178
    v_cvt_pk_bf16_f32 v179, v83, v179
    ds_write_b128 v56, v[176:179] offset:4096
    v_pk_fma_f32 v[84:85], v[84:85], v[44:45], v[40:41] op_sel:[0,1,1] op_sel_hi:[1,1,1] neg_lo:[0,0,1] neg_hi:[0,0,1]
    v_pk_fma_f32 v[180:181], v[180:181], v[44:45], v[40:41] op_sel:[0,1,1] op_sel_hi:[1,1,1] neg_lo:[0,0,1] neg_hi:[0,0,1]
    v_pk_fma_f32 v[86:87], v[86:87], v[44:45], v[40:41] op_sel:[0,1,1] op_sel_hi:[1,1,1] neg_lo:[0,0,1] neg_hi:[0,0,1]
    v_pk_fma_f32 v[182:183], v[182:183], v[44:45], v[40:41] op_sel:[0,1,1] op_sel_hi:[1,1,1] neg_lo:[0,0,1] neg_hi:[0,0,1]
    v_cvt_pk_bf16_f32 v180, v84, v180
    v_cvt_pk_bf16_f32 v181, v85, v181
    v_cvt_pk_bf16_f32 v182, v86, v182
    v_cvt_pk_bf16_f32 v183, v87, v183
    ds_write_b128 v57, v[180:183] offset:5120
    v_pk_fma_f32 v[88:89], v[88:89], v[46:47], v[42:43] op_sel:[0,0,0] op_sel_hi:[1,0,0] neg_lo:[0,0,1] neg_hi:[0,0,1]
    v_pk_fma_f32 v[184:185], v[184:185], v[46:47], v[42:43] op_sel:[0,0,0] op_sel_hi:[1,0,0] neg_lo:[0,0,1] neg_hi:[0,0,1]
    v_pk_fma_f32 v[90:91], v[90:91], v[46:47], v[42:43] op_sel:[0,0,0] op_sel_hi:[1,0,0] neg_lo:[0,0,1] neg_hi:[0,0,1]
    v_pk_fma_f32 v[186:187], v[186:187], v[46:47], v[42:43] op_sel:[0,0,0] op_sel_hi:[1,0,0] neg_lo:[0,0,1] neg_hi:[0,0,1]
    v_cvt_pk_bf16_f32 v184, v88, v184
    v_cvt_pk_bf16_f32 v185, v89, v185
    v_cvt_pk_bf16_f32 v186, v90, v186
    v_cvt_pk_bf16_f32 v187, v91, v187
    ds_write_b128 v58, v[184:187] offset:6144
    v_pk_fma_f32 v[92:93], v[92:93], v[46:47], v[42:43] op_sel:[0,1,1] op_sel_hi:[1,1,1] neg_lo:[0,0,1] neg_hi:[0,0,1]
    v_pk_fma_f32 v[188:189], v[188:189], v[46:47], v[42:43] op_sel:[0,1,1] op_sel_hi:[1,1,1] neg_lo:[0,0,1] neg_hi:[0,0,1]
    v_pk_fma_f32 v[94:95], v[94:95], v[46:47], v[42:43] op_sel:[0,1,1] op_sel_hi:[1,1,1] neg_lo:[0,0,1] neg_hi:[0,0,1]
    v_pk_fma_f32 v[190:191], v[190:191], v[46:47], v[42:43] op_sel:[0,1,1] op_sel_hi:[1,1,1] neg_lo:[0,0,1] neg_hi:[0,0,1]
    v_cvt_pk_bf16_f32 v188, v92, v188
    v_cvt_pk_bf16_f32 v189, v93, v189
    v_cvt_pk_bf16_f32 v190, v94, v190
    v_cvt_pk_bf16_f32 v191, v95, v191
    ds_write_b128 v59, v[188:191] offset:7168
    ds_read_b128 v[176:179], v60 offset:4096
    ds_read_b128 v[180:183], v61 offset:4096
    ds_read_b128 v[184:187], v62 offset:4096
    ds_read_b128 v[188:191], v63 offset:4096
    v_pk_fma_f32 v[96:97], v[96:97], v[44:45], v[40:41] op_sel:[0,0,0] op_sel_hi:[1,0,0] neg_lo:[0,0,1] neg_hi:[0,0,1]
    v_pk_fma_f32 v[192:193], v[192:193], v[44:45], v[40:41] op_sel:[0,0,0] op_sel_hi:[1,0,0] neg_lo:[0,0,1] neg_hi:[0,0,1]
    v_pk_fma_f32 v[98:99], v[98:99], v[44:45], v[40:41] op_sel:[0,0,0] op_sel_hi:[1,0,0] neg_lo:[0,0,1] neg_hi:[0,0,1]
    v_pk_fma_f32 v[194:195], v[194:195], v[44:45], v[40:41] op_sel:[0,0,0] op_sel_hi:[1,0,0] neg_lo:[0,0,1] neg_hi:[0,0,1]
    v_cvt_pk_bf16_f32 v192, v96, v192
    v_cvt_pk_bf16_f32 v193, v97, v193
    v_cvt_pk_bf16_f32 v194, v98, v194
    v_cvt_pk_bf16_f32 v195, v99, v195
    ds_write_b128 v56, v[192:195] offset:8192
    v_pk_fma_f32 v[100:101], v[100:101], v[44:45], v[40:41] op_sel:[0,1,1] op_sel_hi:[1,1,1] neg_lo:[0,0,1] neg_hi:[0,0,1]
    v_pk_fma_f32 v[196:197], v[196:197], v[44:45], v[40:41] op_sel:[0,1,1] op_sel_hi:[1,1,1] neg_lo:[0,0,1] neg_hi:[0,0,1]
    v_pk_fma_f32 v[102:103], v[102:103], v[44:45], v[40:41] op_sel:[0,1,1] op_sel_hi:[1,1,1] neg_lo:[0,0,1] neg_hi:[0,0,1]
    v_pk_fma_f32 v[198:199], v[198:199], v[44:45], v[40:41] op_sel:[0,1,1] op_sel_hi:[1,1,1] neg_lo:[0,0,1] neg_hi:[0,0,1]
    v_cvt_pk_bf16_f32 v196, v100, v196
    v_cvt_pk_bf16_f32 v197, v101, v197
    v_cvt_pk_bf16_f32 v198, v102, v198
    v_cvt_pk_bf16_f32 v199, v103, v199
    ds_write_b128 v57, v[196:199] offset:9216
    v_pk_fma_f32 v[104:105], v[104:105], v[46:47], v[42:43] op_sel:[0,0,0] op_sel_hi:[1,0,0] neg_lo:[0,0,1] neg_hi:[0,0,1]
    v_pk_fma_f32 v[200:201], v[200:201], v[46:47], v[42:43] op_sel:[0,0,0] op_sel_hi:[1,0,0] neg_lo:[0,0,1] neg_hi:[0,0,1]
    v_pk_fma_f32 v[106:107], v[106:107], v[46:47], v[42:43] op_sel:[0,0,0] op_sel_hi:[1,0,0] neg_lo:[0,0,1] neg_hi:[0,0,1]
    v_pk_fma_f32 v[202:203], v[202:203], v[46:47], v[42:43] op_sel:[0,0,0] op_sel_hi:[1,0,0] neg_lo:[0,0,1] neg_hi:[0,0,1]
    v_cvt_pk_bf16_f32 v200, v104, v200
    v_cvt_pk_bf16_f32 v201, v105, v201
    v_cvt_pk_bf16_f32 v202, v106, v202
    v_cvt_pk_bf16_f32 v203, v107, v203
    ds_write_b128 v58, v[200:203] offset:10240
    v_pk_fma_f32 v[108:109], v[108:109], v[46:47], v[42:43] op_sel:[0,1,1] op_sel_hi:[1,1,1] neg_lo:[0,0,1] neg_hi:[0,0,1]
    v_pk_fma_f32 v[204:205], v[204:205], v[46:47], v[42:43] op_sel:[0,1,1] op_sel_hi:[1,1,1] neg_lo:[0,0,1] neg_hi:[0,0,1]
    v_pk_fma_f32 v[110:111], v[110:111], v[46:47], v[42:43] op_sel:[0,1,1] op_sel_hi:[1,1,1] neg_lo:[0,0,1] neg_hi:[0,0,1]
    v_pk_fma_f32 v[206:207], v[206:207], v[46:47], v[42:43] op_sel:[0,1,1] op_sel_hi:[1,1,1] neg_lo:[0,0,1] neg_hi:[0,0,1]
    v_cvt_pk_bf16_f32 v204, v108, v204
    v_cvt_pk_bf16_f32 v205, v109, v205
    v_cvt_pk_bf16_f32 v206, v110, v206
    v_cvt_pk_bf16_f32 v207, v111, v207
    ds_write_b128 v59, v[204:207] offset:11264
    ds_read_b128 v[192:195], v60 offset:8192
    ds_read_b128 v[196:199], v61 offset:8192
    ds_read_b128 v[200:203], v62 offset:8192
    ds_read_b128 v[204:207], v63 offset:8192
    s_cmp_eq_u32 s42, 1
    s_cbranch_scc1 L_k1_sa2
    s_barrier
    s_add_u32 m0, s47, 49152
    s_nop 0
    buffer_load_dwordx4 v1, s[12:15], s6 offen offset:0 lds
    buffer_load_dwordx4 v1, s[12:15], s6 offen offset:1024 lds
    buffer_load_dwordx4 v1, s[12:15], s6 offen offset:2048 lds
    s_add_u32 s6, s6, 24576
    s_waitcnt vmcnt(3) lgkmcnt(0)
    s_branch L_k1_sc2
L_k1_sa2:
    s_waitcnt lgkmcnt(0)
    s_barrier
    s_waitcnt vmcnt(0)
L_k1_sc2:
    v_dot2_f32_bf16 v40, v208, v48, 0
    v_dot2_f32_bf16 v40, v209, v49, v40
    v_dot2_f32_bf16 v40, v210, v50, v40
    v_dot2_f32_bf16 v40, v211, v51, v40
    v_dot2_f32_bf16 v64, v208, v16, 0
    v_dot2_f32_bf16 v65, v209, v18, 0
    v_dot2_f32_bf16 v66, v210, v20, 0
    v_dot2_f32_bf16 v67, v211, v22, 0
    v_dot2_f32_bf16 v208, v208, v17, 0
    v_dot2_f32_bf16 v209, v209, v19, 0
    v_dot2_f32_bf16 v210, v210, v21, 0
    v_dot2_f32_bf16 v211, v211, v23, 0
    v_pk_mul_f32 v[10:11], v[64:65], v[64:65]
    v_pk_fma_f32 v[10:11], v[66:67], v[66:67], v[10:11]
    v_pk_fma_f32 v[10:11], v[208:209], v[208:209], v[10:11]
    v_pk_fma_f32 v[10:11], v[210:211], v[210:211], v[10:11]
    v_dot2_f32_bf16 v40, v224, v52, v40
    v_dot2_f32_bf16 v40, v225, v53, v40
    v_dot2_f32_bf16 v40, v226, v54, v40
    v_dot2_f32_bf16 v40, v227, v55, v40
    v_dot2_f32_bf16 v80, v224, v24, 0
    v_dot2_f32_bf16 v81, v225, v26, 0
    v_dot2_f32_bf16 v82, v226, v28, 0
    v_dot2_f32_bf16 v83, v227, v30, 0
    v_dot2_f32_bf16 v224, v224, v25, 0
    v_dot2_f32_bf16 v225, v225, v27, 0
    v_dot2_f32_bf16 v226, v226, v29, 0
    v_dot2_f32_bf16 v227, v227, v31, 0
    v_pk_fma_f32 v[10:11], v[80:81], v[80:81], v[10:11]
    v_pk_fma_f32 v[10:11], v[82:83], v[82:83], v[10:11]
    v_pk_fma_f32 v[10:11], v[224:225], v[224:225], v[10:11]
    v_pk_fma_f32 v[10:11], v[226:227], v[226:227], v[10:11]
    v_dot2_f32_bf16 v40, v240, v12, v40
    v_dot2_f32_bf16 v40, v241, v13, v40
    v_dot2_f32_bf16 v40, v242, v14, v40
    v_dot2_f32_bf16 v40, v243, v15, v40
    v_dot2_f32_bf16 v96, v240, v32, 0
    v_dot2_f32_bf16 v97, v241, v34, 0
    v_dot2_f32_bf16 v98, v242, v36, 0
    v_dot2_f32_bf16 v99, v243, v38, 0
    v_dot2_f32_bf16 v240, v240, v33, 0
    v_dot2_f32_bf16 v241, v241, v35, 0
    v_dot2_f32_bf16 v242, v242, v37, 0
    v_dot2_f32_bf16 v243, v243, v39, 0
    v_pk_fma_f32 v[10:11], v[96:97], v[96:97], v[10:11]
    v_pk_fma_f32 v[10:11], v[98:99], v[98:99], v[10:11]
    v_pk_fma_f32 v[10:11], v[240:241], v[240:241], v[10:11]
    v_pk_fma_f32 v[10:11], v[242:243], v[242:243], v[10:11]
    v_add_f32 v44, v10, v11
    v_dot2_f32_bf16 v41, v212, v48, 0
    v_dot2_f32_bf16 v41, v213, v49, v41
    v_dot2_f32_bf16 v41, v214, v50, v41
    v_dot2_f32_bf16 v41, v215, v51, v41
    v_dot2_f32_bf16 v68, v212, v16, 0
    v_dot2_f32_bf16 v69, v213, v18, 0
    v_dot2_f32_bf16 v70, v214, v20, 0
    v_dot2_f32_bf16 v71, v215, v22, 0
    v_dot2_f32_bf16 v212, v212, v17, 0
    v_dot2_f32_bf16 v213, v213, v19, 0
    v_dot2_f32_bf16 v214, v214, v21, 0
    v_dot2_f32_bf16 v215, v215, v23, 0
    v_pk_mul_f32 v[10:11], v[68:69], v[68:69]
    v_pk_fma_f32 v[10:11], v[70:71], v[70:71], v[10:11]
    v_pk_fma_f32 v[10:11], v[212:213], v[212:213], v[10:11]
    v_pk_fma_f32 v[10:11], v[214:215], v[214:215], v[10:11]
    v_dot2_f32_bf16 v41, v228, v52, v41
    v_dot2_f32_bf16 v41, v229, v53, v41
    v_dot2_f32_bf16 v41, v230, v54, v41
    v_dot2_f32_bf16 v41, v231, v55, v41
    v_dot2_f32_bf16 v84, v228, v24, 0
    v_dot2_f32_bf16 v85, v229, v26, 0
    v_dot2_f32_bf16 v86, v230, v28, 0
    v_dot2_f32_bf16 v87, v231, v30, 0
    v_dot2_f32_bf16 v228, v228, v25, 0
    v_dot2_f32_bf16 v229, v229, v27, 0
    v_dot2_f32_bf16 v230, v230, v29, 0
    v_dot2_f32_bf16 v231, v231, v31, 0
    v_pk_fma_f32 v[10:11], v[84:85], v[84:85], v[10:11]
    v_pk_fma_f32 v[10:11], v[86:87], v[86:87], v[10:11]
    v_pk_fma_f32 v[10:11], v[228:229], v[228:229], v[10:11]
    v_pk_fma_f32 v[10:11], v[230:231], v[230:231], v[10:11]
    v_dot2_f32_bf16 v41, v244, v12, v41
    v_dot2_f32_bf16 v41, v245, v13, v41
    v_dot2_f32_bf16 v41, v246, v14, v41
    v_dot2_f32_bf16 v41, v247, v15, v41
    v_dot2_f32_bf16 v100, v244, v32, 0
    v_dot2_f32_bf16 v101, v245, v34, 0
    v_dot2_f32_bf16 v102, v246, v36, 0
    v_dot2_f32_bf16 v103, v247, v38, 0
    v_dot2_f32_bf16 v244, v244, v33, 0
    v_dot2_f32_bf16 v245, v245, v35, 0
    v_dot2_f32_bf16 v246, v246, v37, 0
    v_dot2_f32_bf16 v247, v247, v39, 0
    v_pk_fma_f32 v[10:11], v[100:101], v[100:101], v[10:11]
    v_pk_fma_f32 v[10:11], v[102:103], v[102:103], v[10:11]
    v_pk_fma_f32 v[10:11], v[244:245], v[244:245], v[10:11]
    v_pk_fma_f32 v[10:11], v[246:247], v[246:247], v[10:11]
    v_add_f32 v45, v10, v11
    v_dot2_f32_bf16 v42, v216, v48, 0
    v_dot2_f32_bf16 v42, v217, v49, v42
    v_dot2_f32_bf16 v42, v218, v50, v42
    v_dot2_f32_bf16 v42, v219, v51, v42
    v_dot2_f32_bf16 v72, v216, v16, 0
    v_dot2_f32_bf16 v73, v217, v18, 0
    v_dot2_f32_bf16 v74, v218, v20, 0
    v_dot2_f32_bf16 v75, v219, v22, 0
    v_dot2_f32_bf16 v216, v216, v17, 0
    v_dot2_f32_bf16 v217, v217, v19, 0
    v_dot2_f32_bf16 v218, v218, v21, 0
    v_dot2_f32_bf16 v219, v219, v23, 0
    v_pk_mul_f32 v[10:11], v[72:73], v[72:73]
    v_pk_fma_f32 v[10:11], v[74:75], v[74:75], v[10:11]
    v_pk_fma_f32 v[10:11], v[216:217], v[216:217], v[10:11]
    v_pk_fma_f32 v[10:11], v[218:219], v[218:219], v[10:11]
    v_dot2_f32_bf16 v42, v232, v52, v42
    v_dot2_f32_bf16 v42, v233, v53, v42
    v_dot2_f32_bf16 v42, v234, v54, v42
    v_dot2_f32_bf16 v42, v235, v55, v42
    v_dot2_f32_bf16 v88, v232, v24, 0
    v_dot2_f32_bf16 v89, v233, v26, 0
    v_dot2_f32_bf16 v90, v234, v28, 0
    v_dot2_f32_bf16 v91, v235, v30, 0
    v_dot2_f32_bf16 v232, v232, v25, 0
    v_dot2_f32_bf16 v233, v233, v27, 0
    v_dot2_f32_bf16 v234, v234, v29, 0
    v_dot2_f32_bf16 v235, v235, v31, 0
    v_pk_fma_f32 v[10:11], v[88:89], v[88:89], v[10:11]
    v_pk_fma_f32 v[10:11], v[90:91], v[90:91], v[10:11]
    v_pk_fma_f32 v[10:11], v[232:233], v[232:233], v[10:11]
    v_pk_fma_f32 v[10:11], v[234:235], v[234:235], v[10:11]
    v_dot2_f32_bf16 v42, v248, v12, v42
    v_dot2_f32_bf16 v42, v249, v13, v42
    v_dot2_f32_bf16 v42, v250, v14, v42
    v_dot2_f32_bf16 v42, v251, v15, v42
    v_dot2_f32_bf16 v104, v248, v32, 0
    v_dot2_f32_bf16 v105, v249, v34, 0
    v_dot2_f32_bf16 v106, v250, v36, 0
    v_dot2_f32_bf16 v107, v251, v38, 0
    v_dot2_f32_bf16 v248, v248, v33, 0
    v_dot2_f32_bf16 v249, v249, v35, 0
    v_dot2_f32_bf16 v250, v250, v37, 0
    v_dot2_f32_bf16 v251, v251, v39, 0
    v_pk_fma_f32 v[10:11], v[104:105], v[104:105], v[10:11]
    v_pk_fma_f32 v[10:11], v[106:107], v[106:107], v[10:11]
    v_pk_fma_f32 v[10:11], v[248:249], v[248:249], v[10:11]
    v_pk_fma_f32 v[10:11], v[250:251], v[250:251], v[10:11]
    v_add_f32 v46, v10, v11
    v_dot2_f32_bf16 v43, v220, v48, 0
    v_dot2_f32_bf16 v43, v221, v49, v43
    v_dot2_f32_bf16 v43, v222, v50, v43
    v_dot2_f32_bf16 v43, v223, v51, v43
    v_dot2_f32_bf16 v76, v220, v16, 0
    v_dot2_f32_bf16 v77, v221, v18, 0
    v_dot2_f32_bf16 v78, v222, v20, 0
    v_dot2_f32_bf16 v79, v223, v22, 0
    v_dot2_f32_bf16 v220, v220, v17, 0
    v_dot2_f32_bf16 v221, v221, v19, 0
    v_dot2_f32_bf16 v222, v222, v21, 0
    v_dot2_f32_bf16 v223, v223, v23, 0
    v_pk_mul_f32 v[10:11], v[76:77], v[76:77]
    v_pk_fma_f32 v[10:11], v[78:79], v[78:79], v[10:11]
    v_pk_fma_f32 v[10:11], v[220:221], v[220:221], v[10:11]
    v_pk_fma_f32 v[10:11], v[222:223], v[222:223], v[10:11]
    v_dot2_f32_bf16 v43, v236, v52, v43
    v_dot2_f32_bf16 v43, v237, v53, v43
    v_dot2_f32_bf16 v43, v238, v54, v43
    v_dot2_f32_bf16 v43, v239, v55, v43
    v_dot2_f32_bf16 v92, v236, v24, 0
    v_dot2_f32_bf16 v93, v237, v26, 0
    v_dot2_f32_bf16 v94, v238, v28, 0
    v_dot2_f32_bf16 v95, v239, v30, 0
    v_dot2_f32_bf16 v236, v236, v25, 0
    v_dot2_f32_bf16 v237, v237, v27, 0
    v_dot2_f32_bf16 v238, v238, v29, 0
    v_dot2_f32_bf16 v239, v239, v31, 0
    v_pk_fma_f32 v[10:11], v[92:93], v[92:93], v[10:11]
    v_pk_fma_f32 v[10:11], v[94:95], v[94:95], v[10:11]
    v_pk_fma_f32 v[10:11], v[236:237], v[236:237], v[10:11]
    v_pk_fma_f32 v[10:11], v[238:239], v[238:239], v[10:11]
    v_dot2_f32_bf16 v43, v252, v12, v43
    v_dot2_f32_bf16 v43, v253, v13, v43
    v_dot2_f32_bf16 v43, v254, v14, v43
    v_dot2_f32_bf16 v43, v255, v15, v43
    v_dot2_f32_bf16 v108, v252, v32, 0
    v_dot2_f32_bf16 v109, v253, v34, 0
    v_dot2_f32_bf16 v110, v254, v36, 0
    v_dot2_f32_bf16 v111, v255, v38, 0
    v_dot2_f32_bf16 v252, v252, v33, 0
    v_dot2_f32_bf16 v253, v253, v35, 0
    v_dot2_f32_bf16 v254, v254, v37, 0
    v_dot2_f32_bf16 v255, v255, v39, 0
    v_pk_fma_f32 v[10:11], v[108:109], v[108:109], v[10:11]
    v_pk_fma_f32 v[10:11], v[110:111], v[110:111], v[10:11]
    v_pk_fma_f32 v[10:11], v[252:253], v[252:253], v[10:11]
    v_pk_fma_f32 v[10:11], v[254:255], v[254:255], v[10:11]
    v_add_f32 v47, v10, v11
    s_cmp_eq_u32 s42, 1
    s_cbranch_scc0 L_k1_sy2
    s_barrier
L_k1_sy2:
    s_nop 1
    v_add_f32_dpp v40, v40, v40 row_ror:8 row_mask:0xf bank_mask:0xf
    v_add_f32_dpp v41, v41, v41 row_ror:8 row_mask:0xf bank_mask:0xf
    v_add_f32_dpp v42, v42, v42 row_ror:8 row_mask:0xf bank_mask:0xf
    v_add_f32_dpp v43, v43, v43 row_ror:8 row_mask:0xf bank_mask:0xf
    v_add_f32_dpp v44, v44, v44 row_ror:8 row_mask:0xf bank_mask:0xf
    v_add_f32_dpp v45, v45, v45 row_ror:8 row_mask:0xf bank_mask:0xf
    v_add_f32_dpp v46, v46, v46 row_ror:8 row_mask:0xf bank_mask:0xf
    v_add_f32_dpp v47, v47, v47 row_ror:8 row_mask:0xf bank_mask:0xf
    v_add_f32_dpp v40, v40, v40 row_ror:4 row_mask:0xf bank_mask:0xf
    v_add_f32_dpp v41, v41, v41 row_ror:4 row_mask:0xf bank_mask:0xf
    v_add_f32_dpp v42, v42, v42 row_ror:4 row_mask:0xf bank_mask:0xf
    v_add_f32_dpp v43, v43, v43 row_ror:4 row_mask:0xf bank_mask:0xf
    v_add_f32_dpp v44, v44, v44 row_ror:4 row_mask:0xf bank_mask:0xf
    v_add_f32_dpp v45, v45, v45 row_ror:4 row_mask:0xf bank_mask:0xf
    v_add_f32_dpp v46, v46, v46 row_ror:4 row_mask:0xf bank_mask:0xf
    v_add_f32_dpp v47, v47, v47 row_ror:4 row_mask:0xf bank_mask:0xf
    v_add_f32_dpp v40, v40, v40 row_ror:2 row_mask:0xf bank_mask:0xf
    v_add_f32_dpp v41, v41, v41 row_ror:2 row_mask:0xf bank_mask:0xf
    v_add_f32_dpp v42, v42, v42 row_ror:2 row_mask:0xf bank_mask:0xf
    v_add_f32_dpp v43, v43, v43 row_ror:2 row_mask:0xf bank_mask:0xf
    v_add_f32_dpp v44, v44, v44 row_ror:2 row_mask:0xf bank_mask:0xf
    v_add_f32_dpp v45, v45, v45 row_ror:2 row_mask:0xf bank_mask:0xf
    v_add_f32_dpp v46, v46, v46 row_ror:2 row_mask:0xf bank_mask:0xf
    v_add_f32_dpp v47, v47, v47 row_ror:2 row_mask:0xf bank_mask:0xf
    v_add_f32_dpp v40, v40, v40 row_ror:1 row_mask:0xf bank_mask:0xf
    v_add_f32_dpp v41, v41, v41 row_ror:1 row_mask:0xf bank_mask:0xf
    v_add_f32_dpp v42, v42, v42 row_ror:1 row_mask:0xf bank_mask:0xf
    v_add_f32_dpp v43, v43, v43 row_ror:1 row_mask:0xf bank_mask:0xf
    v_add_f32_dpp v44, v44, v44 row_ror:1 row_mask:0xf bank_mask:0xf
    v_add_f32_dpp v45, v45, v45 row_ror:1 row_mask:0xf bank_mask:0xf
    v_add_f32_dpp v46, v46, v46 row_ror:1 row_mask:0xf bank_mask:0xf
    v_add_f32_dpp v47, v47, v47 row_ror:1 row_mask:0xf bank_mask:0xf
    v_mul_f32 v40, 0x3b2aaaab, v40
    v_mul_f32 v41, 0x3b2aaaab, v41
    v_mul_f32 v42, 0x3b2aaaab, v42
    v_mul_f32 v43, 0x3b2aaaab, v43
    v_mul_f32 v44, 0x3b2aaaab, v44
    v_mul_f32 v45, 0x3b2aaaab, v45
    v_mul_f32 v46, 0x3b2aaaab, v46
    v_mul_f32 v47, 0x3b2aaaab, v47
    v_fma_f32 v44, -v40, v40, v44
    v_fma_f32 v45, -v41, v41, v45
    v_fma_f32 v46, -v42, v42, v46
    v_fma_f32 v47, -v43, v43, v47
    v_max_f32 v44, 0, v44
    v_max_f32 v45, 0, v45
    v_max_f32 v46, 0, v46
    v_max_f32 v47, 0, v47
    v_add_f32 v44, 0x3727c5ac, v44
    v_add_f32 v45, 0x3727c5ac, v45
    v_add_f32 v46, 0x3727c5ac, v46
    v_add_f32 v47, 0x3727c5ac, v47
    v_rsq_f32 v44, v44
    v_rsq_f32 v45, v45
    v_rsq_f32 v46, v46
    v_rsq_f32 v47, v47
    v_mul_f32 v44, 0x3eefde6e, v44
    v_mul_f32 v45, 0x3eefde6e, v45
    v_mul_f32 v46, 0x3eefde6e, v46
    v_mul_f32 v47, 0x3eefde6e, v47
    v_mul_f32 v40, v40, v44
    v_mul_f32 v41, v41, v45
    v_mul_f32 v42, v42, v46
    v_mul_f32 v43, v43, v47
    v_pk_fma_f32 v[64:65], v[64:65], v[44:45], v[40:41] op_sel:[0,0,0] op_sel_hi:[1,0,0] neg_lo:[0,0,1] neg_hi:[0,0,1]
    v_pk_fma_f32 v[208:209], v[208:209], v[44:45], v[40:41] op_sel:[0,0,0] op_sel_hi:[1,0,0] neg_lo:[0,0,1] neg_hi:[0,0,1]
    v_pk_fma_f32 v[66:67], v[66:67], v[44:45], v[40:41] op_sel:[0,0,0] op_sel_hi:[1,0,0] neg_lo:[0,0,1] neg_hi:[0,0,1]
    v_pk_fma_f32 v[210:211], v[210:211], v[44:45], v[40:41] op_sel:[0,0,0] op_sel_hi:[1,0,0] neg_lo:[0,0,1] neg_hi:[0,0,1]
    v_cvt_pk_bf16_f32 v208, v64, v208
    v_cvt_pk_bf16_f32 v209, v65, v209
    v_cvt_pk_bf16_f32 v210, v66, v210
    v_cvt_pk_bf16_f32 v211, v67, v211
    ds_write_b128 v56, v[208:211] offset:0
    v_pk_fma_f32 v[68:69], v[68:69], v[44:45], v[40:41] op_sel:[0,1,1] op_sel_hi:[1,1,1] neg_lo:[0,0,1] neg_hi:[0,0,1]
    v_pk_fma_f32 v[212:213], v[212:213], v[44:45], v[40:41] op_sel:[0,1,1] op_sel_hi:[1,1,1] neg_lo:[0,0,1] neg_hi:[0,0,1]
    v_pk_fma_f32 v[70:71], v[70:71], v[44:45], v[40:41] op_sel:[0,1,1] op_sel_hi:[1,1,1] neg_lo:[0,0,1] neg_hi:[0,0,1]
    v_pk_fma_f32 v[214:215], v[214:215], v[44:45], v[40:41] op_sel:[0,1,1] op_sel_hi:[1,1,1] neg_lo:[0,0,1] neg_hi:[0,0,1]
    v_cvt_pk_bf16_f32 v212, v68, v212
    v_cvt_pk_bf16_f32 v213, v69, v213
    v_cvt_pk_bf16_f32 v214, v70, v214
    v_cvt_pk_bf16_f32 v215, v71, v215
    ds_write_b128 v57, v[212:215] offset:1024
    v_pk_fma_f32 v[72:73], v[72:73], v[46:47], v[42:43] op_sel:[0,0,0] op_sel_hi:[1,0,0] neg_lo:[0,0,1] neg_hi:[0,0,1]
    v_pk_fma_f32 v[216:217], v[216:217], v[46:47], v[42:43] op_sel:[0,0,0] op_sel_hi:[1,0,0] neg_lo:[0,0,1] neg_hi:[0,0,1]
    v_pk_fma_f32 v[74:75], v[74:75], v[46:47], v[42:43] op_sel:[0,0,0] op_sel_hi:[1,0,0] neg_lo:[0,0,1] neg_hi:[0,0,1]
    v_pk_fma_f32 v[218:219], v[218:219], v[46:47], v[42:43] op_sel:[0,0,0] op_sel_hi:[1,0,0] neg_lo:[0,0,1] neg_hi:[0,0,1]
    v_cvt_pk_bf16_f32 v216, v72, v216
    v_cvt_pk_bf16_f32 v217, v73, v217
    v_cvt_pk_bf16_f32 v218, v74, v218
    v_cvt_pk_bf16_f32 v219, v75, v219
    ds_write_b128 v58, v[216:219] offset:2048
    v_pk_fma_f32 v[76:77], v[76:77], v[46:47], v[42:43] op_sel:[0,1,1] op_sel_hi:[1,1,1] neg_lo:[0,0,1] neg_hi:[0,0,1]
    v_pk_fma_f32 v[220:221], v[220:221], v[46:47], v[42:43] op_sel:[0,1,1] op_sel_hi:[1,1,1] neg_lo:[0,0,1] neg_hi:[0,0,1]
    v_pk_fma_f32 v[78:79], v[78:79], v[46:47], v[42:43] op_sel:[0,1,1] op_sel_hi:[1,1,1] neg_lo:[0,0,1] neg_hi:[0,0,1]
    v_pk_fma_f32 v[222:223], v[222:223], v[46:47], v[42:43] op_sel:[0,1,1] op_sel_hi:[1,1,1] neg_lo:[0,0,1] neg_hi:[0,0,1]
    v_cvt_pk_bf16_f32 v220, v76, v220
    v_cvt_pk_bf16_f32 v221, v77, v221
    v_cvt_pk_bf16_f32 v222, v78, v222
    v_cvt_pk_bf16_f32 v223, v79, v223
    ds_write_b128 v59, v[220:223] offset:3072
    ds_read_b128 v[208:211], v60 offset:0
    ds_read_b128 v[212:215], v61 offset:0
    ds_read_b128 v[216:219], v62 offset:0
    ds_read_b128 v[220:223], v63 offset:0
    v_pk_fma_f32 v[80:81], v[80:81], v[44:45], v[40:41] op_sel:[0,0,0] op_sel_hi:[1,0,0] neg_lo:[0,0,1] neg_hi:[0,0,1]
    v_pk_fma_f32 v[224:225], v[224:225], v[44:45], v[40:41] op_sel:[0,0,0] op_sel_hi:[1,0,0] neg_lo:[0,0,1] neg_hi:[0,0,1]
    v_pk_fma_f32 v[82:83], v[82:83], v[44:45], v[40:41] op_sel:[0,0,0] op_sel_hi:[1,0,0] neg_lo:[0,0,1] neg_hi:[0,0,1]
    v_pk_fma_f32 v[226:227], v[226:227], v[44:45], v[40:41] op_sel:[0,0,0] op_sel_hi:[1,0,0] neg_lo:[0,0,1] neg_hi:[0,0,1]
    v_cvt_pk_bf16_f32 v224, v80, v224
    v_cvt_pk_bf16_f32 v225, v81, v225
    v_cvt_pk_bf16_f32 v226, v82, v226
    v_cvt_pk_bf16_f32 v227, v83, v227
    ds_write_b128 v56, v[224:227] offset:4096
    v_pk_fma_f32 v[84:85], v[84:85], v[44:45], v[40:41] op_sel:[0,1,1] op_sel_hi:[1,1,1] neg_lo:[0,0,1] neg_hi:[0,0,1]
    v_pk_fma_f32 v[228:229], v[228:229], v[44:45], v[40:41] op_sel:[0,1,1] op_sel_hi:[1,1,1] neg_lo:[0,0,1] neg_hi:[0,0,1]
    v_pk_fma_f32 v[86:87], v[86:87], v[44:45], v[40:41] op_sel:[0,1,1] op_sel_hi:[1,1,1] neg_lo:[0,0,1] neg_hi:[0,0,1]
    v_pk_fma_f32 v[230:231], v[230:231], v[44:45], v[40:41] op_sel:[0,1,1] op_sel_hi:[1,1,1] neg_lo:[0,0,1] neg_hi:[0,0,1]
    v_cvt_pk_bf16_f32 v228, v84, v228
    v_cvt_pk_bf16_f32 v229, v85, v229
    v_cvt_pk_bf16_f32 v230, v86, v230
    v_cvt_pk_bf16_f32 v231, v87, v231
    ds_write_b128 v57, v[228:231] offset:5120
    v_pk_fma_f32 v[88:89], v[88:89], v[46:47], v[42:43] op_sel:[0,0,0] op_sel_hi:[1,0,0] neg_lo:[0,0,1] neg_hi:[0,0,1]
    v_pk_fma_f32 v[232:233], v[232:233], v[46:47], v[42:43] op_sel:[0,0,0] op_sel_hi:[1,0,0] neg_lo:[0,0,1] neg_hi:[0,0,1]
    v_pk_fma_f32 v[90:91], v[90:91], v[46:47], v[42:43] op_sel:[0,0,0] op_sel_hi:[1,0,0] neg_lo:[0,0,1] neg_hi:[0,0,1]
    v_pk_fma_f32 v[234:235], v[234:235], v[46:47], v[42:43] op_sel:[0,0,0] op_sel_hi:[1,0,0] neg_lo:[0,0,1] neg_hi:[0,0,1]
    v_cvt_pk_bf16_f32 v232, v88, v232
    v_cvt_pk_bf16_f32 v233, v89, v233
    v_cvt_pk_bf16_f32 v234, v90, v234
    v_cvt_pk_bf16_f32 v235, v91, v235
    ds_write_b128 v58, v[232:235] offset:6144
    v_pk_fma_f32 v[92:93], v[92:93], v[46:47], v[42:43] op_sel:[0,1,1] op_sel_hi:[1,1,1] neg_lo:[0,0,1] neg_hi:[0,0,1]
    v_pk_fma_f32 v[236:237], v[236:237], v[46:47], v[42:43] op_sel:[0,1,1] op_sel_hi:[1,1,1] neg_lo:[0,0,1] neg_hi:[0,0,1]
    v_pk_fma_f32 v[94:95], v[94:95], v[46:47], v[42:43] op_sel:[0,1,1] op_sel_hi:[1,1,1] neg_lo:[0,0,1] neg_hi:[0,0,1]
    v_pk_fma_f32 v[238:239], v[238:239], v[46:47], v[42:43] op_sel:[0,1,1] op_sel_hi:[1,1,1] neg_lo:[0,0,1] neg_hi:[0,0,1]
    v_cvt_pk_bf16_f32 v236, v92, v236
    v_cvt_pk_bf16_f32 v237, v93, v237
    v_cvt_pk_bf16_f32 v238, v94, v238
    v_cvt_pk_bf16_f32 v239, v95, v239
    ds_write_b128 v59, v[236:239] offset:7168
    ds_read_b128 v[224:227], v60 offset:4096
    ds_read_b128 v[228:231], v61 offset:4096
    ds_read_b128 v[232:235], v62 offset:4096
    ds_read_b128 v[236:239], v63 offset:4096
    v_pk_fma_f32 v[96:97], v[96:97], v[44:45], v[40:41] op_sel:[0,0,0] op_sel_hi:[1,0,0] neg_lo:[0,0,1] neg_hi:[0,0,1]
    v_pk_fma_f32 v[240:241], v[240:241], v[44:45], v[40:41] op_sel:[0,0,0] op_sel_hi:[1,0,0] neg_lo:[0,0,1] neg_hi:[0,0,1]
    v_pk_fma_f32 v[98:99], v[98:99], v[44:45], v[40:41] op_sel:[0,0,0] op_sel_hi:[1,0,0] neg_lo:[0,0,1] neg_hi:[0,0,1]
    v_pk_fma_f32 v[242:243], v[242:243], v[44:45], v[40:41] op_sel:[0,0,0] op_sel_hi:[1,0,0] neg_lo:[0,0,1] neg_hi:[0,0,1]
    v_cvt_pk_bf16_f32 v240, v96, v240
    v_cvt_pk_bf16_f32 v241, v97, v241
    v_cvt_pk_bf16_f32 v242, v98, v242
    v_cvt_pk_bf16_f32 v243, v99, v243
    ds_write_b128 v56, v[240:243] offset:8192
    v_pk_fma_f32 v[100:101], v[100:101], v[44:45], v[40:41] op_sel:[0,1,1] op_sel_hi:[1,1,1] neg_lo:[0,0,1] neg_hi:[0,0,1]
    v_pk_fma_f32 v[244:245], v[244:245], v[44:45], v[40:41] op_sel:[0,1,1] op_sel_hi:[1,1,1] neg_lo:[0,0,1] neg_hi:[0,0,1]
    v_pk_fma_f32 v[102:103], v[102:103], v[44:45], v[40:41] op_sel:[0,1,1] op_sel_hi:[1,1,1] neg_lo:[0,0,1] neg_hi:[0,0,1]
    v_pk_fma_f32 v[246:247], v[246:247], v[44:45], v[40:41] op_sel:[0,1,1] op_sel_hi:[1,1,1] neg_lo:[0,0,1] neg_hi:[0,0,1]
    v_cvt_pk_bf16_f32 v244, v100, v244
    v_cvt_pk_bf16_f32 v245, v101, v245
    v_cvt_pk_bf16_f32 v246, v102, v246
    v_cvt_pk_bf16_f32 v247, v103, v247
    ds_write_b128 v57, v[244:247] offset:9216
    v_pk_fma_f32 v[104:105], v[104:105], v[46:47], v[42:43] op_sel:[0,0,0] op_sel_hi:[1,0,0] neg_lo:[0,0,1] neg_hi:[0,0,1]
    v_pk_fma_f32 v[248:249], v[248:249], v[46:47], v[42:43] op_sel:[0,0,0] op_sel_hi:[1,0,0] neg_lo:[0,0,1] neg_hi:[0,0,1]
    v_pk_fma_f32 v[106:107], v[106:107], v[46:47], v[42:43] op_sel:[0,0,0] op_sel_hi:[1,0,0] neg_lo:[0,0,1] neg_hi:[0,0,1]
    v_pk_fma_f32 v[250:251], v[250:251], v[46:47], v[42:43] op_sel:[0,0,0] op_sel_hi:[1,0,0] neg_lo:[0,0,1] neg_hi:[0,0,1]
    v_cvt_pk_bf16_f32 v248, v104, v248
    v_cvt_pk_bf16_f32 v249, v105, v249
    v_cvt_pk_bf16_f32 v250, v106, v250
    v_cvt_pk_bf16_f32 v251, v107, v251
    ds_write_b128 v58, v[248:251] offset:10240
    v_pk_fma_f32 v[108:109], v[108:109], v[46:47], v[42:43] op_sel:[0,1,1] op_sel_hi:[1,1,1] neg_lo:[0,0,1] neg_hi:[0,0,1]
    v_pk_fma_f32 v[252:253], v[252:253], v[46:47], v[42:43] op_sel:[0,1,1] op_sel_hi:[1,1,1] neg_lo:[0,0,1] neg_hi:[0,0,1]
    v_pk_fma_f32 v[110:111], v[110:111], v[46:47], v[42:43] op_sel:[0,1,1] op_sel_hi:[1,1,1] neg_lo:[0,0,1] neg_hi:[0,0,1]
    v_pk_fma_f32 v[254:255], v[254:255], v[46:47], v[42:43] op_sel:[0,1,1] op_sel_hi:[1,1,1] neg_lo:[0,0,1] neg_hi:[0,0,1]
    v_cvt_pk_bf16_f32 v252, v108, v252
    v_cvt_pk_bf16_f32 v253, v109, v253
    v_cvt_pk_bf16_f32 v254, v110, v254
    v_cvt_pk_bf16_f32 v255, v111, v255
    ds_write_b128 v59, v[252:255] offset:11264
    ds_read_b128 v[240:243], v60 offset:8192
    ds_read_b128 v[244:247], v61 offset:8192
    ds_read_b128 v[248:251], v62 offset:8192
    ds_read_b128 v[252:255], v63 offset:8192
    s_waitcnt lgkmcnt(0)
    s_waitcnt vmcnt(0)
    s_cmp_eq_u32 s42, 1
    s_cbranch_scc1 L_k1_dstart
    s_barrier
    s_add_u32 m0, s47, 73728
    s_nop 0
    buffer_load_dwordx4 v1, s[12:15], s6 offen offset:0 lds
    s_mov_b32 s42, 0
    ds_read_b128 v[56:59], v1 offset:0
    ds_read_b128 v[60:63], v1 offset:1024
    ds_read_b128 v[64:67], v1 offset:2048
    ds_read_b128 v[68:71], v1 offset:3072
    s_waitcnt lgkmcnt(0)
    v_mfma_f32_16x16x32_bf16 v[88:91], v[112:115], v[56:59], 0
    ds_read_b128 v[72:75], v1 offset:4096
    v_mfma_f32_16x16x32_bf16 v[88:91], v[116:119], v[60:63], v[88:91]
    ds_read_b128 v[76:79], v1 offset:5120
    v_mfma_f32_16x16x32_bf16 v[92:95], v[164:167], v[60:63], 0
    ds_read_b128 v[80:83], v1 offset:6144
    v_mfma_f32_16x16x32_bf16 v[92:95], v[160:163], v[56:59], v[92:95]
    ds_read_b128 v[84:87], v1 offset:7168
    v_mfma_f32_16x16x32_bf16 v[96:99], v[208:211], v[56:59], 0
    v_mfma_f32_16x16x32_bf16 v[96:99], v[212:215], v[60:63], v[96:99]
    v_mfma_f32_16x16x32_bf16 v[96:99], v[216:219], v[64:67], v[96:99]
    v_mfma_f32_16x16x32_bf16 v[96:99], v[220:223], v[68:71], v[96:99]
    v_mfma_f32_16x16x32_bf16 v[92:95], v[172:175], v[68:71], v[92:95]
    v_mfma_f32_16x16x32_bf16 v[92:95], v[168:171], v[64:67], v[92:95]
    v_mfma_f32_16x16x32_bf16 v[88:91], v[120:123], v[64:67], v[88:91]
    v_mfma_f32_16x16x32_bf16 v[88:91], v[124:127], v[68:71], v[88:91]
    s_waitcnt lgkmcnt(0)
    v_mfma_f32_16x16x32_bf16 v[88:91], v[128:131], v[72:75], v[88:91]
    ds_read_b128 v[56:59], v1 offset:8192
    v_mfma_f32_16x16x32_bf16 v[88:91], v[132:135], v[76:79], v[88:91]
    ds_read_b128 v[60:63], v1 offset:9216
    v_mfma_f32_16x16x32_bf16 v[92:95], v[180:183], v[76:79], v[92:95]
    ds_read_b128 v[64:67], v1 offset:10240
    v_mfma_f32_16x16x32_bf16 v[92:95], v[176:179], v[72:75], v[92:95]
    ds_read_b128 v[68:71], v1 offset:11264
    v_mfma_f32_16x16x32_bf16 v[96:99], v[224:227], v[72:75], v[96:99]
    v_mfma_f32_16x16x32_bf16 v[96:99], v[228:231], v[76:79], v[96:99]
    buffer_load_dwordx4 v1, s[12:15], s6 offen offset:1024 lds
    v_mfma_f32_16x16x32_bf16 v[96:99], v[232:235], v[80:83], v[96:99]
    v_mfma_f32_16x16x32_bf16 v[96:99], v[236:239], v[84:87], v[96:99]
    v_mfma_f32_16x16x32_bf16 v[92:95], v[188:191], v[84:87], v[92:95]
    v_mfma_f32_16x16x32_bf16 v[92:95], v[184:187], v[80:83], v[92:95]
    v_mfma_f32_16x16x32_bf16 v[88:91], v[136:139], v[80:83], v[88:91]
    v_mfma_f32_16x16x32_bf16 v[88:91], v[140:143], v[84:87], v[88:91]
    s_waitcnt lgkmcnt(0)
    v_mfma_f32_16x16x32_bf16 v[96:99], v[240:243], v[56:59], v[96:99]
    ds_read_b128 v[72:75], v1 offset:12288
    v_mfma_f32_16x16x32_bf16 v[96:99], v[244:247], v[60:63], v[96:99]
    ds_read_b128 v[76:79], v1 offset:13312
    v_mfma_f32_16x16x32_bf16 v[92:95], v[196:199], v[60:63], v[92:95]
    ds_read_b128 v[80:83], v1 offset:14336
    v_mfma_f32_16x16x32_bf16 v[92:95], v[192:195], v[56:59], v[92:95]
    ds_read_b128 v[84:87], v1 offset:15360
    v_mfma_f32_16x16x32_bf16 v[88:91], v[144:147], v[56:59], v[88:91]
    v_mfma_f32_16x16x32_bf16 v[88:91], v[148:151], v[60:63], v[88:91]
    v_mfma_f32_16x16x32_bf16 v[88:91], v[152:155], v[64:67], v[88:91]
    v_mfma_f32_16x16x32_bf16 v[88:91], v[156:159], v[68:71], v[88:91]
    v_mfma_f32_16x16x32_bf16 v[92:95], v[204:207], v[68:71], v[92:95]
    v_mfma_f32_16x16x32_bf16 v[92:95], v[200:203], v[64:67], v[92:95]
    v_mfma_f32_16x16x32_bf16 v[96:99], v[248:251], v[64:67], v[96:99]
    v_mfma_f32_16x16x32_bf16 v[96:99], v[252:255], v[68:71], v[96:99]
    s_nop 3
    s_branch L_k1_mid
L_k1_evt:
    s_cmp_ge_u32 s24, 48
    s_cselect_b32 s27, 48, 0
    s_sub_u32 s24, s24, s27
    s_mul_i32 s27, s34, 12
    s_lshr_b32 s43, s24, 2
    s_add_u32 s27, s27, s43
    s_mul_i32 s7, s27, 36864
    s_add_u32 s7, s7, s39
    s_mul_i32 s32, s27, 12288
    s_add_u32 s32, s32, s39
    s_branch L_k1_mid
L_k1_dstart:
    s_barrier
L_k1_dstart2:
    s_mov_b32 s42, 0
    s_mul_i32 s27, s48, 24576
    v_add_u32 v22, s27, v1
    v_add_u32 v23, s27, v2
    s_cmp_ge_u32 s24, 48
    s_cselect_b32 s27, 48, 0
    s_sub_u32 s24, s24, s27
    s_mul_i32 s27, s34, 12
    s_lshr_b32 s43, s24, 2
    s_add_u32 s27, s27, s43
    s_mul_i32 s7, s27, 36864
    s_add_u32 s7, s7, s39
    s_mul_i32 s32, s27, 12288
    s_add_u32 s32, s32, s39
    s_add_u32 s27, s7, 24576
    s_cmp_eq_u32 s48, 0
    s_cselect_b32 s32, s27, s32
    s_cselect_b32 s27, 0, 12288
    s_add_u32 s7, s7, s27
    s_cmp_eq_u32 s48, 0
    s_movk_i32 s56, 12288
    s_cselect_b32 s56, 36864, s56
    s_cselect_b32 s52, s16, s52
    s_cselect_b32 s53, s17, s53
    s_cselect_b32 s54, s18, s54
    s_cselect_b32 s5, 1, 0
    s_add_u32 s57, s46, s48
    s_lshl_b32 s57, s57, 7
    s_add_u32 s50, s50, s57
    ds_read_b128 v[56:59], v22 offset:0
    ds_read_b128 v[60:63], v22 offset:1024
    ds_read_b128 v[64:67], v22 offset:2048
    ds_read_b128 v[68:71], v22 offset:3072
    s_waitcnt lgkmcnt(0)
    v_mfma_f32_16x16x32_bf16 v[88:91], v[112:115], v[56:59], 0
    ds_read_b128 v[72:75], v22 offset:4096
    v_mfma_f32_16x16x32_bf16 v[88:91], v[116:119], v[60:63], v[88:91]
    ds_read_b128 v[76:79], v22 offset:5120
    v_mfma_f32_16x16x32_bf16 v[92:95], v[164:167], v[60:63], 0
    ds_read_b128 v[80:83], v22 offset:6144
    v_mfma_f32_16x16x32_bf16 v[92:95], v[160:163], v[56:59], v[92:95]
    ds_read_b128 v[84:87], v22 offset:7168
    v_mfma_f32_16x16x32_bf16 v[96:99], v[208:211], v[56:59], 0
    v_mfma_f32_16x16x32_bf16 v[96:99], v[212:215], v[60:63], v[96:99]
    v_mfma_f32_16x16x32_bf16 v[96:99], v[216:219], v[64:67], v[96:99]
    v_mfma_f32_16x16x32_bf16 v[96:99], v[220:223], v[68:71], v[96:99]
    v_mfma_f32_16x16x32_bf16 v[92:95], v[172:175], v[68:71], v[92:95]
    v_mfma_f32_16x16x32_bf16 v[92:95], v[168:171], v[64:67], v[92:95]
    v_mfma_f32_16x16x32_bf16 v[88:91], v[120:123], v[64:67], v[88:91]
    v_mfma_f32_16x16x32_bf16 v[88:91], v[124:127], v[68:71], v[88:91]
    s_waitcnt lgkmcnt(0)
    v_mfma_f32_16x16x32_bf16 v[88:91], v[128:131], v[72:75], v[88:91]
    ds_read_b128 v[56:59], v22 offset:8192
    v_mfma_f32_16x16x32_bf16 v[88:91], v[132:135], v[76:79], v[88:91]
    ds_read_b128 v[60:63], v22 offset:9216
    v_mfma_f32_16x16x32_bf16 v[92:95], v[180:183], v[76:79], v[92:95]
    ds_read_b128 v[64:67], v22 offset:10240
    v_mfma_f32_16x16x32_bf16 v[92:95], v[176:179], v[72:75], v[92:95]
    ds_read_b128 v[68:71], v22 offset:11264
    v_mfma_f32_16x16x32_bf16 v[96:99], v[224:227], v[72:75], v[96:99]
    v_mfma_f32_16x16x32_bf16 v[96:99], v[228:231], v[76:79], v[96:99]
    v_mfma_f32_16x16x32_bf16 v[96:99], v[232:235], v[80:83], v[96:99]
    v_mfma_f32_16x16x32_bf16 v[96:99], v[236:239], v[84:87], v[96:99]
    v_mfma_f32_16x16x32_bf16 v[92:95], v[188:191], v[84:87], v[92:95]
    v_mfma_f32_16x16x32_bf16 v[92:95], v[184:187], v[80:83], v[92:95]
    v_mfma_f32_16x16x32_bf16 v[88:91], v[136:139], v[80:83], v[88:91]
    v_mfma_f32_16x16x32_bf16 v[88:91], v[140:143], v[84:87], v[88:91]
    s_waitcnt lgkmcnt(0)
    v_mfma_f32_16x16x32_bf16 v[96:99], v[240:243], v[56:59], v[96:99]
    ds_read_b128 v[72:75], v22 offset:12288
    v_mfma_f32_16x16x32_bf16 v[96:99], v[244:247], v[60:63], v[96:99]
    ds_read_b128 v[76:79], v22 offset:13312
    v_mfma_f32_16x16x32_bf16 v[92:95], v[196:199], v[60:63], v[92:95]
    ds_read_b128 v[80:83], v22 offset:14336
    v_mfma_f32_16x16x32_bf16 v[92:95], v[192:195], v[56:59], v[92:95]
    ds_read_b128 v[84:87], v22 offset:15360
    v_mfma_f32_16x16x32_bf16 v[88:91], v[144:147], v[56:59], v[88:91]
    v_mfma_f32_16x16x32_bf16 v[88:91], v[148:151], v[60:63], v[88:91]
    v_mfma_f32_16x16x32_bf16 v[88:91], v[152:155], v[64:67], v[88:91]
    v_mfma_f32_16x16x32_bf16 v[88:91], v[156:159], v[68:71], v[88:91]
    v_mfma_f32_16x16x32_bf16 v[92:95], v[204:207], v[68:71], v[92:95]
    v_mfma_f32_16x16x32_bf16 v[92:95], v[200:203], v[64:67], v[92:95]
    v_mfma_f32_16x16x32_bf16 v[96:99], v[248:251], v[64:67], v[96:99]
    v_mfma_f32_16x16x32_bf16 v[96:99], v[252:255], v[68:71], v[96:99]
    s_nop 3
    s_branch L_k1_dmid
L_k1_devt:
    s_cmp_ge_u32 s24, 48
    s_cselect_b32 s27, 48, 0
    s_sub_u32 s24, s24, s27
    s_mul_i32 s27, s34, 12
    s_lshr_b32 s43, s24, 2
    s_add_u32 s27, s27, s43
    s_mul_i32 s7, s27, 36864
    s_add_u32 s7, s7, s39
    s_mul_i32 s32, s27, 12288
    s_add_u32 s32, s32, s39
    s_add_u32 s27, s7, 24576
    s_cmp_eq_u32 s48, 0
    s_cselect_b32 s32, s27, s32
    s_cselect_b32 s27, 0, 12288
    s_add_u32 s7, s7, s27
    s_branch L_k1_dmid
.p2align 6
L_k1_dloop:
    s_waitcnt lgkmcnt(0)
    v_mfma_f32_16x16x32_bf16 v[88:91], v[112:115], v[56:59], 0
    ds_read_b128 v[72:75], v22 offset:4096
    v_cvt_pk_f16_f32 v16, v100, v101
    v_cvt_pk_f16_f32 v17, v102, v103
    v_pk_fma_f16 v32, v16, v16, s25 neg_lo:[1,0,0] neg_hi:[1,0,0]
    v_mfma_f32_16x16x32_bf16 v[88:91], v[116:119], v[60:63], v[88:91]
    ds_read_b128 v[76:79], v22 offset:5120
    v_pk_fma_f16 v34, v17, v17, s25 neg_lo:[1,0,0] neg_hi:[1,0,0]
    v_pk_mul_f16 v32, v16, v32
    v_mfma_f32_16x16x32_bf16 v[92:95], v[164:167], v[60:63], 0
    ds_read_b128 v[80:83], v22 offset:6144
    v_pk_mul_f16 v34, v17, v34
    v_exp_f16 v16, v32
    v_mfma_f32_16x16x32_bf16 v[92:95], v[160:163], v[56:59], v[92:95]
    ds_read_b128 v[84:87], v22 offset:7168
    v_exp_f16 v17, v34
    v_exp_f16_sdwa v16, v32 dst_sel:WORD_1 dst_unused:UNUSED_PRESERVE src0_sel:WORD_1
    v_exp_f16_sdwa v17, v34 dst_sel:WORD_1 dst_unused:UNUSED_PRESERVE src0_sel:WORD_1
    v_mfma_f32_16x16x32_bf16 v[96:99], v[208:211], v[56:59], 0
    s_add_u32 m0, s47, 73728
    v_pk_add_f16 v16, v16, 1.0 op_sel_hi:[1,0]
    v_pk_add_f16 v17, v17, 1.0 op_sel_hi:[1,0]
    v_mfma_f32_16x16x32_bf16 v[96:99], v[212:215], v[60:63], v[96:99]
    buffer_load_dwordx4 v1, s[12:15], s6 offen offset:0 lds
    v_rcp_f16 v32, v16
    v_rcp_f16 v34, v17
    v_mfma_f32_16x16x32_bf16 v[96:99], v[216:219], v[64:67], v[96:99]
    v_rcp_f16_sdwa v33, v16 dst_sel:DWORD dst_unused:UNUSED_PAD src0_sel:WORD_1
    v_rcp_f16_sdwa v35, v17 dst_sel:DWORD dst_unused:UNUSED_PAD src0_sel:WORD_1
    v_fma_mix_f32 v32, v100, v32, 0 op_sel_hi:[0,1,0]
    v_mfma_f32_16x16x32_bf16 v[96:99], v[220:223], v[68:71], v[96:99]
    buffer_load_dwordx4 v1, s[12:15], s6 offen offset:1024 lds
    v_fma_mix_f32 v34, v102, v34, 0 op_sel_hi:[0,1,0]
    v_fma_mix_f32 v33, v101, v33, 0 op_sel_hi:[0,1,0]
    v_mfma_f32_16x16x32_bf16 v[92:95], v[172:175], v[68:71], v[92:95]
    v_fma_mix_f32 v35, v103, v35, 0 op_sel_hi:[0,1,0]
    v_mul_f32 v9, v32, v32
    v_mfma_f32_16x16x32_bf16 v[92:95], v[168:171], v[64:67], v[92:95]
    buffer_load_dwordx4 v1, s[12:15], s6 offen offset:2048 lds
    v_fmac_f32 v9, v33, v33
    v_fmac_f32 v9, v34, v34
    v_fmac_f32 v9, v35, v35
    v_mfma_f32_16x16x32_bf16 v[88:91], v[120:123], v[64:67], v[88:91]
    s_add_u32 s6, s6, 24576
    s_cmp_ge_u32 s6, s38
    s_cselect_b32 s6, s47, s6
    v_cvt_pk_bf16_f32 v46, v32, v33
    v_cvt_pk_bf16_f32 v47, v34, v35
    v_mfma_f32_16x16x32_bf16 v[88:91], v[124:127], v[68:71], v[88:91]
    buffer_store_dwordx4 v[44:47], v4, s[52:55], s32 offen offset:0
    v_cvt_pk_f16_f32 v18, v104, v105
    s_waitcnt lgkmcnt(0)
    v_mfma_f32_16x16x32_bf16 v[88:91], v[128:131], v[72:75], v[88:91]
    ds_read_b128 v[56:59], v22 offset:8192
    v_cvt_pk_f16_f32 v19, v106, v107
    v_pk_fma_f16 v36, v18, v18, s25 neg_lo:[1,0,0] neg_hi:[1,0,0]
    v_mfma_f32_16x16x32_bf16 v[88:91], v[132:135], v[76:79], v[88:91]
    ds_read_b128 v[60:63], v22 offset:9216
    v_pk_fma_f16 v38, v19, v19, s25 neg_lo:[1,0,0] neg_hi:[1,0,0]
    v_pk_mul_f16 v36, v18, v36
    v_pk_mul_f16 v38, v19, v38
    v_mfma_f32_16x16x32_bf16 v[92:95], v[180:183], v[76:79], v[92:95]
    ds_read_b128 v[64:67], v22 offset:10240
    v_exp_f16 v18, v36
    v_exp_f16 v19, v38
    v_mfma_f32_16x16x32_bf16 v[92:95], v[176:179], v[72:75], v[92:95]
    ds_read_b128 v[68:71], v22 offset:11264
    v_exp_f16_sdwa v18, v36 dst_sel:WORD_1 dst_unused:UNUSED_PRESERVE src0_sel:WORD_1
    v_exp_f16_sdwa v19, v38 dst_sel:WORD_1 dst_unused:UNUSED_PRESERVE src0_sel:WORD_1
    v_mfma_f32_16x16x32_bf16 v[96:99], v[224:227], v[72:75], v[96:99]
    v_pk_add_f16 v18, v18, 1.0 op_sel_hi:[1,0]
    v_pk_add_f16 v19, v19, 1.0 op_sel_hi:[1,0]
    v_rcp_f16 v36, v18
    v_mfma_f32_16x16x32_bf16 v[96:99], v[228:231], v[76:79], v[96:99]
    v_rcp_f16 v38, v19
    v_rcp_f16_sdwa v37, v18 dst_sel:DWORD dst_unused:UNUSED_PAD src0_sel:WORD_1
    v_mfma_f32_16x16x32_bf16 v[96:99], v[232:235], v[80:83], v[96:99]
    v_rcp_f16_sdwa v39, v19 dst_sel:DWORD dst_unused:UNUSED_PAD src0_sel:WORD_1
    v_fma_mix_f32 v36, v104, v36, 0 op_sel_hi:[0,1,0]
    v_mfma_f32_16x16x32_bf16 v[96:99], v[236:239], v[84:87], v[96:99]
    v_fma_mix_f32 v38, v106, v38, 0 op_sel_hi:[0,1,0]
    v_fma_mix_f32 v37, v105, v37, 0 op_sel_hi:[0,1,0]
    v_fma_mix_f32 v39, v107, v39, 0 op_sel_hi:[0,1,0]
    v_mfma_f32_16x16x32_bf16 v[92:95], v[188:191], v[84:87], v[92:95]
    v_fmac_f32 v9, v36, v36
    v_fmac_f32 v9, v37, v37
    v_mfma_f32_16x16x32_bf16 v[92:95], v[184:187], v[80:83], v[92:95]
    v_fmac_f32 v9, v38, v38
    v_fmac_f32 v9, v39, v39
    v_mfma_f32_16x16x32_bf16 v[88:91], v[136:139], v[80:83], v[88:91]
    v_cvt_pk_bf16_f32 v50, v36, v37
    v_cvt_pk_bf16_f32 v51, v38, v39
    buffer_store_dwordx4 v[48:51], v4, s[52:55], s32 offen offset:1024
    v_mfma_f32_16x16x32_bf16 v[88:91], v[140:143], v[84:87], v[88:91]
    v_cvt_pk_f16_f32 v20, v108, v109
    v_cvt_pk_f16_f32 v21, v110, v111
    s_waitcnt lgkmcnt(0)
    v_mfma_f32_16x16x32_bf16 v[96:99], v[240:243], v[56:59], v[96:99]
    ds_read_b128 v[72:75], v22 offset:12288
    v_pk_fma_f16 v40, v20, v20, s25 neg_lo:[1,0,0] neg_hi:[1,0,0]
    v_pk_fma_f16 v42, v21, v21, s25 neg_lo:[1,0,0] neg_hi:[1,0,0]
    v_mfma_f32_16x16x32_bf16 v[96:99], v[244:247], v[60:63], v[96:99]
    ds_read_b128 v[76:79], v22 offset:13312
    v_pk_mul_f16 v40, v20, v40
    v_pk_mul_f16 v42, v21, v42
    v_mfma_f32_16x16x32_bf16 v[92:95], v[196:199], v[60:63], v[92:95]
    ds_read_b128 v[80:83], v22 offset:14336
    v_exp_f16 v20, v40
    v_exp_f16 v21, v42
    v_exp_f16_sdwa v20, v40 dst_sel:WORD_1 dst_unused:UNUSED_PRESERVE src0_sel:WORD_1
    v_mfma_f32_16x16x32_bf16 v[92:95], v[192:195], v[56:59], v[92:95]
    ds_read_b128 v[84:87], v22 offset:15360
    v_exp_f16_sdwa v21, v42 dst_sel:WORD_1 dst_unused:UNUSED_PRESERVE src0_sel:WORD_1
    v_pk_add_f16 v20, v20, 1.0 op_sel_hi:[1,0]
    v_mfma_f32_16x16x32_bf16 v[88:91], v[144:147], v[56:59], v[88:91]
    v_pk_add_f16 v21, v21, 1.0 op_sel_hi:[1,0]
    v_rcp_f16 v40, v20
    v_mfma_f32_16x16x32_bf16 v[88:91], v[148:151], v[60:63], v[88:91]
    v_rcp_f16 v42, v21
    v_rcp_f16_sdwa v41, v20 dst_sel:DWORD dst_unused:UNUSED_PAD src0_sel:WORD_1
    v_rcp_f16_sdwa v43, v21 dst_sel:DWORD dst_unused:UNUSED_PAD src0_sel:WORD_1
    v_mfma_f32_16x16x32_bf16 v[88:91], v[152:155], v[64:67], v[88:91]
    v_fma_mix_f32 v40, v108, v40, 0 op_sel_hi:[0,1,0]
    v_fma_mix_f32 v42, v110, v42, 0 op_sel_hi:[0,1,0]
    v_mfma_f32_16x16x32_bf16 v[88:91], v[156:159], v[68:71], v[88:91]
    v_fma_mix_f32 v41, v109, v41, 0 op_sel_hi:[0,1,0]
    v_fma_mix_f32 v43, v111, v43, 0 op_sel_hi:[0,1,0]
    v_mfma_f32_16x16x32_bf16 v[92:95], v[204:207], v[68:71], v[92:95]
    v_fmac_f32 v9, v40, v40
    v_fmac_f32 v9, v41, v41
    v_fmac_f32 v9, v42, v42
    v_mfma_f32_16x16x32_bf16 v[92:95], v[200:203], v[64:67], v[92:95]
    v_fmac_f32 v9, v43, v43
    v_cvt_pk_bf16_f32 v54, v40, v41
    v_mfma_f32_16x16x32_bf16 v[96:99], v[248:251], v[64:67], v[96:99]
    v_cvt_pk_bf16_f32 v55, v42, v43
    v_permlane16_swap_b32 v8, v9
    v_mfma_f32_16x16x32_bf16 v[96:99], v[252:255], v[68:71], v[96:99]
    buffer_store_dwordx4 v[52:55], v4, s[52:55], s32 offen offset:2048
    v_add_f32 v9, v8, v9
    ds_write_b32 v3, v9 offset:3072
    s_add_u32 s7, s7, 36864
    s_add_u32 s32, s32, s56
    s_add_u32 s24, s24, 8
    s_cmp_eq_u32 s24, 48
    s_cbranch_scc1 L_k1_devt
L_k1_dmid:
L_k1_dmid2:
    s_waitcnt lgkmcnt(0)
    v_mfma_f32_16x16x32_bf16 v[100:103], v[112:115], v[72:75], 0
    ds_read_b128 v[56:59], v22 offset:16384
    v_cvt_pk_f16_f32 v16, v88, v89
    v_cvt_pk_f16_f32 v17, v90, v91
    v_pk_fma_f16 v32, v16, v16, s25 neg_lo:[1,0,0] neg_hi:[1,0,0]
    v_mfma_f32_16x16x32_bf16 v[100:103], v[116:119], v[76:79], v[100:103]
    ds_read_b128 v[60:63], v22 offset:17408
    v_pk_fma_f16 v34, v17, v17, s25 neg_lo:[1,0,0] neg_hi:[1,0,0]
    v_pk_mul_f16 v32, v16, v32
    v_mfma_f32_16x16x32_bf16 v[104:107], v[164:167], v[76:79], 0
    ds_read_b128 v[64:67], v22 offset:18432
    v_pk_mul_f16 v34, v17, v34
    v_exp_f16 v16, v32
    v_mfma_f32_16x16x32_bf16 v[104:107], v[160:163], v[72:75], v[104:107]
    ds_read_b128 v[68:71], v22 offset:19456
    v_exp_f16 v17, v34
    v_exp_f16_sdwa v16, v32 dst_sel:WORD_1 dst_unused:UNUSED_PRESERVE src0_sel:WORD_1
    v_mfma_f32_16x16x32_bf16 v[108:111], v[208:211], v[72:75], 0
    v_exp_f16_sdwa v17, v34 dst_sel:WORD_1 dst_unused:UNUSED_PRESERVE src0_sel:WORD_1
    v_pk_add_f16 v16, v16, 1.0 op_sel_hi:[1,0]
    v_mfma_f32_16x16x32_bf16 v[108:111], v[212:215], v[76:79], v[108:111]
    v_pk_add_f16 v17, v17, 1.0 op_sel_hi:[1,0]
    v_rcp_f16 v32, v16
    v_mfma_f32_16x16x32_bf16 v[108:111], v[216:219], v[80:83], v[108:111]
    v_rcp_f16 v34, v17
    v_rcp_f16_sdwa v33, v16 dst_sel:DWORD dst_unused:UNUSED_PAD src0_sel:WORD_1
    v_rcp_f16_sdwa v35, v17 dst_sel:DWORD dst_unused:UNUSED_PAD src0_sel:WORD_1
    v_mfma_f32_16x16x32_bf16 v[108:111], v[220:223], v[84:87], v[108:111]
    v_fma_mix_f32 v32, v88, v32, 0 op_sel_hi:[0,1,0]
    v_fma_mix_f32 v34, v90, v34, 0 op_sel_hi:[0,1,0]
    v_mfma_f32_16x16x32_bf16 v[104:107], v[172:175], v[84:87], v[104:107]
    v_fma_mix_f32 v33, v89, v33, 0 op_sel_hi:[0,1,0]
    v_fma_mix_f32 v35, v91, v35, 0 op_sel_hi:[0,1,0]
    v_mfma_f32_16x16x32_bf16 v[104:107], v[168:171], v[80:83], v[104:107]
    v_mul_f32 v8, v32, v32
    v_fmac_f32 v8, v33, v33
    v_mfma_f32_16x16x32_bf16 v[100:103], v[120:123], v[80:83], v[100:103]
    v_fmac_f32 v8, v34, v34
    v_fmac_f32 v8, v35, v35
    v_mfma_f32_16x16x32_bf16 v[100:103], v[124:127], v[84:87], v[100:103]
    v_cvt_pk_bf16_f32 v44, v32, v33
    v_cvt_pk_bf16_f32 v45, v34, v35
    s_waitcnt lgkmcnt(0)
    v_mfma_f32_16x16x32_bf16 v[100:103], v[128:131], v[56:59], v[100:103]
    ds_read_b128 v[72:75], v22 offset:20480
    v_cvt_pk_f16_f32 v18, v92, v93
    v_cvt_pk_f16_f32 v19, v94, v95
    v_pk_fma_f16 v36, v18, v18, s25 neg_lo:[1,0,0] neg_hi:[1,0,0]
    v_mfma_f32_16x16x32_bf16 v[100:103], v[132:135], v[60:63], v[100:103]
    ds_read_b128 v[76:79], v22 offset:21504
    v_pk_fma_f16 v38, v19, v19, s25 neg_lo:[1,0,0] neg_hi:[1,0,0]
    v_pk_mul_f16 v36, v18, v36
    v_mfma_f32_16x16x32_bf16 v[104:107], v[180:183], v[60:63], v[104:107]
    ds_read_b128 v[80:83], v22 offset:22528
    v_pk_mul_f16 v38, v19, v38
    v_exp_f16 v18, v36
    v_mfma_f32_16x16x32_bf16 v[104:107], v[176:179], v[56:59], v[104:107]
    ds_read_b128 v[84:87], v22 offset:23552
    v_exp_f16 v19, v38
    v_exp_f16_sdwa v18, v36 dst_sel:WORD_1 dst_unused:UNUSED_PRESERVE src0_sel:WORD_1
    v_mfma_f32_16x16x32_bf16 v[108:111], v[224:227], v[56:59], v[108:111]
    v_exp_f16_sdwa v19, v38 dst_sel:WORD_1 dst_unused:UNUSED_PRESERVE src0_sel:WORD_1
    v_pk_add_f16 v18, v18, 1.0 op_sel_hi:[1,0]
    v_mfma_f32_16x16x32_bf16 v[108:111], v[228:231], v[60:63], v[108:111]
    v_xor_b32 v3, 0x1000, v3
    v_pk_add_f16 v19, v19, 1.0 op_sel_hi:[1,0]
    v_rcp_f16 v36, v18
    v_mfma_f32_16x16x32_bf16 v[108:111], v[232:235], v[64:67], v[108:111]
    v_xor_b32 v6, 0x1000, v6
    v_rcp_f16 v38, v19
    v_rcp_f16_sdwa v37, v18 dst_sel:DWORD dst_unused:UNUSED_PAD src0_sel:WORD_1
    v_rcp_f16_sdwa v39, v19 dst_sel:DWORD dst_unused:UNUSED_PAD src0_sel:WORD_1
    v_mfma_f32_16x16x32_bf16 v[108:111], v[236:239], v[68:71], v[108:111]
    v_fma_mix_f32 v36, v92, v36, 0 op_sel_hi:[0,1,0]
    v_fma_mix_f32 v38, v94, v38, 0 op_sel_hi:[0,1,0]
    v_mfma_f32_16x16x32_bf16 v[104:107], v[188:191], v[68:71], v[104:107]
    s_mov_b32 s44, s45
    s_lshl_b32 s45, s24, 7
    s_add_u32 s45, s45, s50
    v_fma_mix_f32 v37, v93, v37, 0 op_sel_hi:[0,1,0]
    v_fma_mix_f32 v39, v95, v39, 0 op_sel_hi:[0,1,0]
    v_mfma_f32_16x16x32_bf16 v[104:107], v[184:187], v[64:67], v[104:107]
    v_fmac_f32 v8, v36, v36
    v_fmac_f32 v8, v37, v37
    v_mfma_f32_16x16x32_bf16 v[100:103], v[136:139], v[64:67], v[100:103]
    v_fmac_f32 v8, v38, v38
    v_fmac_f32 v8, v39, v39
    v_mfma_f32_16x16x32_bf16 v[100:103], v[140:143], v[68:71], v[100:103]
    v_cvt_pk_bf16_f32 v48, v36, v37
    v_cvt_pk_bf16_f32 v49, v38, v39
    s_waitcnt vmcnt(3) lgkmcnt(0)
    s_barrier
    v_mfma_f32_16x16x32_bf16 v[108:111], v[240:243], v[72:75], v[108:111]
    ds_read_b128 v[56:59], v23 offset:0
    v_cvt_pk_f16_f32 v20, v96, v97
    v_cvt_pk_f16_f32 v21, v98, v99
    v_pk_fma_f16 v40, v20, v20, s25 neg_lo:[1,0,0] neg_hi:[1,0,0]
    v_mfma_f32_16x16x32_bf16 v[108:111], v[244:247], v[76:79], v[108:111]
    ds_read_b128 v[60:63], v23 offset:1024
    v_pk_fma_f16 v42, v21, v21, s25 neg_lo:[1,0,0] neg_hi:[1,0,0]
    v_pk_mul_f16 v40, v20, v40
    v_mfma_f32_16x16x32_bf16 v[104:107], v[196:199], v[76:79], v[104:107]
    ds_read_b128 v[64:67], v23 offset:2048
    v_pk_mul_f16 v42, v21, v42
    v_exp_f16 v20, v40
    v_mfma_f32_16x16x32_bf16 v[104:107], v[192:195], v[72:75], v[104:107]
    ds_read_b128 v[68:71], v23 offset:3072
    v_exp_f16 v21, v42
    v_exp_f16_sdwa v20, v40 dst_sel:WORD_1 dst_unused:UNUSED_PRESERVE src0_sel:WORD_1
    v_mfma_f32_16x16x32_bf16 v[100:103], v[144:147], v[72:75], v[100:103]
    s_add_u32 m0, s47, 0
    v_exp_f16_sdwa v21, v42 dst_sel:WORD_1 dst_unused:UNUSED_PRESERVE src0_sel:WORD_1
    v_pk_add_f16 v20, v20, 1.0 op_sel_hi:[1,0]
    v_mfma_f32_16x16x32_bf16 v[100:103], v[148:151], v[76:79], v[100:103]
    buffer_load_dwordx4 v1, s[12:15], s6 offen offset:0 lds
    v_pk_add_f16 v21, v21, 1.0 op_sel_hi:[1,0]
    v_rcp_f16 v40, v20
    v_mfma_f32_16x16x32_bf16 v[100:103], v[152:155], v[80:83], v[100:103]
    v_rcp_f16 v42, v21
    v_rcp_f16_sdwa v41, v20 dst_sel:DWORD dst_unused:UNUSED_PAD src0_sel:WORD_1
    v_rcp_f16_sdwa v43, v21 dst_sel:DWORD dst_unused:UNUSED_PAD src0_sel:WORD_1
    v_mfma_f32_16x16x32_bf16 v[100:103], v[156:159], v[84:87], v[100:103]
    buffer_load_dwordx4 v1, s[12:15], s6 offen offset:1024 lds
    v_fma_mix_f32 v40, v96, v40, 0 op_sel_hi:[0,1,0]
    v_fma_mix_f32 v42, v98, v42, 0 op_sel_hi:[0,1,0]
    v_mfma_f32_16x16x32_bf16 v[104:107], v[204:207], v[84:87], v[104:107]
    v_fma_mix_f32 v41, v97, v41, 0 op_sel_hi:[0,1,0]
    v_fma_mix_f32 v43, v99, v43, 0 op_sel_hi:[0,1,0]
    v_mfma_f32_16x16x32_bf16 v[104:107], v[200:203], v[80:83], v[104:107]
    buffer_load_dwordx4 v1, s[12:15], s6 offen offset:2048 lds
    v_fmac_f32 v8, v40, v40
    v_fmac_f32 v8, v41, v41
    v_mfma_f32_16x16x32_bf16 v[108:111], v[248:251], v[80:83], v[108:111]
    s_add_u32 s6, s6, 24576
    v_fmac_f32 v8, v42, v42
    v_fmac_f32 v8, v43, v43
    v_mfma_f32_16x16x32_bf16 v[108:111], v[252:255], v[84:87], v[108:111]
    v_cvt_pk_bf16_f32 v52, v40, v41
    v_cvt_pk_bf16_f32 v53, v42, v43
    s_waitcnt lgkmcnt(0)
    v_mfma_f32_16x16x32_bf16 v[88:91], v[112:115], v[56:59], 0
    ds_read_b128 v[72:75], v23 offset:4096
    v_cvt_pk_f16_f32 v16, v100, v101
    v_cvt_pk_f16_f32 v17, v102, v103
    v_pk_fma_f16 v32, v16, v16, s25 neg_lo:[1,0,0] neg_hi:[1,0,0]
    v_mfma_f32_16x16x32_bf16 v[88:91], v[116:119], v[60:63], v[88:91]
    ds_read_b128 v[76:79], v23 offset:5120
    v_pk_fma_f16 v34, v17, v17, s25 neg_lo:[1,0,0] neg_hi:[1,0,0]
    v_pk_mul_f16 v32, v16, v32
    v_mfma_f32_16x16x32_bf16 v[92:95], v[164:167], v[60:63], 0
    ds_read_b128 v[80:83], v23 offset:6144
    v_pk_mul_f16 v34, v17, v34
    v_exp_f16 v16, v32
    v_mfma_f32_16x16x32_bf16 v[92:95], v[160:163], v[56:59], v[92:95]
    ds_read_b128 v[84:87], v23 offset:7168
    v_exp_f16 v17, v34
    v_exp_f16_sdwa v16, v32 dst_sel:WORD_1 dst_unused:UNUSED_PRESERVE src0_sel:WORD_1
    v_exp_f16_sdwa v17, v34 dst_sel:WORD_1 dst_unused:UNUSED_PRESERVE src0_sel:WORD_1
    v_mfma_f32_16x16x32_bf16 v[96:99], v[208:211], v[56:59], 0
    s_add_u32 m0, s47, 24576
    v_pk_add_f16 v16, v16, 1.0 op_sel_hi:[1,0]
    v_pk_add_f16 v17, v17, 1.0 op_sel_hi:[1,0]
    v_mfma_f32_16x16x32_bf16 v[96:99], v[212:215], v[60:63], v[96:99]
    buffer_load_dwordx4 v1, s[12:15], s6 offen offset:0 lds
    v_rcp_f16 v32, v16
    v_rcp_f16 v34, v17
    v_mfma_f32_16x16x32_bf16 v[96:99], v[216:219], v[64:67], v[96:99]
    v_rcp_f16_sdwa v33, v16 dst_sel:DWORD dst_unused:UNUSED_PAD src0_sel:WORD_1
    v_rcp_f16_sdwa v35, v17 dst_sel:DWORD dst_unused:UNUSED_PAD src0_sel:WORD_1
    v_fma_mix_f32 v32, v100, v32, 0 op_sel_hi:[0,1,0]
    v_mfma_f32_16x16x32_bf16 v[96:99], v[220:223], v[68:71], v[96:99]
    buffer_load_dwordx4 v1, s[12:15], s6 offen offset:1024 lds
    v_fma_mix_f32 v34, v102, v34, 0 op_sel_hi:[0,1,0]
    v_fma_mix_f32 v33, v101, v33, 0 op_sel_hi:[0,1,0]
    v_mfma_f32_16x16x32_bf16 v[92:95], v[172:175], v[68:71], v[92:95]
    v_fma_mix_f32 v35, v103, v35, 0 op_sel_hi:[0,1,0]
    v_mul_f32 v9, v32, v32
    v_mfma_f32_16x16x32_bf16 v[92:95], v[168:171], v[64:67], v[92:95]
    buffer_load_dwordx4 v1, s[12:15], s6 offen offset:2048 lds
    v_fmac_f32 v9, v33, v33
    v_fmac_f32 v9, v34, v34
    v_fmac_f32 v9, v35, v35
    v_mfma_f32_16x16x32_bf16 v[88:91], v[120:123], v[64:67], v[88:91]
    s_add_u32 s6, s6, 24576
    v_cvt_pk_bf16_f32 v46, v32, v33
    v_cvt_pk_bf16_f32 v47, v34, v35
    v_mfma_f32_16x16x32_bf16 v[88:91], v[124:127], v[68:71], v[88:91]
    buffer_store_dwordx4 v[44:47], v4, s[16:19], s7 offen offset:0 nt
    v_cvt_pk_f16_f32 v18, v104, v105
    s_waitcnt lgkmcnt(0)
    v_mfma_f32_16x16x32_bf16 v[88:91], v[128:131], v[72:75], v[88:91]
    ds_read_b128 v[56:59], v23 offset:8192
    v_cvt_pk_f16_f32 v19, v106, v107
    v_pk_fma_f16 v36, v18, v18, s25 neg_lo:[1,0,0] neg_hi:[1,0,0]
    v_mfma_f32_16x16x32_bf16 v[88:91], v[132:135], v[76:79], v[88:91]
    ds_read_b128 v[60:63], v23 offset:9216
    v_pk_fma_f16 v38, v19, v19, s25 neg_lo:[1,0,0] neg_hi:[1,0,0]
    v_pk_mul_f16 v36, v18, v36
    v_pk_mul_f16 v38, v19, v38
    v_mfma_f32_16x16x32_bf16 v[92:95], v[180:183], v[76:79], v[92:95]
    ds_read_b128 v[64:67], v23 offset:10240
    v_exp_f16 v18, v36
    v_exp_f16 v19, v38
    v_mfma_f32_16x16x32_bf16 v[92:95], v[176:179], v[72:75], v[92:95]
    ds_read_b128 v[68:71], v23 offset:11264
    v_exp_f16_sdwa v18, v36 dst_sel:WORD_1 dst_unused:UNUSED_PRESERVE src0_sel:WORD_1
    v_exp_f16_sdwa v19, v38 dst_sel:WORD_1 dst_unused:UNUSED_PRESERVE src0_sel:WORD_1
    v_mfma_f32_16x16x32_bf16 v[96:99], v[224:227], v[72:75], v[96:99]
    ds_read_b32 v12, v6 offset:0
    v_pk_add_f16 v18, v18, 1.0 op_sel_hi:[1,0]
    v_pk_add_f16 v19, v19, 1.0 op_sel_hi:[1,0]
    v_rcp_f16 v36, v18
    v_mfma_f32_16x16x32_bf16 v[96:99], v[228:231], v[76:79], v[96:99]
    ds_read_b32 v13, v6 offset:256
    v_rcp_f16 v38, v19
    v_rcp_f16_sdwa v37, v18 dst_sel:DWORD dst_unused:UNUSED_PAD src0_sel:WORD_1
    v_mfma_f32_16x16x32_bf16 v[96:99], v[232:235], v[80:83], v[96:99]
    ds_read_b32 v14, v6 offset:512
    v_rcp_f16_sdwa v39, v19 dst_sel:DWORD dst_unused:UNUSED_PAD src0_sel:WORD_1
    v_fma_mix_f32 v36, v104, v36, 0 op_sel_hi:[0,1,0]
    v_mfma_f32_16x16x32_bf16 v[96:99], v[236:239], v[84:87], v[96:99]
    ds_read_b32 v15, v6 offset:768
    v_fma_mix_f32 v38, v106, v38, 0 op_sel_hi:[0,1,0]
    v_fma_mix_f32 v37, v105, v37, 0 op_sel_hi:[0,1,0]
    v_fma_mix_f32 v39, v107, v39, 0 op_sel_hi:[0,1,0]
    v_mfma_f32_16x16x32_bf16 v[92:95], v[188:191], v[84:87], v[92:95]
    v_fmac_f32 v9, v36, v36
    v_fmac_f32 v9, v37, v37
    v_mfma_f32_16x16x32_bf16 v[92:95], v[184:187], v[80:83], v[92:95]
    v_fmac_f32 v9, v38, v38
    v_fmac_f32 v9, v39, v39
    v_mfma_f32_16x16x32_bf16 v[88:91], v[136:139], v[80:83], v[88:91]
    v_cvt_pk_bf16_f32 v50, v36, v37
    v_cvt_pk_bf16_f32 v51, v38, v39
    buffer_store_dwordx4 v[48:51], v4, s[16:19], s7 offen offset:1024 nt
    v_mfma_f32_16x16x32_bf16 v[88:91], v[140:143], v[84:87], v[88:91]
    v_cvt_pk_f16_f32 v20, v108, v109
    v_cvt_pk_f16_f32 v21, v110, v111
    s_waitcnt lgkmcnt(0)
    v_mfma_f32_16x16x32_bf16 v[96:99], v[240:243], v[56:59], v[96:99]
    ds_read_b128 v[72:75], v23 offset:12288
    v_pk_fma_f16 v40, v20, v20, s25 neg_lo:[1,0,0] neg_hi:[1,0,0]
    v_pk_fma_f16 v42, v21, v21, s25 neg_lo:[1,0,0] neg_hi:[1,0,0]
    v_mfma_f32_16x16x32_bf16 v[96:99], v[244:247], v[60:63], v[96:99]
    ds_read_b128 v[76:79], v23 offset:13312
    v_add_f32 v12, v12, v13
    v_pk_mul_f16 v40, v20, v40
    v_pk_mul_f16 v42, v21, v42
    v_mfma_f32_16x16x32_bf16 v[92:95], v[196:199], v[60:63], v[92:95]
    ds_read_b128 v[80:83], v23 offset:14336
    v_add_f32 v14, v14, v15
    v_exp_f16 v20, v40
    v_exp_f16 v21, v42
    v_exp_f16_sdwa v20, v40 dst_sel:WORD_1 dst_unused:UNUSED_PRESERVE src0_sel:WORD_1
    v_mfma_f32_16x16x32_bf16 v[92:95], v[192:195], v[56:59], v[92:95]
    ds_read_b128 v[84:87], v23 offset:15360
    v_exp_f16_sdwa v21, v42 dst_sel:WORD_1 dst_unused:UNUSED_PRESERVE src0_sel:WORD_1
    v_pk_add_f16 v20, v20, 1.0 op_sel_hi:[1,0]
    v_mfma_f32_16x16x32_bf16 v[88:91], v[144:147], v[56:59], v[88:91]
    v_pk_add_f16 v21, v21, 1.0 op_sel_hi:[1,0]
    v_rcp_f16 v40, v20
    v_mfma_f32_16x16x32_bf16 v[88:91], v[148:151], v[60:63], v[88:91]
    v_rcp_f16 v42, v21
    v_rcp_f16_sdwa v41, v20 dst_sel:DWORD dst_unused:UNUSED_PAD src0_sel:WORD_1
    v_rcp_f16_sdwa v43, v21 dst_sel:DWORD dst_unused:UNUSED_PAD src0_sel:WORD_1
    v_mfma_f32_16x16x32_bf16 v[88:91], v[152:155], v[64:67], v[88:91]
    v_add_f32 v12, v12, v14
    v_fma_mix_f32 v40, v108, v40, 0 op_sel_hi:[0,1,0]
    v_fma_mix_f32 v42, v110, v42, 0 op_sel_hi:[0,1,0]
    v_mfma_f32_16x16x32_bf16 v[88:91], v[156:159], v[68:71], v[88:91]
    v_fma_mix_f32 v41, v109, v41, 0 op_sel_hi:[0,1,0]
    v_fma_mix_f32 v43, v111, v43, 0 op_sel_hi:[0,1,0]
    v_mfma_f32_16x16x32_bf16 v[92:95], v[204:207], v[68:71], v[92:95]
    buffer_atomic_add_f32 v12, v7, s[20:23], s44 offen
    v_fmac_f32 v9, v40, v40
    v_fmac_f32 v9, v41, v41
    v_fmac_f32 v9, v42, v42
    v_mfma_f32_16x16x32_bf16 v[92:95], v[200:203], v[64:67], v[92:95]
    v_fmac_f32 v9, v43, v43
    v_cvt_pk_bf16_f32 v54, v40, v41
    v_mfma_f32_16x16x32_bf16 v[96:99], v[248:251], v[64:67], v[96:99]
    v_cvt_pk_bf16_f32 v55, v42, v43
    v_permlane16_swap_b32 v8, v9
    v_mfma_f32_16x16x32_bf16 v[96:99], v[252:255], v[68:71], v[96:99]
    buffer_store_dwordx4 v[52:55], v4, s[16:19], s7 offen offset:2048 nt
    v_add_f32 v9, v8, v9
    s_waitcnt lgkmcnt(0)
    v_mfma_f32_16x16x32_bf16 v[100:103], v[112:115], v[72:75], 0
    ds_read_b128 v[56:59], v23 offset:16384
    v_cvt_pk_f16_f32 v16, v88, v89
    v_cvt_pk_f16_f32 v17, v90, v91
    v_pk_fma_f16 v32, v16, v16, s25 neg_lo:[1,0,0] neg_hi:[1,0,0]
    v_mfma_f32_16x16x32_bf16 v[100:103], v[116:119], v[76:79], v[100:103]
    ds_read_b128 v[60:63], v23 offset:17408
    v_pk_fma_f16 v34, v17, v17, s25 neg_lo:[1,0,0] neg_hi:[1,0,0]
    v_pk_mul_f16 v32, v16, v32
    v_mfma_f32_16x16x32_bf16 v[104:107], v[164:167], v[76:79], 0
    ds_read_b128 v[64:67], v23 offset:18432
    v_pk_mul_f16 v34, v17, v34
    v_exp_f16 v16, v32
    v_mfma_f32_16x16x32_bf16 v[104:107], v[160:163], v[72:75], v[104:107]
    ds_read_b128 v[68:71], v23 offset:19456
    v_exp_f16 v17, v34
    v_exp_f16_sdwa v16, v32 dst_sel:WORD_1 dst_unused:UNUSED_PRESERVE src0_sel:WORD_1
    v_mfma_f32_16x16x32_bf16 v[108:111], v[208:211], v[72:75], 0
    ds_write_b32 v3, v9 offset:0
    v_exp_f16_sdwa v17, v34 dst_sel:WORD_1 dst_unused:UNUSED_PRESERVE src0_sel:WORD_1
    v_pk_add_f16 v16, v16, 1.0 op_sel_hi:[1,0]
    v_mfma_f32_16x16x32_bf16 v[108:111], v[212:215], v[76:79], v[108:111]
    v_pk_add_f16 v17, v17, 1.0 op_sel_hi:[1,0]
    v_rcp_f16 v32, v16
    v_mfma_f32_16x16x32_bf16 v[108:111], v[216:219], v[80:83], v[108:111]
    v_rcp_f16 v34, v17
    v_rcp_f16_sdwa v33, v16 dst_sel:DWORD dst_unused:UNUSED_PAD src0_sel:WORD_1
    v_rcp_f16_sdwa v35, v17 dst_sel:DWORD dst_unused:UNUSED_PAD src0_sel:WORD_1
    v_mfma_f32_16x16x32_bf16 v[108:111], v[220:223], v[84:87], v[108:111]
    v_fma_mix_f32 v32, v88, v32, 0 op_sel_hi:[0,1,0]
    v_fma_mix_f32 v34, v90, v34, 0 op_sel_hi:[0,1,0]
    v_mfma_f32_16x16x32_bf16 v[104:107], v[172:175], v[84:87], v[104:107]
    v_fma_mix_f32 v33, v89, v33, 0 op_sel_hi:[0,1,0]
    v_fma_mix_f32 v35, v91, v35, 0 op_sel_hi:[0,1,0]
    v_mfma_f32_16x16x32_bf16 v[104:107], v[168:171], v[80:83], v[104:107]
    v_mul_f32 v8, v32, v32
    v_fmac_f32 v8, v33, v33
    v_mfma_f32_16x16x32_bf16 v[100:103], v[120:123], v[80:83], v[100:103]
    v_fmac_f32 v8, v34, v34
    v_fmac_f32 v8, v35, v35
    v_mfma_f32_16x16x32_bf16 v[100:103], v[124:127], v[84:87], v[100:103]
    v_cvt_pk_bf16_f32 v44, v32, v33
    v_cvt_pk_bf16_f32 v45, v34, v35
    s_waitcnt lgkmcnt(0)
    v_mfma_f32_16x16x32_bf16 v[100:103], v[128:131], v[56:59], v[100:103]
    ds_read_b128 v[72:75], v23 offset:20480
    v_cvt_pk_f16_f32 v18, v92, v93
    v_cvt_pk_f16_f32 v19, v94, v95
    v_pk_fma_f16 v36, v18, v18, s25 neg_lo:[1,0,0] neg_hi:[1,0,0]
    v_mfma_f32_16x16x32_bf16 v[100:103], v[132:135], v[60:63], v[100:103]
    ds_read_b128 v[76:79], v23 offset:21504
    v_pk_fma_f16 v38, v19, v19, s25 neg_lo:[1,0,0] neg_hi:[1,0,0]
    v_pk_mul_f16 v36, v18, v36
    v_mfma_f32_16x16x32_bf16 v[104:107], v[180:183], v[60:63], v[104:107]
    ds_read_b128 v[80:83], v23 offset:22528
    v_pk_mul_f16 v38, v19, v38
    v_exp_f16 v18, v36
    v_mfma_f32_16x16x32_bf16 v[104:107], v[176:179], v[56:59], v[104:107]
    ds_read_b128 v[84:87], v23 offset:23552
    v_exp_f16 v19, v38
    v_exp_f16_sdwa v18, v36 dst_sel:WORD_1 dst_unused:UNUSED_PRESERVE src0_sel:WORD_1
    v_mfma_f32_16x16x32_bf16 v[108:111], v[224:227], v[56:59], v[108:111]
    v_exp_f16_sdwa v19, v38 dst_sel:WORD_1 dst_unused:UNUSED_PRESERVE src0_sel:WORD_1
    v_pk_add_f16 v18, v18, 1.0 op_sel_hi:[1,0]
    v_mfma_f32_16x16x32_bf16 v[108:111], v[228:231], v[60:63], v[108:111]
    v_pk_add_f16 v19, v19, 1.0 op_sel_hi:[1,0]
    v_rcp_f16 v36, v18
    v_mfma_f32_16x16x32_bf16 v[108:111], v[232:235], v[64:67], v[108:111]
    v_rcp_f16 v38, v19
    v_rcp_f16_sdwa v37, v18 dst_sel:DWORD dst_unused:UNUSED_PAD src0_sel:WORD_1
    v_rcp_f16_sdwa v39, v19 dst_sel:DWORD dst_unused:UNUSED_PAD src0_sel:WORD_1
    v_mfma_f32_16x16x32_bf16 v[108:111], v[236:239], v[68:71], v[108:111]
    v_fma_mix_f32 v36, v92, v36, 0 op_sel_hi:[0,1,0]
    v_fma_mix_f32 v38, v94, v38, 0 op_sel_hi:[0,1,0]
    v_mfma_f32_16x16x32_bf16 v[104:107], v[188:191], v[68:71], v[104:107]
    v_fma_mix_f32 v37, v93, v37, 0 op_sel_hi:[0,1,0]
    v_fma_mix_f32 v39, v95, v39, 0 op_sel_hi:[0,1,0]
    v_mfma_f32_16x16x32_bf16 v[104:107], v[184:187], v[64:67], v[104:107]
    v_fmac_f32 v8, v36, v36
    v_fmac_f32 v8, v37, v37
    v_mfma_f32_16x16x32_bf16 v[100:103], v[136:139], v[64:67], v[100:103]
    v_fmac_f32 v8, v38, v38
    v_fmac_f32 v8, v39, v39
    v_mfma_f32_16x16x32_bf16 v[100:103], v[140:143], v[68:71], v[100:103]
    v_cvt_pk_bf16_f32 v48, v36, v37
    v_cvt_pk_bf16_f32 v49, v38, v39
    s_waitcnt vmcnt(3) lgkmcnt(0)
    s_barrier
    v_mfma_f32_16x16x32_bf16 v[108:111], v[240:243], v[72:75], v[108:111]
    ds_read_b128 v[56:59], v22 offset:0
    v_cvt_pk_f16_f32 v20, v96, v97
    v_cvt_pk_f16_f32 v21, v98, v99
    v_pk_fma_f16 v40, v20, v20, s25 neg_lo:[1,0,0] neg_hi:[1,0,0]
    v_mfma_f32_16x16x32_bf16 v[108:111], v[244:247], v[76:79], v[108:111]
    ds_read_b128 v[60:63], v22 offset:1024
    v_pk_fma_f16 v42, v21, v21, s25 neg_lo:[1,0,0] neg_hi:[1,0,0]
    v_pk_mul_f16 v40, v20, v40
    v_mfma_f32_16x16x32_bf16 v[104:107], v[196:199], v[76:79], v[104:107]
    ds_read_b128 v[64:67], v22 offset:2048
    v_pk_mul_f16 v42, v21, v42
    v_exp_f16 v20, v40
    v_mfma_f32_16x16x32_bf16 v[104:107], v[192:195], v[72:75], v[104:107]
    ds_read_b128 v[68:71], v22 offset:3072
    v_exp_f16 v21, v42
    v_exp_f16_sdwa v20, v40 dst_sel:WORD_1 dst_unused:UNUSED_PRESERVE src0_sel:WORD_1
    v_mfma_f32_16x16x32_bf16 v[100:103], v[144:147], v[72:75], v[100:103]
    s_add_u32 m0, s47, 49152
    v_exp_f16_sdwa v21, v42 dst_sel:WORD_1 dst_unused:UNUSED_PRESERVE src0_sel:WORD_1
    v_pk_add_f16 v20, v20, 1.0 op_sel_hi:[1,0]
    v_mfma_f32_16x16x32_bf16 v[100:103], v[148:151], v[76:79], v[100:103]
    buffer_load_dwordx4 v1, s[12:15], s6 offen offset:0 lds
    v_pk_add_f16 v21, v21, 1.0 op_sel_hi:[1,0]
    v_rcp_f16 v40, v20
    v_mfma_f32_16x16x32_bf16 v[100:103], v[152:155], v[80:83], v[100:103]
    v_rcp_f16 v42, v21
    v_rcp_f16_sdwa v41, v20 dst_sel:DWORD dst_unused:UNUSED_PAD src0_sel:WORD_1
    v_rcp_f16_sdwa v43, v21 dst_sel:DWORD dst_unused:UNUSED_PAD src0_sel:WORD_1
    v_mfma_f32_16x16x32_bf16 v[100:103], v[156:159], v[84:87], v[100:103]
    buffer_load_dwordx4 v1, s[12:15], s6 offen offset:1024 lds
    v_fma_mix_f32 v40, v96, v40, 0 op_sel_hi:[0,1,0]
    v_fma_mix_f32 v42, v98, v42, 0 op_sel_hi:[0,1,0]
    v_mfma_f32_16x16x32_bf16 v[104:107], v[204:207], v[84:87], v[104:107]
    v_fma_mix_f32 v41, v97, v41, 0 op_sel_hi:[0,1,0]
    v_fma_mix_f32 v43, v99, v43, 0 op_sel_hi:[0,1,0]
    v_mfma_f32_16x16x32_bf16 v[104:107], v[200:203], v[80:83], v[104:107]
    buffer_load_dwordx4 v1, s[12:15], s6 offen offset:2048 lds
    v_fmac_f32 v8, v40, v40
    v_fmac_f32 v8, v41, v41
    v_mfma_f32_16x16x32_bf16 v[108:111], v[248:251], v[80:83], v[108:111]
    s_add_u32 s6, s6, 24576
    v_fmac_f32 v8, v42, v42
    v_fmac_f32 v8, v43, v43
    v_mfma_f32_16x16x32_bf16 v[108:111], v[252:255], v[84:87], v[108:111]
    v_cvt_pk_bf16_f32 v52, v40, v41
    v_cvt_pk_bf16_f32 v53, v42, v43
    s_waitcnt lgkmcnt(0)
    v_mfma_f32_16x16x32_bf16 v[88:91], v[112:115], v[56:59], 0
    ds_read_b128 v[72:75], v22 offset:4096
    v_cvt_pk_f16_f32 v16, v100, v101
    v_cvt_pk_f16_f32 v17, v102, v103
    v_pk_fma_f16 v32, v16, v16, s25 neg_lo:[1,0,0] neg_hi:[1,0,0]
    v_mfma_f32_16x16x32_bf16 v[88:91], v[116:119], v[60:63], v[88:91]
    ds_read_b128 v[76:79], v22 offset:5120
    v_pk_fma_f16 v34, v17, v17, s25 neg_lo:[1,0,0] neg_hi:[1,0,0]
    v_pk_mul_f16 v32, v16, v32
    v_mfma_f32_16x16x32_bf16 v[92:95], v[164:167], v[60:63], 0
    ds_read_b128 v[80:83], v22 offset:6144
    v_pk_mul_f16 v34, v17, v34
    v_exp_f16 v16, v32
    v_mfma_f32_16x16x32_bf16 v[92:95], v[160:163], v[56:59], v[92:95]
    ds_read_b128 v[84:87], v22 offset:7168
    v_exp_f16 v17, v34
    v_exp_f16_sdwa v16, v32 dst_sel:WORD_1 dst_unused:UNUSED_PRESERVE src0_sel:WORD_1
    v_exp_f16_sdwa v17, v34 dst_sel:WORD_1 dst_unused:UNUSED_PRESERVE src0_sel:WORD_1
    v_mfma_f32_16x16x32_bf16 v[96:99], v[208:211], v[56:59], 0
    s_add_u32 m0, s47, 73728
    v_pk_add_f16 v16, v16, 1.0 op_sel_hi:[1,0]
    v_pk_add_f16 v17, v17, 1.0 op_sel_hi:[1,0]
    v_mfma_f32_16x16x32_bf16 v[96:99], v[212:215], v[60:63], v[96:99]
    buffer_load_dwordx4 v1, s[12:15], s6 offen offset:0 lds
    v_rcp_f16 v32, v16
    v_rcp_f16 v34, v17
    v_mfma_f32_16x16x32_bf16 v[96:99], v[216:219], v[64:67], v[96:99]
    v_rcp_f16_sdwa v33, v16 dst_sel:DWORD dst_unused:UNUSED_PAD src0_sel:WORD_1
    v_rcp_f16_sdwa v35, v17 dst_sel:DWORD dst_unused:UNUSED_PAD src0_sel:WORD_1
    v_fma_mix_f32 v32, v100, v32, 0 op_sel_hi:[0,1,0]
    v_mfma_f32_16x16x32_bf16 v[96:99], v[220:223], v[68:71], v[96:99]
    buffer_load_dwordx4 v1, s[12:15], s6 offen offset:1024 lds
    v_fma_mix_f32 v34, v102, v34, 0 op_sel_hi:[0,1,0]
    v_fma_mix_f32 v33, v101, v33, 0 op_sel_hi:[0,1,0]
    v_mfma_f32_16x16x32_bf16 v[92:95], v[172:175], v[68:71], v[92:95]
    v_fma_mix_f32 v35, v103, v35, 0 op_sel_hi:[0,1,0]
    v_mul_f32 v9, v32, v32
    v_mfma_f32_16x16x32_bf16 v[92:95], v[168:171], v[64:67], v[92:95]
    buffer_load_dwordx4 v1, s[12:15], s6 offen offset:2048 lds
    v_fmac_f32 v9, v33, v33
    v_fmac_f32 v9, v34, v34
    v_fmac_f32 v9, v35, v35
    v_mfma_f32_16x16x32_bf16 v[88:91], v[120:123], v[64:67], v[88:91]
    s_add_u32 s6, s6, 24576
    s_cmp_ge_u32 s6, s38
    s_cselect_b32 s6, s47, s6
    v_cvt_pk_bf16_f32 v46, v32, v33
    v_cvt_pk_bf16_f32 v47, v34, v35
    v_mfma_f32_16x16x32_bf16 v[88:91], v[124:127], v[68:71], v[88:91]
    buffer_store_dwordx4 v[44:47], v4, s[52:55], s32 offen offset:0
    v_cvt_pk_f16_f32 v18, v104, v105
    s_waitcnt lgkmcnt(0)
    v_mfma_f32_16x16x32_bf16 v[88:91], v[128:131], v[72:75], v[88:91]
    ds_read_b128 v[56:59], v22 offset:8192
    v_cvt_pk_f16_f32 v19, v106, v107
    v_pk_fma_f16 v36, v18, v18, s25 neg_lo:[1,0,0] neg_hi:[1,0,0]
    v_mfma_f32_16x16x32_bf16 v[88:91], v[132:135], v[76:79], v[88:91]
    ds_read_b128 v[60:63], v22 offset:9216
    v_pk_fma_f16 v38, v19, v19, s25 neg_lo:[1,0,0] neg_hi:[1,0,0]
    v_pk_mul_f16 v36, v18, v36
    v_pk_mul_f16 v38, v19, v38
    v_mfma_f32_16x16x32_bf16 v[92:95], v[180:183], v[76:79], v[92:95]
    ds_read_b128 v[64:67], v22 offset:10240
    v_exp_f16 v18, v36
    v_exp_f16 v19, v38
    v_mfma_f32_16x16x32_bf16 v[92:95], v[176:179], v[72:75], v[92:95]
    ds_read_b128 v[68:71], v22 offset:11264
    v_exp_f16_sdwa v18, v36 dst_sel:WORD_1 dst_unused:UNUSED_PRESERVE src0_sel:WORD_1
    v_exp_f16_sdwa v19, v38 dst_sel:WORD_1 dst_unused:UNUSED_PRESERVE src0_sel:WORD_1
    v_mfma_f32_16x16x32_bf16 v[96:99], v[224:227], v[72:75], v[96:99]
    v_pk_add_f16 v18, v18, 1.0 op_sel_hi:[1,0]
    v_pk_add_f16 v19, v19, 1.0 op_sel_hi:[1,0]
    v_rcp_f16 v36, v18
    v_mfma_f32_16x16x32_bf16 v[96:99], v[228:231], v[76:79], v[96:99]
    v_rcp_f16 v38, v19
    v_rcp_f16_sdwa v37, v18 dst_sel:DWORD dst_unused:UNUSED_PAD src0_sel:WORD_1
    v_mfma_f32_16x16x32_bf16 v[96:99], v[232:235], v[80:83], v[96:99]
    v_rcp_f16_sdwa v39, v19 dst_sel:DWORD dst_unused:UNUSED_PAD src0_sel:WORD_1
    v_fma_mix_f32 v36, v104, v36, 0 op_sel_hi:[0,1,0]
    v_mfma_f32_16x16x32_bf16 v[96:99], v[236:239], v[84:87], v[96:99]
    v_fma_mix_f32 v38, v106, v38, 0 op_sel_hi:[0,1,0]
    v_fma_mix_f32 v37, v105, v37, 0 op_sel_hi:[0,1,0]
    v_fma_mix_f32 v39, v107, v39, 0 op_sel_hi:[0,1,0]
    v_mfma_f32_16x16x32_bf16 v[92:95], v[188:191], v[84:87], v[92:95]
    v_fmac_f32 v9, v36, v36
    v_fmac_f32 v9, v37, v37
    v_mfma_f32_16x16x32_bf16 v[92:95], v[184:187], v[80:83], v[92:95]
    v_fmac_f32 v9, v38, v38
    v_fmac_f32 v9, v39, v39
    v_mfma_f32_16x16x32_bf16 v[88:91], v[136:139], v[80:83], v[88:91]
    v_cvt_pk_bf16_f32 v50, v36, v37
    v_cvt_pk_bf16_f32 v51, v38, v39
    buffer_store_dwordx4 v[48:51], v4, s[52:55], s32 offen offset:1024
    v_mfma_f32_16x16x32_bf16 v[88:91], v[140:143], v[84:87], v[88:91]
    v_cvt_pk_f16_f32 v20, v108, v109
    v_cvt_pk_f16_f32 v21, v110, v111
    s_waitcnt lgkmcnt(0)
    v_mfma_f32_16x16x32_bf16 v[96:99], v[240:243], v[56:59], v[96:99]
    ds_read_b128 v[72:75], v22 offset:12288
    v_pk_fma_f16 v40, v20, v20, s25 neg_lo:[1,0,0] neg_hi:[1,0,0]
    v_pk_fma_f16 v42, v21, v21, s25 neg_lo:[1,0,0] neg_hi:[1,0,0]
    v_mfma_f32_16x16x32_bf16 v[96:99], v[244:247], v[60:63], v[96:99]
    ds_read_b128 v[76:79], v22 offset:13312
    v_pk_mul_f16 v40, v20, v40
    v_pk_mul_f16 v42, v21, v42
    v_mfma_f32_16x16x32_bf16 v[92:95], v[196:199], v[60:63], v[92:95]
    ds_read_b128 v[80:83], v22 offset:14336
    v_exp_f16 v20, v40
    v_exp_f16 v21, v42
    v_exp_f16_sdwa v20, v40 dst_sel:WORD_1 dst_unused:UNUSED_PRESERVE src0_sel:WORD_1
    v_mfma_f32_16x16x32_bf16 v[92:95], v[192:195], v[56:59], v[92:95]
    ds_read_b128 v[84:87], v22 offset:15360
    v_exp_f16_sdwa v21, v42 dst_sel:WORD_1 dst_unused:UNUSED_PRESERVE src0_sel:WORD_1
    v_pk_add_f16 v20, v20, 1.0 op_sel_hi:[1,0]
    v_mfma_f32_16x16x32_bf16 v[88:91], v[144:147], v[56:59], v[88:91]
    v_pk_add_f16 v21, v21, 1.0 op_sel_hi:[1,0]
    v_rcp_f16 v40, v20
    v_mfma_f32_16x16x32_bf16 v[88:91], v[148:151], v[60:63], v[88:91]
    v_rcp_f16 v42, v21
    v_rcp_f16_sdwa v41, v20 dst_sel:DWORD dst_unused:UNUSED_PAD src0_sel:WORD_1
    v_rcp_f16_sdwa v43, v21 dst_sel:DWORD dst_unused:UNUSED_PAD src0_sel:WORD_1
    v_mfma_f32_16x16x32_bf16 v[88:91], v[152:155], v[64:67], v[88:91]
    v_fma_mix_f32 v40, v108, v40, 0 op_sel_hi:[0,1,0]
    v_fma_mix_f32 v42, v110, v42, 0 op_sel_hi:[0,1,0]
    v_mfma_f32_16x16x32_bf16 v[88:91], v[156:159], v[68:71], v[88:91]
    v_fma_mix_f32 v41, v109, v41, 0 op_sel_hi:[0,1,0]
    v_fma_mix_f32 v43, v111, v43, 0 op_sel_hi:[0,1,0]
    v_mfma_f32_16x16x32_bf16 v[92:95], v[204:207], v[68:71], v[92:95]
    v_fmac_f32 v9, v40, v40
    v_fmac_f32 v9, v41, v41
    v_fmac_f32 v9, v42, v42
    v_mfma_f32_16x16x32_bf16 v[92:95], v[200:203], v[64:67], v[92:95]
    v_fmac_f32 v9, v43, v43
    v_cvt_pk_bf16_f32 v54, v40, v41
    v_mfma_f32_16x16x32_bf16 v[96:99], v[248:251], v[64:67], v[96:99]
    v_cvt_pk_bf16_f32 v55, v42, v43
    v_permlane16_swap_b32 v8, v9
    v_mfma_f32_16x16x32_bf16 v[96:99], v[252:255], v[68:71], v[96:99]
    buffer_store_dwordx4 v[52:55], v4, s[52:55], s32 offen offset:2048
    v_add_f32 v9, v8, v9
    s_waitcnt lgkmcnt(0)
    v_mfma_f32_16x16x32_bf16 v[100:103], v[112:115], v[72:75], 0
    ds_read_b128 v[56:59], v22 offset:16384
    v_cvt_pk_f16_f32 v16, v88, v89
    v_cvt_pk_f16_f32 v17, v90, v91
    v_pk_fma_f16 v32, v16, v16, s25 neg_lo:[1,0,0] neg_hi:[1,0,0]
    v_mfma_f32_16x16x32_bf16 v[100:103], v[116:119], v[76:79], v[100:103]
    ds_read_b128 v[60:63], v22 offset:17408
    v_pk_fma_f16 v34, v17, v17, s25 neg_lo:[1,0,0] neg_hi:[1,0,0]
    v_pk_mul_f16 v32, v16, v32
    v_mfma_f32_16x16x32_bf16 v[104:107], v[164:167], v[76:79], 0
    ds_read_b128 v[64:67], v22 offset:18432
    v_pk_mul_f16 v34, v17, v34
    v_exp_f16 v16, v32
    v_mfma_f32_16x16x32_bf16 v[104:107], v[160:163], v[72:75], v[104:107]
    ds_read_b128 v[68:71], v22 offset:19456
    v_exp_f16 v17, v34
    v_exp_f16_sdwa v16, v32 dst_sel:WORD_1 dst_unused:UNUSED_PRESERVE src0_sel:WORD_1
    v_mfma_f32_16x16x32_bf16 v[108:111], v[208:211], v[72:75], 0
    ds_write_b32 v3, v9 offset:1024
    v_exp_f16_sdwa v17, v34 dst_sel:WORD_1 dst_unused:UNUSED_PRESERVE src0_sel:WORD_1
    v_pk_add_f16 v16, v16, 1.0 op_sel_hi:[1,0]
    v_mfma_f32_16x16x32_bf16 v[108:111], v[212:215], v[76:79], v[108:111]
    s_add_u32 s7, s7, 36864
    s_add_u32 s32, s32, s56
    v_pk_add_f16 v17, v17, 1.0 op_sel_hi:[1,0]
    v_rcp_f16 v32, v16
    v_mfma_f32_16x16x32_bf16 v[108:111], v[216:219], v[80:83], v[108:111]
    v_rcp_f16 v34, v17
    v_rcp_f16_sdwa v33, v16 dst_sel:DWORD dst_unused:UNUSED_PAD src0_sel:WORD_1
    v_rcp_f16_sdwa v35, v17 dst_sel:DWORD dst_unused:UNUSED_PAD src0_sel:WORD_1
    v_mfma_f32_16x16x32_bf16 v[108:111], v[220:223], v[84:87], v[108:111]
    v_fma_mix_f32 v32, v88, v32, 0 op_sel_hi:[0,1,0]
    v_fma_mix_f32 v34, v90, v34, 0 op_sel_hi:[0,1,0]
    v_mfma_f32_16x16x32_bf16 v[104:107], v[172:175], v[84:87], v[104:107]
    v_fma_mix_f32 v33, v89, v33, 0 op_sel_hi:[0,1,0]
    v_fma_mix_f32 v35, v91, v35, 0 op_sel_hi:[0,1,0]
    v_mfma_f32_16x16x32_bf16 v[104:107], v[168:171], v[80:83], v[104:107]
    v_mul_f32 v8, v32, v32
    v_fmac_f32 v8, v33, v33
    v_mfma_f32_16x16x32_bf16 v[100:103], v[120:123], v[80:83], v[100:103]
    v_fmac_f32 v8, v34, v34
    v_fmac_f32 v8, v35, v35
    v_mfma_f32_16x16x32_bf16 v[100:103], v[124:127], v[84:87], v[100:103]
    v_cvt_pk_bf16_f32 v44, v32, v33
    v_cvt_pk_bf16_f32 v45, v34, v35
    s_waitcnt lgkmcnt(0)
    v_mfma_f32_16x16x32_bf16 v[100:103], v[128:131], v[56:59], v[100:103]
    ds_read_b128 v[72:75], v22 offset:20480
    v_cvt_pk_f16_f32 v18, v92, v93
    v_cvt_pk_f16_f32 v19, v94, v95
    v_pk_fma_f16 v36, v18, v18, s25 neg_lo:[1,0,0] neg_hi:[1,0,0]
    v_mfma_f32_16x16x32_bf16 v[100:103], v[132:135], v[60:63], v[100:103]
    ds_read_b128 v[76:79], v22 offset:21504
    v_pk_fma_f16 v38, v19, v19, s25 neg_lo:[1,0,0] neg_hi:[1,0,0]
    v_pk_mul_f16 v36, v18, v36
    v_mfma_f32_16x16x32_bf16 v[104:107], v[180:183], v[60:63], v[104:107]
    ds_read_b128 v[80:83], v22 offset:22528
    v_pk_mul_f16 v38, v19, v38
    v_exp_f16 v18, v36
    v_mfma_f32_16x16x32_bf16 v[104:107], v[176:179], v[56:59], v[104:107]
    ds_read_b128 v[84:87], v22 offset:23552
    v_exp_f16 v19, v38
    v_exp_f16_sdwa v18, v36 dst_sel:WORD_1 dst_unused:UNUSED_PRESERVE src0_sel:WORD_1
    v_mfma_f32_16x16x32_bf16 v[108:111], v[224:227], v[56:59], v[108:111]
    v_exp_f16_sdwa v19, v38 dst_sel:WORD_1 dst_unused:UNUSED_PRESERVE src0_sel:WORD_1
    v_pk_add_f16 v18, v18, 1.0 op_sel_hi:[1,0]
    v_mfma_f32_16x16x32_bf16 v[108:111], v[228:231], v[60:63], v[108:111]
    v_pk_add_f16 v19, v19, 1.0 op_sel_hi:[1,0]
    v_rcp_f16 v36, v18
    v_mfma_f32_16x16x32_bf16 v[108:111], v[232:235], v[64:67], v[108:111]
    v_rcp_f16 v38, v19
    v_rcp_f16_sdwa v37, v18 dst_sel:DWORD dst_unused:UNUSED_PAD src0_sel:WORD_1
    v_rcp_f16_sdwa v39, v19 dst_sel:DWORD dst_unused:UNUSED_PAD src0_sel:WORD_1
    v_mfma_f32_16x16x32_bf16 v[108:111], v[236:239], v[68:71], v[108:111]
    v_fma_mix_f32 v36, v92, v36, 0 op_sel_hi:[0,1,0]
    v_fma_mix_f32 v38, v94, v38, 0 op_sel_hi:[0,1,0]
    v_mfma_f32_16x16x32_bf16 v[104:107], v[188:191], v[68:71], v[104:107]
    v_fma_mix_f32 v37, v93, v37, 0 op_sel_hi:[0,1,0]
    v_fma_mix_f32 v39, v95, v39, 0 op_sel_hi:[0,1,0]
    v_mfma_f32_16x16x32_bf16 v[104:107], v[184:187], v[64:67], v[104:107]
    v_fmac_f32 v8, v36, v36
    v_fmac_f32 v8, v37, v37
    v_mfma_f32_16x16x32_bf16 v[100:103], v[136:139], v[64:67], v[100:103]
    v_fmac_f32 v8, v38, v38
    v_fmac_f32 v8, v39, v39
    v_mfma_f32_16x16x32_bf16 v[100:103], v[140:143], v[68:71], v[100:103]
    v_cvt_pk_bf16_f32 v48, v36, v37
    v_cvt_pk_bf16_f32 v49, v38, v39
    s_waitcnt vmcnt(3) lgkmcnt(0)
    s_barrier
    v_mfma_f32_16x16x32_bf16 v[108:111], v[240:243], v[72:75], v[108:111]
    ds_read_b128 v[56:59], v23 offset:0
    v_cvt_pk_f16_f32 v20, v96, v97
    v_cvt_pk_f16_f32 v21, v98, v99
    v_pk_fma_f16 v40, v20, v20, s25 neg_lo:[1,0,0] neg_hi:[1,0,0]
    v_mfma_f32_16x16x32_bf16 v[108:111], v[244:247], v[76:79], v[108:111]
    ds_read_b128 v[60:63], v23 offset:1024
    v_pk_fma_f16 v42, v21, v21, s25 neg_lo:[1,0,0] neg_hi:[1,0,0]
    v_pk_mul_f16 v40, v20, v40
    v_mfma_f32_16x16x32_bf16 v[104:107], v[196:199], v[76:79], v[104:107]
    ds_read_b128 v[64:67], v23 offset:2048
    v_pk_mul_f16 v42, v21, v42
    v_exp_f16 v20, v40
    v_mfma_f32_16x16x32_bf16 v[104:107], v[192:195], v[72:75], v[104:107]
    ds_read_b128 v[68:71], v23 offset:3072
    v_exp_f16 v21, v42
    v_exp_f16_sdwa v20, v40 dst_sel:WORD_1 dst_unused:UNUSED_PRESERVE src0_sel:WORD_1
    v_mfma_f32_16x16x32_bf16 v[100:103], v[144:147], v[72:75], v[100:103]
    s_add_u32 m0, s47, 0
    v_exp_f16_sdwa v21, v42 dst_sel:WORD_1 dst_unused:UNUSED_PRESERVE src0_sel:WORD_1
    v_pk_add_f16 v20, v20, 1.0 op_sel_hi:[1,0]
    v_mfma_f32_16x16x32_bf16 v[100:103], v[148:151], v[76:79], v[100:103]
    buffer_load_dwordx4 v1, s[12:15], s6 offen offset:0 lds
    v_pk_add_f16 v21, v21, 1.0 op_sel_hi:[1,0]
    v_rcp_f16 v40, v20
    v_mfma_f32_16x16x32_bf16 v[100:103], v[152:155], v[80:83], v[100:103]
    v_rcp_f16 v42, v21
    v_rcp_f16_sdwa v41, v20 dst_sel:DWORD dst_unused:UNUSED_PAD src0_sel:WORD_1
    v_rcp_f16_sdwa v43, v21 dst_sel:DWORD dst_unused:UNUSED_PAD src0_sel:WORD_1
    v_mfma_f32_16x16x32_bf16 v[100:103], v[156:159], v[84:87], v[100:103]
    buffer_load_dwordx4 v1, s[12:15], s6 offen offset:1024 lds
    v_fma_mix_f32 v40, v96, v40, 0 op_sel_hi:[0,1,0]
    v_fma_mix_f32 v42, v98, v42, 0 op_sel_hi:[0,1,0]
    v_mfma_f32_16x16x32_bf16 v[104:107], v[204:207], v[84:87], v[104:107]
    v_fma_mix_f32 v41, v97, v41, 0 op_sel_hi:[0,1,0]
    v_fma_mix_f32 v43, v99, v43, 0 op_sel_hi:[0,1,0]
    v_mfma_f32_16x16x32_bf16 v[104:107], v[200:203], v[80:83], v[104:107]
    buffer_load_dwordx4 v1, s[12:15], s6 offen offset:2048 lds
    v_fmac_f32 v8, v40, v40
    v_fmac_f32 v8, v41, v41
    v_mfma_f32_16x16x32_bf16 v[108:111], v[248:251], v[80:83], v[108:111]
    s_add_u32 s6, s6, 24576
    v_fmac_f32 v8, v42, v42
    v_fmac_f32 v8, v43, v43
    v_mfma_f32_16x16x32_bf16 v[108:111], v[252:255], v[84:87], v[108:111]
    v_cvt_pk_bf16_f32 v52, v40, v41
    v_cvt_pk_bf16_f32 v53, v42, v43
    s_waitcnt lgkmcnt(0)
    v_mfma_f32_16x16x32_bf16 v[88:91], v[112:115], v[56:59], 0
    ds_read_b128 v[72:75], v23 offset:4096
    v_cvt_pk_f16_f32 v16, v100, v101
    v_cvt_pk_f16_f32 v17, v102, v103
    v_pk_fma_f16 v32, v16, v16, s25 neg_lo:[1,0,0] neg_hi:[1,0,0]
    v_mfma_f32_16x16x32_bf16 v[88:91], v[116:119], v[60:63], v[88:91]
    ds_read_b128 v[76:79], v23 offset:5120
    v_pk_fma_f16 v34, v17, v17, s25 neg_lo:[1,0,0] neg_hi:[1,0,0]
    v_pk_mul_f16 v32, v16, v32
    v_mfma_f32_16x16x32_bf16 v[92:95], v[164:167], v[60:63], 0
    ds_read_b128 v[80:83], v23 offset:6144
    v_pk_mul_f16 v34, v17, v34
    v_exp_f16 v16, v32
    v_mfma_f32_16x16x32_bf16 v[92:95], v[160:163], v[56:59], v[92:95]
    ds_read_b128 v[84:87], v23 offset:7168
    v_exp_f16 v17, v34
    v_exp_f16_sdwa v16, v32 dst_sel:WORD_1 dst_unused:UNUSED_PRESERVE src0_sel:WORD_1
    v_exp_f16_sdwa v17, v34 dst_sel:WORD_1 dst_unused:UNUSED_PRESERVE src0_sel:WORD_1
    v_mfma_f32_16x16x32_bf16 v[96:99], v[208:211], v[56:59], 0
    s_add_u32 m0, s47, 24576
    v_pk_add_f16 v16, v16, 1.0 op_sel_hi:[1,0]
    v_pk_add_f16 v17, v17, 1.0 op_sel_hi:[1,0]
    v_mfma_f32_16x16x32_bf16 v[96:99], v[212:215], v[60:63], v[96:99]
    buffer_load_dwordx4 v1, s[12:15], s6 offen offset:0 lds
    v_rcp_f16 v32, v16
    v_rcp_f16 v34, v17
    v_mfma_f32_16x16x32_bf16 v[96:99], v[216:219], v[64:67], v[96:99]
    v_rcp_f16_sdwa v33, v16 dst_sel:DWORD dst_unused:UNUSED_PAD src0_sel:WORD_1
    v_rcp_f16_sdwa v35, v17 dst_sel:DWORD dst_unused:UNUSED_PAD src0_sel:WORD_1
    v_fma_mix_f32 v32, v100, v32, 0 op_sel_hi:[0,1,0]
    v_mfma_f32_16x16x32_bf16 v[96:99], v[220:223], v[68:71], v[96:99]
    buffer_load_dwordx4 v1, s[12:15], s6 offen offset:1024 lds
    v_fma_mix_f32 v34, v102, v34, 0 op_sel_hi:[0,1,0]
    v_fma_mix_f32 v33, v101, v33, 0 op_sel_hi:[0,1,0]
    v_mfma_f32_16x16x32_bf16 v[92:95], v[172:175], v[68:71], v[92:95]
    v_fma_mix_f32 v35, v103, v35, 0 op_sel_hi:[0,1,0]
    v_mul_f32 v9, v32, v32
    v_mfma_f32_16x16x32_bf16 v[92:95], v[168:171], v[64:67], v[92:95]
    buffer_load_dwordx4 v1, s[12:15], s6 offen offset:2048 lds
    v_fmac_f32 v9, v33, v33
    v_fmac_f32 v9, v34, v34
    v_fmac_f32 v9, v35, v35
    v_mfma_f32_16x16x32_bf16 v[88:91], v[120:123], v[64:67], v[88:91]
    s_add_u32 s6, s6, 24576
    v_cvt_pk_bf16_f32 v46, v32, v33
    v_cvt_pk_bf16_f32 v47, v34, v35
    v_mfma_f32_16x16x32_bf16 v[88:91], v[124:127], v[68:71], v[88:91]
    buffer_store_dwordx4 v[44:47], v4, s[16:19], s7 offen offset:0 nt
    v_cvt_pk_f16_f32 v18, v104, v105
    s_waitcnt lgkmcnt(0)
    v_mfma_f32_16x16x32_bf16 v[88:91], v[128:131], v[72:75], v[88:91]
    ds_read_b128 v[56:59], v23 offset:8192
    v_cvt_pk_f16_f32 v19, v106, v107
    v_pk_fma_f16 v36, v18, v18, s25 neg_lo:[1,0,0] neg_hi:[1,0,0]
    v_mfma_f32_16x16x32_bf16 v[88:91], v[132:135], v[76:79], v[88:91]
    ds_read_b128 v[60:63], v23 offset:9216
    v_pk_fma_f16 v38, v19, v19, s25 neg_lo:[1,0,0] neg_hi:[1,0,0]
    v_pk_mul_f16 v36, v18, v36
    v_pk_mul_f16 v38, v19, v38
    v_mfma_f32_16x16x32_bf16 v[92:95], v[180:183], v[76:79], v[92:95]
    ds_read_b128 v[64:67], v23 offset:10240
    v_exp_f16 v18, v36
    v_exp_f16 v19, v38
    v_mfma_f32_16x16x32_bf16 v[92:95], v[176:179], v[72:75], v[92:95]
    ds_read_b128 v[68:71], v23 offset:11264
    v_exp_f16_sdwa v18, v36 dst_sel:WORD_1 dst_unused:UNUSED_PRESERVE src0_sel:WORD_1
    v_exp_f16_sdwa v19, v38 dst_sel:WORD_1 dst_unused:UNUSED_PRESERVE src0_sel:WORD_1
    v_mfma_f32_16x16x32_bf16 v[96:99], v[224:227], v[72:75], v[96:99]
    v_pk_add_f16 v18, v18, 1.0 op_sel_hi:[1,0]
    v_pk_add_f16 v19, v19, 1.0 op_sel_hi:[1,0]
    v_rcp_f16 v36, v18
    v_mfma_f32_16x16x32_bf16 v[96:99], v[228:231], v[76:79], v[96:99]
    v_rcp_f16 v38, v19
    v_rcp_f16_sdwa v37, v18 dst_sel:DWORD dst_unused:UNUSED_PAD src0_sel:WORD_1
    v_mfma_f32_16x16x32_bf16 v[96:99], v[232:235], v[80:83], v[96:99]
    v_rcp_f16_sdwa v39, v19 dst_sel:DWORD dst_unused:UNUSED_PAD src0_sel:WORD_1
    v_fma_mix_f32 v36, v104, v36, 0 op_sel_hi:[0,1,0]
    v_mfma_f32_16x16x32_bf16 v[96:99], v[236:239], v[84:87], v[96:99]
    v_fma_mix_f32 v38, v106, v38, 0 op_sel_hi:[0,1,0]
    v_fma_mix_f32 v37, v105, v37, 0 op_sel_hi:[0,1,0]
    v_fma_mix_f32 v39, v107, v39, 0 op_sel_hi:[0,1,0]
    v_mfma_f32_16x16x32_bf16 v[92:95], v[188:191], v[84:87], v[92:95]
    v_fmac_f32 v9, v36, v36
    v_fmac_f32 v9, v37, v37
    v_mfma_f32_16x16x32_bf16 v[92:95], v[184:187], v[80:83], v[92:95]
    v_fmac_f32 v9, v38, v38
    v_fmac_f32 v9, v39, v39
    v_mfma_f32_16x16x32_bf16 v[88:91], v[136:139], v[80:83], v[88:91]
    v_cvt_pk_bf16_f32 v50, v36, v37
    v_cvt_pk_bf16_f32 v51, v38, v39
    buffer_store_dwordx4 v[48:51], v4, s[16:19], s7 offen offset:1024 nt
    v_mfma_f32_16x16x32_bf16 v[88:91], v[140:143], v[84:87], v[88:91]
    v_cvt_pk_f16_f32 v20, v108, v109
    v_cvt_pk_f16_f32 v21, v110, v111
    s_waitcnt lgkmcnt(0)
    v_mfma_f32_16x16x32_bf16 v[96:99], v[240:243], v[56:59], v[96:99]
    ds_read_b128 v[72:75], v23 offset:12288
    v_pk_fma_f16 v40, v20, v20, s25 neg_lo:[1,0,0] neg_hi:[1,0,0]
    v_pk_fma_f16 v42, v21, v21, s25 neg_lo:[1,0,0] neg_hi:[1,0,0]
    v_mfma_f32_16x16x32_bf16 v[96:99], v[244:247], v[60:63], v[96:99]
    ds_read_b128 v[76:79], v23 offset:13312
    v_pk_mul_f16 v40, v20, v40
    v_pk_mul_f16 v42, v21, v42
    v_mfma_f32_16x16x32_bf16 v[92:95], v[196:199], v[60:63], v[92:95]
    ds_read_b128 v[80:83], v23 offset:14336
    v_exp_f16 v20, v40
    v_exp_f16 v21, v42
    v_exp_f16_sdwa v20, v40 dst_sel:WORD_1 dst_unused:UNUSED_PRESERVE src0_sel:WORD_1
    v_mfma_f32_16x16x32_bf16 v[92:95], v[192:195], v[56:59], v[92:95]
    ds_read_b128 v[84:87], v23 offset:15360
    v_exp_f16_sdwa v21, v42 dst_sel:WORD_1 dst_unused:UNUSED_PRESERVE src0_sel:WORD_1
    v_pk_add_f16 v20, v20, 1.0 op_sel_hi:[1,0]
    v_mfma_f32_16x16x32_bf16 v[88:91], v[144:147], v[56:59], v[88:91]
    v_pk_add_f16 v21, v21, 1.0 op_sel_hi:[1,0]
    v_rcp_f16 v40, v20
    v_mfma_f32_16x16x32_bf16 v[88:91], v[148:151], v[60:63], v[88:91]
    v_rcp_f16 v42, v21
    v_rcp_f16_sdwa v41, v20 dst_sel:DWORD dst_unused:UNUSED_PAD src0_sel:WORD_1
    v_rcp_f16_sdwa v43, v21 dst_sel:DWORD dst_unused:UNUSED_PAD src0_sel:WORD_1
    v_mfma_f32_16x16x32_bf16 v[88:91], v[152:155], v[64:67], v[88:91]
    v_fma_mix_f32 v40, v108, v40, 0 op_sel_hi:[0,1,0]
    v_fma_mix_f32 v42, v110, v42, 0 op_sel_hi:[0,1,0]
    v_mfma_f32_16x16x32_bf16 v[88:91], v[156:159], v[68:71], v[88:91]
    v_fma_mix_f32 v41, v109, v41, 0 op_sel_hi:[0,1,0]
    v_fma_mix_f32 v43, v111, v43, 0 op_sel_hi:[0,1,0]
    v_mfma_f32_16x16x32_bf16 v[92:95], v[204:207], v[68:71], v[92:95]
    v_fmac_f32 v9, v40, v40
    v_fmac_f32 v9, v41, v41
    v_fmac_f32 v9, v42, v42
    v_mfma_f32_16x16x32_bf16 v[92:95], v[200:203], v[64:67], v[92:95]
    v_fmac_f32 v9, v43, v43
    v_cvt_pk_bf16_f32 v54, v40, v41
    v_mfma_f32_16x16x32_bf16 v[96:99], v[248:251], v[64:67], v[96:99]
    v_cvt_pk_bf16_f32 v55, v42, v43
    v_permlane16_swap_b32 v8, v9
    v_mfma_f32_16x16x32_bf16 v[96:99], v[252:255], v[68:71], v[96:99]
    buffer_store_dwordx4 v[52:55], v4, s[16:19], s7 offen offset:2048 nt
    v_add_f32 v9, v8, v9
    s_waitcnt lgkmcnt(0)
    v_mfma_f32_16x16x32_bf16 v[100:103], v[112:115], v[72:75], 0
    ds_read_b128 v[56:59], v23 offset:16384
    v_cvt_pk_f16_f32 v16, v88, v89
    v_cvt_pk_f16_f32 v17, v90, v91
    v_pk_fma_f16 v32, v16, v16, s25 neg_lo:[1,0,0] neg_hi:[1,0,0]
    v_mfma_f32_16x16x32_bf16 v[100:103], v[116:119], v[76:79], v[100:103]
    ds_read_b128 v[60:63], v23 offset:17408
    v_pk_fma_f16 v34, v17, v17, s25 neg_lo:[1,0,0] neg_hi:[1,0,0]
    v_pk_mul_f16 v32, v16, v32
    v_mfma_f32_16x16x32_bf16 v[104:107], v[164:167], v[76:79], 0
    ds_read_b128 v[64:67], v23 offset:18432
    v_pk_mul_f16 v34, v17, v34
    v_exp_f16 v16, v32
    v_mfma_f32_16x16x32_bf16 v[104:107], v[160:163], v[72:75], v[104:107]
    ds_read_b128 v[68:71], v23 offset:19456
    v_exp_f16 v17, v34
    v_exp_f16_sdwa v16, v32 dst_sel:WORD_1 dst_unused:UNUSED_PRESERVE src0_sel:WORD_1
    v_mfma_f32_16x16x32_bf16 v[108:111], v[208:211], v[72:75], 0
    ds_write_b32 v3, v9 offset:2048
    v_exp_f16_sdwa v17, v34 dst_sel:WORD_1 dst_unused:UNUSED_PRESERVE src0_sel:WORD_1
    v_pk_add_f16 v16, v16, 1.0 op_sel_hi:[1,0]
    v_mfma_f32_16x16x32_bf16 v[108:111], v[212:215], v[76:79], v[108:111]
    v_pk_add_f16 v17, v17, 1.0 op_sel_hi:[1,0]
    v_rcp_f16 v32, v16
    v_mfma_f32_16x16x32_bf16 v[108:111], v[216:219], v[80:83], v[108:111]
    v_rcp_f16 v34, v17
    v_rcp_f16_sdwa v33, v16 dst_sel:DWORD dst_unused:UNUSED_PAD src0_sel:WORD_1
    v_rcp_f16_sdwa v35, v17 dst_sel:DWORD dst_unused:UNUSED_PAD src0_sel:WORD_1
    v_mfma_f32_16x16x32_bf16 v[108:111], v[220:223], v[84:87], v[108:111]
    v_fma_mix_f32 v32, v88, v32, 0 op_sel_hi:[0,1,0]
    v_fma_mix_f32 v34, v90, v34, 0 op_sel_hi:[0,1,0]
    v_mfma_f32_16x16x32_bf16 v[104:107], v[172:175], v[84:87], v[104:107]
    v_fma_mix_f32 v33, v89, v33, 0 op_sel_hi:[0,1,0]
    v_fma_mix_f32 v35, v91, v35, 0 op_sel_hi:[0,1,0]
    v_mfma_f32_16x16x32_bf16 v[104:107], v[168:171], v[80:83], v[104:107]
    v_mul_f32 v8, v32, v32
    v_fmac_f32 v8, v33, v33
    v_mfma_f32_16x16x32_bf16 v[100:103], v[120:123], v[80:83], v[100:103]
    v_fmac_f32 v8, v34, v34
    v_fmac_f32 v8, v35, v35
    v_mfma_f32_16x16x32_bf16 v[100:103], v[124:127], v[84:87], v[100:103]
    v_cvt_pk_bf16_f32 v44, v32, v33
    v_cvt_pk_bf16_f32 v45, v34, v35
    s_waitcnt lgkmcnt(0)
    v_mfma_f32_16x16x32_bf16 v[100:103], v[128:131], v[56:59], v[100:103]
    ds_read_b128 v[72:75], v23 offset:20480
    v_cvt_pk_f16_f32 v18, v92, v93
    v_cvt_pk_f16_f32 v19, v94, v95
    v_pk_fma_f16 v36, v18, v18, s25 neg_lo:[1,0,0] neg_hi:[1,0,0]
    v_mfma_f32_16x16x32_bf16 v[100:103], v[132:135], v[60:63], v[100:103]
    ds_read_b128 v[76:79], v23 offset:21504
    v_pk_fma_f16 v38, v19, v19, s25 neg_lo:[1,0,0] neg_hi:[1,0,0]
    v_pk_mul_f16 v36, v18, v36
    v_mfma_f32_16x16x32_bf16 v[104:107], v[180:183], v[60:63], v[104:107]
    ds_read_b128 v[80:83], v23 offset:22528
    v_pk_mul_f16 v38, v19, v38
    v_exp_f16 v18, v36
    v_mfma_f32_16x16x32_bf16 v[104:107], v[176:179], v[56:59], v[104:107]
    ds_read_b128 v[84:87], v23 offset:23552
    v_exp_f16 v19, v38
    v_exp_f16_sdwa v18, v36 dst_sel:WORD_1 dst_unused:UNUSED_PRESERVE src0_sel:WORD_1
    v_mfma_f32_16x16x32_bf16 v[108:111], v[224:227], v[56:59], v[108:111]
    v_exp_f16_sdwa v19, v38 dst_sel:WORD_1 dst_unused:UNUSED_PRESERVE src0_sel:WORD_1
    v_pk_add_f16 v18, v18, 1.0 op_sel_hi:[1,0]
    v_mfma_f32_16x16x32_bf16 v[108:111], v[228:231], v[60:63], v[108:111]
    v_pk_add_f16 v19, v19, 1.0 op_sel_hi:[1,0]
    v_rcp_f16 v36, v18
    v_mfma_f32_16x16x32_bf16 v[108:111], v[232:235], v[64:67], v[108:111]
    v_rcp_f16 v38, v19
    v_rcp_f16_sdwa v37, v18 dst_sel:DWORD dst_unused:UNUSED_PAD src0_sel:WORD_1
    v_rcp_f16_sdwa v39, v19 dst_sel:DWORD dst_unused:UNUSED_PAD src0_sel:WORD_1
    v_mfma_f32_16x16x32_bf16 v[108:111], v[236:239], v[68:71], v[108:111]
    v_fma_mix_f32 v36, v92, v36, 0 op_sel_hi:[0,1,0]
    v_fma_mix_f32 v38, v94, v38, 0 op_sel_hi:[0,1,0]
    v_mfma_f32_16x16x32_bf16 v[104:107], v[188:191], v[68:71], v[104:107]
    s_sub_u32 s33, s33, 1
    v_fma_mix_f32 v37, v93, v37, 0 op_sel_hi:[0,1,0]
    v_fma_mix_f32 v39, v95, v39, 0 op_sel_hi:[0,1,0]
    v_mfma_f32_16x16x32_bf16 v[104:107], v[184:187], v[64:67], v[104:107]
    v_fmac_f32 v8, v36, v36
    v_fmac_f32 v8, v37, v37
    v_mfma_f32_16x16x32_bf16 v[100:103], v[136:139], v[64:67], v[100:103]
    v_fmac_f32 v8, v38, v38
    v_fmac_f32 v8, v39, v39
    v_mfma_f32_16x16x32_bf16 v[100:103], v[140:143], v[68:71], v[100:103]
    v_cvt_pk_bf16_f32 v48, v36, v37
    v_cvt_pk_bf16_f32 v49, v38, v39
    s_waitcnt vmcnt(3) lgkmcnt(0)
    s_barrier
    v_mfma_f32_16x16x32_bf16 v[108:111], v[240:243], v[72:75], v[108:111]
    ds_read_b128 v[56:59], v22 offset:0
    v_cvt_pk_f16_f32 v20, v96, v97
    v_cvt_pk_f16_f32 v21, v98, v99
    v_pk_fma_f16 v40, v20, v20, s25 neg_lo:[1,0,0] neg_hi:[1,0,0]
    v_mfma_f32_16x16x32_bf16 v[108:111], v[244:247], v[76:79], v[108:111]
    ds_read_b128 v[60:63], v22 offset:1024
    v_pk_fma_f16 v42, v21, v21, s25 neg_lo:[1,0,0] neg_hi:[1,0,0]
    v_pk_mul_f16 v40, v20, v40
    v_mfma_f32_16x16x32_bf16 v[104:107], v[196:199], v[76:79], v[104:107]
    ds_read_b128 v[64:67], v22 offset:2048
    v_pk_mul_f16 v42, v21, v42
    v_exp_f16 v20, v40
    v_mfma_f32_16x16x32_bf16 v[104:107], v[192:195], v[72:75], v[104:107]
    ds_read_b128 v[68:71], v22 offset:3072
    v_exp_f16 v21, v42
    v_exp_f16_sdwa v20, v40 dst_sel:WORD_1 dst_unused:UNUSED_PRESERVE src0_sel:WORD_1
    v_mfma_f32_16x16x32_bf16 v[100:103], v[144:147], v[72:75], v[100:103]
    s_add_u32 m0, s47, 49152
    v_exp_f16_sdwa v21, v42 dst_sel:WORD_1 dst_unused:UNUSED_PRESERVE src0_sel:WORD_1
    v_pk_add_f16 v20, v20, 1.0 op_sel_hi:[1,0]
    v_mfma_f32_16x16x32_bf16 v[100:103], v[148:151], v[76:79], v[100:103]
    buffer_load_dwordx4 v1, s[12:15], s6 offen offset:0 lds
    v_pk_add_f16 v21, v21, 1.0 op_sel_hi:[1,0]
    v_rcp_f16 v40, v20
    v_mfma_f32_16x16x32_bf16 v[100:103], v[152:155], v[80:83], v[100:103]
    v_rcp_f16 v42, v21
    v_rcp_f16_sdwa v41, v20 dst_sel:DWORD dst_unused:UNUSED_PAD src0_sel:WORD_1
    v_rcp_f16_sdwa v43, v21 dst_sel:DWORD dst_unused:UNUSED_PAD src0_sel:WORD_1
    v_mfma_f32_16x16x32_bf16 v[100:103], v[156:159], v[84:87], v[100:103]
    buffer_load_dwordx4 v1, s[12:15], s6 offen offset:1024 lds
    v_fma_mix_f32 v40, v96, v40, 0 op_sel_hi:[0,1,0]
    v_fma_mix_f32 v42, v98, v42, 0 op_sel_hi:[0,1,0]
    v_mfma_f32_16x16x32_bf16 v[104:107], v[204:207], v[84:87], v[104:107]
    v_fma_mix_f32 v41, v97, v41, 0 op_sel_hi:[0,1,0]
    v_fma_mix_f32 v43, v99, v43, 0 op_sel_hi:[0,1,0]
    v_mfma_f32_16x16x32_bf16 v[104:107], v[200:203], v[80:83], v[104:107]
    buffer_load_dwordx4 v1, s[12:15], s6 offen offset:2048 lds
    v_fmac_f32 v8, v40, v40
    v_fmac_f32 v8, v41, v41
    v_mfma_f32_16x16x32_bf16 v[108:111], v[248:251], v[80:83], v[108:111]
    s_add_u32 s6, s6, 24576
    v_fmac_f32 v8, v42, v42
    v_fmac_f32 v8, v43, v43
    v_mfma_f32_16x16x32_bf16 v[108:111], v[252:255], v[84:87], v[108:111]
    v_cvt_pk_bf16_f32 v52, v40, v41
    v_cvt_pk_bf16_f32 v53, v42, v43
    s_cmp_lg_u32 s33, 0
    s_cbranch_scc1 L_k1_dloop
    s_add_u32 m0, s47, 73728
    s_nop 0
    buffer_load_dwordx4 v1, s[12:15], s6 offen offset:0 lds
    s_sub_u32 s50, s50, s57
    s_add_u32 s24, s24, 4
    s_cmp_eq_u32 s48, 0
    s_cbranch_scc1 L_k1_tail
    s_add_u32 s7, s7, 24576
    s_mov_b32 s33, 2
    s_mov_b32 s5, 1
    s_waitcnt lgkmcnt(0)
    ds_read_b128 v[56:59], v1 offset:0
    ds_read_b128 v[60:63], v1 offset:1024
    ds_read_b128 v[64:67], v1 offset:2048
    ds_read_b128 v[68:71], v1 offset:3072
    s_branch L_k1_loop
L_k1_pf:
    s_mul_i32 s26, s35, 147456
    s_add_u32 s26, s26, s40
    s_sub_u32 s43, 1, s33
    s_mul_i32 s27, s43, 73728
    s_add_u32 s27, s27, s26
    s_mul_i32 s43, s43, 4096
    s_add_u32 s43, s43, s4
    s_add_u32 m0, s43, 0
    s_nop 0
    buffer_load_dwordx4 v5, s[8:11], s27 offen offset:0 lds
    s_add_u32 m0, s43, 3840
    s_nop 0
    buffer_load_dwordx4 v5, s[8:11], s27 offen offset:256 lds
    s_add_u32 m0, s43, 7680
    s_nop 0
    buffer_load_dwordx4 v5, s[8:11], s27 offen offset:512 lds
    s_add_u32 s27, s27, 18432
    s_add_u32 m0, s43, 1024
    s_nop 0
    buffer_load_dwordx4 v5, s[8:11], s27 offen offset:0 lds
    s_add_u32 m0, s43, 4864
    s_nop 0
    buffer_load_dwordx4 v5, s[8:11], s27 offen offset:256 lds
    s_add_u32 m0, s43, 8704
    s_nop 0
    buffer_load_dwordx4 v5, s[8:11], s27 offen offset:512 lds
    s_add_u32 s27, s27, 18432
    s_add_u32 m0, s43, 2048
    s_nop 0
    buffer_load_dwordx4 v5, s[8:11], s27 offen offset:0 lds
    s_add_u32 m0, s43, 5888
    s_nop 0
    buffer_load_dwordx4 v5, s[8:11], s27 offen offset:256 lds
    s_add_u32 m0, s43, 9728
    s_nop 0
    buffer_load_dwordx4 v5, s[8:11], s27 offen offset:512 lds
    s_add_u32 s27, s27, 18432
    s_add_u32 m0, s43, 3072
    s_nop 0
    buffer_load_dwordx4 v5, s[8:11], s27 offen offset:0 lds
    s_add_u32 m0, s43, 6912
    s_nop 0
    buffer_load_dwordx4 v5, s[8:11], s27 offen offset:256 lds
    s_add_u32 m0, s43, 10752
    s_nop 0
    buffer_load_dwordx4 v5, s[8:11], s27 offen offset:512 lds
    s_add_u32 m0, s47, 73728
    s_branch L_k1_mid2
.p2align 6
L_k1_loop:
    s_waitcnt lgkmcnt(0)
    v_mfma_f32_16x16x32_bf16 v[88:91], v[112:115], v[56:59], 0
    ds_read_b128 v[72:75], v1 offset:4096
    v_cvt_pk_f16_f32 v16, v100, v101
    v_cvt_pk_f16_f32 v17, v102, v103
    v_pk_fma_f16 v32, v16, v16, s25 neg_lo:[1,0,0] neg_hi:[1,0,0]
    v_mfma_f32_16x16x32_bf16 v[88:91], v[116:119], v[60:63], v[88:91]
    ds_read_b128 v[76:79], v1 offset:5120
    v_pk_fma_f16 v34, v17, v17, s25 neg_lo:[1,0,0] neg_hi:[1,0,0]
    v_pk_mul_f16 v32, v16, v32
    v_mfma_f32_16x16x32_bf16 v[92:95], v[164:167], v[60:63], 0
    ds_read_b128 v[80:83], v1 offset:6144
    v_pk_mul_f16 v34, v17, v34
    v_exp_f16 v16, v32
    v_mfma_f32_16x16x32_bf16 v[92:95], v[160:163], v[56:59], v[92:95]
    ds_read_b128 v[84:87], v1 offset:7168
    v_exp_f16 v17, v34
    v_exp_f16_sdwa v16, v32 dst_sel:WORD_1 dst_unused:UNUSED_PRESERVE src0_sel:WORD_1
    v_exp_f16_sdwa v17, v34 dst_sel:WORD_1 dst_unused:UNUSED_PRESERVE src0_sel:WORD_1
    v_mfma_f32_16x16x32_bf16 v[96:99], v[208:211], v[56:59], 0
    v_pk_add_f16 v16, v16, 1.0 op_sel_hi:[1,0]
    v_pk_add_f16 v17, v17, 1.0 op_sel_hi:[1,0]
    v_mfma_f32_16x16x32_bf16 v[96:99], v[212:215], v[60:63], v[96:99]
    v_rcp_f16 v32, v16
    v_rcp_f16 v34, v17
    v_mfma_f32_16x16x32_bf16 v[96:99], v[216:219], v[64:67], v[96:99]
    v_rcp_f16_sdwa v33, v16 dst_sel:DWORD dst_unused:UNUSED_PAD src0_sel:WORD_1
    v_rcp_f16_sdwa v35, v17 dst_sel:DWORD dst_unused:UNUSED_PAD src0_sel:WORD_1
    v_fma_mix_f32 v32, v100, v32, 0 op_sel_hi:[0,1,0]
    v_mfma_f32_16x16x32_bf16 v[96:99], v[220:223], v[68:71], v[96:99]
    v_fma_mix_f32 v34, v102, v34, 0 op_sel_hi:[0,1,0]
    v_fma_mix_f32 v33, v101, v33, 0 op_sel_hi:[0,1,0]
    v_mfma_f32_16x16x32_bf16 v[92:95], v[172:175], v[68:71], v[92:95]
    v_fma_mix_f32 v35, v103, v35, 0 op_sel_hi:[0,1,0]
    v_mul_f32 v9, v32, v32
    v_mfma_f32_16x16x32_bf16 v[92:95], v[168:171], v[64:67], v[92:95]
    v_fmac_f32 v9, v33, v33
    v_fmac_f32 v9, v34, v34
    v_fmac_f32 v9, v35, v35
    v_mfma_f32_16x16x32_bf16 v[88:91], v[120:123], v[64:67], v[88:91]
    v_cvt_pk_bf16_f32 v46, v32, v33
    v_cvt_pk_bf16_f32 v47, v34, v35
    v_mfma_f32_16x16x32_bf16 v[88:91], v[124:127], v[68:71], v[88:91]
    buffer_store_dwordx4 v[44:47], v4, s[52:55], s32 offen offset:0
    v_cvt_pk_f16_f32 v18, v104, v105
    s_waitcnt lgkmcnt(0)
    v_mfma_f32_16x16x32_bf16 v[88:91], v[128:131], v[72:75], v[88:91]
    ds_read_b128 v[56:59], v1 offset:8192
    v_cvt_pk_f16_f32 v19, v106, v107
    v_pk_fma_f16 v36, v18, v18, s25 neg_lo:[1,0,0] neg_hi:[1,0,0]
    v_mfma_f32_16x16x32_bf16 v[88:91], v[132:135], v[76:79], v[88:91]
    ds_read_b128 v[60:63], v1 offset:9216
    v_pk_fma_f16 v38, v19, v19, s25 neg_lo:[1,0,0] neg_hi:[1,0,0]
    v_pk_mul_f16 v36, v18, v36
    v_pk_mul_f16 v38, v19, v38
    v_mfma_f32_16x16x32_bf16 v[92:95], v[180:183], v[76:79], v[92:95]
    ds_read_b128 v[64:67], v1 offset:10240
    v_exp_f16 v18, v36
    v_exp_f16 v19, v38
    v_mfma_f32_16x16x32_bf16 v[92:95], v[176:179], v[72:75], v[92:95]
    ds_read_b128 v[68:71], v1 offset:11264
    v_exp_f16_sdwa v18, v36 dst_sel:WORD_1 dst_unused:UNUSED_PRESERVE src0_sel:WORD_1
    v_exp_f16_sdwa v19, v38 dst_sel:WORD_1 dst_unused:UNUSED_PRESERVE src0_sel:WORD_1
    v_mfma_f32_16x16x32_bf16 v[96:99], v[224:227], v[72:75], v[96:99]
    v_pk_add_f16 v18, v18, 1.0 op_sel_hi:[1,0]
    v_pk_add_f16 v19, v19, 1.0 op_sel_hi:[1,0]
    v_rcp_f16 v36, v18
    v_mfma_f32_16x16x32_bf16 v[96:99], v[228:231], v[76:79], v[96:99]
    buffer_load_dwordx4 v1, s[12:15], s6 offen offset:1024 lds
    v_rcp_f16 v38, v19
    v_rcp_f16_sdwa v37, v18 dst_sel:DWORD dst_unused:UNUSED_PAD src0_sel:WORD_1
    v_mfma_f32_16x16x32_bf16 v[96:99], v[232:235], v[80:83], v[96:99]
    v_rcp_f16_sdwa v39, v19 dst_sel:DWORD dst_unused:UNUSED_PAD src0_sel:WORD_1
    v_fma_mix_f32 v36, v104, v36, 0 op_sel_hi:[0,1,0]
    v_mfma_f32_16x16x32_bf16 v[96:99], v[236:239], v[84:87], v[96:99]
    v_fma_mix_f32 v38, v106, v38, 0 op_sel_hi:[0,1,0]
    v_fma_mix_f32 v37, v105, v37, 0 op_sel_hi:[0,1,0]
    v_fma_mix_f32 v39, v107, v39, 0 op_sel_hi:[0,1,0]
    v_mfma_f32_16x16x32_bf16 v[92:95], v[188:191], v[84:87], v[92:95]
    v_fmac_f32 v9, v36, v36
    v_fmac_f32 v9, v37, v37
    v_mfma_f32_16x16x32_bf16 v[92:95], v[184:187], v[80:83], v[92:95]
    v_fmac_f32 v9, v38, v38
    v_fmac_f32 v9, v39, v39
    v_mfma_f32_16x16x32_bf16 v[88:91], v[136:139], v[80:83], v[88:91]
    v_cvt_pk_bf16_f32 v50, v36, v37
    v_cvt_pk_bf16_f32 v51, v38, v39
    buffer_store_dwordx4 v[48:51], v4, s[52:55], s32 offen offset:1024
    v_mfma_f32_16x16x32_bf16 v[88:91], v[140:143], v[84:87], v[88:91]
    v_cvt_pk_f16_f32 v20, v108, v109
    v_cvt_pk_f16_f32 v21, v110, v111
    s_waitcnt lgkmcnt(0)
    v_mfma_f32_16x16x32_bf16 v[96:99], v[240:243], v[56:59], v[96:99]
    ds_read_b128 v[72:75], v1 offset:12288
    v_pk_fma_f16 v40, v20, v20, s25 neg_lo:[1,0,0] neg_hi:[1,0,0]
    v_pk_fma_f16 v42, v21, v21, s25 neg_lo:[1,0,0] neg_hi:[1,0,0]
    v_mfma_f32_16x16x32_bf16 v[96:99], v[244:247], v[60:63], v[96:99]
    ds_read_b128 v[76:79], v1 offset:13312
    v_pk_mul_f16 v40, v20, v40
    v_pk_mul_f16 v42, v21, v42
    v_mfma_f32_16x16x32_bf16 v[92:95], v[196:199], v[60:63], v[92:95]
    ds_read_b128 v[80:83], v1 offset:14336
    v_exp_f16 v20, v40
    v_exp_f16 v21, v42
    v_exp_f16_sdwa v20, v40 dst_sel:WORD_1 dst_unused:UNUSED_PRESERVE src0_sel:WORD_1
    v_mfma_f32_16x16x32_bf16 v[92:95], v[192:195], v[56:59], v[92:95]
    ds_read_b128 v[84:87], v1 offset:15360
    v_exp_f16_sdwa v21, v42 dst_sel:WORD_1 dst_unused:UNUSED_PRESERVE src0_sel:WORD_1
    v_pk_add_f16 v20, v20, 1.0 op_sel_hi:[1,0]
    v_mfma_f32_16x16x32_bf16 v[88:91], v[144:147], v[56:59], v[88:91]
    v_pk_add_f16 v21, v21, 1.0 op_sel_hi:[1,0]
    v_rcp_f16 v40, v20
    v_mfma_f32_16x16x32_bf16 v[88:91], v[148:151], v[60:63], v[88:91]
    v_rcp_f16 v42, v21
    v_rcp_f16_sdwa v41, v20 dst_sel:DWORD dst_unused:UNUSED_PAD src0_sel:WORD_1
    v_rcp_f16_sdwa v43, v21 dst_sel:DWORD dst_unused:UNUSED_PAD src0_sel:WORD_1
    v_mfma_f32_16x16x32_bf16 v[88:91], v[152:155], v[64:67], v[88:91]
    v_fma_mix_f32 v40, v108, v40, 0 op_sel_hi:[0,1,0]
    v_fma_mix_f32 v42, v110, v42, 0 op_sel_hi:[0,1,0]
    v_mfma_f32_16x16x32_bf16 v[88:91], v[156:159], v[68:71], v[88:91]
    v_fma_mix_f32 v41, v109, v41, 0 op_sel_hi:[0,1,0]
    v_fma_mix_f32 v43, v111, v43, 0 op_sel_hi:[0,1,0]
    v_mfma_f32_16x16x32_bf16 v[92:95], v[204:207], v[68:71], v[92:95]
    v_fmac_f32 v9, v40, v40
    v_fmac_f32 v9, v41, v41
    v_fmac_f32 v9, v42, v42
    v_mfma_f32_16x16x32_bf16 v[92:95], v[200:203], v[64:67], v[92:95]
    v_fmac_f32 v9, v43, v43
    v_cvt_pk_bf16_f32 v54, v40, v41
    v_mfma_f32_16x16x32_bf16 v[96:99], v[248:251], v[64:67], v[96:99]
    v_cvt_pk_bf16_f32 v55, v42, v43
    v_permlane16_swap_b32 v8, v9
    v_mfma_f32_16x16x32_bf16 v[96:99], v[252:255], v[68:71], v[96:99]
    buffer_store_dwordx4 v[52:55], v4, s[52:55], s32 offen offset:2048
    v_add_f32 v9, v8, v9
    ds_write_b32 v3, v9 offset:3072
    s_add_u32 s32, s32, 12288
    s_add_u32 s24, s24, 4
    s_cmp_eq_u32 s24, 48
    s_cbranch_scc1 L_k1_evt
L_k1_mid:
    s_cmp_le_u32 s33, s5
    s_cbranch_scc1 L_k1_pf
L_k1_mid2:
    s_waitcnt lgkmcnt(0)
    v_mfma_f32_16x16x32_bf16 v[100:103], v[112:115], v[72:75], 0
    ds_read_b128 v[56:59], v1 offset:16384
    v_cvt_pk_f16_f32 v16, v88, v89
    v_cvt_pk_f16_f32 v17, v90, v91
    v_pk_fma_f16 v32, v16, v16, s25 neg_lo:[1,0,0] neg_hi:[1,0,0]
    v_mfma_f32_16x16x32_bf16 v[100:103], v[116:119], v[76:79], v[100:103]
    ds_read_b128 v[60:63], v1 offset:17408
    v_pk_fma_f16 v34, v17, v17, s25 neg_lo:[1,0,0] neg_hi:[1,0,0]
    v_pk_mul_f16 v32, v16, v32
    v_mfma_f32_16x16x32_bf16 v[104:107], v[164:167], v[76:79], 0
    ds_read_b128 v[64:67], v1 offset:18432
    v_pk_mul_f16 v34, v17, v34
    v_exp_f16 v16, v32
    v_mfma_f32_16x16x32_bf16 v[104:107], v[160:163], v[72:75], v[104:107]
    ds_read_b128 v[68:71], v1 offset:19456
    v_exp_f16 v17, v34
    v_exp_f16_sdwa v16, v32 dst_sel:WORD_1 dst_unused:UNUSED_PRESERVE src0_sel:WORD_1
    v_mfma_f32_16x16x32_bf16 v[108:111], v[208:211], v[72:75], 0
    v_exp_f16_sdwa v17, v34 dst_sel:WORD_1 dst_unused:UNUSED_PRESERVE src0_sel:WORD_1
    v_pk_add_f16 v16, v16, 1.0 op_sel_hi:[1,0]
    v_mfma_f32_16x16x32_bf16 v[108:111], v[212:215], v[76:79], v[108:111]
    buffer_load_dwordx4 v1, s[12:15], s6 offen offset:2048 lds
    v_pk_add_f16 v17, v17, 1.0 op_sel_hi:[1,0]
    v_rcp_f16 v32, v16
    v_mfma_f32_16x16x32_bf16 v[108:111], v[216:219], v[80:83], v[108:111]
    s_add_u32 s6, s6, 24576
    s_cmp_ge_u32 s6, s38
    s_cselect_b32 s6, s47, s6
    v_rcp_f16 v34, v17
    v_rcp_f16_sdwa v33, v16 dst_sel:DWORD dst_unused:UNUSED_PAD src0_sel:WORD_1
    v_rcp_f16_sdwa v35, v17 dst_sel:DWORD dst_unused:UNUSED_PAD src0_sel:WORD_1
    v_mfma_f32_16x16x32_bf16 v[108:111], v[220:223], v[84:87], v[108:111]
    v_fma_mix_f32 v32, v88, v32, 0 op_sel_hi:[0,1,0]
    v_fma_mix_f32 v34, v90, v34, 0 op_sel_hi:[0,1,0]
    v_mfma_f32_16x16x32_bf16 v[104:107], v[172:175], v[84:87], v[104:107]
    v_fma_mix_f32 v33, v89, v33, 0 op_sel_hi:[0,1,0]
    v_fma_mix_f32 v35, v91, v35, 0 op_sel_hi:[0,1,0]
    v_mfma_f32_16x16x32_bf16 v[104:107], v[168:171], v[80:83], v[104:107]
    v_mul_f32 v8, v32, v32
    v_fmac_f32 v8, v33, v33
    v_mfma_f32_16x16x32_bf16 v[100:103], v[120:123], v[80:83], v[100:103]
    v_fmac_f32 v8, v34, v34
    v_fmac_f32 v8, v35, v35
    v_mfma_f32_16x16x32_bf16 v[100:103], v[124:127], v[84:87], v[100:103]
    v_cvt_pk_bf16_f32 v44, v32, v33
    v_cvt_pk_bf16_f32 v45, v34, v35
    s_waitcnt lgkmcnt(0)
    v_mfma_f32_16x16x32_bf16 v[100:103], v[128:131], v[56:59], v[100:103]
    ds_read_b128 v[72:75], v1 offset:20480
    v_cvt_pk_f16_f32 v18, v92, v93
    v_cvt_pk_f16_f32 v19, v94, v95
    v_pk_fma_f16 v36, v18, v18, s25 neg_lo:[1,0,0] neg_hi:[1,0,0]
    v_mfma_f32_16x16x32_bf16 v[100:103], v[132:135], v[60:63], v[100:103]
    ds_read_b128 v[76:79], v1 offset:21504
    v_pk_fma_f16 v38, v19, v19, s25 neg_lo:[1,0,0] neg_hi:[1,0,0]
    v_pk_mul_f16 v36, v18, v36
    v_mfma_f32_16x16x32_bf16 v[104:107], v[180:183], v[60:63], v[104:107]
    ds_read_b128 v[80:83], v1 offset:22528
    v_pk_mul_f16 v38, v19, v38
    v_exp_f16 v18, v36
    v_mfma_f32_16x16x32_bf16 v[104:107], v[176:179], v[56:59], v[104:107]
    ds_read_b128 v[84:87], v1 offset:23552
    v_exp_f16 v19, v38
    v_exp_f16_sdwa v18, v36 dst_sel:WORD_1 dst_unused:UNUSED_PRESERVE src0_sel:WORD_1
    v_mfma_f32_16x16x32_bf16 v[108:111], v[224:227], v[56:59], v[108:111]
    v_exp_f16_sdwa v19, v38 dst_sel:WORD_1 dst_unused:UNUSED_PRESERVE src0_sel:WORD_1
    v_pk_add_f16 v18, v18, 1.0 op_sel_hi:[1,0]
    v_mfma_f32_16x16x32_bf16 v[108:111], v[228:231], v[60:63], v[108:111]
    v_xor_b32 v3, 0x1000, v3
    v_pk_add_f16 v19, v19, 1.0 op_sel_hi:[1,0]
    v_rcp_f16 v36, v18
    v_mfma_f32_16x16x32_bf16 v[108:111], v[232:235], v[64:67], v[108:111]
    v_xor_b32 v6, 0x1000, v6
    v_rcp_f16 v38, v19
    v_rcp_f16_sdwa v37, v18 dst_sel:DWORD dst_unused:UNUSED_PAD src0_sel:WORD_1
    v_rcp_f16_sdwa v39, v19 dst_sel:DWORD dst_unused:UNUSED_PAD src0_sel:WORD_1
    v_mfma_f32_16x16x32_bf16 v[108:111], v[236:239], v[68:71], v[108:111]
    v_fma_mix_f32 v36, v92, v36, 0 op_sel_hi:[0,1,0]
    v_fma_mix_f32 v38, v94, v38, 0 op_sel_hi:[0,1,0]
    v_mfma_f32_16x16x32_bf16 v[104:107], v[188:191], v[68:71], v[104:107]
    s_mov_b32 s44, s45
    s_lshl_b32 s45, s24, 7
    s_add_u32 s45, s45, s50
    v_fma_mix_f32 v37, v93, v37, 0 op_sel_hi:[0,1,0]
    v_fma_mix_f32 v39, v95, v39, 0 op_sel_hi:[0,1,0]
    v_mfma_f32_16x16x32_bf16 v[104:107], v[184:187], v[64:67], v[104:107]
    v_fmac_f32 v8, v36, v36
    v_fmac_f32 v8, v37, v37
    v_mfma_f32_16x16x32_bf16 v[100:103], v[136:139], v[64:67], v[100:103]
    v_fmac_f32 v8, v38, v38
    v_fmac_f32 v8, v39, v39
    v_mfma_f32_16x16x32_bf16 v[100:103], v[140:143], v[68:71], v[100:103]
    v_cvt_pk_bf16_f32 v48, v36, v37
    v_cvt_pk_bf16_f32 v49, v38, v39
    s_waitcnt vmcnt(12) lgkmcnt(0)
    s_barrier
    v_mfma_f32_16x16x32_bf16 v[108:111], v[240:243], v[72:75], v[108:111]
    ds_read_b128 v[56:59], v1 offset:24576
    v_cvt_pk_f16_f32 v20, v96, v97
    v_cvt_pk_f16_f32 v21, v98, v99
    v_pk_fma_f16 v40, v20, v20, s25 neg_lo:[1,0,0] neg_hi:[1,0,0]
    v_mfma_f32_16x16x32_bf16 v[108:111], v[244:247], v[76:79], v[108:111]
    ds_read_b128 v[60:63], v1 offset:25600
    v_pk_fma_f16 v42, v21, v21, s25 neg_lo:[1,0,0] neg_hi:[1,0,0]
    v_pk_mul_f16 v40, v20, v40
    v_mfma_f32_16x16x32_bf16 v[104:107], v[196:199], v[76:79], v[104:107]
    ds_read_b128 v[64:67], v1 offset:26624
    v_pk_mul_f16 v42, v21, v42
    v_exp_f16 v20, v40
    v_mfma_f32_16x16x32_bf16 v[104:107], v[192:195], v[72:75], v[104:107]
    ds_read_b128 v[68:71], v1 offset:27648
    v_exp_f16 v21, v42
    v_exp_f16_sdwa v20, v40 dst_sel:WORD_1 dst_unused:UNUSED_PRESERVE src0_sel:WORD_1
    v_mfma_f32_16x16x32_bf16 v[100:103], v[144:147], v[72:75], v[100:103]
    s_add_u32 m0, s47, 0
    v_exp_f16_sdwa v21, v42 dst_sel:WORD_1 dst_unused:UNUSED_PRESERVE src0_sel:WORD_1
    v_pk_add_f16 v20, v20, 1.0 op_sel_hi:[1,0]
    v_mfma_f32_16x16x32_bf16 v[100:103], v[148:151], v[76:79], v[100:103]
    buffer_load_dwordx4 v1, s[12:15], s6 offen offset:0 lds
    v_pk_add_f16 v21, v21, 1.0 op_sel_hi:[1,0]
    v_rcp_f16 v40, v20
    v_mfma_f32_16x16x32_bf16 v[100:103], v[152:155], v[80:83], v[100:103]
    v_rcp_f16 v42, v21
    v_rcp_f16_sdwa v41, v20 dst_sel:DWORD dst_unused:UNUSED_PAD src0_sel:WORD_1
    v_rcp_f16_sdwa v43, v21 dst_sel:DWORD dst_unused:UNUSED_PAD src0_sel:WORD_1
    v_mfma_f32_16x16x32_bf16 v[100:103], v[156:159], v[84:87], v[100:103]
    v_fma_mix_f32 v40, v96, v40, 0 op_sel_hi:[0,1,0]
    v_fma_mix_f32 v42, v98, v42, 0 op_sel_hi:[0,1,0]
    v_mfma_f32_16x16x32_bf16 v[104:107], v[204:207], v[84:87], v[104:107]
    v_fma_mix_f32 v41, v97, v41, 0 op_sel_hi:[0,1,0]
    v_fma_mix_f32 v43, v99, v43, 0 op_sel_hi:[0,1,0]
    v_mfma_f32_16x16x32_bf16 v[104:107], v[200:203], v[80:83], v[104:107]
    v_fmac_f32 v8, v40, v40
    v_fmac_f32 v8, v41, v41
    v_mfma_f32_16x16x32_bf16 v[108:111], v[248:251], v[80:83], v[108:111]
    v_fmac_f32 v8, v42, v42
    v_fmac_f32 v8, v43, v43
    v_mfma_f32_16x16x32_bf16 v[108:111], v[252:255], v[84:87], v[108:111]
    v_cvt_pk_bf16_f32 v52, v40, v41
    v_cvt_pk_bf16_f32 v53, v42, v43
    s_waitcnt lgkmcnt(0)
    v_mfma_f32_16x16x32_bf16 v[88:91], v[112:115], v[56:59], 0
    ds_read_b128 v[72:75], v1 offset:28672
    v_cvt_pk_f16_f32 v16, v100, v101
    v_cvt_pk_f16_f32 v17, v102, v103
    v_pk_fma_f16 v32, v16, v16, s25 neg_lo:[1,0,0] neg_hi:[1,0,0]
    v_mfma_f32_16x16x32_bf16 v[88:91], v[116:119], v[60:63], v[88:91]
    ds_read_b128 v[76:79], v1 offset:29696
    v_pk_fma_f16 v34, v17, v17, s25 neg_lo:[1,0,0] neg_hi:[1,0,0]
    v_pk_mul_f16 v32, v16, v32
    v_mfma_f32_16x16x32_bf16 v[92:95], v[164:167], v[60:63], 0
    ds_read_b128 v[80:83], v1 offset:30720
    v_pk_mul_f16 v34, v17, v34
    v_exp_f16 v16, v32
    v_mfma_f32_16x16x32_bf16 v[92:95], v[160:163], v[56:59], v[92:95]
    ds_read_b128 v[84:87], v1 offset:31744
    v_exp_f16 v17, v34
    v_exp_f16_sdwa v16, v32 dst_sel:WORD_1 dst_unused:UNUSED_PRESERVE src0_sel:WORD_1
    v_exp_f16_sdwa v17, v34 dst_sel:WORD_1 dst_unused:UNUSED_PRESERVE src0_sel:WORD_1
    v_mfma_f32_16x16x32_bf16 v[96:99], v[208:211], v[56:59], 0
    v_pk_add_f16 v16, v16, 1.0 op_sel_hi:[1,0]
    v_pk_add_f16 v17, v17, 1.0 op_sel_hi:[1,0]
    v_mfma_f32_16x16x32_bf16 v[96:99], v[212:215], v[60:63], v[96:99]
    ds_read_b32 v12, v6 offset:0
    v_rcp_f16 v32, v16
    v_rcp_f16 v34, v17
    v_mfma_f32_16x16x32_bf16 v[96:99], v[216:219], v[64:67], v[96:99]
    ds_read_b32 v13, v6 offset:256
    v_rcp_f16_sdwa v33, v16 dst_sel:DWORD dst_unused:UNUSED_PAD src0_sel:WORD_1
    v_rcp_f16_sdwa v35, v17 dst_sel:DWORD dst_unused:UNUSED_PAD src0_sel:WORD_1
    v_fma_mix_f32 v32, v100, v32, 0 op_sel_hi:[0,1,0]
    v_mfma_f32_16x16x32_bf16 v[96:99], v[220:223], v[68:71], v[96:99]
    ds_read_b32 v14, v6 offset:512
    v_fma_mix_f32 v34, v102, v34, 0 op_sel_hi:[0,1,0]
    v_fma_mix_f32 v33, v101, v33, 0 op_sel_hi:[0,1,0]
    v_mfma_f32_16x16x32_bf16 v[92:95], v[172:175], v[68:71], v[92:95]
    ds_read_b32 v15, v6 offset:768
    v_fma_mix_f32 v35, v103, v35, 0 op_sel_hi:[0,1,0]
    v_mul_f32 v9, v32, v32
    v_mfma_f32_16x16x32_bf16 v[92:95], v[168:171], v[64:67], v[92:95]
    v_fmac_f32 v9, v33, v33
    v_fmac_f32 v9, v34, v34
    v_fmac_f32 v9, v35, v35
    v_mfma_f32_16x16x32_bf16 v[88:91], v[120:123], v[64:67], v[88:91]
    v_cvt_pk_bf16_f32 v46, v32, v33
    v_cvt_pk_bf16_f32 v47, v34, v35
    v_mfma_f32_16x16x32_bf16 v[88:91], v[124:127], v[68:71], v[88:91]
    buffer_store_dwordx4 v[44:47], v4, s[16:19], s7 offen offset:0 nt
    v_cvt_pk_f16_f32 v18, v104, v105
    s_waitcnt lgkmcnt(0)
    v_mfma_f32_16x16x32_bf16 v[88:91], v[128:131], v[72:75], v[88:91]
    ds_read_b128 v[56:59], v1 offset:32768
    v_cvt_pk_f16_f32 v19, v106, v107
    v_pk_fma_f16 v36, v18, v18, s25 neg_lo:[1,0,0] neg_hi:[1,0,0]
    v_mfma_f32_16x16x32_bf16 v[88:91], v[132:135], v[76:79], v[88:91]
    ds_read_b128 v[60:63], v1 offset:33792
    v_add_f32 v12, v12, v13
    v_pk_fma_f16 v38, v19, v19, s25 neg_lo:[1,0,0] neg_hi:[1,0,0]
    v_pk_mul_f16 v36, v18, v36
    v_pk_mul_f16 v38, v19, v38
    v_mfma_f32_16x16x32_bf16 v[92:95], v[180:183], v[76:79], v[92:95]
    ds_read_b128 v[64:67], v1 offset:34816
    v_add_f32 v14, v14, v15
    v_exp_f16 v18, v36
    v_exp_f16 v19, v38
    v_mfma_f32_16x16x32_bf16 v[92:95], v[176:179], v[72:75], v[92:95]
    ds_read_b128 v[68:71], v1 offset:35840
    v_exp_f16_sdwa v18, v36 dst_sel:WORD_1 dst_unused:UNUSED_PRESERVE src0_sel:WORD_1
    v_exp_f16_sdwa v19, v38 dst_sel:WORD_1 dst_unused:UNUSED_PRESERVE src0_sel:WORD_1
    v_mfma_f32_16x16x32_bf16 v[96:99], v[224:227], v[72:75], v[96:99]
    v_pk_add_f16 v18, v18, 1.0 op_sel_hi:[1,0]
    v_pk_add_f16 v19, v19, 1.0 op_sel_hi:[1,0]
    v_rcp_f16 v36, v18
    v_mfma_f32_16x16x32_bf16 v[96:99], v[228:231], v[76:79], v[96:99]
    buffer_load_dwordx4 v1, s[12:15], s6 offen offset:1024 lds
    v_rcp_f16 v38, v19
    v_rcp_f16_sdwa v37, v18 dst_sel:DWORD dst_unused:UNUSED_PAD src0_sel:WORD_1
    v_mfma_f32_16x16x32_bf16 v[96:99], v[232:235], v[80:83], v[96:99]
    v_rcp_f16_sdwa v39, v19 dst_sel:DWORD dst_unused:UNUSED_PAD src0_sel:WORD_1
    v_fma_mix_f32 v36, v104, v36, 0 op_sel_hi:[0,1,0]
    v_mfma_f32_16x16x32_bf16 v[96:99], v[236:239], v[84:87], v[96:99]
    v_fma_mix_f32 v38, v106, v38, 0 op_sel_hi:[0,1,0]
    v_fma_mix_f32 v37, v105, v37, 0 op_sel_hi:[0,1,0]
    v_fma_mix_f32 v39, v107, v39, 0 op_sel_hi:[0,1,0]
    v_mfma_f32_16x16x32_bf16 v[92:95], v[188:191], v[84:87], v[92:95]
    v_add_f32 v12, v12, v14
    v_fmac_f32 v9, v36, v36
    v_fmac_f32 v9, v37, v37
    v_mfma_f32_16x16x32_bf16 v[92:95], v[184:187], v[80:83], v[92:95]
    v_fmac_f32 v9, v38, v38
    v_fmac_f32 v9, v39, v39
    v_mfma_f32_16x16x32_bf16 v[88:91], v[136:139], v[80:83], v[88:91]
    buffer_atomic_add_f32 v12, v7, s[20:23], s44 offen
    v_cvt_pk_bf16_f32 v50, v36, v37
    v_cvt_pk_bf16_f32 v51, v38, v39
    buffer_store_dwordx4 v[48:51], v4, s[16:19], s7 offen offset:1024 nt
    v_mfma_f32_16x16x32_bf16 v[88:91], v[140:143], v[84:87], v[88:91]
    v_cvt_pk_f16_f32 v20, v108, v109
    v_cvt_pk_f16_f32 v21, v110, v111
    s_waitcnt lgkmcnt(0)
    v_mfma_f32_16x16x32_bf16 v[96:99], v[240:243], v[56:59], v[96:99]
    ds_read_b128 v[72:75], v1 offset:36864
    v_pk_fma_f16 v40, v20, v20, s25 neg_lo:[1,0,0] neg_hi:[1,0,0]
    v_pk_fma_f16 v42, v21, v21, s25 neg_lo:[1,0,0] neg_hi:[1,0,0]
    v_mfma_f32_16x16x32_bf16 v[96:99], v[244:247], v[60:63], v[96:99]
    ds_read_b128 v[76:79], v1 offset:37888
    v_pk_mul_f16 v40, v20, v40
    v_pk_mul_f16 v42, v21, v42
    v_mfma_f32_16x16x32_bf16 v[92:95], v[196:199], v[60:63], v[92:95]
    ds_read_b128 v[80:83], v1 offset:38912
    v_exp_f16 v20, v40
    v_exp_f16 v21, v42
    v_exp_f16_sdwa v20, v40 dst_sel:WORD_1 dst_unused:UNUSED_PRESERVE src0_sel:WORD_1
    v_mfma_f32_16x16x32_bf16 v[92:95], v[192:195], v[56:59], v[92:95]
    ds_read_b128 v[84:87], v1 offset:39936
    v_exp_f16_sdwa v21, v42 dst_sel:WORD_1 dst_unused:UNUSED_PRESERVE src0_sel:WORD_1
    v_pk_add_f16 v20, v20, 1.0 op_sel_hi:[1,0]
    v_mfma_f32_16x16x32_bf16 v[88:91], v[144:147], v[56:59], v[88:91]
    v_pk_add_f16 v21, v21, 1.0 op_sel_hi:[1,0]
    v_rcp_f16 v40, v20
    v_mfma_f32_16x16x32_bf16 v[88:91], v[148:151], v[60:63], v[88:91]
    v_rcp_f16 v42, v21
    v_rcp_f16_sdwa v41, v20 dst_sel:DWORD dst_unused:UNUSED_PAD src0_sel:WORD_1
    v_rcp_f16_sdwa v43, v21 dst_sel:DWORD dst_unused:UNUSED_PAD src0_sel:WORD_1
    v_mfma_f32_16x16x32_bf16 v[88:91], v[152:155], v[64:67], v[88:91]
    v_fma_mix_f32 v40, v108, v40, 0 op_sel_hi:[0,1,0]
    v_fma_mix_f32 v42, v110, v42, 0 op_sel_hi:[0,1,0]
    v_mfma_f32_16x16x32_bf16 v[88:91], v[156:159], v[68:71], v[88:91]
    v_fma_mix_f32 v41, v109, v41, 0 op_sel_hi:[0,1,0]
    v_fma_mix_f32 v43, v111, v43, 0 op_sel_hi:[0,1,0]
    v_mfma_f32_16x16x32_bf16 v[92:95], v[204:207], v[68:71], v[92:95]
    v_fmac_f32 v9, v40, v40
    v_fmac_f32 v9, v41, v41
    v_fmac_f32 v9, v42, v42
    v_mfma_f32_16x16x32_bf16 v[92:95], v[200:203], v[64:67], v[92:95]
    v_fmac_f32 v9, v43, v43
    v_cvt_pk_bf16_f32 v54, v40, v41
    v_mfma_f32_16x16x32_bf16 v[96:99], v[248:251], v[64:67], v[96:99]
    v_cvt_pk_bf16_f32 v55, v42, v43
    v_permlane16_swap_b32 v8, v9
    v_mfma_f32_16x16x32_bf16 v[96:99], v[252:255], v[68:71], v[96:99]
    buffer_store_dwordx4 v[52:55], v4, s[16:19], s7 offen offset:2048 nt
    v_add_f32 v9, v8, v9
    s_waitcnt lgkmcnt(0)
    v_mfma_f32_16x16x32_bf16 v[100:103], v[112:115], v[72:75], 0
    ds_read_b128 v[56:59], v1 offset:40960
    v_cvt_pk_f16_f32 v16, v88, v89
    v_cvt_pk_f16_f32 v17, v90, v91
    v_pk_fma_f16 v32, v16, v16, s25 neg_lo:[1,0,0] neg_hi:[1,0,0]
    v_mfma_f32_16x16x32_bf16 v[100:103], v[116:119], v[76:79], v[100:103]
    ds_read_b128 v[60:63], v1 offset:41984
    v_pk_fma_f16 v34, v17, v17, s25 neg_lo:[1,0,0] neg_hi:[1,0,0]
    v_pk_mul_f16 v32, v16, v32
    v_mfma_f32_16x16x32_bf16 v[104:107], v[164:167], v[76:79], 0
    ds_read_b128 v[64:67], v1 offset:43008
    v_pk_mul_f16 v34, v17, v34
    v_exp_f16 v16, v32
    v_mfma_f32_16x16x32_bf16 v[104:107], v[160:163], v[72:75], v[104:107]
    ds_read_b128 v[68:71], v1 offset:44032
    v_exp_f16 v17, v34
    v_exp_f16_sdwa v16, v32 dst_sel:WORD_1 dst_unused:UNUSED_PRESERVE src0_sel:WORD_1
    v_mfma_f32_16x16x32_bf16 v[108:111], v[208:211], v[72:75], 0
    ds_write_b32 v3, v9 offset:0
    v_exp_f16_sdwa v17, v34 dst_sel:WORD_1 dst_unused:UNUSED_PRESERVE src0_sel:WORD_1
    v_pk_add_f16 v16, v16, 1.0 op_sel_hi:[1,0]
    v_mfma_f32_16x16x32_bf16 v[108:111], v[212:215], v[76:79], v[108:111]
    buffer_load_dwordx4 v1, s[12:15], s6 offen offset:2048 lds
    s_add_u32 s7, s7, 12288
    v_pk_add_f16 v17, v17, 1.0 op_sel_hi:[1,0]
    v_rcp_f16 v32, v16
    v_mfma_f32_16x16x32_bf16 v[108:111], v[216:219], v[80:83], v[108:111]
    s_add_u32 s6, s6, 24576
    v_rcp_f16 v34, v17
    v_rcp_f16_sdwa v33, v16 dst_sel:DWORD dst_unused:UNUSED_PAD src0_sel:WORD_1
    v_rcp_f16_sdwa v35, v17 dst_sel:DWORD dst_unused:UNUSED_PAD src0_sel:WORD_1
    v_mfma_f32_16x16x32_bf16 v[108:111], v[220:223], v[84:87], v[108:111]
    v_fma_mix_f32 v32, v88, v32, 0 op_sel_hi:[0,1,0]
    v_fma_mix_f32 v34, v90, v34, 0 op_sel_hi:[0,1,0]
    v_mfma_f32_16x16x32_bf16 v[104:107], v[172:175], v[84:87], v[104:107]
    v_fma_mix_f32 v33, v89, v33, 0 op_sel_hi:[0,1,0]
    v_fma_mix_f32 v35, v91, v35, 0 op_sel_hi:[0,1,0]
    v_mfma_f32_16x16x32_bf16 v[104:107], v[168:171], v[80:83], v[104:107]
    v_mul_f32 v8, v32, v32
    v_fmac_f32 v8, v33, v33
    v_mfma_f32_16x16x32_bf16 v[100:103], v[120:123], v[80:83], v[100:103]
    v_fmac_f32 v8, v34, v34
    v_fmac_f32 v8, v35, v35
    v_mfma_f32_16x16x32_bf16 v[100:103], v[124:127], v[84:87], v[100:103]
    v_cvt_pk_bf16_f32 v44, v32, v33
    v_cvt_pk_bf16_f32 v45, v34, v35
    s_waitcnt lgkmcnt(0)
    v_mfma_f32_16x16x32_bf16 v[100:103], v[128:131], v[56:59], v[100:103]
    ds_read_b128 v[72:75], v1 offset:45056
    v_cvt_pk_f16_f32 v18, v92, v93
    v_cvt_pk_f16_f32 v19, v94, v95
    v_pk_fma_f16 v36, v18, v18, s25 neg_lo:[1,0,0] neg_hi:[1,0,0]
    v_mfma_f32_16x16x32_bf16 v[100:103], v[132:135], v[60:63], v[100:103]
    ds_read_b128 v[76:79], v1 offset:46080
    v_pk_fma_f16 v38, v19, v19, s25 neg_lo:[1,0,0] neg_hi:[1,0,0]
    v_pk_mul_f16 v36, v18, v36
    v_mfma_f32_16x16x32_bf16 v[104:107], v[180:183], v[60:63], v[104:107]
    ds_read_b128 v[80:83], v1 offset:47104
    v_pk_mul_f16 v38, v19, v38
    v_exp_f16 v18, v36
    v_mfma_f32_16x16x32_bf16 v[104:107], v[176:179], v[56:59], v[104:107]
    ds_read_b128 v[84:87], v1 offset:48128
    v_exp_f16 v19, v38
    v_exp_f16_sdwa v18, v36 dst_sel:WORD_1 dst_unused:UNUSED_PRESERVE src0_sel:WORD_1
    v_mfma_f32_16x16x32_bf16 v[108:111], v[224:227], v[56:59], v[108:111]
    v_exp_f16_sdwa v19, v38 dst_sel:WORD_1 dst_unused:UNUSED_PRESERVE src0_sel:WORD_1
    v_pk_add_f16 v18, v18, 1.0 op_sel_hi:[1,0]
    v_mfma_f32_16x16x32_bf16 v[108:111], v[228:231], v[60:63], v[108:111]
    v_pk_add_f16 v19, v19, 1.0 op_sel_hi:[1,0]
    v_rcp_f16 v36, v18
    v_mfma_f32_16x16x32_bf16 v[108:111], v[232:235], v[64:67], v[108:111]
    v_rcp_f16 v38, v19
    v_rcp_f16_sdwa v37, v18 dst_sel:DWORD dst_unused:UNUSED_PAD src0_sel:WORD_1
    v_rcp_f16_sdwa v39, v19 dst_sel:DWORD dst_unused:UNUSED_PAD src0_sel:WORD_1
    v_mfma_f32_16x16x32_bf16 v[108:111], v[236:239], v[68:71], v[108:111]
    v_fma_mix_f32 v36, v92, v36, 0 op_sel_hi:[0,1,0]
    v_fma_mix_f32 v38, v94, v38, 0 op_sel_hi:[0,1,0]
    v_mfma_f32_16x16x32_bf16 v[104:107], v[188:191], v[68:71], v[104:107]
    v_fma_mix_f32 v37, v93, v37, 0 op_sel_hi:[0,1,0]
    v_fma_mix_f32 v39, v95, v39, 0 op_sel_hi:[0,1,0]
    v_mfma_f32_16x16x32_bf16 v[104:107], v[184:187], v[64:67], v[104:107]
    v_fmac_f32 v8, v36, v36
    v_fmac_f32 v8, v37, v37
    v_mfma_f32_16x16x32_bf16 v[100:103], v[136:139], v[64:67], v[100:103]
    v_fmac_f32 v8, v38, v38
    v_fmac_f32 v8, v39, v39
    v_mfma_f32_16x16x32_bf16 v[100:103], v[140:143], v[68:71], v[100:103]
    v_cvt_pk_bf16_f32 v48, v36, v37
    v_cvt_pk_bf16_f32 v49, v38, v39
    s_waitcnt vmcnt(12) lgkmcnt(0)
    s_barrier
    v_mfma_f32_16x16x32_bf16 v[108:111], v[240:243], v[72:75], v[108:111]
    ds_read_b128 v[56:59], v2 offset:0
    v_cvt_pk_f16_f32 v20, v96, v97
    v_cvt_pk_f16_f32 v21, v98, v99
    v_pk_fma_f16 v40, v20, v20, s25 neg_lo:[1,0,0] neg_hi:[1,0,0]
    v_mfma_f32_16x16x32_bf16 v[108:111], v[244:247], v[76:79], v[108:111]
    ds_read_b128 v[60:63], v2 offset:1024
    v_pk_fma_f16 v42, v21, v21, s25 neg_lo:[1,0,0] neg_hi:[1,0,0]
    v_pk_mul_f16 v40, v20, v40
    v_mfma_f32_16x16x32_bf16 v[104:107], v[196:199], v[76:79], v[104:107]
    ds_read_b128 v[64:67], v2 offset:2048
    v_pk_mul_f16 v42, v21, v42
    v_exp_f16 v20, v40
    v_mfma_f32_16x16x32_bf16 v[104:107], v[192:195], v[72:75], v[104:107]
    ds_read_b128 v[68:71], v2 offset:3072
    v_exp_f16 v21, v42
    v_exp_f16_sdwa v20, v40 dst_sel:WORD_1 dst_unused:UNUSED_PRESERVE src0_sel:WORD_1
    v_mfma_f32_16x16x32_bf16 v[100:103], v[144:147], v[72:75], v[100:103]
    s_add_u32 m0, s47, 24576
    v_exp_f16_sdwa v21, v42 dst_sel:WORD_1 dst_unused:UNUSED_PRESERVE src0_sel:WORD_1
    v_pk_add_f16 v20, v20, 1.0 op_sel_hi:[1,0]
    v_mfma_f32_16x16x32_bf16 v[100:103], v[148:151], v[76:79], v[100:103]
    buffer_load_dwordx4 v1, s[12:15], s6 offen offset:0 lds
    v_pk_add_f16 v21, v21, 1.0 op_sel_hi:[1,0]
    v_rcp_f16 v40, v20
    v_mfma_f32_16x16x32_bf16 v[100:103], v[152:155], v[80:83], v[100:103]
    v_rcp_f16 v42, v21
    v_rcp_f16_sdwa v41, v20 dst_sel:DWORD dst_unused:UNUSED_PAD src0_sel:WORD_1
    v_rcp_f16_sdwa v43, v21 dst_sel:DWORD dst_unused:UNUSED_PAD src0_sel:WORD_1
    v_mfma_f32_16x16x32_bf16 v[100:103], v[156:159], v[84:87], v[100:103]
    v_fma_mix_f32 v40, v96, v40, 0 op_sel_hi:[0,1,0]
    v_fma_mix_f32 v42, v98, v42, 0 op_sel_hi:[0,1,0]
    v_mfma_f32_16x16x32_bf16 v[104:107], v[204:207], v[84:87], v[104:107]
    v_fma_mix_f32 v41, v97, v41, 0 op_sel_hi:[0,1,0]
    v_fma_mix_f32 v43, v99, v43, 0 op_sel_hi:[0,1,0]
    v_mfma_f32_16x16x32_bf16 v[104:107], v[200:203], v[80:83], v[104:107]
    v_fmac_f32 v8, v40, v40
    v_fmac_f32 v8, v41, v41
    v_mfma_f32_16x16x32_bf16 v[108:111], v[248:251], v[80:83], v[108:111]
    v_fmac_f32 v8, v42, v42
    v_fmac_f32 v8, v43, v43
    v_mfma_f32_16x16x32_bf16 v[108:111], v[252:255], v[84:87], v[108:111]
    v_cvt_pk_bf16_f32 v52, v40, v41
    v_cvt_pk_bf16_f32 v53, v42, v43
    s_waitcnt lgkmcnt(0)
    v_mfma_f32_16x16x32_bf16 v[88:91], v[112:115], v[56:59], 0
    ds_read_b128 v[72:75], v2 offset:4096
    v_cvt_pk_f16_f32 v16, v100, v101
    v_cvt_pk_f16_f32 v17, v102, v103
    v_pk_fma_f16 v32, v16, v16, s25 neg_lo:[1,0,0] neg_hi:[1,0,0]
    v_mfma_f32_16x16x32_bf16 v[88:91], v[116:119], v[60:63], v[88:91]
    ds_read_b128 v[76:79], v2 offset:5120
    v_pk_fma_f16 v34, v17, v17, s25 neg_lo:[1,0,0] neg_hi:[1,0,0]
    v_pk_mul_f16 v32, v16, v32
    v_mfma_f32_16x16x32_bf16 v[92:95], v[164:167], v[60:63], 0
    ds_read_b128 v[80:83], v2 offset:6144
    v_pk_mul_f16 v34, v17, v34
    v_exp_f16 v16, v32
    v_mfma_f32_16x16x32_bf16 v[92:95], v[160:163], v[56:59], v[92:95]
    ds_read_b128 v[84:87], v2 offset:7168
    v_exp_f16 v17, v34
    v_exp_f16_sdwa v16, v32 dst_sel:WORD_1 dst_unused:UNUSED_PRESERVE src0_sel:WORD_1
    v_exp_f16_sdwa v17, v34 dst_sel:WORD_1 dst_unused:UNUSED_PRESERVE src0_sel:WORD_1
    v_mfma_f32_16x16x32_bf16 v[96:99], v[208:211], v[56:59], 0
    v_pk_add_f16 v16, v16, 1.0 op_sel_hi:[1,0]
    v_pk_add_f16 v17, v17, 1.0 op_sel_hi:[1,0]
    v_mfma_f32_16x16x32_bf16 v[96:99], v[212:215], v[60:63], v[96:99]
    v_rcp_f16 v32, v16
    v_rcp_f16 v34, v17
    v_mfma_f32_16x16x32_bf16 v[96:99], v[216:219], v[64:67], v[96:99]
    v_rcp_f16_sdwa v33, v16 dst_sel:DWORD dst_unused:UNUSED_PAD src0_sel:WORD_1
    v_rcp_f16_sdwa v35, v17 dst_sel:DWORD dst_unused:UNUSED_PAD src0_sel:WORD_1
    v_fma_mix_f32 v32, v100, v32, 0 op_sel_hi:[0,1,0]
    v_mfma_f32_16x16x32_bf16 v[96:99], v[220:223], v[68:71], v[96:99]
    v_fma_mix_f32 v34, v102, v34, 0 op_sel_hi:[0,1,0]
    v_fma_mix_f32 v33, v101, v33, 0 op_sel_hi:[0,1,0]
    v_mfma_f32_16x16x32_bf16 v[92:95], v[172:175], v[68:71], v[92:95]
    v_fma_mix_f32 v35, v103, v35, 0 op_sel_hi:[0,1,0]
    v_mul_f32 v9, v32, v32
    v_mfma_f32_16x16x32_bf16 v[92:95], v[168:171], v[64:67], v[92:95]
    v_fmac_f32 v9, v33, v33
    v_fmac_f32 v9, v34, v34
    v_fmac_f32 v9, v35, v35
    v_mfma_f32_16x16x32_bf16 v[88:91], v[120:123], v[64:67], v[88:91]
    v_cvt_pk_bf16_f32 v46, v32, v33
    v_cvt_pk_bf16_f32 v47, v34, v35
    v_mfma_f32_16x16x32_bf16 v[88:91], v[124:127], v[68:71], v[88:91]
    buffer_store_dwordx4 v[44:47], v4, s[16:19], s7 offen offset:0 nt
    v_cvt_pk_f16_f32 v18, v104, v105
    s_waitcnt lgkmcnt(0)
    v_mfma_f32_16x16x32_bf16 v[88:91], v[128:131], v[72:75], v[88:91]
    ds_read_b128 v[56:59], v2 offset:8192
    v_cvt_pk_f16_f32 v19, v106, v107
    v_pk_fma_f16 v36, v18, v18, s25 neg_lo:[1,0,0] neg_hi:[1,0,0]
    v_mfma_f32_16x16x32_bf16 v[88:91], v[132:135], v[76:79], v[88:91]
    ds_read_b128 v[60:63], v2 offset:9216
    v_pk_fma_f16 v38, v19, v19, s25 neg_lo:[1,0,0] neg_hi:[1,0,0]
    v_pk_mul_f16 v36, v18, v36
    v_pk_mul_f16 v38, v19, v38
    v_mfma_f32_16x16x32_bf16 v[92:95], v[180:183], v[76:79], v[92:95]
    ds_read_b128 v[64:67], v2 offset:10240
    v_exp_f16 v18, v36
    v_exp_f16 v19, v38
    v_mfma_f32_16x16x32_bf16 v[92:95], v[176:179], v[72:75], v[92:95]
    ds_read_b128 v[68:71], v2 offset:11264
    v_exp_f16_sdwa v18, v36 dst_sel:WORD_1 dst_unused:UNUSED_PRESERVE src0_sel:WORD_1
    v_exp_f16_sdwa v19, v38 dst_sel:WORD_1 dst_unused:UNUSED_PRESERVE src0_sel:WORD_1
    v_mfma_f32_16x16x32_bf16 v[96:99], v[224:227], v[72:75], v[96:99]
    v_pk_add_f16 v18, v18, 1.0 op_sel_hi:[1,0]
    v_pk_add_f16 v19, v19, 1.0 op_sel_hi:[1,0]
    v_rcp_f16 v36, v18
    v_mfma_f32_16x16x32_bf16 v[96:99], v[228:231], v[76:79], v[96:99]
    buffer_load_dwordx4 v1, s[12:15], s6 offen offset:1024 lds
    v_rcp_f16 v38, v19
    v_rcp_f16_sdwa v37, v18 dst_sel:DWORD dst_unused:UNUSED_PAD src0_sel:WORD_1
    v_mfma_f32_16x16x32_bf16 v[96:99], v[232:235], v[80:83], v[96:99]
    v_rcp_f16_sdwa v39, v19 dst_sel:DWORD dst_unused:UNUSED_PAD src0_sel:WORD_1
    v_fma_mix_f32 v36, v104, v36, 0 op_sel_hi:[0,1,0]
    v_mfma_f32_16x16x32_bf16 v[96:99], v[236:239], v[84:87], v[96:99]
    v_fma_mix_f32 v38, v106, v38, 0 op_sel_hi:[0,1,0]
    v_fma_mix_f32 v37, v105, v37, 0 op_sel_hi:[0,1,0]
    v_fma_mix_f32 v39, v107, v39, 0 op_sel_hi:[0,1,0]
    v_mfma_f32_16x16x32_bf16 v[92:95], v[188:191], v[84:87], v[92:95]
    v_fmac_f32 v9, v36, v36
    v_fmac_f32 v9, v37, v37
    v_mfma_f32_16x16x32_bf16 v[92:95], v[184:187], v[80:83], v[92:95]
    v_fmac_f32 v9, v38, v38
    v_fmac_f32 v9, v39, v39
    v_mfma_f32_16x16x32_bf16 v[88:91], v[136:139], v[80:83], v[88:91]
    v_cvt_pk_bf16_f32 v50, v36, v37
    v_cvt_pk_bf16_f32 v51, v38, v39
    buffer_store_dwordx4 v[48:51], v4, s[16:19], s7 offen offset:1024 nt
    v_mfma_f32_16x16x32_bf16 v[88:91], v[140:143], v[84:87], v[88:91]
    v_cvt_pk_f16_f32 v20, v108, v109
    v_cvt_pk_f16_f32 v21, v110, v111
    s_waitcnt lgkmcnt(0)
    v_mfma_f32_16x16x32_bf16 v[96:99], v[240:243], v[56:59], v[96:99]
    ds_read_b128 v[72:75], v2 offset:12288
    v_pk_fma_f16 v40, v20, v20, s25 neg_lo:[1,0,0] neg_hi:[1,0,0]
    v_pk_fma_f16 v42, v21, v21, s25 neg_lo:[1,0,0] neg_hi:[1,0,0]
    v_mfma_f32_16x16x32_bf16 v[96:99], v[244:247], v[60:63], v[96:99]
    ds_read_b128 v[76:79], v2 offset:13312
    v_pk_mul_f16 v40, v20, v40
    v_pk_mul_f16 v42, v21, v42
    v_mfma_f32_16x16x32_bf16 v[92:95], v[196:199], v[60:63], v[92:95]
    ds_read_b128 v[80:83], v2 offset:14336
    v_exp_f16 v20, v40
    v_exp_f16 v21, v42
    v_exp_f16_sdwa v20, v40 dst_sel:WORD_1 dst_unused:UNUSED_PRESERVE src0_sel:WORD_1
    v_mfma_f32_16x16x32_bf16 v[92:95], v[192:195], v[56:59], v[92:95]
    ds_read_b128 v[84:87], v2 offset:15360
    v_exp_f16_sdwa v21, v42 dst_sel:WORD_1 dst_unused:UNUSED_PRESERVE src0_sel:WORD_1
    v_pk_add_f16 v20, v20, 1.0 op_sel_hi:[1,0]
    v_mfma_f32_16x16x32_bf16 v[88:91], v[144:147], v[56:59], v[88:91]
    v_pk_add_f16 v21, v21, 1.0 op_sel_hi:[1,0]
    v_rcp_f16 v40, v20
    v_mfma_f32_16x16x32_bf16 v[88:91], v[148:151], v[60:63], v[88:91]
    v_rcp_f16 v42, v21
    v_rcp_f16_sdwa v41, v20 dst_sel:DWORD dst_unused:UNUSED_PAD src0_sel:WORD_1
    v_rcp_f16_sdwa v43, v21 dst_sel:DWORD dst_unused:UNUSED_PAD src0_sel:WORD_1
    v_mfma_f32_16x16x32_bf16 v[88:91], v[152:155], v[64:67], v[88:91]
    v_fma_mix_f32 v40, v108, v40, 0 op_sel_hi:[0,1,0]
    v_fma_mix_f32 v42, v110, v42, 0 op_sel_hi:[0,1,0]
    v_mfma_f32_16x16x32_bf16 v[88:91], v[156:159], v[68:71], v[88:91]
    v_fma_mix_f32 v41, v109, v41, 0 op_sel_hi:[0,1,0]
    v_fma_mix_f32 v43, v111, v43, 0 op_sel_hi:[0,1,0]
    v_mfma_f32_16x16x32_bf16 v[92:95], v[204:207], v[68:71], v[92:95]
    v_fmac_f32 v9, v40, v40
    v_fmac_f32 v9, v41, v41
    v_fmac_f32 v9, v42, v42
    v_mfma_f32_16x16x32_bf16 v[92:95], v[200:203], v[64:67], v[92:95]
    v_fmac_f32 v9, v43, v43
    v_cvt_pk_bf16_f32 v54, v40, v41
    v_mfma_f32_16x16x32_bf16 v[96:99], v[248:251], v[64:67], v[96:99]
    v_cvt_pk_bf16_f32 v55, v42, v43
    v_permlane16_swap_b32 v8, v9
    v_mfma_f32_16x16x32_bf16 v[96:99], v[252:255], v[68:71], v[96:99]
    buffer_store_dwordx4 v[52:55], v4, s[16:19], s7 offen offset:2048 nt
    v_add_f32 v9, v8, v9
    s_waitcnt lgkmcnt(0)
    v_mfma_f32_16x16x32_bf16 v[100:103], v[112:115], v[72:75], 0
    ds_read_b128 v[56:59], v2 offset:16384
    v_cvt_pk_f16_f32 v16, v88, v89
    v_cvt_pk_f16_f32 v17, v90, v91
    v_pk_fma_f16 v32, v16, v16, s25 neg_lo:[1,0,0] neg_hi:[1,0,0]
    v_mfma_f32_16x16x32_bf16 v[100:103], v[116:119], v[76:79], v[100:103]
    ds_read_b128 v[60:63], v2 offset:17408
    v_pk_fma_f16 v34, v17, v17, s25 neg_lo:[1,0,0] neg_hi:[1,0,0]
    v_pk_mul_f16 v32, v16, v32
    v_mfma_f32_16x16x32_bf16 v[104:107], v[164:167], v[76:79], 0
    ds_read_b128 v[64:67], v2 offset:18432
    v_pk_mul_f16 v34, v17, v34
    v_exp_f16 v16, v32
    v_mfma_f32_16x16x32_bf16 v[104:107], v[160:163], v[72:75], v[104:107]
    ds_read_b128 v[68:71], v2 offset:19456
    v_exp_f16 v17, v34
    v_exp_f16_sdwa v16, v32 dst_sel:WORD_1 dst_unused:UNUSED_PRESERVE src0_sel:WORD_1
    v_mfma_f32_16x16x32_bf16 v[108:111], v[208:211], v[72:75], 0
    ds_write_b32 v3, v9 offset:1024
    v_exp_f16_sdwa v17, v34 dst_sel:WORD_1 dst_unused:UNUSED_PRESERVE src0_sel:WORD_1
    v_pk_add_f16 v16, v16, 1.0 op_sel_hi:[1,0]
    v_mfma_f32_16x16x32_bf16 v[108:111], v[212:215], v[76:79], v[108:111]
    buffer_load_dwordx4 v1, s[12:15], s6 offen offset:2048 lds
    s_add_u32 s7, s7, 12288
    v_pk_add_f16 v17, v17, 1.0 op_sel_hi:[1,0]
    v_rcp_f16 v32, v16
    v_mfma_f32_16x16x32_bf16 v[108:111], v[216:219], v[80:83], v[108:111]
    s_add_u32 s6, s6, 24576
    v_rcp_f16 v34, v17
    v_rcp_f16_sdwa v33, v16 dst_sel:DWORD dst_unused:UNUSED_PAD src0_sel:WORD_1
    v_rcp_f16_sdwa v35, v17 dst_sel:DWORD dst_unused:UNUSED_PAD src0_sel:WORD_1
    v_mfma_f32_16x16x32_bf16 v[108:111], v[220:223], v[84:87], v[108:111]
    v_fma_mix_f32 v32, v88, v32, 0 op_sel_hi:[0,1,0]
    v_fma_mix_f32 v34, v90, v34, 0 op_sel_hi:[0,1,0]
    v_mfma_f32_16x16x32_bf16 v[104:107], v[172:175], v[84:87], v[104:107]
    v_fma_mix_f32 v33, v89, v33, 0 op_sel_hi:[0,1,0]
    v_fma_mix_f32 v35, v91, v35, 0 op_sel_hi:[0,1,0]
    v_mfma_f32_16x16x32_bf16 v[104:107], v[168:171], v[80:83], v[104:107]
    v_mul_f32 v8, v32, v32
    v_fmac_f32 v8, v33, v33
    v_mfma_f32_16x16x32_bf16 v[100:103], v[120:123], v[80:83], v[100:103]
    v_fmac_f32 v8, v34, v34
    v_fmac_f32 v8, v35, v35
    v_mfma_f32_16x16x32_bf16 v[100:103], v[124:127], v[84:87], v[100:103]
    v_cvt_pk_bf16_f32 v44, v32, v33
    v_cvt_pk_bf16_f32 v45, v34, v35
    s_waitcnt lgkmcnt(0)
    v_mfma_f32_16x16x32_bf16 v[100:103], v[128:131], v[56:59], v[100:103]
    ds_read_b128 v[72:75], v2 offset:20480
    v_cvt_pk_f16_f32 v18, v92, v93
    v_cvt_pk_f16_f32 v19, v94, v95
    v_pk_fma_f16 v36, v18, v18, s25 neg_lo:[1,0,0] neg_hi:[1,0,0]
    v_mfma_f32_16x16x32_bf16 v[100:103], v[132:135], v[60:63], v[100:103]
    ds_read_b128 v[76:79], v2 offset:21504
    v_pk_fma_f16 v38, v19, v19, s25 neg_lo:[1,0,0] neg_hi:[1,0,0]
    v_pk_mul_f16 v36, v18, v36
    v_mfma_f32_16x16x32_bf16 v[104:107], v[180:183], v[60:63], v[104:107]
    ds_read_b128 v[80:83], v2 offset:22528
    v_pk_mul_f16 v38, v19, v38
    v_exp_f16 v18, v36
    v_mfma_f32_16x16x32_bf16 v[104:107], v[176:179], v[56:59], v[104:107]
    ds_read_b128 v[84:87], v2 offset:23552
    v_exp_f16 v19, v38
    v_exp_f16_sdwa v18, v36 dst_sel:WORD_1 dst_unused:UNUSED_PRESERVE src0_sel:WORD_1
    v_mfma_f32_16x16x32_bf16 v[108:111], v[224:227], v[56:59], v[108:111]
    v_exp_f16_sdwa v19, v38 dst_sel:WORD_1 dst_unused:UNUSED_PRESERVE src0_sel:WORD_1
    v_pk_add_f16 v18, v18, 1.0 op_sel_hi:[1,0]
    v_mfma_f32_16x16x32_bf16 v[108:111], v[228:231], v[60:63], v[108:111]
    v_pk_add_f16 v19, v19, 1.0 op_sel_hi:[1,0]
    v_rcp_f16 v36, v18
    v_mfma_f32_16x16x32_bf16 v[108:111], v[232:235], v[64:67], v[108:111]
    v_rcp_f16 v38, v19
    v_rcp_f16_sdwa v37, v18 dst_sel:DWORD dst_unused:UNUSED_PAD src0_sel:WORD_1
    v_rcp_f16_sdwa v39, v19 dst_sel:DWORD dst_unused:UNUSED_PAD src0_sel:WORD_1
    v_mfma_f32_16x16x32_bf16 v[108:111], v[236:239], v[68:71], v[108:111]
    v_fma_mix_f32 v36, v92, v36, 0 op_sel_hi:[0,1,0]
    v_fma_mix_f32 v38, v94, v38, 0 op_sel_hi:[0,1,0]
    v_mfma_f32_16x16x32_bf16 v[104:107], v[188:191], v[68:71], v[104:107]
    v_fma_mix_f32 v37, v93, v37, 0 op_sel_hi:[0,1,0]
    v_fma_mix_f32 v39, v95, v39, 0 op_sel_hi:[0,1,0]
    v_mfma_f32_16x16x32_bf16 v[104:107], v[184:187], v[64:67], v[104:107]
    v_fmac_f32 v8, v36, v36
    v_fmac_f32 v8, v37, v37
    v_mfma_f32_16x16x32_bf16 v[100:103], v[136:139], v[64:67], v[100:103]
    v_fmac_f32 v8, v38, v38
    v_fmac_f32 v8, v39, v39
    v_mfma_f32_16x16x32_bf16 v[100:103], v[140:143], v[68:71], v[100:103]
    v_cvt_pk_bf16_f32 v48, v36, v37
    v_cvt_pk_bf16_f32 v49, v38, v39
    s_waitcnt vmcnt(12) lgkmcnt(0)
    s_barrier
    v_mfma_f32_16x16x32_bf16 v[108:111], v[240:243], v[72:75], v[108:111]
    ds_read_b128 v[56:59], v2 offset:24576
    v_cvt_pk_f16_f32 v20, v96, v97
    v_cvt_pk_f16_f32 v21, v98, v99
    v_pk_fma_f16 v40, v20, v20, s25 neg_lo:[1,0,0] neg_hi:[1,0,0]
    v_mfma_f32_16x16x32_bf16 v[108:111], v[244:247], v[76:79], v[108:111]
    ds_read_b128 v[60:63], v2 offset:25600
    v_pk_fma_f16 v42, v21, v21, s25 neg_lo:[1,0,0] neg_hi:[1,0,0]
    v_pk_mul_f16 v40, v20, v40
    v_mfma_f32_16x16x32_bf16 v[104:107], v[196:199], v[76:79], v[104:107]
    ds_read_b128 v[64:67], v2 offset:26624
    v_pk_mul_f16 v42, v21, v42
    v_exp_f16 v20, v40
    v_mfma_f32_16x16x32_bf16 v[104:107], v[192:195], v[72:75], v[104:107]
    ds_read_b128 v[68:71], v2 offset:27648
    v_exp_f16 v21, v42
    v_exp_f16_sdwa v20, v40 dst_sel:WORD_1 dst_unused:UNUSED_PRESERVE src0_sel:WORD_1
    v_mfma_f32_16x16x32_bf16 v[100:103], v[144:147], v[72:75], v[100:103]
    s_add_u32 m0, s47, 49152
    v_exp_f16_sdwa v21, v42 dst_sel:WORD_1 dst_unused:UNUSED_PRESERVE src0_sel:WORD_1
    v_pk_add_f16 v20, v20, 1.0 op_sel_hi:[1,0]
    v_mfma_f32_16x16x32_bf16 v[100:103], v[148:151], v[76:79], v[100:103]
    buffer_load_dwordx4 v1, s[12:15], s6 offen offset:0 lds
    v_pk_add_f16 v21, v21, 1.0 op_sel_hi:[1,0]
    v_rcp_f16 v40, v20
    v_mfma_f32_16x16x32_bf16 v[100:103], v[152:155], v[80:83], v[100:103]
    v_rcp_f16 v42, v21
    v_rcp_f16_sdwa v41, v20 dst_sel:DWORD dst_unused:UNUSED_PAD src0_sel:WORD_1
    v_rcp_f16_sdwa v43, v21 dst_sel:DWORD dst_unused:UNUSED_PAD src0_sel:WORD_1
    v_mfma_f32_16x16x32_bf16 v[100:103], v[156:159], v[84:87], v[100:103]
    v_fma_mix_f32 v40, v96, v40, 0 op_sel_hi:[0,1,0]
    v_fma_mix_f32 v42, v98, v42, 0 op_sel_hi:[0,1,0]
    v_mfma_f32_16x16x32_bf16 v[104:107], v[204:207], v[84:87], v[104:107]
    v_fma_mix_f32 v41, v97, v41, 0 op_sel_hi:[0,1,0]
    v_fma_mix_f32 v43, v99, v43, 0 op_sel_hi:[0,1,0]
    v_mfma_f32_16x16x32_bf16 v[104:107], v[200:203], v[80:83], v[104:107]
    v_fmac_f32 v8, v40, v40
    v_fmac_f32 v8, v41, v41
    v_mfma_f32_16x16x32_bf16 v[108:111], v[248:251], v[80:83], v[108:111]
    v_fmac_f32 v8, v42, v42
    v_fmac_f32 v8, v43, v43
    v_mfma_f32_16x16x32_bf16 v[108:111], v[252:255], v[84:87], v[108:111]
    v_cvt_pk_bf16_f32 v52, v40, v41
    v_cvt_pk_bf16_f32 v53, v42, v43
    s_waitcnt lgkmcnt(0)
    v_mfma_f32_16x16x32_bf16 v[88:91], v[112:115], v[56:59], 0
    ds_read_b128 v[72:75], v2 offset:28672
    v_cvt_pk_f16_f32 v16, v100, v101
    v_cvt_pk_f16_f32 v17, v102, v103
    v_pk_fma_f16 v32, v16, v16, s25 neg_lo:[1,0,0] neg_hi:[1,0,0]
    v_mfma_f32_16x16x32_bf16 v[88:91], v[116:119], v[60:63], v[88:91]
    ds_read_b128 v[76:79], v2 offset:29696
    v_pk_fma_f16 v34, v17, v17, s25 neg_lo:[1,0,0] neg_hi:[1,0,0]
    v_pk_mul_f16 v32, v16, v32
    v_mfma_f32_16x16x32_bf16 v[92:95], v[164:167], v[60:63], 0
    ds_read_b128 v[80:83], v2 offset:30720
    v_pk_mul_f16 v34, v17, v34
    v_exp_f16 v16, v32
    v_mfma_f32_16x16x32_bf16 v[92:95], v[160:163], v[56:59], v[92:95]
    ds_read_b128 v[84:87], v2 offset:31744
    v_exp_f16 v17, v34
    v_exp_f16_sdwa v16, v32 dst_sel:WORD_1 dst_unused:UNUSED_PRESERVE src0_sel:WORD_1
    v_exp_f16_sdwa v17, v34 dst_sel:WORD_1 dst_unused:UNUSED_PRESERVE src0_sel:WORD_1
    v_mfma_f32_16x16x32_bf16 v[96:99], v[208:211], v[56:59], 0
    v_pk_add_f16 v16, v16, 1.0 op_sel_hi:[1,0]
    v_pk_add_f16 v17, v17, 1.0 op_sel_hi:[1,0]
    v_mfma_f32_16x16x32_bf16 v[96:99], v[212:215], v[60:63], v[96:99]
    v_rcp_f16 v32, v16
    v_rcp_f16 v34, v17
    v_mfma_f32_16x16x32_bf16 v[96:99], v[216:219], v[64:67], v[96:99]
    v_rcp_f16_sdwa v33, v16 dst_sel:DWORD dst_unused:UNUSED_PAD src0_sel:WORD_1
    v_rcp_f16_sdwa v35, v17 dst_sel:DWORD dst_unused:UNUSED_PAD src0_sel:WORD_1
    v_fma_mix_f32 v32, v100, v32, 0 op_sel_hi:[0,1,0]
    v_mfma_f32_16x16x32_bf16 v[96:99], v[220:223], v[68:71], v[96:99]
    v_fma_mix_f32 v34, v102, v34, 0 op_sel_hi:[0,1,0]
    v_fma_mix_f32 v33, v101, v33, 0 op_sel_hi:[0,1,0]
    v_mfma_f32_16x16x32_bf16 v[92:95], v[172:175], v[68:71], v[92:95]
    v_fma_mix_f32 v35, v103, v35, 0 op_sel_hi:[0,1,0]
    v_mul_f32 v9, v32, v32
    v_mfma_f32_16x16x32_bf16 v[92:95], v[168:171], v[64:67], v[92:95]
    v_fmac_f32 v9, v33, v33
    v_fmac_f32 v9, v34, v34
    v_fmac_f32 v9, v35, v35
    v_mfma_f32_16x16x32_bf16 v[88:91], v[120:123], v[64:67], v[88:91]
    v_cvt_pk_bf16_f32 v46, v32, v33
    v_cvt_pk_bf16_f32 v47, v34, v35
    v_mfma_f32_16x16x32_bf16 v[88:91], v[124:127], v[68:71], v[88:91]
    buffer_store_dwordx4 v[44:47], v4, s[16:19], s7 offen offset:0 nt
    v_cvt_pk_f16_f32 v18, v104, v105
    s_waitcnt lgkmcnt(0)
    v_mfma_f32_16x16x32_bf16 v[88:91], v[128:131], v[72:75], v[88:91]
    ds_read_b128 v[56:59], v2 offset:32768
    v_cvt_pk_f16_f32 v19, v106, v107
    v_pk_fma_f16 v36, v18, v18, s25 neg_lo:[1,0,0] neg_hi:[1,0,0]
    v_mfma_f32_16x16x32_bf16 v[88:91], v[132:135], v[76:79], v[88:91]
    ds_read_b128 v[60:63], v2 offset:33792
    v_pk_fma_f16 v38, v19, v19, s25 neg_lo:[1,0,0] neg_hi:[1,0,0]
    v_pk_mul_f16 v36, v18, v36
    v_pk_mul_f16 v38, v19, v38
    v_mfma_f32_16x16x32_bf16 v[92:95], v[180:183], v[76:79], v[92:95]
    ds_read_b128 v[64:67], v2 offset:34816
    v_exp_f16 v18, v36
    v_exp_f16 v19, v38
    v_mfma_f32_16x16x32_bf16 v[92:95], v[176:179], v[72:75], v[92:95]
    ds_read_b128 v[68:71], v2 offset:35840
    v_exp_f16_sdwa v18, v36 dst_sel:WORD_1 dst_unused:UNUSED_PRESERVE src0_sel:WORD_1
    v_exp_f16_sdwa v19, v38 dst_sel:WORD_1 dst_unused:UNUSED_PRESERVE src0_sel:WORD_1
    v_mfma_f32_16x16x32_bf16 v[96:99], v[224:227], v[72:75], v[96:99]
    v_pk_add_f16 v18, v18, 1.0 op_sel_hi:[1,0]
    v_pk_add_f16 v19, v19, 1.0 op_sel_hi:[1,0]
    v_rcp_f16 v36, v18
    v_mfma_f32_16x16x32_bf16 v[96:99], v[228:231], v[76:79], v[96:99]
    buffer_load_dwordx4 v1, s[12:15], s6 offen offset:1024 lds
    v_rcp_f16 v38, v19
    v_rcp_f16_sdwa v37, v18 dst_sel:DWORD dst_unused:UNUSED_PAD src0_sel:WORD_1
    v_mfma_f32_16x16x32_bf16 v[96:99], v[232:235], v[80:83], v[96:99]
    v_rcp_f16_sdwa v39, v19 dst_sel:DWORD dst_unused:UNUSED_PAD src0_sel:WORD_1
    v_fma_mix_f32 v36, v104, v36, 0 op_sel_hi:[0,1,0]
    v_mfma_f32_16x16x32_bf16 v[96:99], v[236:239], v[84:87], v[96:99]
    v_fma_mix_f32 v38, v106, v38, 0 op_sel_hi:[0,1,0]
    v_fma_mix_f32 v37, v105, v37, 0 op_sel_hi:[0,1,0]
    v_fma_mix_f32 v39, v107, v39, 0 op_sel_hi:[0,1,0]
    v_mfma_f32_16x16x32_bf16 v[92:95], v[188:191], v[84:87], v[92:95]
    v_fmac_f32 v9, v36, v36
    v_fmac_f32 v9, v37, v37
    v_mfma_f32_16x16x32_bf16 v[92:95], v[184:187], v[80:83], v[92:95]
    v_fmac_f32 v9, v38, v38
    v_fmac_f32 v9, v39, v39
    v_mfma_f32_16x16x32_bf16 v[88:91], v[136:139], v[80:83], v[88:91]
    v_cvt_pk_bf16_f32 v50, v36, v37
    v_cvt_pk_bf16_f32 v51, v38, v39
    buffer_store_dwordx4 v[48:51], v4, s[16:19], s7 offen offset:1024 nt
    v_mfma_f32_16x16x32_bf16 v[88:91], v[140:143], v[84:87], v[88:91]
    v_cvt_pk_f16_f32 v20, v108, v109
    v_cvt_pk_f16_f32 v21, v110, v111
    s_waitcnt lgkmcnt(0)
    v_mfma_f32_16x16x32_bf16 v[96:99], v[240:243], v[56:59], v[96:99]
    ds_read_b128 v[72:75], v2 offset:36864
    v_pk_fma_f16 v40, v20, v20, s25 neg_lo:[1,0,0] neg_hi:[1,0,0]
    v_pk_fma_f16 v42, v21, v21, s25 neg_lo:[1,0,0] neg_hi:[1,0,0]
    v_mfma_f32_16x16x32_bf16 v[96:99], v[244:247], v[60:63], v[96:99]
    ds_read_b128 v[76:79], v2 offset:37888
    v_pk_mul_f16 v40, v20, v40
    v_pk_mul_f16 v42, v21, v42
    v_mfma_f32_16x16x32_bf16 v[92:95], v[196:199], v[60:63], v[92:95]
    ds_read_b128 v[80:83], v2 offset:38912
    v_exp_f16 v20, v40
    v_exp_f16 v21, v42
    v_exp_f16_sdwa v20, v40 dst_sel:WORD_1 dst_unused:UNUSED_PRESERVE src0_sel:WORD_1
    v_mfma_f32_16x16x32_bf16 v[92:95], v[192:195], v[56:59], v[92:95]
    ds_read_b128 v[84:87], v2 offset:39936
    v_exp_f16_sdwa v21, v42 dst_sel:WORD_1 dst_unused:UNUSED_PRESERVE src0_sel:WORD_1
    v_pk_add_f16 v20, v20, 1.0 op_sel_hi:[1,0]
    v_mfma_f32_16x16x32_bf16 v[88:91], v[144:147], v[56:59], v[88:91]
    v_pk_add_f16 v21, v21, 1.0 op_sel_hi:[1,0]
    v_rcp_f16 v40, v20
    v_mfma_f32_16x16x32_bf16 v[88:91], v[148:151], v[60:63], v[88:91]
    v_rcp_f16 v42, v21
    v_rcp_f16_sdwa v41, v20 dst_sel:DWORD dst_unused:UNUSED_PAD src0_sel:WORD_1
    v_rcp_f16_sdwa v43, v21 dst_sel:DWORD dst_unused:UNUSED_PAD src0_sel:WORD_1
    v_mfma_f32_16x16x32_bf16 v[88:91], v[152:155], v[64:67], v[88:91]
    v_fma_mix_f32 v40, v108, v40, 0 op_sel_hi:[0,1,0]
    v_fma_mix_f32 v42, v110, v42, 0 op_sel_hi:[0,1,0]
    v_mfma_f32_16x16x32_bf16 v[88:91], v[156:159], v[68:71], v[88:91]
    v_fma_mix_f32 v41, v109, v41, 0 op_sel_hi:[0,1,0]
    v_fma_mix_f32 v43, v111, v43, 0 op_sel_hi:[0,1,0]
    v_mfma_f32_16x16x32_bf16 v[92:95], v[204:207], v[68:71], v[92:95]
    v_fmac_f32 v9, v40, v40
    v_fmac_f32 v9, v41, v41
    v_fmac_f32 v9, v42, v42
    v_mfma_f32_16x16x32_bf16 v[92:95], v[200:203], v[64:67], v[92:95]
    v_fmac_f32 v9, v43, v43
    v_cvt_pk_bf16_f32 v54, v40, v41
    v_mfma_f32_16x16x32_bf16 v[96:99], v[248:251], v[64:67], v[96:99]
    v_cvt_pk_bf16_f32 v55, v42, v43
    v_permlane16_swap_b32 v8, v9
    v_mfma_f32_16x16x32_bf16 v[96:99], v[252:255], v[68:71], v[96:99]
    buffer_store_dwordx4 v[52:55], v4, s[16:19], s7 offen offset:2048 nt
    v_add_f32 v9, v8, v9
    s_waitcnt lgkmcnt(0)
    v_mfma_f32_16x16x32_bf16 v[100:103], v[112:115], v[72:75], 0
    ds_read_b128 v[56:59], v2 offset:40960
    v_cvt_pk_f16_f32 v16, v88, v89
    v_cvt_pk_f16_f32 v17, v90, v91
    v_pk_fma_f16 v32, v16, v16, s25 neg_lo:[1,0,0] neg_hi:[1,0,0]
    v_mfma_f32_16x16x32_bf16 v[100:103], v[116:119], v[76:79], v[100:103]
    ds_read_b128 v[60:63], v2 offset:41984
    v_pk_fma_f16 v34, v17, v17, s25 neg_lo:[1,0,0] neg_hi:[1,0,0]
    v_pk_mul_f16 v32, v16, v32
    v_mfma_f32_16x16x32_bf16 v[104:107], v[164:167], v[76:79], 0
    ds_read_b128 v[64:67], v2 offset:43008
    v_pk_mul_f16 v34, v17, v34
    v_exp_f16 v16, v32
    v_mfma_f32_16x16x32_bf16 v[104:107], v[160:163], v[72:75], v[104:107]
    ds_read_b128 v[68:71], v2 offset:44032
    v_exp_f16 v17, v34
    v_exp_f16_sdwa v16, v32 dst_sel:WORD_1 dst_unused:UNUSED_PRESERVE src0_sel:WORD_1
    v_mfma_f32_16x16x32_bf16 v[108:111], v[208:211], v[72:75], 0
    ds_write_b32 v3, v9 offset:2048
    v_exp_f16_sdwa v17, v34 dst_sel:WORD_1 dst_unused:UNUSED_PRESERVE src0_sel:WORD_1
    v_pk_add_f16 v16, v16, 1.0 op_sel_hi:[1,0]
    v_mfma_f32_16x16x32_bf16 v[108:111], v[212:215], v[76:79], v[108:111]
    buffer_load_dwordx4 v1, s[12:15], s6 offen offset:2048 lds
    s_add_u32 s7, s7, 12288
    v_pk_add_f16 v17, v17, 1.0 op_sel_hi:[1,0]
    v_rcp_f16 v32, v16
    v_mfma_f32_16x16x32_bf16 v[108:111], v[216:219], v[80:83], v[108:111]
    s_add_u32 s6, s6, 24576
    v_rcp_f16 v34, v17
    v_rcp_f16_sdwa v33, v16 dst_sel:DWORD dst_unused:UNUSED_PAD src0_sel:WORD_1
    v_rcp_f16_sdwa v35, v17 dst_sel:DWORD dst_unused:UNUSED_PAD src0_sel:WORD_1
    v_mfma_f32_16x16x32_bf16 v[108:111], v[220:223], v[84:87], v[108:111]
    v_fma_mix_f32 v32, v88, v32, 0 op_sel_hi:[0,1,0]
    v_fma_mix_f32 v34, v90, v34, 0 op_sel_hi:[0,1,0]
    v_mfma_f32_16x16x32_bf16 v[104:107], v[172:175], v[84:87], v[104:107]
    v_fma_mix_f32 v33, v89, v33, 0 op_sel_hi:[0,1,0]
    v_fma_mix_f32 v35, v91, v35, 0 op_sel_hi:[0,1,0]
    v_mfma_f32_16x16x32_bf16 v[104:107], v[168:171], v[80:83], v[104:107]
    v_mul_f32 v8, v32, v32
    v_fmac_f32 v8, v33, v33
    v_mfma_f32_16x16x32_bf16 v[100:103], v[120:123], v[80:83], v[100:103]
    v_fmac_f32 v8, v34, v34
    v_fmac_f32 v8, v35, v35
    v_mfma_f32_16x16x32_bf16 v[100:103], v[124:127], v[84:87], v[100:103]
    v_cvt_pk_bf16_f32 v44, v32, v33
    v_cvt_pk_bf16_f32 v45, v34, v35
    s_waitcnt lgkmcnt(0)
    v_mfma_f32_16x16x32_bf16 v[100:103], v[128:131], v[56:59], v[100:103]
    ds_read_b128 v[72:75], v2 offset:45056
    v_cvt_pk_f16_f32 v18, v92, v93
    v_cvt_pk_f16_f32 v19, v94, v95
    v_pk_fma_f16 v36, v18, v18, s25 neg_lo:[1,0,0] neg_hi:[1,0,0]
    v_mfma_f32_16x16x32_bf16 v[100:103], v[132:135], v[60:63], v[100:103]
    ds_read_b128 v[76:79], v2 offset:46080
    v_pk_fma_f16 v38, v19, v19, s25 neg_lo:[1,0,0] neg_hi:[1,0,0]
    v_pk_mul_f16 v36, v18, v36
    v_mfma_f32_16x16x32_bf16 v[104:107], v[180:183], v[60:63], v[104:107]
    ds_read_b128 v[80:83], v2 offset:47104
    v_pk_mul_f16 v38, v19, v38
    v_exp_f16 v18, v36
    v_mfma_f32_16x16x32_bf16 v[104:107], v[176:179], v[56:59], v[104:107]
    ds_read_b128 v[84:87], v2 offset:48128
    v_exp_f16 v19, v38
    v_exp_f16_sdwa v18, v36 dst_sel:WORD_1 dst_unused:UNUSED_PRESERVE src0_sel:WORD_1
    v_mfma_f32_16x16x32_bf16 v[108:111], v[224:227], v[56:59], v[108:111]
    v_exp_f16_sdwa v19, v38 dst_sel:WORD_1 dst_unused:UNUSED_PRESERVE src0_sel:WORD_1
    v_pk_add_f16 v18, v18, 1.0 op_sel_hi:[1,0]
    v_mfma_f32_16x16x32_bf16 v[108:111], v[228:231], v[60:63], v[108:111]
    v_pk_add_f16 v19, v19, 1.0 op_sel_hi:[1,0]
    v_rcp_f16 v36, v18
    v_mfma_f32_16x16x32_bf16 v[108:111], v[232:235], v[64:67], v[108:111]
    v_rcp_f16 v38, v19
    v_rcp_f16_sdwa v37, v18 dst_sel:DWORD dst_unused:UNUSED_PAD src0_sel:WORD_1
    v_rcp_f16_sdwa v39, v19 dst_sel:DWORD dst_unused:UNUSED_PAD src0_sel:WORD_1
    v_mfma_f32_16x16x32_bf16 v[108:111], v[236:239], v[68:71], v[108:111]
    v_fma_mix_f32 v36, v92, v36, 0 op_sel_hi:[0,1,0]
    v_fma_mix_f32 v38, v94, v38, 0 op_sel_hi:[0,1,0]
    v_mfma_f32_16x16x32_bf16 v[104:107], v[188:191], v[68:71], v[104:107]
    v_fma_mix_f32 v37, v93, v37, 0 op_sel_hi:[0,1,0]
    v_fma_mix_f32 v39, v95, v39, 0 op_sel_hi:[0,1,0]
    v_mfma_f32_16x16x32_bf16 v[104:107], v[184:187], v[64:67], v[104:107]
    v_fmac_f32 v8, v36, v36
    v_fmac_f32 v8, v37, v37
    v_mfma_f32_16x16x32_bf16 v[100:103], v[136:139], v[64:67], v[100:103]
    v_fmac_f32 v8, v38, v38
    v_fmac_f32 v8, v39, v39
    v_mfma_f32_16x16x32_bf16 v[100:103], v[140:143], v[68:71], v[100:103]
    v_cvt_pk_bf16_f32 v48, v36, v37
    v_cvt_pk_bf16_f32 v49, v38, v39
    s_waitcnt vmcnt(12) lgkmcnt(0)
    s_barrier
    v_mfma_f32_16x16x32_bf16 v[108:111], v[240:243], v[72:75], v[108:111]
    ds_read_b128 v[56:59], v1 offset:0
    v_cvt_pk_f16_f32 v20, v96, v97
    v_cvt_pk_f16_f32 v21, v98, v99
    v_pk_fma_f16 v40, v20, v20, s25 neg_lo:[1,0,0] neg_hi:[1,0,0]
    v_mfma_f32_16x16x32_bf16 v[108:111], v[244:247], v[76:79], v[108:111]
    ds_read_b128 v[60:63], v1 offset:1024
    v_pk_fma_f16 v42, v21, v21, s25 neg_lo:[1,0,0] neg_hi:[1,0,0]
    v_pk_mul_f16 v40, v20, v40
    v_mfma_f32_16x16x32_bf16 v[104:107], v[196:199], v[76:79], v[104:107]
    ds_read_b128 v[64:67], v1 offset:2048
    v_pk_mul_f16 v42, v21, v42
    v_exp_f16 v20, v40
    v_mfma_f32_16x16x32_bf16 v[104:107], v[192:195], v[72:75], v[104:107]
    ds_read_b128 v[68:71], v1 offset:3072
    v_exp_f16 v21, v42
    v_exp_f16_sdwa v20, v40 dst_sel:WORD_1 dst_unused:UNUSED_PRESERVE src0_sel:WORD_1
    v_mfma_f32_16x16x32_bf16 v[100:103], v[144:147], v[72:75], v[100:103]
    s_add_u32 m0, s47, 73728
    v_exp_f16_sdwa v21, v42 dst_sel:WORD_1 dst_unused:UNUSED_PRESERVE src0_sel:WORD_1
    v_pk_add_f16 v20, v20, 1.0 op_sel_hi:[1,0]
    v_mfma_f32_16x16x32_bf16 v[100:103], v[148:151], v[76:79], v[100:103]
    buffer_load_dwordx4 v1, s[12:15], s6 offen offset:0 lds
    v_pk_add_f16 v21, v21, 1.0 op_sel_hi:[1,0]
    v_rcp_f16 v40, v20
    v_mfma_f32_16x16x32_bf16 v[100:103], v[152:155], v[80:83], v[100:103]
    s_sub_u32 s33, s33, 1
    v_rcp_f16 v42, v21
    v_rcp_f16_sdwa v41, v20 dst_sel:DWORD dst_unused:UNUSED_PAD src0_sel:WORD_1
    v_rcp_f16_sdwa v43, v21 dst_sel:DWORD dst_unused:UNUSED_PAD src0_sel:WORD_1
    v_mfma_f32_16x16x32_bf16 v[100:103], v[156:159], v[84:87], v[100:103]
    v_fma_mix_f32 v40, v96, v40, 0 op_sel_hi:[0,1,0]
    v_fma_mix_f32 v42, v98, v42, 0 op_sel_hi:[0,1,0]
    v_mfma_f32_16x16x32_bf16 v[104:107], v[204:207], v[84:87], v[104:107]
    v_fma_mix_f32 v41, v97, v41, 0 op_sel_hi:[0,1,0]
    v_fma_mix_f32 v43, v99, v43, 0 op_sel_hi:[0,1,0]
    v_mfma_f32_16x16x32_bf16 v[104:107], v[200:203], v[80:83], v[104:107]
    v_fmac_f32 v8, v40, v40
    v_fmac_f32 v8, v41, v41
    v_mfma_f32_16x16x32_bf16 v[108:111], v[248:251], v[80:83], v[108:111]
    v_fmac_f32 v8, v42, v42
    v_fmac_f32 v8, v43, v43
    v_mfma_f32_16x16x32_bf16 v[108:111], v[252:255], v[84:87], v[108:111]
    v_cvt_pk_bf16_f32 v52, v40, v41
    v_cvt_pk_bf16_f32 v53, v42, v43
    s_cmp_lg_u32 s33, 0
    s_cbranch_scc1 L_k1_loop
L_k1_tail:
    s_nop 7
    v_cvt_pk_f16_f32 v16, v100, v101
    v_cvt_pk_f16_f32 v17, v102, v103
    v_pk_fma_f16 v32, v16, v16, s25 neg_lo:[1,0,0] neg_hi:[1,0,0]
    v_pk_fma_f16 v34, v17, v17, s25 neg_lo:[1,0,0] neg_hi:[1,0,0]
    v_pk_mul_f16 v32, v16, v32
    v_pk_mul_f16 v34, v17, v34
    v_exp_f16 v16, v32
    v_exp_f16 v17, v34
    v_exp_f16_sdwa v16, v32 dst_sel:WORD_1 dst_unused:UNUSED_PRESERVE src0_sel:WORD_1
    v_exp_f16_sdwa v17, v34 dst_sel:WORD_1 dst_unused:UNUSED_PRESERVE src0_sel:WORD_1
    v_pk_add_f16 v16, v16, 1.0 op_sel_hi:[1,0]
    v_pk_add_f16 v17, v17, 1.0 op_sel_hi:[1,0]
    v_rcp_f16 v32, v16
    v_rcp_f16 v34, v17
    v_rcp_f16_sdwa v33, v16 dst_sel:DWORD dst_unused:UNUSED_PAD src0_sel:WORD_1
    v_rcp_f16_sdwa v35, v17 dst_sel:DWORD dst_unused:UNUSED_PAD src0_sel:WORD_1
    v_fma_mix_f32 v32, v100, v32, 0 op_sel_hi:[0,1,0]
    v_fma_mix_f32 v34, v102, v34, 0 op_sel_hi:[0,1,0]
    v_fma_mix_f32 v33, v101, v33, 0 op_sel_hi:[0,1,0]
    v_fma_mix_f32 v35, v103, v35, 0 op_sel_hi:[0,1,0]
    v_mul_f32 v9, v32, v32
    v_fmac_f32 v9, v33, v33
    v_fmac_f32 v9, v34, v34
    v_fmac_f32 v9, v35, v35
    v_cvt_pk_bf16_f32 v46, v32, v33
    v_cvt_pk_bf16_f32 v47, v34, v35
    buffer_store_dwordx4 v[44:47], v4, s[52:55], s32 offen offset:0
    v_cvt_pk_f16_f32 v18, v104, v105
    v_cvt_pk_f16_f32 v19, v106, v107
    v_pk_fma_f16 v36, v18, v18, s25 neg_lo:[1,0,0] neg_hi:[1,0,0]
    v_pk_fma_f16 v38, v19, v19, s25 neg_lo:[1,0,0] neg_hi:[1,0,0]
    v_pk_mul_f16 v36, v18, v36
    v_pk_mul_f16 v38, v19, v38
    v_exp_f16 v18, v36
    v_exp_f16 v19, v38
    v_exp_f16_sdwa v18, v36 dst_sel:WORD_1 dst_unused:UNUSED_PRESERVE src0_sel:WORD_1
    v_exp_f16_sdwa v19, v38 dst_sel:WORD_1 dst_unused:UNUSED_PRESERVE src0_sel:WORD_1
    v_pk_add_f16 v18, v18, 1.0 op_sel_hi:[1,0]
    v_pk_add_f16 v19, v19, 1.0 op_sel_hi:[1,0]
    v_rcp_f16 v36, v18
    v_rcp_f16 v38, v19
    v_rcp_f16_sdwa v37, v18 dst_sel:DWORD dst_unused:UNUSED_PAD src0_sel:WORD_1
    v_rcp_f16_sdwa v39, v19 dst_sel:DWORD dst_unused:UNUSED_PAD src0_sel:WORD_1
    v_fma_mix_f32 v36, v104, v36, 0 op_sel_hi:[0,1,0]
    v_fma_mix_f32 v38, v106, v38, 0 op_sel_hi:[0,1,0]
    v_fma_mix_f32 v37, v105, v37, 0 op_sel_hi:[0,1,0]
    v_fma_mix_f32 v39, v107, v39, 0 op_sel_hi:[0,1,0]
    v_fmac_f32 v9, v36, v36
    v_fmac_f32 v9, v37, v37
    v_fmac_f32 v9, v38, v38
    v_fmac_f32 v9, v39, v39
    v_cvt_pk_bf16_f32 v50, v36, v37
    v_cvt_pk_bf16_f32 v51, v38, v39
    buffer_store_dwordx4 v[48:51], v4, s[52:55], s32 offen offset:1024
    v_cvt_pk_f16_f32 v20, v108, v109
    v_cvt_pk_f16_f32 v21, v110, v111
    v_pk_fma_f16 v40, v20, v20, s25 neg_lo:[1,0,0] neg_hi:[1,0,0]
    v_pk_fma_f16 v42, v21, v21, s25 neg_lo:[1,0,0] neg_hi:[1,0,0]
    v_pk_mul_f16 v40, v20, v40
    v_pk_mul_f16 v42, v21, v42
    v_exp_f16 v20, v40
    v_exp_f16 v21, v42
    v_exp_f16_sdwa v20, v40 dst_sel:WORD_1 dst_unused:UNUSED_PRESERVE src0_sel:WORD_1
    v_exp_f16_sdwa v21, v42 dst_sel:WORD_1 dst_unused:UNUSED_PRESERVE src0_sel:WORD_1
    v_pk_add_f16 v20, v20, 1.0 op_sel_hi:[1,0]
    v_pk_add_f16 v21, v21, 1.0 op_sel_hi:[1,0]
    v_rcp_f16 v40, v20
    v_rcp_f16 v42, v21
    v_rcp_f16_sdwa v41, v20 dst_sel:DWORD dst_unused:UNUSED_PAD src0_sel:WORD_1
    v_rcp_f16_sdwa v43, v21 dst_sel:DWORD dst_unused:UNUSED_PAD src0_sel:WORD_1
    v_fma_mix_f32 v40, v108, v40, 0 op_sel_hi:[0,1,0]
    v_fma_mix_f32 v42, v110, v42, 0 op_sel_hi:[0,1,0]
    v_fma_mix_f32 v41, v109, v41, 0 op_sel_hi:[0,1,0]
    v_fma_mix_f32 v43, v111, v43, 0 op_sel_hi:[0,1,0]
    v_fmac_f32 v9, v40, v40
    v_fmac_f32 v9, v41, v41
    v_fmac_f32 v9, v42, v42
    v_fmac_f32 v9, v43, v43
    v_cvt_pk_bf16_f32 v54, v40, v41
    v_cvt_pk_bf16_f32 v55, v42, v43
    s_nop 1
    v_permlane16_swap_b32 v8, v9
    buffer_store_dwordx4 v[52:55], v4, s[52:55], s32 offen offset:2048
    v_add_f32 v9, v8, v9
    ds_write_b32 v3, v9 offset:3072
    buffer_load_dwordx4 v1, s[12:15], s6 offen offset:1024 lds
    buffer_load_dwordx4 v1, s[12:15], s6 offen offset:2048 lds
    s_add_u32 s6, s6, 24576
    s_cmp_ge_u32 s6, s38
    s_cselect_b32 s6, s47, s6
    s_waitcnt lgkmcnt(0)
    s_cmp_eq_u32 s36, 0
    s_cbranch_scc1 L_k1_fin
    s_add_u32 s24, s24, 8
    s_mov_b32 s34, s35
    s_mov_b32 s33, s36
    s_mov_b32 s36, 0
    s_mov_b32 s5, 0
    s_mov_b32 s52, s76
    s_and_b32 s53, s77, 0xffff
    s_mov_b32 s54, 0x6c00000
    s_mov_b32 s55, 0x20000
    v_add_u32 v11, s4, v1
    ds_read_b128 v[112:115], v11 offset:0
    ds_read_b128 v[116:119], v11 offset:1024
    ds_read_b128 v[120:123], v11 offset:2048
    ds_read_b128 v[124:127], v11 offset:3072
    ds_read_b128 v[128:131], v11 offset:4096
    ds_read_b128 v[132:135], v11 offset:5120
    ds_read_b128 v[136:139], v11 offset:6144
    ds_read_b128 v[140:143], v11 offset:7168
    ds_read_b128 v[144:147], v11 offset:8192
    ds_read_b128 v[148:151], v11 offset:9216
    ds_read_b128 v[152:155], v11 offset:10240
    ds_read_b128 v[156:159], v11 offset:11264
    s_mul_i32 s26, s34, 147456
    s_add_u32 s26, s26, s40
    v_and_b32 v10, 0xf0, v1
    buffer_load_dwordx4 v[48:51], v10, s[28:31], 0 offen offset:0
    buffer_load_dwordx4 v[52:55], v10, s[28:31], 0 offen offset:256
    buffer_load_dwordx4 v[12:15], v10, s[28:31], 0 offen offset:512
    s_branch L_k1_ln
L_k1_fin:
    s_waitcnt vmcnt(12)
    s_barrier
    s_add_u32 m0, s47, 0
    s_nop 0
    buffer_load_dwordx4 v1, s[12:15], s6 offen offset:0 lds
    buffer_load_dwordx4 v1, s[12:15], s6 offen offset:1024 lds
    buffer_load_dwordx4 v1, s[12:15], s6 offen offset:2048 lds
    s_add_u32 s6, s6, 24576
    v_xor_b32 v6, 0x1000, v6
    s_mov_b32 s44, s45
    ds_read_b32 v12, v6 offset:0
    ds_read_b32 v13, v6 offset:256
    ds_read_b32 v14, v6 offset:512
    ds_read_b32 v15, v6 offset:768
    s_waitcnt lgkmcnt(0)
    v_add_f32 v12, v12, v13
    v_add_f32 v14, v14, v15
    v_add_f32 v12, v12, v14
    buffer_atomic_add_f32 v12, v7, s[20:23], s44 offen
    s_cmp_eq_u32 s48, 0
    s_cbranch_scc0 L_k1_done
    s_waitcnt vmcnt(6)
    s_barrier
    s_add_u32 m0, s47, 24576
    s_nop 0
    buffer_load_dwordx4 v1, s[12:15], s6 offen offset:0 lds
    buffer_load_dwordx4 v1, s[12:15], s6 offen offset:1024 lds
    buffer_load_dwordx4 v1, s[12:15], s6 offen offset:2048 lds
    s_add_u32 s6, s6, 24576
    s_waitcnt vmcnt(6)
    s_barrier
    s_add_u32 m0, s47, 49152
    s_nop 0
    buffer_load_dwordx4 v1, s[12:15], s6 offen offset:0 lds
    buffer_load_dwordx4 v1, s[12:15], s6 offen offset:1024 lds
    buffer_load_dwordx4 v1, s[12:15], s6 offen offset:2048 lds
    s_add_u32 s6, s6, 24576
    s_waitcnt vmcnt(6)
    s_barrier
    s_add_u32 m0, s47, 73728
    s_nop 0
    buffer_load_dwordx4 v1, s[12:15], s6 offen offset:0 lds
    buffer_load_dwordx4 v1, s[12:15], s6 offen offset:1024 lds
    buffer_load_dwordx4 v1, s[12:15], s6 offen offset:2048 lds
    s_add_u32 s6, s6, 24576
    s_cmp_ge_u32 s6, s38
    s_cselect_b32 s6, s47, s6
L_k1_done:
    s_waitcnt vmcnt(0)
L_k1_end:
    s_endpgm
.globl grn_kernel
.p2align 8
.type grn_kernel,@function
grn_kernel:
    s_cmp_gt_u32 s2, 144
    s_cbranch_scc1 L_km_end
    s_load_dwordx16 s[64:79], s[0:1], 0
    s_load_dwordx2 s[80:81], s[0:1], 64
    s_cmp_eq_u32 s2, 144
    s_cbranch_scc1 L_km_bias
    v_lshrrev_b32 v1, 6, v0
    v_and_b32 v2, 15, v0
    v_readfirstlane_b32 s3, v1
    v_bfe_u32 v3, v0, 4, 2
    s_mul_i32 s4, s2, 43691
    s_lshr_b32 s4, s4, 17
    s_mul_i32 s5, s4, 3
    s_sub_u32 s5, s2, s5
    s_lshl_b32 s5, s5, 3
    s_add_u32 s5, s5, s3
    s_mul_i32 s6, s5, 43
    s_lshr_b32 s6, s6, 8
    s_mul_i32 s6, s6, 90
    s_add_u32 s6, s6, s5
    v_mul_u32_u24 v4, 6, v2
    v_add_u32 v4, s6, v4
    v_and_b32 v5, 1, v3
    v_lshlrev_b32 v5, 4, v5
    v_lshrrev_b32 v6, 1, v3
    v_lshl_add_u32 v5, v6, 2, v5
    v_mul_u32_u24 v6, 768, v5
    v_lshl_add_u32 v6, v4, 1, v6
    s_mul_i32 s7, s4, 24576
    s_waitcnt lgkmcnt(0)
    s_mov_b32 s8, s70
    s_and_b32 s9, s71, 0xffff
    s_mov_b32 s10, 0x120000
    s_mov_b32 s11, 0x20000
    s_add_u32 s12, s80, 0x14640000
    s_addc_u32 s13, s81, 0
    s_and_b32 s13, s13, 0xffff
    s_mov_b32 s14, 0xc000
    s_mov_b32 s15, 0x20000
    s_add_u32 s16, s80, 0x14520000
    s_addc_u32 s17, s81, 0
    s_and_b32 s17, s17, 0xffff
    s_mov_b32 s18, 0x120000
    s_mov_b32 s19, 0x20000
    s_mov_b32 s20, s72
    s_and_b32 s21, s73, 0xffff
    s_mov_b32 s22, 0xc00
    s_mov_b32 s23, 0x20000
    v_lshlrev_b32 v7, 2, v0
    s_mov_b32 s24, 0
    buffer_load_dword v32, v7, s[12:15], s24 offen offset:0
    buffer_load_dword v33, v7, s[12:15], s24 offen offset:2048
    s_add_u32 s24, s24, 4096
    buffer_load_dword v34, v7, s[12:15], s24 offen offset:0
    s_add_u32 s24, s24, 2048
    buffer_load_dword v35, v7, s[12:15], s24 offen offset:0
    buffer_load_dword v36, v7, s[12:15], s24 offen offset:2048
    s_add_u32 s24, s24, 4096
    buffer_load_dword v37, v7, s[12:15], s24 offen offset:0
    s_add_u32 s24, s24, 2048
    buffer_load_dword v38, v7, s[12:15], s24 offen offset:0
    buffer_load_dword v39, v7, s[12:15], s24 offen offset:2048
    s_add_u32 s24, s24, 4096
    buffer_load_dword v40, v7, s[12:15], s24 offen offset:0
    s_add_u32 s24, s24, 2048
    buffer_load_dword v41, v7, s[12:15], s24 offen offset:0
    buffer_load_dword v42, v7, s[12:15], s24 offen offset:2048
    s_add_u32 s24, s24, 4096
    buffer_load_dword v43, v7, s[12:15], s24 offen offset:0
    s_add_u32 s24, s24, 2048
    buffer_load_dword v44, v7, s[12:15], s24 offen offset:0
    buffer_load_dword v45, v7, s[12:15], s24 offen offset:2048
    s_add_u32 s24, s24, 4096
    buffer_load_dword v46, v7, s[12:15], s24 offen offset:0
    s_add_u32 s24, s24, 2048
    buffer_load_dword v47, v7, s[12:15], s24 offen offset:0
    buffer_load_dword v48, v7, s[12:15], s24 offen offset:2048
    s_add_u32 s24, s24, 4096
    buffer_load_dword v49, v7, s[12:15], s24 offen offset:0
    s_add_u32 s24, s24, 2048
    buffer_load_dword v50, v7, s[12:15], s24 offen offset:0
    buffer_load_dword v51, v7, s[12:15], s24 offen offset:2048
    s_add_u32 s24, s24, 4096
    buffer_load_dword v52, v7, s[12:15], s24 offen offset:0
    s_add_u32 s24, s24, 2048
    buffer_load_dword v53, v7, s[12:15], s24 offen offset:0
    buffer_load_dword v54, v7, s[12:15], s24 offen offset:2048
    s_add_u32 s24, s24, 4096
    buffer_load_dword v55, v7, s[12:15], s24 offen offset:0
    s_add_u32 s24, s24, 2048
    s_add_u32 s25, s7, 6144
    buffer_load_ushort v8, v6, s[8:11], s7 offen offset:0
    buffer_load_ushort v9, v6, s[8:11], s7 offen offset:768
    buffer_load_ushort v10, v6, s[8:11], s7 offen offset:1536
    buffer_load_ushort v11, v6, s[8:11], s7 offen offset:2304
    buffer_load_ushort v12, v6, s[8:11], s25 offen offset:0
    buffer_load_ushort v13, v6, s[8:11], s25 offen offset:768
    buffer_load_ushort v14, v6, s[8:11], s25 offen offset:1536
    buffer_load_ushort v15, v6, s[8:11], s25 offen offset:2304
    v_and_b32 v16, 31, v0
    v_lshlrev_b32 v17, 1, v16
    s_lshl_b32 s26, s4, 6
    buffer_load_ushort v18, v17, s[20:23], s26 offen
    s_waitcnt vmcnt(9)
    v_add_f32 v32, v32, v35
    v_add_f32 v32, v32, v38
    v_add_f32 v32, v32, v41
    v_add_f32 v32, v32, v44
    v_add_f32 v32, v32, v47
    v_add_f32 v32, v32, v50
    v_add_f32 v32, v32, v53
    v_add_f32 v33, v33, v36
    v_add_f32 v33, v33, v39
    v_add_f32 v33, v33, v42
    v_add_f32 v33, v33, v45
    v_add_f32 v33, v33, v48
    v_add_f32 v33, v33, v51
    v_add_f32 v33, v33, v54
    v_add_f32 v34, v34, v37
    v_add_f32 v34, v34, v40
    v_add_f32 v34, v34, v43
    v_add_f32 v34, v34, v46
    v_add_f32 v34, v34, v49
    v_add_f32 v34, v34, v52
    v_add_f32 v34, v34, v55
    s_mov_b32 s27, 0x4091cb7a
    v_mov_b32 v19, 0x358637bd
    v_fma_f32 v32, v32, s27, v19
    v_fma_f32 v33, v33, s27, v19
    v_fma_f32 v34, v34, s27, v19
    v_sqrt_f32 v32, v32
    v_sqrt_f32 v33, v33
    v_sqrt_f32 v34, v34
    s_nop 0
    ds_write_b32 v7, v32 offset:0
    ds_write_b32 v7, v33 offset:2048
    ds_write_b32 v7, v34 offset:4096
    v_add_f32 v20, v32, v33
    v_add_f32 v20, v20, v34
    s_nop 1
    v_add_f32_dpp v20, v20, v20 row_ror:8 row_mask:0xf bank_mask:0xf
    s_nop 1
    v_add_f32_dpp v20, v20, v20 row_ror:4 row_mask:0xf bank_mask:0xf
    s_nop 1
    v_add_f32_dpp v20, v20, v20 row_ror:2 row_mask:0xf bank_mask:0xf
    s_nop 1
    v_add_f32_dpp v20, v20, v20 row_ror:1 row_mask:0xf bank_mask:0xf
    v_mov_b32 v21, v20
    s_nop 1
    v_permlane16_swap_b32 v20, v21
    s_nop 1
    v_add_f32 v20, v20, v21
    v_mov_b32 v21, v20
    s_nop 1
    v_permlane32_swap_b32 v20, v21
    s_nop 1
    v_add_f32 v20, v20, v21
    v_lshlrev_b32 v21, 2, v1
    ds_write_b32 v21, v20 offset:6144
    s_waitcnt lgkmcnt(0)
    s_barrier
    v_mov_b32 v21, 0
    ds_read_b128 v[24:27], v21 offset:6144
    ds_read_b128 v[28:31], v21 offset:6160
    s_lshl_b32 s26, s4, 7
    v_lshl_add_u32 v22, v16, 2, s26
    ds_read_b32 v23, v22
    s_waitcnt lgkmcnt(0)
    v_add_f32 v24, v24, v25
    v_add_f32 v24, v24, v26
    v_add_f32 v24, v24, v27
    v_add_f32 v24, v24, v28
    v_add_f32 v24, v24, v29
    v_add_f32 v24, v24, v30
    v_add_f32 v24, v24, v31
    v_mov_b32 v25, 0x3a2aaaab
    v_fma_f32 v24, v24, v25, v19
    v_rcp_f32 v24, v24
    s_waitcnt vmcnt(0)
    v_lshlrev_b32 v18, 16, v18
    v_mul_f32 v23, v23, v24
    v_fma_f32 v23, v23, v18, 1.0
    v_mul_f32 v23, 0x40089ba4, v23
    v_lshlrev_b32 v21, 7, v1
    v_lshl_add_u32 v22, v16, 2, v21
    ds_write_b32 v22, v23 offset:6400
    v_lshl_add_u32 v22, v5, 2, v21
    s_waitcnt lgkmcnt(0)
    ds_read_b128 v[24:27], v22 offset:6400
    ds_read_b128 v[28:31], v22 offset:6432
    v_lshlrev_b32 v8, 16, v8
    v_lshlrev_b32 v9, 16, v9
    v_lshlrev_b32 v10, 16, v10
    v_lshlrev_b32 v11, 16, v11
    v_lshlrev_b32 v12, 16, v12
    v_lshlrev_b32 v13, 16, v13
    v_lshlrev_b32 v14, 16, v14
    v_lshlrev_b32 v15, 16, v15
    s_waitcnt lgkmcnt(0)
    v_mul_f32 v8, v8, v24
    v_mul_f32 v9, v9, v25
    v_mul_f32 v10, v10, v26
    v_mul_f32 v11, v11, v27
    v_mul_f32 v12, v12, v28
    v_mul_f32 v13, v13, v29
    v_mul_f32 v14, v14, v30
    v_mul_f32 v15, v15, v31
    v_cvt_pk_bf16_f32 v24, v8, v9
    v_cvt_pk_bf16_f32 v25, v10, v11
    v_cvt_pk_bf16_f32 v26, v12, v13
    v_cvt_pk_bf16_f32 v27, v14, v15
    v_and_b32 v21, 63, v0
    v_lshlrev_b32 v21, 4, v21
    s_mul_i32 s28, s5, 43
    s_lshr_b32 s28, s28, 8
    s_mul_i32 s28, s28, 6
    s_add_u32 s28, s28, s5
    s_lshr_b32 s26, s4, 1
    s_mul_i32 s26, s26, 48
    s_add_u32 s26, s26, s28
    s_and_b32 s29, s4, 1
    s_mul_i32 s29, s29, 6
    s_add_u32 s26, s26, s29
    s_lshl_b32 s26, s26, 10
    buffer_store_dwordx4 v[24:27], v21, s[16:19], s26 offen
    s_nop 1
    s_endpgm
L_km_bias:
    s_waitcnt lgkmcnt(0)
    s_add_u32 s8, s80, 0x1464c000
    s_addc_u32 s9, s81, 0
    s_and_b32 s9, s9, 0xffff
    s_mov_b32 s10, 0x12000
    s_mov_b32 s11, 0x20000
    s_add_u32 s12, s80, 0x1465e000
    s_addc_u32 s13, s81, 0
    s_and_b32 s13, s13, 0xffff
    s_mov_b32 s14, 0x600
    s_mov_b32 s15, 0x20000
    v_cmp_gt_u32 vcc, 384, v0
    s_and_saveexec_b64 s[22:23], vcc
    s_cbranch_execz L_km_end
    v_lshlrev_b32 v1, 2, v0
    s_mov_b32 s4, 0
    buffer_load_dword v8, v1, s[8:11], s4 offen offset:0
    buffer_load_dword v9, v1, s[8:11], s4 offen offset:1536
    s_add_u32 s4, s4, 3072
    buffer_load_dword v10, v1, s[8:11], s4 offen offset:0
    buffer_load_dword v11, v1, s[8:11], s4 offen offset:1536
    s_add_u32 s4, s4, 3072
    buffer_load_dword v12, v1, s[8:11], s4 offen offset:0
    buffer_load_dword v13, v1, s[8:11], s4 offen offset:1536
    s_add_u32 s4, s4, 3072
    buffer_load_dword v14, v1, s[8:11], s4 offen offset:0
    buffer_load_dword v15, v1, s[8:11], s4 offen offset:1536
    s_add_u32 s4, s4, 3072
    buffer_load_dword v16, v1, s[8:11], s4 offen offset:0
    buffer_load_dword v17, v1, s[8:11], s4 offen offset:1536
    s_add_u32 s4, s4, 3072
    buffer_load_dword v18, v1, s[8:11], s4 offen offset:0
    buffer_load_dword v19, v1, s[8:11], s4 offen offset:1536
    s_add_u32 s4, s4, 3072
    buffer_load_dword v20, v1, s[8:11], s4 offen offset:0
    buffer_load_dword v21, v1, s[8:11], s4 offen offset:1536
    s_add_u32 s4, s4, 3072
    buffer_load_dword v22, v1, s[8:11], s4 offen offset:0
    buffer_load_dword v23, v1, s[8:11], s4 offen offset:1536
    s_add_u32 s4, s4, 3072
    buffer_load_dword v24, v1, s[8:11], s4 offen offset:0
    buffer_load_dword v25, v1, s[8:11], s4 offen offset:1536
    s_add_u32 s4, s4, 3072
    buffer_load_dword v26, v1, s[8:11], s4 offen offset:0
    buffer_load_dword v27, v1, s[8:11], s4 offen offset:1536
    s_add_u32 s4, s4, 3072
    buffer_load_dword v28, v1, s[8:11], s4 offen offset:0
    buffer_load_dword v29, v1, s[8:11], s4 offen offset:1536
    s_add_u32 s4, s4, 3072
    buffer_load_dword v30, v1, s[8:11], s4 offen offset:0
    buffer_load_dword v31, v1, s[8:11], s4 offen offset:1536
    s_add_u32 s4, s4, 3072
    buffer_load_dword v32, v1, s[8:11], s4 offen offset:0
    buffer_load_dword v33, v1, s[8:11], s4 offen offset:1536
    s_add_u32 s4, s4, 3072
    buffer_load_dword v34, v1, s[8:11], s4 offen offset:0
    buffer_load_dword v35, v1, s[8:11], s4 offen offset:1536
    s_add_u32 s4, s4, 3072
    buffer_load_dword v36, v1, s[8:11], s4 offen offset:0
    buffer_load_dword v37, v1, s[8:11], s4 offen offset:1536
    s_add_u32 s4, s4, 3072
    buffer_load_dword v38, v1, s[8:11], s4 offen offset:0
    buffer_load_dword v39, v1, s[8:11], s4 offen offset:1536
    s_add_u32 s4, s4, 3072
    buffer_load_dword v40, v1, s[8:11], s4 offen offset:0
    buffer_load_dword v41, v1, s[8:11], s4 offen offset:1536
    s_add_u32 s4, s4, 3072
    buffer_load_dword v42, v1, s[8:11], s4 offen offset:0
    buffer_load_dword v43, v1, s[8:11], s4 offen offset:1536
    s_add_u32 s4, s4, 3072
    buffer_load_dword v44, v1, s[8:11], s4 offen offset:0
    buffer_load_dword v45, v1, s[8:11], s4 offen offset:1536
    s_add_u32 s4, s4, 3072
    buffer_load_dword v46, v1, s[8:11], s4 offen offset:0
    buffer_load_dword v47, v1, s[8:11], s4 offen offset:1536
    s_add_u32 s4, s4, 3072
    buffer_load_dword v48, v1, s[8:11], s4 offen offset:0
    buffer_load_dword v49, v1, s[8:11], s4 offen offset:1536
    s_add_u32 s4, s4, 3072
    buffer_load_dword v50, v1, s[8:11], s4 offen offset:0
    buffer_load_dword v51, v1, s[8:11], s4 offen offset:1536
    s_add_u32 s4, s4, 3072
    buffer_load_dword v52, v1, s[8:11], s4 offen offset:0
    buffer_load_dword v53, v1, s[8:11], s4 offen offset:1536
    s_add_u32 s4, s4, 3072
    buffer_load_dword v54, v1, s[8:11], s4 offen offset:0
    buffer_load_dword v55, v1, s[8:11], s4 offen offset:1536
    s_add_u32 s4, s4, 3072
    s_waitcnt vmcnt(46)
    v_add_f32 v8, v8, v9
    s_waitcnt vmcnt(45)
    v_add_f32 v8, v8, v10
    s_waitcnt vmcnt(44)
    v_add_f32 v8, v8, v11
    s_waitcnt vmcnt(43)
    v_add_f32 v8, v8, v12
    s_waitcnt vmcnt(42)
    v_add_f32 v8, v8, v13
    s_waitcnt vmcnt(41)
    v_add_f32 v8, v8, v14
    s_waitcnt vmcnt(40)
    v_add_f32 v8, v8, v15
    s_waitcnt vmcnt(39)
    v_add_f32 v8, v8, v16
    s_waitcnt vmcnt(38)
    v_add_f32 v8, v8, v17
    s_waitcnt vmcnt(37)
    v_add_f32 v8, v8, v18
    s_waitcnt vmcnt(36)
    v_add_f32 v8, v8, v19
    s_waitcnt vmcnt(35)
    v_add_f32 v8, v8, v20
    s_waitcnt vmcnt(34)
    v_add_f32 v8, v8, v21
    s_waitcnt vmcnt(33)
    v_add_f32 v8, v8, v22
    s_waitcnt vmcnt(32)
    v_add_f32 v8, v8, v23
    s_waitcnt vmcnt(31)
    v_add_f32 v8, v8, v24
    s_waitcnt vmcnt(30)
    v_add_f32 v8, v8, v25
    s_waitcnt vmcnt(29)
    v_add_f32 v8, v8, v26
    s_waitcnt vmcnt(28)
    v_add_f32 v8, v8, v27
    s_waitcnt vmcnt(27)
    v_add_f32 v8, v8, v28
    s_waitcnt vmcnt(26)
    v_add_f32 v8, v8, v29
    s_waitcnt vmcnt(25)
    v_add_f32 v8, v8, v30
    s_waitcnt vmcnt(24)
    v_add_f32 v8, v8, v31
    s_waitcnt vmcnt(23)
    v_add_f32 v8, v8, v32
    s_waitcnt vmcnt(22)
    v_add_f32 v8, v8, v33
    s_waitcnt vmcnt(21)
    v_add_f32 v8, v8, v34
    s_waitcnt vmcnt(20)
    v_add_f32 v8, v8, v35
    s_waitcnt vmcnt(19)
    v_add_f32 v8, v8, v36
    s_waitcnt vmcnt(18)
    v_add_f32 v8, v8, v37
    s_waitcnt vmcnt(17)
    v_add_f32 v8, v8, v38
    s_waitcnt vmcnt(16)
    v_add_f32 v8, v8, v39
    s_waitcnt vmcnt(15)
    v_add_f32 v8, v8, v40
    s_waitcnt vmcnt(14)
    v_add_f32 v8, v8, v41
    s_waitcnt vmcnt(13)
    v_add_f32 v8, v8, v42
    s_waitcnt vmcnt(12)
    v_add_f32 v8, v8, v43
    s_waitcnt vmcnt(11)
    v_add_f32 v8, v8, v44
    s_waitcnt vmcnt(10)
    v_add_f32 v8, v8, v45
    s_waitcnt vmcnt(9)
    v_add_f32 v8, v8, v46
    s_waitcnt vmcnt(8)
    v_add_f32 v8, v8, v47
    s_waitcnt vmcnt(7)
    v_add_f32 v8, v8, v48
    s_waitcnt vmcnt(6)
    v_add_f32 v8, v8, v49
    s_waitcnt vmcnt(5)
    v_add_f32 v8, v8, v50
    s_waitcnt vmcnt(4)
    v_add_f32 v8, v8, v51
    s_waitcnt vmcnt(3)
    v_add_f32 v8, v8, v52
    s_waitcnt vmcnt(2)
    v_add_f32 v8, v8, v53
    s_waitcnt vmcnt(1)
    v_add_f32 v8, v8, v54
    s_waitcnt vmcnt(0)
    v_add_f32 v8, v8, v55
    v_lshlrev_b32 v2, 2, v0
    buffer_store_dword v8, v2, s[12:15], 0 offen
L_km_end:
    s_endpgm
.globl gemm2_kernel
.p2align 8
.type gemm2_kernel,@function
gemm2_kernel:
    s_cmp_ge_u32 s2, 256
    s_cbranch_scc1 L_k2_end
    s_load_dwordx16 s[64:79], s[0:1], 0
    s_load_dwordx2 s[80:81], s[0:1], 64
    v_lshrrev_b32 v32, 6, v0
    v_and_b32 v33, 63, v0
    v_readfirstlane_b32 s3, v32
    v_and_b32 v34, 15, v0
    v_bfe_u32 v35, v0, 4, 2
    s_mul_i32 s32, s3, 6144
    v_lshl_add_u32 v1, v33, 4, s32
    v_add_u32 v2, s32, v1
    s_lshr_b32 s33, s32, 1
    s_add_u32 s33, s33, 73728
    v_lshl_add_u32 v7, v33, 4, s33
    v_add_u32 v21, 49152, v7
    v_lshrrev_b32 v36, 1, v35
    v_lshlrev_b32 v3, 8, v36
    v_and_b32 v36, 3, v34
    v_lshl_add_u32 v3, v36, 6, v3
    v_lshrrev_b32 v36, 2, v34
    v_lshl_add_u32 v3, v36, 4, v3
    v_and_b32 v36, 1, v35
    v_lshl_add_u32 v3, v36, 3, v3
    v_add_u32 v4, 49152, v3
    v_mul_u32_u24 v41, 18432, v35
    v_mul_u32_u24 v36, 12, v34
    v_add_u32 v41, v41, v36
    s_mul_i32 s34, s3, 192
    s_add_u32 s33, s34, 73728
    v_mul_u32_u24 v5, 3072, v35
    v_add3_u32 v5, v5, v36, s33
    v_add_u32 v6, 49152, v5
    s_mul_i32 s35, s3, 12096
    s_mov_b32 s44, 0x40000000
    s_mov_b32 s26, s2
    s_mov_b32 s28, 0
    s_mov_b32 s41, 0x40000000
    s_waitcnt lgkmcnt(0)
    s_mov_b32 s8, s80
    s_and_b32 s9, s81, 0xffff
    s_mov_b32 s10, 0x14400000
    s_mov_b32 s11, 0x20000
    s_mov_b32 s12, s64
    s_and_b32 s13, s65, 0xffff
    s_mov_b32 s14, 0x6c00000
    s_mov_b32 s15, 0x20000
    s_mov_b32 s16, s76
    s_and_b32 s17, s77, 0xffff
    s_mov_b32 s18, 0x6c00000
    s_mov_b32 s19, 0x20000
    s_add_u32 s20, s80, 0x1465e000
    s_addc_u32 s21, s81, 0
    s_and_b32 s21, s21, 0xffff
    s_mov_b32 s22, 0x600
    s_mov_b32 s23, 0x20000
    s_add_u32 s52, s80, 0x14520000
    s_addc_u32 s53, s81, 0
    s_and_b32 s53, s53, 0xffff
    s_mov_b32 s54, 0x120000
    s_mov_b32 s55, 0x20000
    s_lshr_b32 s39, s32, 1
    s_sub_u32 s37, 24576, s39
    s_add_u32 s56, s80, s37
    s_addc_u32 s57, s81, 0
    s_and_b32 s57, s57, 0xffff
    s_sub_u32 s58, 0x14400000, s37
    s_mov_b32 s59, 0x20000
    s_sub_u32 s60, s76, s39
    s_subb_u32 s61, s77, 0
    s_and_b32 s61, s61, 0xffff
    s_add_u32 s62, s39, 0x6c00000
    s_mov_b32 s63, 0x20000
    s_mul_i32 s4, s26, 442368
    s_mul_i32 s29, s26, 147456
    s_add_u32 s5, s4, 4096
    s_add_u32 m0, s32, 0
    s_nop 0
    buffer_load_dwordx4 v1, s[8:11], s4 offen offset:0 nt lds
    s_add_u32 m0, s32, 0
    s_nop 0
    buffer_load_dwordx4 v1, s[8:11], s4 offen offset:1024 nt lds
    s_add_u32 m0, s32, 0
    s_nop 0
    buffer_load_dwordx4 v1, s[8:11], s4 offen offset:2048 nt lds
    s_add_u32 m0, s32, 0
    s_nop 0
    buffer_load_dwordx4 v1, s[8:11], s4 offen offset:3072 nt lds
    s_add_u32 m0, s32, 4096
    s_nop 0
    buffer_load_dwordx4 v1, s[8:11], s5 offen offset:0 nt lds
    s_add_u32 m0, s32, 4096
    s_nop 0
    buffer_load_dwordx4 v1, s[8:11], s5 offen offset:1024 nt lds
    s_mov_b32 s6, 0
    s_nop 0
    buffer_load_dwordx4 a[96:99], v2, s[52:55], s6 offen offset:0
    buffer_load_dwordx4 a[100:103], v2, s[52:55], s6 offen offset:1024
    buffer_load_dwordx4 a[104:107], v2, s[52:55], s6 offen offset:2048
    buffer_load_dwordx4 a[108:111], v2, s[52:55], s6 offen offset:3072
    s_mov_b32 s6, 4096
    s_nop 0
    buffer_load_dwordx4 a[112:115], v2, s[52:55], s6 offen offset:0
    buffer_load_dwordx4 a[116:119], v2, s[52:55], s6 offen offset:1024
    buffer_load_dwordx4 a[120:123], v2, s[52:55], s6 offen offset:2048
    buffer_load_dwordx4 a[124:127], v2, s[52:55], s6 offen offset:3072
    s_mov_b32 s6, 8192
    s_nop 0
    buffer_load_dwordx4 a[128:131], v2, s[52:55], s6 offen offset:0
    buffer_load_dwordx4 a[132:135], v2, s[52:55], s6 offen offset:1024
    buffer_load_dwordx4 a[136:139], v2, s[52:55], s6 offen offset:2048
    buffer_load_dwordx4 a[140:143], v2, s[52:55], s6 offen offset:3072
    v_lshlrev_b32 v36, 1, v36
    s_lshl_b32 s33, s34, 1
    s_mov_b32 s36, 0xffff0000
    s_getpc_b64 s[24:25]
L_k2_pc:
    v_lshlrev_b32 v37, 7, v0
    v_min_u32 v38, L_k2_end-L_k2_pc-0x8000, v37
    v_add_u32 v38, 0x8000, v38
    v_lshlrev_b32 v23, 7, v33
    v_min_u32 v23, L_k2_end-L_k2_last, v23
    v_add_u32 v23, L_k2_last-L_k2_pc, v23
    v_mov_b32 v0, v41
    global_load_dword v39, v37, s[24:25]
    s_waitcnt vmcnt(13)
    s_barrier
    ds_read_b64_tr_b16 a[240:241], v3 offset:0
    ds_read_b64_tr_b16 a[242:243], v3 offset:512
    ds_read_b64_tr_b16 a[244:245], v3 offset:12288
    ds_read_b64_tr_b16 a[246:247], v3 offset:12800
    ds_read_b64_tr_b16 a[248:249], v3 offset:1024
    ds_read_b64_tr_b16 a[250:251], v3 offset:1536
    ds_read_b64_tr_b16 a[252:253], v3 offset:13312
    ds_read_b64_tr_b16 a[254:255], v3 offset:13824
    s_waitcnt lgkmcnt(0)
    s_waitcnt vmcnt(12)
    v_mfma_f32_16x16x32_bf16 v[64:67], a[240:243], a[96:99], 0
    s_waitcnt vmcnt(6)
    v_mfma_f32_16x16x32_bf16 v[64:67], a[244:247], a[120:123], v[64:67]
    ds_read_b64_tr_b16 v[56:57], v3 offset:2048
    s_waitcnt vmcnt(5)
    v_mfma_f32_16x16x32_bf16 v[68:71], a[244:247], a[124:127], 0
    v_mfma_f32_16x16x32_bf16 v[68:71], a[240:243], a[100:103], v[68:71]
    ds_read_b64_tr_b16 v[58:59], v3 offset:2560
    v_mfma_f32_16x16x32_bf16 v[72:75], a[240:243], a[104:107], 0
    s_waitcnt vmcnt(4)
    v_mfma_f32_16x16x32_bf16 v[72:75], a[244:247], a[128:131], v[72:75]
    ds_read_b64_tr_b16 v[60:61], v3 offset:14336
    s_waitcnt vmcnt(3)
    v_mfma_f32_16x16x32_bf16 v[76:79], a[244:247], a[132:135], 0
    v_mfma_f32_16x16x32_bf16 v[76:79], a[240:243], a[108:111], v[76:79]
    ds_read_b64_tr_b16 v[62:63], v3 offset:14848
    v_mfma_f32_16x16x32_bf16 v[80:83], a[240:243], a[112:115], 0
    s_waitcnt vmcnt(2)
    v_mfma_f32_16x16x32_bf16 v[80:83], a[244:247], a[136:139], v[80:83]
    s_waitcnt vmcnt(1)
    v_mfma_f32_16x16x32_bf16 v[84:87], a[244:247], a[140:143], 0
    v_mfma_f32_16x16x32_bf16 v[84:87], a[240:243], a[116:119], v[84:87]
    v_mfma_f32_16x16x32_bf16 v[108:111], a[248:251], a[116:119], 0
    v_mfma_f32_16x16x32_bf16 v[108:111], a[252:255], a[140:143], v[108:111]
    ds_read_b64_tr_b16 a[240:241], v3 offset:3072
    s_add_u32 m0, s39, 24576
    v_mfma_f32_16x16x32_bf16 v[104:107], a[252:255], a[136:139], 0
    buffer_load_dwordx4 v1, s[56:59], s4 offen offset:0 nt lds
    v_mfma_f32_16x16x32_bf16 v[104:107], a[248:251], a[112:115], v[104:107]
    ds_read_b64_tr_b16 a[242:243], v3 offset:3584
    v_mfma_f32_16x16x32_bf16 v[100:103], a[248:251], a[108:111], 0
    s_add_u32 m0, s39, 24576
    v_mfma_f32_16x16x32_bf16 v[100:103], a[252:255], a[132:135], v[100:103]
    ds_read_b64_tr_b16 a[244:245], v3 offset:15360
    buffer_load_dwordx4 v1, s[56:59], s4 offen offset:1024 nt lds
    v_mfma_f32_16x16x32_bf16 v[96:99], a[252:255], a[128:131], 0
    v_mfma_f32_16x16x32_bf16 v[96:99], a[248:251], a[104:107], v[96:99]
    ds_read_b64_tr_b16 a[246:247], v3 offset:15872
    s_add_u32 m0, s39, 24576
    v_mfma_f32_16x16x32_bf16 v[92:95], a[248:251], a[100:103], 0
    buffer_load_dwordx4 v1, s[56:59], s4 offen offset:2048 nt lds
    v_mfma_f32_16x16x32_bf16 v[92:95], a[252:255], a[124:127], v[92:95]
    v_mfma_f32_16x16x32_bf16 v[88:91], a[252:255], a[120:123], 0
    s_add_u32 m0, s39, 36864
    v_mfma_f32_16x16x32_bf16 v[88:91], a[248:251], a[96:99], v[88:91]
    buffer_load_dwordx4 v1, s[60:63], s29 offen offset:0 nt lds
    s_waitcnt lgkmcnt(4)
    v_mfma_f32_16x16x32_bf16 a[0:3], v[56:59], a[96:99], 0
    v_mfma_f32_16x16x32_bf16 a[0:3], v[60:63], a[120:123], a[0:3]
    ds_read_b64_tr_b16 a[248:249], v3 offset:4096
    s_add_u32 m0, s39, 36864
    v_mfma_f32_16x16x32_bf16 a[4:7], v[60:63], a[124:127], 0
    buffer_load_dwordx4 v1, s[60:63], s29 offen offset:1024 nt lds
    v_mfma_f32_16x16x32_bf16 a[4:7], v[56:59], a[100:103], a[4:7]
    ds_read_b64_tr_b16 a[250:251], v3 offset:4608
    v_mfma_f32_16x16x32_bf16 a[8:11], v[56:59], a[104:107], 0
    s_add_u32 m0, s39, 36864
    v_mfma_f32_16x16x32_bf16 a[8:11], v[60:63], a[128:131], a[8:11]
    ds_read_b64_tr_b16 a[252:253], v3 offset:16384
    buffer_load_dwordx4 v1, s[60:63], s29 offen offset:2048 nt lds
    v_mfma_f32_16x16x32_bf16 a[12:15], v[60:63], a[132:135], 0
    v_mfma_f32_16x16x32_bf16 a[12:15], v[56:59], a[108:111], a[12:15]
    ds_read_b64_tr_b16 a[254:255], v3 offset:16896
    s_mov_b32 s6, 49152
    v_mfma_f32_16x16x32_bf16 a[16:19], v[56:59], a[112:115], 0
    buffer_load_dwordx4 a[144:147], v2, s[52:55], s6 offen offset:0
    v_mfma_f32_16x16x32_bf16 a[16:19], v[60:63], a[136:139], a[16:19]
    v_mfma_f32_16x16x32_bf16 a[20:23], v[60:63], a[140:143], 0
    v_mfma_f32_16x16x32_bf16 a[20:23], v[56:59], a[116:119], a[20:23]
    buffer_load_dwordx4 a[148:151], v2, s[52:55], s6 offen offset:1024
    s_waitcnt lgkmcnt(4)
    v_mfma_f32_16x16x32_bf16 v[132:135], a[240:243], a[116:119], 0
    v_mfma_f32_16x16x32_bf16 v[132:135], a[244:247], a[140:143], v[132:135]
    ds_read_b64_tr_b16 v[56:57], v3 offset:5120
    v_mfma_f32_16x16x32_bf16 v[128:131], a[244:247], a[136:139], 0
    buffer_load_dwordx4 a[152:155], v2, s[52:55], s6 offen offset:2048
    v_mfma_f32_16x16x32_bf16 v[128:131], a[240:243], a[112:115], v[128:131]
    ds_read_b64_tr_b16 v[58:59], v3 offset:5632
    v_mfma_f32_16x16x32_bf16 v[124:127], a[240:243], a[108:111], 0
    v_mfma_f32_16x16x32_bf16 v[124:127], a[244:247], a[132:135], v[124:127]
    ds_read_b64_tr_b16 v[60:61], v3 offset:17408
    buffer_load_dwordx4 a[156:159], v2, s[52:55], s6 offen offset:3072
    v_mfma_f32_16x16x32_bf16 v[120:123], a[244:247], a[128:131], 0
    v_mfma_f32_16x16x32_bf16 v[120:123], a[240:243], a[104:107], v[120:123]
    ds_read_b64_tr_b16 v[62:63], v3 offset:17920
    s_mov_b32 s6, 53248
    v_mfma_f32_16x16x32_bf16 v[116:119], a[240:243], a[100:103], 0
    buffer_load_dwordx4 a[160:163], v2, s[52:55], s6 offen offset:0
    v_mfma_f32_16x16x32_bf16 v[116:119], a[244:247], a[124:127], v[116:119]
    v_mfma_f32_16x16x32_bf16 v[112:115], a[244:247], a[120:123], 0
    v_mfma_f32_16x16x32_bf16 v[112:115], a[240:243], a[96:99], v[112:115]
    buffer_load_dwordx4 a[164:167], v2, s[52:55], s6 offen offset:1024
    s_waitcnt lgkmcnt(4)
    v_mfma_f32_16x16x32_bf16 v[136:139], a[248:251], a[96:99], 0
    v_mfma_f32_16x16x32_bf16 v[136:139], a[252:255], a[120:123], v[136:139]
    ds_read_b64_tr_b16 a[240:241], v3 offset:6144
    v_mfma_f32_16x16x32_bf16 v[140:143], a[252:255], a[124:127], 0
    buffer_load_dwordx4 a[168:171], v2, s[52:55], s6 offen offset:2048
    v_mfma_f32_16x16x32_bf16 v[140:143], a[248:251], a[100:103], v[140:143]
    ds_read_b64_tr_b16 a[242:243], v3 offset:6656
    v_mfma_f32_16x16x32_bf16 v[144:147], a[248:251], a[104:107], 0
    v_mfma_f32_16x16x32_bf16 v[144:147], a[252:255], a[128:131], v[144:147]
    ds_read_b64_tr_b16 a[244:245], v3 offset:18432
    buffer_load_dwordx4 a[172:175], v2, s[52:55], s6 offen offset:3072
    v_mfma_f32_16x16x32_bf16 v[148:151], a[252:255], a[132:135], 0
    v_mfma_f32_16x16x32_bf16 v[148:151], a[248:251], a[108:111], v[148:151]
    ds_read_b64_tr_b16 a[246:247], v3 offset:18944
    s_mov_b32 s6, 57344
    v_mfma_f32_16x16x32_bf16 v[152:155], a[248:251], a[112:115], 0
    buffer_load_dwordx4 a[176:179], v2, s[52:55], s6 offen offset:0
    v_mfma_f32_16x16x32_bf16 v[152:155], a[252:255], a[136:139], v[152:155]
    v_mfma_f32_16x16x32_bf16 v[156:159], a[252:255], a[140:143], 0
    v_mfma_f32_16x16x32_bf16 v[156:159], a[248:251], a[116:119], v[156:159]
    buffer_load_dwordx4 a[180:183], v2, s[52:55], s6 offen offset:1024
    s_waitcnt lgkmcnt(4)
    v_mfma_f32_16x16x32_bf16 a[44:47], v[56:59], a[116:119], 0
    v_mfma_f32_16x16x32_bf16 a[44:47], v[60:63], a[140:143], a[44:47]
    ds_read_b64_tr_b16 a[248:249], v3 offset:7168
    v_mfma_f32_16x16x32_bf16 a[40:43], v[60:63], a[136:139], 0
    buffer_load_dwordx4 a[184:187], v2, s[52:55], s6 offen offset:2048
    v_mfma_f32_16x16x32_bf16 a[40:43], v[56:59], a[112:115], a[40:43]
    ds_read_b64_tr_b16 a[250:251], v3 offset:7680
    v_mfma_f32_16x16x32_bf16 a[36:39], v[56:59], a[108:111], 0
    v_mfma_f32_16x16x32_bf16 a[36:39], v[60:63], a[132:135], a[36:39]
    ds_read_b64_tr_b16 a[252:253], v3 offset:19456
    buffer_load_dwordx4 a[188:191], v2, s[52:55], s6 offen offset:3072
    v_mfma_f32_16x16x32_bf16 a[32:35], v[60:63], a[128:131], 0
    v_mfma_f32_16x16x32_bf16 a[32:35], v[56:59], a[104:107], a[32:35]
    ds_read_b64_tr_b16 a[254:255], v3 offset:19968
    v_mfma_f32_16x16x32_bf16 a[28:31], v[56:59], a[100:103], 0
    buffer_load_dwordx4 v[8:11], v36, s[20:23], s33 offen
    v_mfma_f32_16x16x32_bf16 a[28:31], v[60:63], a[124:127], a[28:31]
    v_mfma_f32_16x16x32_bf16 a[24:27], v[60:63], a[120:123], 0
    v_mfma_f32_16x16x32_bf16 a[24:27], v[56:59], a[96:99], a[24:27]
    buffer_load_dwordx2 v[12:13], v36, s[20:23], s33 offen offset:16
    s_waitcnt lgkmcnt(4)
    v_mfma_f32_16x16x32_bf16 v[160:163], a[240:243], a[96:99], 0
    v_mfma_f32_16x16x32_bf16 v[160:163], a[244:247], a[120:123], v[160:163]
    ds_read_b64_tr_b16 v[56:57], v3 offset:8192
    v_mfma_f32_16x16x32_bf16 v[164:167], a[244:247], a[124:127], 0
    global_load_dword v40, v38, s[24:25]
    v_mfma_f32_16x16x32_bf16 v[164:167], a[240:243], a[100:103], v[164:167]
    ds_read_b64_tr_b16 v[58:59], v3 offset:8704
    v_mfma_f32_16x16x32_bf16 v[168:171], a[240:243], a[104:107], 0
    s_add_u32 s4, s4, 36864
    s_add_u32 s29, s29, 12288
    s_add_u32 s5, s4, 4096
    s_add_u32 m0, s32, 49152
    v_mfma_f32_16x16x32_bf16 v[168:171], a[244:247], a[128:131], v[168:171]
    ds_read_b64_tr_b16 v[60:61], v3 offset:20480
    buffer_load_dwordx4 v1, s[8:11], s4 offen offset:0 nt lds
    v_mfma_f32_16x16x32_bf16 v[172:175], a[244:247], a[132:135], 0
    v_mfma_f32_16x16x32_bf16 v[172:175], a[240:243], a[108:111], v[172:175]
    ds_read_b64_tr_b16 v[62:63], v3 offset:20992
    s_add_u32 m0, s32, 49152
    v_mfma_f32_16x16x32_bf16 v[176:179], a[240:243], a[112:115], 0
    buffer_load_dwordx4 v1, s[8:11], s4 offen offset:1024 nt lds
    v_mfma_f32_16x16x32_bf16 v[176:179], a[244:247], a[136:139], v[176:179]
    v_mfma_f32_16x16x32_bf16 v[180:183], a[244:247], a[140:143], 0
    s_add_u32 m0, s32, 49152
    v_mfma_f32_16x16x32_bf16 v[180:183], a[240:243], a[116:119], v[180:183]
    buffer_load_dwordx4 v1, s[8:11], s4 offen offset:2048 nt lds
    s_waitcnt lgkmcnt(4)
    v_mfma_f32_16x16x32_bf16 v[204:207], a[248:251], a[116:119], 0
    v_mfma_f32_16x16x32_bf16 v[204:207], a[252:255], a[140:143], v[204:207]
    ds_read_b64_tr_b16 a[240:241], v3 offset:9216
    s_add_u32 m0, s32, 49152
    v_mfma_f32_16x16x32_bf16 v[200:203], a[252:255], a[136:139], 0
    buffer_load_dwordx4 v1, s[8:11], s4 offen offset:3072 nt lds
    v_mfma_f32_16x16x32_bf16 v[200:203], a[248:251], a[112:115], v[200:203]
    ds_read_b64_tr_b16 a[242:243], v3 offset:9728
    v_mfma_f32_16x16x32_bf16 v[196:199], a[248:251], a[108:111], 0
    s_add_u32 m0, s32, 53248
    v_mfma_f32_16x16x32_bf16 v[196:199], a[252:255], a[132:135], v[196:199]
    ds_read_b64_tr_b16 a[244:245], v3 offset:21504
    buffer_load_dwordx4 v1, s[8:11], s5 offen offset:0 nt lds
    v_mfma_f32_16x16x32_bf16 v[192:195], a[252:255], a[128:131], 0
    v_mfma_f32_16x16x32_bf16 v[192:195], a[248:251], a[104:107], v[192:195]
    ds_read_b64_tr_b16 a[246:247], v3 offset:22016
    s_add_u32 m0, s32, 53248
    v_mfma_f32_16x16x32_bf16 v[188:191], a[248:251], a[100:103], 0
    buffer_load_dwordx4 v1, s[8:11], s5 offen offset:1024 nt lds
    v_mfma_f32_16x16x32_bf16 v[188:191], a[252:255], a[124:127], v[188:191]
    v_mfma_f32_16x16x32_bf16 v[184:187], a[252:255], a[120:123], 0
    s_mov_b32 s6, 98304
    v_mfma_f32_16x16x32_bf16 v[184:187], a[248:251], a[96:99], v[184:187]
    buffer_load_dwordx4 a[192:195], v2, s[52:55], s6 offen offset:0
    s_waitcnt lgkmcnt(4)
    v_mfma_f32_16x16x32_bf16 a[48:51], v[56:59], a[96:99], 0
    v_mfma_f32_16x16x32_bf16 a[48:51], v[60:63], a[120:123], a[48:51]
    ds_read_b64_tr_b16 a[248:249], v3 offset:10240
    v_mfma_f32_16x16x32_bf16 a[52:55], v[60:63], a[124:127], 0
    buffer_load_dwordx4 a[196:199], v2, s[52:55], s6 offen offset:1024
    v_mfma_f32_16x16x32_bf16 a[52:55], v[56:59], a[100:103], a[52:55]
    ds_read_b64_tr_b16 a[250:251], v3 offset:10752
    v_mfma_f32_16x16x32_bf16 a[56:59], v[56:59], a[104:107], 0
    v_mfma_f32_16x16x32_bf16 a[56:59], v[60:63], a[128:131], a[56:59]
    ds_read_b64_tr_b16 a[252:253], v3 offset:22528
    buffer_load_dwordx4 a[200:203], v2, s[52:55], s6 offen offset:2048
    v_mfma_f32_16x16x32_bf16 a[60:63], v[60:63], a[132:135], 0
    v_mfma_f32_16x16x32_bf16 a[60:63], v[56:59], a[108:111], a[60:63]
    ds_read_b64_tr_b16 a[254:255], v3 offset:23040
    v_mfma_f32_16x16x32_bf16 a[64:67], v[56:59], a[112:115], 0
    buffer_load_dwordx4 a[204:207], v2, s[52:55], s6 offen offset:3072
    v_mfma_f32_16x16x32_bf16 a[64:67], v[60:63], a[136:139], a[64:67]
    v_mfma_f32_16x16x32_bf16 a[68:71], v[60:63], a[140:143], 0
    s_mov_b32 s6, 102400
    v_mfma_f32_16x16x32_bf16 a[68:71], v[56:59], a[116:119], a[68:71]
    buffer_load_dwordx4 a[208:211], v2, s[52:55], s6 offen offset:0
    s_waitcnt lgkmcnt(4)
    v_mfma_f32_16x16x32_bf16 v[228:231], a[240:243], a[116:119], 0
    v_mfma_f32_16x16x32_bf16 v[228:231], a[244:247], a[140:143], v[228:231]
    ds_read_b64_tr_b16 v[56:57], v3 offset:11264
    v_mfma_f32_16x16x32_bf16 v[224:227], a[244:247], a[136:139], 0
    buffer_load_dwordx4 a[212:215], v2, s[52:55], s6 offen offset:1024
    v_mfma_f32_16x16x32_bf16 v[224:227], a[240:243], a[112:115], v[224:227]
    ds_read_b64_tr_b16 v[58:59], v3 offset:11776
    v_mfma_f32_16x16x32_bf16 v[220:223], a[240:243], a[108:111], 0
    v_mfma_f32_16x16x32_bf16 v[220:223], a[244:247], a[132:135], v[220:223]
    ds_read_b64_tr_b16 v[60:61], v3 offset:23552
    buffer_load_dwordx4 a[216:219], v2, s[52:55], s6 offen offset:2048
    v_mfma_f32_16x16x32_bf16 v[216:219], a[244:247], a[128:131], 0
    v_mfma_f32_16x16x32_bf16 v[216:219], a[240:243], a[104:107], v[216:219]
    ds_read_b64_tr_b16 v[62:63], v3 offset:24064
    v_mfma_f32_16x16x32_bf16 v[212:215], a[240:243], a[100:103], 0
    buffer_load_dwordx4 a[220:223], v2, s[52:55], s6 offen offset:3072
    v_mfma_f32_16x16x32_bf16 v[212:215], a[244:247], a[124:127], v[212:215]
    v_mfma_f32_16x16x32_bf16 v[208:211], a[244:247], a[120:123], 0
    s_mov_b32 s6, 106496
    v_mfma_f32_16x16x32_bf16 v[208:211], a[240:243], a[96:99], v[208:211]
    buffer_load_dwordx4 a[224:227], v2, s[52:55], s6 offen offset:0
    s_waitcnt vmcnt(30) lgkmcnt(0)
    s_barrier
    v_mfma_f32_16x16x32_bf16 v[232:235], a[248:251], a[96:99], 0
    v_mfma_f32_16x16x32_bf16 v[232:235], a[252:255], a[120:123], v[232:235]
    ds_read_b64_tr_b16 a[240:241], v3 offset:24576
    v_mfma_f32_16x16x32_bf16 v[236:239], a[252:255], a[124:127], 0
    buffer_load_dwordx4 a[228:231], v2, s[52:55], s6 offen offset:1024
    v_mfma_f32_16x16x32_bf16 v[236:239], a[248:251], a[100:103], v[236:239]
    ds_read_b64_tr_b16 a[242:243], v3 offset:25088
    v_mfma_f32_16x16x32_bf16 v[240:243], a[248:251], a[104:107], 0
    v_mfma_f32_16x16x32_bf16 v[240:243], a[252:255], a[128:131], v[240:243]
    ds_read_b64_tr_b16 a[244:245], v3 offset:36864
    buffer_load_dwordx4 a[232:235], v2, s[52:55], s6 offen offset:2048
    v_mfma_f32_16x16x32_bf16 v[244:247], a[252:255], a[132:135], 0
    v_mfma_f32_16x16x32_bf16 v[244:247], a[248:251], a[108:111], v[244:247]
    ds_read_b64_tr_b16 a[246:247], v3 offset:37376
    v_mfma_f32_16x16x32_bf16 v[248:251], a[248:251], a[112:115], 0
    buffer_load_dwordx4 a[236:239], v2, s[52:55], s6 offen offset:3072
    v_mfma_f32_16x16x32_bf16 v[248:251], a[252:255], a[136:139], v[248:251]
    v_mfma_f32_16x16x32_bf16 v[252:255], a[252:255], a[140:143], 0
    v_mfma_f32_16x16x32_bf16 v[252:255], a[248:251], a[116:119], v[252:255]
    v_mfma_f32_16x16x32_bf16 a[92:95], v[56:59], a[116:119], 0
    v_mfma_f32_16x16x32_bf16 a[92:95], v[60:63], a[140:143], a[92:95]
    ds_read_b64_tr_b16 a[248:249], v3 offset:25600
    v_mfma_f32_16x16x32_bf16 a[88:91], v[60:63], a[136:139], 0
    v_mfma_f32_16x16x32_bf16 a[88:91], v[56:59], a[112:115], a[88:91]
    ds_read_b64_tr_b16 a[250:251], v3 offset:26112
    v_mfma_f32_16x16x32_bf16 a[84:87], v[56:59], a[108:111], 0
    v_mfma_f32_16x16x32_bf16 a[84:87], v[60:63], a[132:135], a[84:87]
    ds_read_b64_tr_b16 a[252:253], v3 offset:37888
    v_mfma_f32_16x16x32_bf16 a[80:83], v[60:63], a[128:131], 0
    v_mfma_f32_16x16x32_bf16 a[80:83], v[56:59], a[104:107], a[80:83]
    ds_read_b64_tr_b16 a[254:255], v3 offset:38400
    v_mfma_f32_16x16x32_bf16 a[76:79], v[56:59], a[100:103], 0
    v_mfma_f32_16x16x32_bf16 a[76:79], v[60:63], a[124:127], a[76:79]
    v_mfma_f32_16x16x32_bf16 a[72:75], v[60:63], a[120:123], 0
    v_mfma_f32_16x16x32_bf16 a[72:75], v[56:59], a[96:99], a[72:75]
    s_branch L_k2_join
.p2align 6
L_k2_cycle:
    s_waitcnt vmcnt(24)
    s_waitcnt lgkmcnt(14)
    v_mfma_f32_16x16x32_bf16 v[64:67], a[240:243], a[96:99], 0
    s_add_u32 s42, s41, 12288
    buffer_store_dwordx3 v[32:34], v0, s[16:19], s42 offen offset:1536
    v_cvt_pk_bf16_f32 v28, v163, v167
    v_mfma_f32_16x16x32_bf16 v[64:67], a[244:247], a[120:123], v[64:67]
    ds_read_b64_tr_b16 v[56:57], v3 offset:2048
    v_cvt_pk_bf16_f32 v29, v171, v175
    v_mfma_f32_16x16x32_bf16 v[68:71], a[244:247], a[124:127], 0
    s_add_u32 s4, s4, 36864
    v_cvt_pk_bf16_f32 v30, v179, v183
    ds_write_b32 v6, v28 offset:2304
    v_mfma_f32_16x16x32_bf16 v[68:71], a[240:243], a[100:103], v[68:71]
    ds_read_b64_tr_b16 v[58:59], v3 offset:2560
    s_add_u32 s29, s29, 12288
    s_add_u32 s5, s4, 4096
    s_add_u32 m0, s32, 49152
    ds_write_b32 v6, v29 offset:2308
    v_mfma_f32_16x16x32_bf16 v[72:75], a[240:243], a[104:107], 0
    buffer_load_dwordx4 v1, s[8:11], s4 offen offset:0 nt lds
    ds_write_b32 v6, v30 offset:2312
    v_mfma_f32_16x16x32_bf16 v[72:75], a[244:247], a[128:131], v[72:75]
    ds_read_b64_tr_b16 v[60:61], v3 offset:14336
    v_cvt_pk_bf16_f32 v40, v184, v188
    v_mfma_f32_16x16x32_bf16 v[76:79], a[244:247], a[132:135], 0
    v_cvt_pk_bf16_f32 v41, v192, v196
    v_cvt_pk_bf16_f32 v42, v200, v204
    v_mfma_f32_16x16x32_bf16 v[76:79], a[240:243], a[108:111], v[76:79]
    ds_read_b64_tr_b16 v[62:63], v3 offset:14848
    s_add_u32 m0, s32, 49152
    v_cvt_pk_bf16_f32 v44, v185, v189
    v_mfma_f32_16x16x32_bf16 v[80:83], a[240:243], a[112:115], 0
    buffer_load_dwordx4 v1, s[8:11], s4 offen offset:1024 nt lds
    v_cvt_pk_bf16_f32 v45, v193, v197
    v_mfma_f32_16x16x32_bf16 v[80:83], a[244:247], a[136:139], v[80:83]
    v_cvt_pk_bf16_f32 v46, v201, v205
    v_cvt_pk_bf16_f32 v48, v186, v190
    v_mfma_f32_16x16x32_bf16 v[84:87], a[244:247], a[140:143], 0
    v_cvt_pk_bf16_f32 v49, v194, v198
    v_cvt_pk_bf16_f32 v50, v202, v206
    v_mfma_f32_16x16x32_bf16 v[84:87], a[240:243], a[116:119], v[84:87]
    s_add_u32 m0, s32, 49152
    v_cvt_pk_bf16_f32 v52, v187, v191
    v_cvt_pk_bf16_f32 v53, v195, v199
    s_waitcnt lgkmcnt(9)
    v_mfma_f32_16x16x32_bf16 v[108:111], a[248:251], a[116:119], 0
    buffer_load_dwordx4 v1, s[8:11], s4 offen offset:2048 nt lds
    v_cvt_pk_bf16_f32 v54, v203, v207
    v_mfma_f32_16x16x32_bf16 v[108:111], a[252:255], a[140:143], v[108:111]
    ds_read_b64_tr_b16 a[240:241], v3 offset:3072
    v_accvgpr_read_b32 v14, a48
    v_mfma_f32_16x16x32_bf16 v[104:107], a[252:255], a[136:139], 0
    s_add_u32 s42, s41, 12288
    buffer_store_dwordx3 v[36:38], v0, s[16:19], s42 offen offset:2304
    v_accvgpr_read_b32 v15, a52
    v_mfma_f32_16x16x32_bf16 v[104:107], a[248:251], a[112:115], v[104:107]
    ds_read_b64_tr_b16 a[242:243], v3 offset:3584
    s_add_u32 m0, s32, 49152
    v_accvgpr_read_b32 v16, a56
    v_mfma_f32_16x16x32_bf16 v[100:103], a[248:251], a[108:111], 0
    buffer_load_dwordx4 v1, s[8:11], s4 offen offset:3072 nt lds
    v_accvgpr_read_b32 v17, a60
    v_mfma_f32_16x16x32_bf16 v[100:103], a[252:255], a[132:135], v[100:103]
    ds_read_b64_tr_b16 a[244:245], v3 offset:15360
    v_accvgpr_read_b32 v18, a64
    v_mfma_f32_16x16x32_bf16 v[96:99], a[252:255], a[128:131], 0
    v_accvgpr_read_b32 v19, a68
    v_cvt_pk_bf16_f32 v24, v14, v15
    v_mfma_f32_16x16x32_bf16 v[96:99], a[248:251], a[104:107], v[96:99]
    ds_read_b64_tr_b16 a[246:247], v3 offset:15872
    s_add_u32 m0, s32, 53248
    v_cvt_pk_bf16_f32 v25, v16, v17
    v_mfma_f32_16x16x32_bf16 v[92:95], a[248:251], a[100:103], 0
    buffer_load_dwordx4 v1, s[8:11], s5 offen offset:0 nt lds
    v_cvt_pk_bf16_f32 v26, v18, v19
    v_mfma_f32_16x16x32_bf16 v[92:95], a[252:255], a[124:127], v[92:95]
    ds_write_b32 v6, v24 offset:12288
    ds_write_b32 v6, v25 offset:12292
    v_mfma_f32_16x16x32_bf16 v[88:91], a[252:255], a[120:123], 0
    ds_write_b32 v6, v26 offset:12296
    v_accvgpr_read_b32 v14, a49
    v_mfma_f32_16x16x32_bf16 v[88:91], a[248:251], a[96:99], v[88:91]
    s_add_u32 m0, s32, 53248
    v_accvgpr_read_b32 v15, a53
    v_accvgpr_read_b32 v16, a57
    s_waitcnt lgkmcnt(7)
    v_mfma_f32_16x16x32_bf16 a[0:3], v[56:59], a[96:99], 0
    buffer_load_dwordx4 v1, s[8:11], s5 offen offset:1024 nt lds
    v_accvgpr_read_b32 v17, a61
    v_mfma_f32_16x16x32_bf16 a[0:3], v[60:63], a[120:123], a[0:3]
    ds_read_b64_tr_b16 a[248:249], v3 offset:4096
    v_accvgpr_read_b32 v18, a65
    v_mfma_f32_16x16x32_bf16 a[4:7], v[60:63], a[124:127], 0
    v_accvgpr_read_b32 v19, a69
    v_cvt_pk_bf16_f32 v28, v14, v15
    v_mfma_f32_16x16x32_bf16 a[4:7], v[56:59], a[100:103], a[4:7]
    ds_read_b64_tr_b16 a[250:251], v3 offset:4608
    v_cvt_pk_bf16_f32 v29, v16, v17
    v_mfma_f32_16x16x32_bf16 a[8:11], v[56:59], a[104:107], 0
    s_add_u32 s42, s41, 76800
    buffer_store_dwordx3 v[40:42], v0, s[16:19], s42 offen offset:0
    v_cvt_pk_bf16_f32 v30, v18, v19
    v_mfma_f32_16x16x32_bf16 a[8:11], v[60:63], a[128:131], a[8:11]
    ds_read_b64_tr_b16 a[252:253], v3 offset:16384
    ds_write_b32 v6, v28 offset:13056
    v_mfma_f32_16x16x32_bf16 a[12:15], v[60:63], a[132:135], 0
    ds_write_b32 v6, v29 offset:13060
    ds_write_b32 v6, v30 offset:13064
    v_mfma_f32_16x16x32_bf16 a[12:15], v[56:59], a[108:111], a[12:15]
    ds_read_b64_tr_b16 a[254:255], v3 offset:16896
    v_accvgpr_read_b32 v14, a50
    v_mfma_f32_16x16x32_bf16 a[16:19], v[56:59], a[112:115], 0
    v_accvgpr_read_b32 v15, a54
    v_accvgpr_read_b32 v16, a58
    v_mfma_f32_16x16x32_bf16 a[16:19], v[60:63], a[136:139], a[16:19]
    v_accvgpr_read_b32 v17, a62
    v_accvgpr_read_b32 v18, a66
    v_mfma_f32_16x16x32_bf16 a[20:23], v[60:63], a[140:143], 0
    v_accvgpr_read_b32 v19, a70
    v_cvt_pk_bf16_f32 v24, v14, v15
    v_mfma_f32_16x16x32_bf16 a[20:23], v[56:59], a[116:119], a[20:23]
    v_cvt_pk_bf16_f32 v25, v16, v17
    v_cvt_pk_bf16_f32 v26, v18, v19
    s_waitcnt lgkmcnt(7)
    v_mfma_f32_16x16x32_bf16 v[132:135], a[240:243], a[116:119], 0
    ds_write_b32 v6, v24 offset:13824
    ds_write_b32 v6, v25 offset:13828
    v_mfma_f32_16x16x32_bf16 v[132:135], a[244:247], a[140:143], v[132:135]
    ds_read_b64_tr_b16 v[56:57], v3 offset:5120
    ds_write_b32 v6, v26 offset:13832
    v_mfma_f32_16x16x32_bf16 v[128:131], a[244:247], a[136:139], 0
    v_accvgpr_read_b32 v14, a51
    v_accvgpr_read_b32 v15, a55
    v_mfma_f32_16x16x32_bf16 v[128:131], a[240:243], a[112:115], v[128:131]
    ds_read_b64_tr_b16 v[58:59], v3 offset:5632
    v_accvgpr_read_b32 v16, a59
    v_mfma_f32_16x16x32_bf16 v[124:127], a[240:243], a[108:111], 0
    v_accvgpr_read_b32 v17, a63
    v_accvgpr_read_b32 v18, a67
    v_mfma_f32_16x16x32_bf16 v[124:127], a[244:247], a[132:135], v[124:127]
    ds_read_b64_tr_b16 v[60:61], v3 offset:17408
    v_accvgpr_read_b32 v19, a71
    v_mfma_f32_16x16x32_bf16 v[120:123], a[244:247], a[128:131], 0
    s_add_u32 s42, s41, 76800
    buffer_store_dwordx3 v[44:46], v0, s[16:19], s42 offen offset:768
    v_cvt_pk_bf16_f32 v28, v14, v15
    v_mfma_f32_16x16x32_bf16 v[120:123], a[240:243], a[104:107], v[120:123]
    ds_read_b64_tr_b16 v[62:63], v3 offset:17920
    v_cvt_pk_bf16_f32 v29, v16, v17
    v_mfma_f32_16x16x32_bf16 v[116:119], a[240:243], a[100:103], 0
    v_cvt_pk_bf16_f32 v30, v18, v19
    ds_write_b32 v6, v28 offset:14592
    v_mfma_f32_16x16x32_bf16 v[116:119], a[244:247], a[124:127], v[116:119]
    ds_write_b32 v6, v29 offset:14596
    ds_write_b32 v6, v30 offset:14600
    v_mfma_f32_16x16x32_bf16 v[112:115], a[244:247], a[120:123], 0
    v_cvt_pk_bf16_f32 v24, v208, v212
    v_cvt_pk_bf16_f32 v25, v216, v220
    v_mfma_f32_16x16x32_bf16 v[112:115], a[240:243], a[96:99], v[112:115]
    v_cvt_pk_bf16_f32 v26, v224, v228
    ds_write_b32 v6, v24 offset:24576
    s_waitcnt lgkmcnt(11)
    v_mfma_f32_16x16x32_bf16 v[136:139], a[248:251], a[96:99], 0
    ds_write_b32 v6, v25 offset:24580
    ds_write_b32 v6, v26 offset:24584
    v_mfma_f32_16x16x32_bf16 v[136:139], a[252:255], a[120:123], v[136:139]
    ds_read_b64_tr_b16 a[240:241], v3 offset:6144
    v_cvt_pk_bf16_f32 v28, v209, v213
    v_mfma_f32_16x16x32_bf16 v[140:143], a[252:255], a[124:127], 0
    v_cvt_pk_bf16_f32 v29, v217, v221
    v_cvt_pk_bf16_f32 v30, v225, v229
    v_mfma_f32_16x16x32_bf16 v[140:143], a[248:251], a[100:103], v[140:143]
    ds_read_b64_tr_b16 a[242:243], v3 offset:6656
    s_mov_b32 s6, 98304
    ds_write_b32 v6, v28 offset:25344
    v_mfma_f32_16x16x32_bf16 v[144:147], a[248:251], a[104:107], 0
    buffer_load_dwordx4 a[192:195], v2, s[52:55], s6 offen offset:0
    ds_write_b32 v6, v29 offset:25348
    v_mfma_f32_16x16x32_bf16 v[144:147], a[252:255], a[128:131], v[144:147]
    ds_read_b64_tr_b16 a[244:245], v3 offset:18432
    ds_write_b32 v6, v30 offset:25352
    v_mfma_f32_16x16x32_bf16 v[148:151], a[252:255], a[132:135], 0
    v_cvt_pk_bf16_f32 v24, v210, v214
    v_cvt_pk_bf16_f32 v25, v218, v222
    v_mfma_f32_16x16x32_bf16 v[148:151], a[248:251], a[108:111], v[148:151]
    ds_read_b64_tr_b16 a[246:247], v3 offset:18944
    v_cvt_pk_bf16_f32 v26, v226, v230
    v_mfma_f32_16x16x32_bf16 v[152:155], a[248:251], a[112:115], 0
    buffer_load_dwordx4 a[196:199], v2, s[52:55], s6 offen offset:1024
    ds_write_b32 v6, v24 offset:26112
    v_mfma_f32_16x16x32_bf16 v[152:155], a[252:255], a[136:139], v[152:155]
    s_add_u32 s42, s41, 76800
    buffer_store_dwordx3 v[48:50], v0, s[16:19], s42 offen offset:1536
    ds_write_b32 v6, v25 offset:26116
    v_mfma_f32_16x16x32_bf16 v[156:159], a[252:255], a[140:143], 0
    ds_write_b32 v6, v26 offset:26120
    v_cvt_pk_bf16_f32 v28, v211, v215
    v_mfma_f32_16x16x32_bf16 v[156:159], a[248:251], a[116:119], v[156:159]
    v_cvt_pk_bf16_f32 v29, v219, v223
    v_cvt_pk_bf16_f32 v30, v227, v231
    s_waitcnt lgkmcnt(13)
    v_mfma_f32_16x16x32_bf16 a[44:47], v[56:59], a[116:119], 0
    buffer_load_dwordx4 a[200:203], v2, s[52:55], s6 offen offset:2048
    ds_write_b32 v6, v28 offset:26880
    v_mfma_f32_16x16x32_bf16 a[44:47], v[60:63], a[140:143], a[44:47]
    ds_read_b64_tr_b16 a[248:249], v3 offset:7168
    ds_write_b32 v6, v29 offset:26884
    v_mfma_f32_16x16x32_bf16 a[40:43], v[60:63], a[136:139], 0
    ds_write_b32 v6, v30 offset:26888
    v_cvt_pk_bf16_f32 v32, v232, v236
    v_mfma_f32_16x16x32_bf16 a[40:43], v[56:59], a[112:115], a[40:43]
    ds_read_b64_tr_b16 a[250:251], v3 offset:7680
    v_cvt_pk_bf16_f32 v33, v240, v244
    v_mfma_f32_16x16x32_bf16 a[36:39], v[56:59], a[108:111], 0
    buffer_load_dwordx4 a[204:207], v2, s[52:55], s6 offen offset:3072
    v_cvt_pk_bf16_f32 v34, v248, v252
    v_mfma_f32_16x16x32_bf16 a[36:39], v[60:63], a[132:135], a[36:39]
    ds_read_b64_tr_b16 a[252:253], v3 offset:19456
    v_cvt_pk_bf16_f32 v36, v233, v237
    v_mfma_f32_16x16x32_bf16 a[32:35], v[60:63], a[128:131], 0
    v_cvt_pk_bf16_f32 v37, v241, v245
    v_cvt_pk_bf16_f32 v38, v249, v253
    v_mfma_f32_16x16x32_bf16 a[32:35], v[56:59], a[104:107], a[32:35]
    ds_read_b64_tr_b16 a[254:255], v3 offset:19968
    s_mov_b32 s6, 102400
    v_cvt_pk_bf16_f32 v40, v234, v238
    v_mfma_f32_16x16x32_bf16 a[28:31], v[56:59], a[100:103], 0
    buffer_load_dwordx4 a[208:211], v2, s[52:55], s6 offen offset:0
    v_cvt_pk_bf16_f32 v41, v242, v246
    v_mfma_f32_16x16x32_bf16 a[28:31], v[60:63], a[124:127], a[28:31]
    v_cvt_pk_bf16_f32 v42, v250, v254
    v_cvt_pk_bf16_f32 v44, v235, v239
    v_mfma_f32_16x16x32_bf16 a[24:27], v[60:63], a[120:123], 0
    s_add_u32 s42, s41, 76800
    buffer_store_dwordx3 v[52:54], v0, s[16:19], s42 offen offset:2304
    v_cvt_pk_bf16_f32 v45, v243, v247
    v_mfma_f32_16x16x32_bf16 a[24:27], v[56:59], a[96:99], a[24:27]
    v_cvt_pk_bf16_f32 v46, v251, v255
    v_accvgpr_read_b32 v14, a72
    s_waitcnt lgkmcnt(7)
    v_mfma_f32_16x16x32_bf16 v[160:163], a[240:243], a[96:99], 0
    buffer_load_dwordx4 a[212:215], v2, s[52:55], s6 offen offset:1024
    v_accvgpr_read_b32 v15, a76
    v_mfma_f32_16x16x32_bf16 v[160:163], a[244:247], a[120:123], v[160:163]
    ds_read_b64_tr_b16 v[56:57], v3 offset:8192
    v_accvgpr_read_b32 v16, a80
    v_mfma_f32_16x16x32_bf16 v[164:167], a[244:247], a[124:127], 0
    v_accvgpr_read_b32 v17, a84
    v_accvgpr_read_b32 v18, a88
    v_mfma_f32_16x16x32_bf16 v[164:167], a[240:243], a[100:103], v[164:167]
    ds_read_b64_tr_b16 v[58:59], v3 offset:8704
    v_accvgpr_read_b32 v19, a92
    v_mfma_f32_16x16x32_bf16 v[168:171], a[240:243], a[104:107], 0
    v_cvt_pk_bf16_f32 v48, v14, v15
    v_cvt_pk_bf16_f32 v49, v16, v17
    v_mfma_f32_16x16x32_bf16 v[168:171], a[244:247], a[128:131], v[168:171]
    ds_read_b64_tr_b16 v[60:61], v3 offset:20480
    v_cvt_pk_bf16_f32 v50, v18, v19
    v_mfma_f32_16x16x32_bf16 v[172:175], a[244:247], a[132:135], 0
    v_accvgpr_read_b32 v14, a73
    v_accvgpr_read_b32 v15, a77
    v_mfma_f32_16x16x32_bf16 v[172:175], a[240:243], a[108:111], v[172:175]
    ds_read_b64_tr_b16 v[62:63], v3 offset:20992
    v_accvgpr_read_b32 v16, a81
    v_mfma_f32_16x16x32_bf16 v[176:179], a[240:243], a[112:115], 0
    v_accvgpr_read_b32 v17, a85
    v_accvgpr_read_b32 v18, a89
    v_mfma_f32_16x16x32_bf16 v[176:179], a[244:247], a[136:139], v[176:179]
    v_accvgpr_read_b32 v19, a93
    v_cvt_pk_bf16_f32 v52, v14, v15
    v_mfma_f32_16x16x32_bf16 v[180:183], a[244:247], a[140:143], 0
    v_cvt_pk_bf16_f32 v53, v16, v17
    v_cvt_pk_bf16_f32 v54, v18, v19
    v_mfma_f32_16x16x32_bf16 v[180:183], a[240:243], a[116:119], v[180:183]
    s_waitcnt lgkmcnt(4)
    v_mfma_f32_16x16x32_bf16 v[204:207], a[248:251], a[116:119], 0
    s_add_u32 s42, s41, 86016
    buffer_store_dwordx3 v[32:34], v0, s[16:19], s42 offen offset:0
    v_mfma_f32_16x16x32_bf16 v[204:207], a[252:255], a[140:143], v[204:207]
    ds_read_b64_tr_b16 a[240:241], v3 offset:9216
    v_mfma_f32_16x16x32_bf16 v[200:203], a[252:255], a[136:139], 0
    v_mfma_f32_16x16x32_bf16 v[200:203], a[248:251], a[112:115], v[200:203]
    ds_read_b64_tr_b16 a[242:243], v3 offset:9728
    v_mfma_f32_16x16x32_bf16 v[196:199], a[248:251], a[108:111], 0
    v_mfma_f32_16x16x32_bf16 v[196:199], a[252:255], a[132:135], v[196:199]
    ds_read_b64_tr_b16 a[244:245], v3 offset:21504
    v_mfma_f32_16x16x32_bf16 v[192:195], a[252:255], a[128:131], 0
    v_accvgpr_read_b32 v14, a74
    v_accvgpr_read_b32 v15, a78
    v_mfma_f32_16x16x32_bf16 v[192:195], a[248:251], a[104:107], v[192:195]
    ds_read_b64_tr_b16 a[246:247], v3 offset:22016
    v_accvgpr_read_b32 v16, a82
    v_mfma_f32_16x16x32_bf16 v[188:191], a[248:251], a[100:103], 0
    v_accvgpr_read_b32 v17, a86
    v_accvgpr_read_b32 v18, a90
    v_mfma_f32_16x16x32_bf16 v[188:191], a[252:255], a[124:127], v[188:191]
    v_accvgpr_read_b32 v19, a94
    v_cvt_pk_bf16_f32 v32, v14, v15
    v_mfma_f32_16x16x32_bf16 v[184:187], a[252:255], a[120:123], 0
    v_cvt_pk_bf16_f32 v33, v16, v17
    v_cvt_pk_bf16_f32 v34, v18, v19
    v_mfma_f32_16x16x32_bf16 v[184:187], a[248:251], a[96:99], v[184:187]
    s_waitcnt lgkmcnt(4)
    v_mfma_f32_16x16x32_bf16 a[48:51], v[56:59], a[96:99], 0
    v_mfma_f32_16x16x32_bf16 a[48:51], v[60:63], a[120:123], a[48:51]
    ds_read_b64_tr_b16 a[248:249], v3 offset:10240
    v_mfma_f32_16x16x32_bf16 a[52:55], v[60:63], a[124:127], 0
    s_add_u32 s42, s41, 86016
    buffer_store_dwordx3 v[36:38], v0, s[16:19], s42 offen offset:768
    v_mfma_f32_16x16x32_bf16 a[52:55], v[56:59], a[100:103], a[52:55]
    ds_read_b64_tr_b16 a[250:251], v3 offset:10752
    v_mfma_f32_16x16x32_bf16 a[56:59], v[56:59], a[104:107], 0
    buffer_load_dwordx4 a[216:219], v2, s[52:55], s6 offen offset:2048
    v_mfma_f32_16x16x32_bf16 a[56:59], v[60:63], a[128:131], a[56:59]
    ds_read_b64_tr_b16 a[252:253], v3 offset:22528
    v_mfma_f32_16x16x32_bf16 a[60:63], v[60:63], a[132:135], 0
    v_mfma_f32_16x16x32_bf16 a[60:63], v[56:59], a[108:111], a[60:63]
    ds_read_b64_tr_b16 a[254:255], v3 offset:23040
    v_mfma_f32_16x16x32_bf16 a[64:67], v[56:59], a[112:115], 0
    buffer_load_dwordx4 a[220:223], v2, s[52:55], s6 offen offset:3072
    v_accvgpr_read_b32 v14, a75
    v_mfma_f32_16x16x32_bf16 a[64:67], v[60:63], a[136:139], a[64:67]
    v_accvgpr_read_b32 v15, a79
    v_accvgpr_read_b32 v16, a83
    v_mfma_f32_16x16x32_bf16 a[68:71], v[60:63], a[140:143], 0
    v_accvgpr_read_b32 v17, a87
    v_accvgpr_read_b32 v18, a91
    v_mfma_f32_16x16x32_bf16 a[68:71], v[56:59], a[116:119], a[68:71]
    s_mov_b32 s6, 106496
    v_accvgpr_read_b32 v19, a95
    v_cvt_pk_bf16_f32 v36, v14, v15
    s_waitcnt lgkmcnt(4)
    v_mfma_f32_16x16x32_bf16 v[228:231], a[240:243], a[116:119], 0
    buffer_load_dwordx4 a[224:227], v2, s[52:55], s6 offen offset:0
    v_cvt_pk_bf16_f32 v37, v16, v17
    v_mfma_f32_16x16x32_bf16 v[228:231], a[244:247], a[140:143], v[228:231]
    ds_read_b64_tr_b16 v[56:57], v3 offset:11264
    v_cvt_pk_bf16_f32 v38, v18, v19
    v_mfma_f32_16x16x32_bf16 v[224:227], a[244:247], a[136:139], 0
    v_mfma_f32_16x16x32_bf16 v[224:227], a[240:243], a[112:115], v[224:227]
    ds_read_b64_tr_b16 v[58:59], v3 offset:11776
    v_mfma_f32_16x16x32_bf16 v[220:223], a[240:243], a[108:111], 0
    buffer_load_dwordx4 a[228:231], v2, s[52:55], s6 offen offset:1024
    v_mfma_f32_16x16x32_bf16 v[220:223], a[244:247], a[132:135], v[220:223]
    ds_read_b64_tr_b16 v[60:61], v3 offset:23552
    v_mfma_f32_16x16x32_bf16 v[216:219], a[244:247], a[128:131], 0
    s_add_u32 s42, s41, 86016
    buffer_store_dwordx3 v[40:42], v0, s[16:19], s42 offen offset:1536
    v_mfma_f32_16x16x32_bf16 v[216:219], a[240:243], a[104:107], v[216:219]
    ds_read_b64_tr_b16 v[62:63], v3 offset:24064
    v_mfma_f32_16x16x32_bf16 v[212:215], a[240:243], a[100:103], 0
    buffer_load_dwordx4 a[232:235], v2, s[52:55], s6 offen offset:2048
    v_mfma_f32_16x16x32_bf16 v[212:215], a[244:247], a[124:127], v[212:215]
    v_mfma_f32_16x16x32_bf16 v[208:211], a[244:247], a[120:123], 0
    v_mfma_f32_16x16x32_bf16 v[208:211], a[240:243], a[96:99], v[208:211]
    s_waitcnt vmcnt(44) lgkmcnt(0)
    s_barrier
    v_mfma_f32_16x16x32_bf16 v[232:235], a[248:251], a[96:99], 0
    buffer_load_dwordx4 a[236:239], v2, s[52:55], s6 offen offset:3072
    v_mfma_f32_16x16x32_bf16 v[232:235], a[252:255], a[120:123], v[232:235]
    ds_read_b64_tr_b16 a[240:241], v3 offset:24576
    v_mfma_f32_16x16x32_bf16 v[236:239], a[252:255], a[124:127], 0
    v_mfma_f32_16x16x32_bf16 v[236:239], a[248:251], a[100:103], v[236:239]
    ds_read_b64_tr_b16 a[242:243], v3 offset:25088
    v_mfma_f32_16x16x32_bf16 v[240:243], a[248:251], a[104:107], 0
    v_mfma_f32_16x16x32_bf16 v[240:243], a[252:255], a[128:131], v[240:243]
    ds_read_b64_tr_b16 a[244:245], v3 offset:36864
    v_mfma_f32_16x16x32_bf16 v[244:247], a[252:255], a[132:135], 0
    s_add_u32 s42, s41, 86016
    buffer_store_dwordx3 v[44:46], v0, s[16:19], s42 offen offset:2304
    v_mfma_f32_16x16x32_bf16 v[244:247], a[248:251], a[108:111], v[244:247]
    ds_read_b64_tr_b16 a[246:247], v3 offset:37376
    v_mfma_f32_16x16x32_bf16 v[248:251], a[248:251], a[112:115], 0
    v_mfma_f32_16x16x32_bf16 v[248:251], a[252:255], a[136:139], v[248:251]
    v_mfma_f32_16x16x32_bf16 v[252:255], a[252:255], a[140:143], 0
    v_mfma_f32_16x16x32_bf16 v[252:255], a[248:251], a[116:119], v[252:255]
    v_mfma_f32_16x16x32_bf16 a[92:95], v[56:59], a[116:119], 0
    v_mfma_f32_16x16x32_bf16 a[92:95], v[60:63], a[140:143], a[92:95]
    ds_read_b64_tr_b16 a[248:249], v3 offset:25600
    v_mfma_f32_16x16x32_bf16 a[88:91], v[60:63], a[136:139], 0
    v_mfma_f32_16x16x32_bf16 a[88:91], v[56:59], a[112:115], a[88:91]
    ds_read_b64_tr_b16 a[250:251], v3 offset:26112
    v_mfma_f32_16x16x32_bf16 a[84:87], v[56:59], a[108:111], 0
    v_mfma_f32_16x16x32_bf16 a[84:87], v[60:63], a[132:135], a[84:87]
    ds_read_b64_tr_b16 a[252:253], v3 offset:37888
    v_mfma_f32_16x16x32_bf16 a[80:83], v[60:63], a[128:131], 0
    v_mfma_f32_16x16x32_bf16 a[80:83], v[56:59], a[104:107], a[80:83]
    ds_read_b64_tr_b16 a[254:255], v3 offset:38400
    v_mfma_f32_16x16x32_bf16 a[76:79], v[56:59], a[100:103], 0
    s_add_u32 s42, s41, 89088
    buffer_store_dwordx3 v[48:50], v0, s[16:19], s42 offen offset:0
    v_mfma_f32_16x16x32_bf16 a[76:79], v[60:63], a[124:127], a[76:79]
    v_mfma_f32_16x16x32_bf16 a[72:75], v[60:63], a[120:123], 0
    v_mfma_f32_16x16x32_bf16 a[72:75], v[56:59], a[96:99], a[72:75]
L_k2_join:
    s_cmp_lg_u32 s28, 0
    s_cbranch_scc1 L_k2_fw144
    s_waitcnt vmcnt(21)
L_k2_fw144:
    s_waitcnt vmcnt(30)
    s_waitcnt lgkmcnt(4)
    v_mfma_f32_16x16x32_bf16 v[64:67], a[240:243], a[144:147], v[64:67]
    v_mfma_f32_16x16x32_bf16 v[64:67], a[244:247], a[168:171], v[64:67]
    ds_read_b64_tr_b16 v[56:57], v3 offset:26624
    v_mfma_f32_16x16x32_bf16 v[68:71], a[244:247], a[172:175], v[68:71]
    v_mfma_f32_16x16x32_bf16 v[68:71], a[240:243], a[148:151], v[68:71]
    ds_read_b64_tr_b16 v[58:59], v3 offset:27136
    s_add_u32 m0, s39, 0
    v_mfma_f32_16x16x32_bf16 v[72:75], a[240:243], a[152:155], v[72:75]
    buffer_load_dwordx4 v1, s[56:59], s4 offen offset:0 nt lds
    v_mfma_f32_16x16x32_bf16 v[72:75], a[244:247], a[176:179], v[72:75]
    ds_read_b64_tr_b16 v[60:61], v3 offset:38912
    v_mfma_f32_16x16x32_bf16 v[76:79], a[244:247], a[180:183], v[76:79]
    v_mfma_f32_16x16x32_bf16 v[76:79], a[240:243], a[156:159], v[76:79]
    ds_read_b64_tr_b16 v[62:63], v3 offset:39424
    s_add_u32 m0, s39, 0
    v_mfma_f32_16x16x32_bf16 v[80:83], a[240:243], a[160:163], v[80:83]
    buffer_load_dwordx4 v1, s[56:59], s4 offen offset:1024 nt lds
    v_mfma_f32_16x16x32_bf16 v[80:83], a[244:247], a[184:187], v[80:83]
    v_mfma_f32_16x16x32_bf16 v[84:87], a[244:247], a[188:191], v[84:87]
    s_add_u32 s42, s41, 89088
    buffer_store_dwordx3 v[52:54], v0, s[16:19], s42 offen offset:768
    v_mfma_f32_16x16x32_bf16 v[84:87], a[240:243], a[164:167], v[84:87]
    s_add_u32 m0, s39, 0
    s_waitcnt lgkmcnt(4)
    v_mfma_f32_16x16x32_bf16 v[108:111], a[248:251], a[164:167], v[108:111]
    buffer_load_dwordx4 v1, s[56:59], s4 offen offset:2048 nt lds
    v_mfma_f32_16x16x32_bf16 v[108:111], a[252:255], a[188:191], v[108:111]
    ds_read_b64_tr_b16 a[240:241], v3 offset:27648
    v_mfma_f32_16x16x32_bf16 v[104:107], a[252:255], a[184:187], v[104:107]
    v_mfma_f32_16x16x32_bf16 v[104:107], a[248:251], a[160:163], v[104:107]
    ds_read_b64_tr_b16 a[242:243], v3 offset:28160
    s_add_u32 m0, s39, 12288
    v_mfma_f32_16x16x32_bf16 v[100:103], a[248:251], a[156:159], v[100:103]
    buffer_load_dwordx4 v1, s[60:63], s29 offen offset:0 nt lds
    v_mfma_f32_16x16x32_bf16 v[100:103], a[252:255], a[180:183], v[100:103]
    ds_read_b64_tr_b16 a[244:245], v3 offset:39936
    v_mfma_f32_16x16x32_bf16 v[96:99], a[252:255], a[176:179], v[96:99]
    v_mfma_f32_16x16x32_bf16 v[96:99], a[248:251], a[152:155], v[96:99]
    ds_read_b64_tr_b16 a[246:247], v3 offset:40448
    s_add_u32 m0, s39, 12288
    v_mfma_f32_16x16x32_bf16 v[92:95], a[248:251], a[148:151], v[92:95]
    buffer_load_dwordx4 v1, s[60:63], s29 offen offset:1024 nt lds
    v_mfma_f32_16x16x32_bf16 v[92:95], a[252:255], a[172:175], v[92:95]
    v_mfma_f32_16x16x32_bf16 v[88:91], a[252:255], a[168:171], v[88:91]
    v_mfma_f32_16x16x32_bf16 v[88:91], a[248:251], a[144:147], v[88:91]
    s_add_u32 m0, s39, 12288
    s_waitcnt lgkmcnt(4)
    v_mfma_f32_16x16x32_bf16 a[0:3], v[56:59], a[144:147], a[0:3]
    buffer_load_dwordx4 v1, s[60:63], s29 offen offset:2048 nt lds
    v_mfma_f32_16x16x32_bf16 a[0:3], v[60:63], a[168:171], a[0:3]
    ds_read_b64_tr_b16 a[248:249], v3 offset:28672
    v_mfma_f32_16x16x32_bf16 a[4:7], v[60:63], a[172:175], a[4:7]
    s_add_u32 s42, s41, 89088
    buffer_store_dwordx3 v[32:34], v0, s[16:19], s42 offen offset:1536
    v_mfma_f32_16x16x32_bf16 a[4:7], v[56:59], a[148:151], a[4:7]
    ds_read_b64_tr_b16 a[250:251], v3 offset:29184
    v_mfma_f32_16x16x32_bf16 a[8:11], v[56:59], a[152:155], a[8:11]
    v_mfma_f32_16x16x32_bf16 a[8:11], v[60:63], a[176:179], a[8:11]
    ds_read_b64_tr_b16 a[252:253], v3 offset:40960
    v_mfma_f32_16x16x32_bf16 a[12:15], v[60:63], a[180:183], a[12:15]
    v_mfma_f32_16x16x32_bf16 a[12:15], v[56:59], a[156:159], a[12:15]
    ds_read_b64_tr_b16 a[254:255], v3 offset:41472
    v_mfma_f32_16x16x32_bf16 a[16:19], v[56:59], a[160:163], a[16:19]
    v_mfma_f32_16x16x32_bf16 a[16:19], v[60:63], a[184:187], a[16:19]
    v_mfma_f32_16x16x32_bf16 a[20:23], v[60:63], a[188:191], a[20:23]
    v_mfma_f32_16x16x32_bf16 a[20:23], v[56:59], a[164:167], a[20:23]
    s_waitcnt lgkmcnt(4)
    v_mfma_f32_16x16x32_bf16 v[132:135], a[240:243], a[164:167], v[132:135]
    v_mfma_f32_16x16x32_bf16 v[132:135], a[244:247], a[188:191], v[132:135]
    ds_read_b64_tr_b16 v[56:57], v3 offset:29696
    v_mfma_f32_16x16x32_bf16 v[128:131], a[244:247], a[184:187], v[128:131]
    s_add_u32 s42, s41, 89088
    buffer_store_dwordx3 v[36:38], v0, s[16:19], s42 offen offset:2304
    v_mfma_f32_16x16x32_bf16 v[128:131], a[240:243], a[160:163], v[128:131]
    ds_read_b64_tr_b16 v[58:59], v3 offset:30208
    v_mfma_f32_16x16x32_bf16 v[124:127], a[240:243], a[156:159], v[124:127]
    v_mfma_f32_16x16x32_bf16 v[124:127], a[244:247], a[180:183], v[124:127]
    ds_read_b64_tr_b16 v[60:61], v3 offset:41984
    v_mfma_f32_16x16x32_bf16 v[120:123], a[244:247], a[176:179], v[120:123]
    v_mfma_f32_16x16x32_bf16 v[120:123], a[240:243], a[152:155], v[120:123]
    ds_read_b64_tr_b16 v[62:63], v3 offset:42496
    v_mfma_f32_16x16x32_bf16 v[116:119], a[240:243], a[148:151], v[116:119]
    v_mfma_f32_16x16x32_bf16 v[116:119], a[244:247], a[172:175], v[116:119]
    v_mfma_f32_16x16x32_bf16 v[112:115], a[244:247], a[168:171], v[112:115]
    v_mfma_f32_16x16x32_bf16 v[112:115], a[240:243], a[144:147], v[112:115]
    s_waitcnt lgkmcnt(4)
    v_mfma_f32_16x16x32_bf16 v[136:139], a[248:251], a[144:147], v[136:139]
    v_mfma_f32_16x16x32_bf16 v[136:139], a[252:255], a[168:171], v[136:139]
    ds_read_b64_tr_b16 a[240:241], v3 offset:30720
    v_mfma_f32_16x16x32_bf16 v[140:143], a[252:255], a[172:175], v[140:143]
    v_mfma_f32_16x16x32_bf16 v[140:143], a[248:251], a[148:151], v[140:143]
    ds_read_b64_tr_b16 a[242:243], v3 offset:31232
    s_mov_b32 s6, 147456
    v_mfma_f32_16x16x32_bf16 v[144:147], a[248:251], a[152:155], v[144:147]
    buffer_load_dwordx4 a[96:99], v2, s[52:55], s6 offen offset:0
    v_mfma_f32_16x16x32_bf16 v[144:147], a[252:255], a[176:179], v[144:147]
    ds_read_b64_tr_b16 a[244:245], v3 offset:43008
    v_mfma_f32_16x16x32_bf16 v[148:151], a[252:255], a[180:183], v[148:151]
    v_mfma_f32_16x16x32_bf16 v[148:151], a[248:251], a[156:159], v[148:151]
    ds_read_b64_tr_b16 a[246:247], v3 offset:43520
    v_mfma_f32_16x16x32_bf16 v[152:155], a[248:251], a[160:163], v[152:155]
    buffer_load_dwordx4 a[100:103], v2, s[52:55], s6 offen offset:1024
    v_mfma_f32_16x16x32_bf16 v[152:155], a[252:255], a[184:187], v[152:155]
    v_mfma_f32_16x16x32_bf16 v[156:159], a[252:255], a[188:191], v[156:159]
    v_mfma_f32_16x16x32_bf16 v[156:159], a[248:251], a[164:167], v[156:159]
    s_waitcnt lgkmcnt(4)
    v_mfma_f32_16x16x32_bf16 a[44:47], v[56:59], a[164:167], a[44:47]
    buffer_load_dwordx4 a[104:107], v2, s[52:55], s6 offen offset:2048
    v_mfma_f32_16x16x32_bf16 a[44:47], v[60:63], a[188:191], a[44:47]
    ds_read_b64_tr_b16 a[248:249], v3 offset:31744
    v_mfma_f32_16x16x32_bf16 a[40:43], v[60:63], a[184:187], a[40:43]
    v_mfma_f32_16x16x32_bf16 a[40:43], v[56:59], a[160:163], a[40:43]
    ds_read_b64_tr_b16 a[250:251], v3 offset:32256
    v_mfma_f32_16x16x32_bf16 a[36:39], v[56:59], a[156:159], a[36:39]
    buffer_load_dwordx4 a[108:111], v2, s[52:55], s6 offen offset:3072
    v_mfma_f32_16x16x32_bf16 a[36:39], v[60:63], a[180:183], a[36:39]
    ds_read_b64_tr_b16 a[252:253], v3 offset:44032
    v_mfma_f32_16x16x32_bf16 a[32:35], v[60:63], a[176:179], a[32:35]
    v_mfma_f32_16x16x32_bf16 a[32:35], v[56:59], a[152:155], a[32:35]
    ds_read_b64_tr_b16 a[254:255], v3 offset:44544
    s_mov_b32 s6, 151552
    v_mfma_f32_16x16x32_bf16 a[28:31], v[56:59], a[148:151], a[28:31]
    buffer_load_dwordx4 a[112:115], v2, s[52:55], s6 offen offset:0
    v_mfma_f32_16x16x32_bf16 a[28:31], v[60:63], a[172:175], a[28:31]
    v_mfma_f32_16x16x32_bf16 a[24:27], v[60:63], a[168:171], a[24:27]
    v_mfma_f32_16x16x32_bf16 a[24:27], v[56:59], a[144:147], a[24:27]
    s_waitcnt lgkmcnt(4)
    v_mfma_f32_16x16x32_bf16 v[160:163], a[240:243], a[144:147], v[160:163]
    buffer_load_dwordx4 a[116:119], v2, s[52:55], s6 offen offset:1024
    v_mfma_f32_16x16x32_bf16 v[160:163], a[244:247], a[168:171], v[160:163]
    ds_read_b64_tr_b16 v[56:57], v3 offset:32768
    v_mfma_f32_16x16x32_bf16 v[164:167], a[244:247], a[172:175], v[164:167]
    v_mfma_f32_16x16x32_bf16 v[164:167], a[240:243], a[148:151], v[164:167]
    ds_read_b64_tr_b16 v[58:59], v3 offset:33280
    v_mfma_f32_16x16x32_bf16 v[168:171], a[240:243], a[152:155], v[168:171]
    v_mfma_f32_16x16x32_bf16 v[168:171], a[244:247], a[176:179], v[168:171]
    ds_read_b64_tr_b16 v[60:61], v3 offset:45056
    v_mfma_f32_16x16x32_bf16 v[172:175], a[244:247], a[180:183], v[172:175]
    v_mfma_f32_16x16x32_bf16 v[172:175], a[240:243], a[156:159], v[172:175]
    ds_read_b64_tr_b16 v[62:63], v3 offset:45568
    v_mfma_f32_16x16x32_bf16 v[176:179], a[240:243], a[160:163], v[176:179]
    v_mfma_f32_16x16x32_bf16 v[176:179], a[244:247], a[184:187], v[176:179]
    v_mfma_f32_16x16x32_bf16 v[180:183], a[244:247], a[188:191], v[180:183]
    v_mfma_f32_16x16x32_bf16 v[180:183], a[240:243], a[164:167], v[180:183]
    s_waitcnt lgkmcnt(4)
    v_mfma_f32_16x16x32_bf16 v[204:207], a[248:251], a[164:167], v[204:207]
    v_mfma_f32_16x16x32_bf16 v[204:207], a[252:255], a[188:191], v[204:207]
    ds_read_b64_tr_b16 a[240:241], v3 offset:33792
    v_mfma_f32_16x16x32_bf16 v[200:203], a[252:255], a[184:187], v[200:203]
    v_mfma_f32_16x16x32_bf16 v[200:203], a[248:251], a[160:163], v[200:203]
    ds_read_b64_tr_b16 a[242:243], v3 offset:34304
    v_mfma_f32_16x16x32_bf16 v[196:199], a[248:251], a[156:159], v[196:199]
    v_mfma_f32_16x16x32_bf16 v[196:199], a[252:255], a[180:183], v[196:199]
    ds_read_b64_tr_b16 a[244:245], v3 offset:46080
    v_mfma_f32_16x16x32_bf16 v[192:195], a[252:255], a[176:179], v[192:195]
    v_mfma_f32_16x16x32_bf16 v[192:195], a[248:251], a[152:155], v[192:195]
    ds_read_b64_tr_b16 a[246:247], v3 offset:46592
    v_mfma_f32_16x16x32_bf16 v[188:191], a[248:251], a[148:151], v[188:191]
    v_mfma_f32_16x16x32_bf16 v[188:191], a[252:255], a[172:175], v[188:191]
    v_mfma_f32_16x16x32_bf16 v[184:187], a[252:255], a[168:171], v[184:187]
    v_mfma_f32_16x16x32_bf16 v[184:187], a[248:251], a[144:147], v[184:187]
    s_waitcnt lgkmcnt(4)
    v_mfma_f32_16x16x32_bf16 a[48:51], v[56:59], a[144:147], a[48:51]
    v_mfma_f32_16x16x32_bf16 a[48:51], v[60:63], a[168:171], a[48:51]
    ds_read_b64_tr_b16 a[248:249], v3 offset:34816
    v_mfma_f32_16x16x32_bf16 a[52:55], v[60:63], a[172:175], a[52:55]
    v_mfma_f32_16x16x32_bf16 a[52:55], v[56:59], a[148:151], a[52:55]
    ds_read_b64_tr_b16 a[250:251], v3 offset:35328
    v_mfma_f32_16x16x32_bf16 a[56:59], v[56:59], a[152:155], a[56:59]
    buffer_load_dwordx4 a[120:123], v2, s[52:55], s6 offen offset:2048
    v_mfma_f32_16x16x32_bf16 a[56:59], v[60:63], a[176:179], a[56:59]
    ds_read_b64_tr_b16 a[252:253], v3 offset:47104
    v_mfma_f32_16x16x32_bf16 a[60:63], v[60:63], a[180:183], a[60:63]
    ds_read_b128 v[24:27], v7 offset:0
    v_mfma_f32_16x16x32_bf16 a[60:63], v[56:59], a[156:159], a[60:63]
    ds_read_b64_tr_b16 a[254:255], v3 offset:47616
    v_mfma_f32_16x16x32_bf16 a[64:67], v[56:59], a[160:163], a[64:67]
    buffer_load_dwordx4 a[124:127], v2, s[52:55], s6 offen offset:3072
    v_mfma_f32_16x16x32_bf16 a[64:67], v[60:63], a[184:187], a[64:67]
    ds_read_b128 v[28:31], v7 offset:1024
    v_mfma_f32_16x16x32_bf16 a[68:71], v[60:63], a[188:191], a[68:71]
    v_mfma_f32_16x16x32_bf16 a[68:71], v[56:59], a[164:167], a[68:71]
    s_mov_b32 s6, 155648
    s_waitcnt lgkmcnt(6)
    v_mfma_f32_16x16x32_bf16 v[228:231], a[240:243], a[164:167], v[228:231]
    buffer_load_dwordx4 a[128:131], v2, s[52:55], s6 offen offset:0
    v_mfma_f32_16x16x32_bf16 v[228:231], a[244:247], a[188:191], v[228:231]
    ds_read_b64_tr_b16 v[56:57], v3 offset:35840
    v_mfma_f32_16x16x32_bf16 v[224:227], a[244:247], a[184:187], v[224:227]
    ds_read_b128 v[32:35], v7 offset:2048
    v_mfma_f32_16x16x32_bf16 v[224:227], a[240:243], a[160:163], v[224:227]
    ds_read_b64_tr_b16 v[58:59], v3 offset:36352
    v_mfma_f32_16x16x32_bf16 v[220:223], a[240:243], a[156:159], v[220:223]
    buffer_load_dwordx4 a[132:135], v2, s[52:55], s6 offen offset:1024
    v_mfma_f32_16x16x32_bf16 v[220:223], a[244:247], a[180:183], v[220:223]
    ds_read_b64_tr_b16 v[60:61], v3 offset:48128
    v_mfma_f32_16x16x32_bf16 v[216:219], a[244:247], a[176:179], v[216:219]
    v_mfma_f32_16x16x32_bf16 v[216:219], a[240:243], a[152:155], v[216:219]
    ds_read_b64_tr_b16 v[62:63], v3 offset:48640
    v_mfma_f32_16x16x32_bf16 v[212:215], a[240:243], a[148:151], v[212:215]
    buffer_load_dwordx4 a[136:139], v2, s[52:55], s6 offen offset:2048
    v_mfma_f32_16x16x32_bf16 v[212:215], a[244:247], a[172:175], v[212:215]
    v_mfma_f32_16x16x32_bf16 v[208:211], a[244:247], a[168:171], v[208:211]
    v_mfma_f32_16x16x32_bf16 v[208:211], a[240:243], a[144:147], v[208:211]
    s_cmp_lg_u32 s28, 0
    s_cbranch_scc1 L_k2_fw264
    s_waitcnt vmcnt(32)
L_k2_fw264:
    s_waitcnt vmcnt(41) lgkmcnt(0)
    s_barrier
    v_mfma_f32_16x16x32_bf16 v[232:235], a[248:251], a[144:147], v[232:235]
    buffer_load_dwordx4 a[140:143], v2, s[52:55], s6 offen offset:3072
    v_mfma_f32_16x16x32_bf16 v[232:235], a[252:255], a[168:171], v[232:235]
    ds_read_b64_tr_b16 a[240:241], v4 offset:0
    v_mfma_f32_16x16x32_bf16 v[236:239], a[252:255], a[172:175], v[236:239]
    v_mfma_f32_16x16x32_bf16 v[236:239], a[248:251], a[148:151], v[236:239]
    ds_read_b64_tr_b16 a[242:243], v4 offset:512
    v_mfma_f32_16x16x32_bf16 v[240:243], a[248:251], a[152:155], v[240:243]
    s_add_u32 s42, s44, 0
    buffer_store_dwordx4 v[24:27], v1, s[16:19], s42 offen offset:0
    v_mfma_f32_16x16x32_bf16 v[240:243], a[252:255], a[176:179], v[240:243]
    ds_read_b64_tr_b16 a[244:245], v4 offset:12288
    v_mfma_f32_16x16x32_bf16 v[244:247], a[252:255], a[180:183], v[244:247]
    v_mfma_f32_16x16x32_bf16 v[244:247], a[248:251], a[156:159], v[244:247]
    ds_read_b64_tr_b16 a[246:247], v4 offset:12800
    v_mfma_f32_16x16x32_bf16 v[248:251], a[248:251], a[160:163], v[248:251]
    s_add_u32 s42, s44, 0
    buffer_store_dwordx4 v[28:31], v1, s[16:19], s42 offen offset:1024
    v_mfma_f32_16x16x32_bf16 v[248:251], a[252:255], a[184:187], v[248:251]
    v_mfma_f32_16x16x32_bf16 v[252:255], a[252:255], a[188:191], v[252:255]
    v_mfma_f32_16x16x32_bf16 v[252:255], a[248:251], a[164:167], v[252:255]
    v_mfma_f32_16x16x32_bf16 a[92:95], v[56:59], a[164:167], a[92:95]
    s_add_u32 s42, s44, 0
    buffer_store_dwordx4 v[32:35], v1, s[16:19], s42 offen offset:2048
    v_mfma_f32_16x16x32_bf16 a[92:95], v[60:63], a[188:191], a[92:95]
    ds_read_b64_tr_b16 a[248:249], v4 offset:1024
    v_mfma_f32_16x16x32_bf16 a[88:91], v[60:63], a[184:187], a[88:91]
    v_mfma_f32_16x16x32_bf16 a[88:91], v[56:59], a[160:163], a[88:91]
    ds_read_b64_tr_b16 a[250:251], v4 offset:1536
    v_mfma_f32_16x16x32_bf16 a[84:87], v[56:59], a[156:159], a[84:87]
    v_mfma_f32_16x16x32_bf16 a[84:87], v[60:63], a[180:183], a[84:87]
    ds_read_b64_tr_b16 a[252:253], v4 offset:13312
    v_mfma_f32_16x16x32_bf16 a[80:83], v[60:63], a[176:179], a[80:83]
    v_mfma_f32_16x16x32_bf16 a[80:83], v[56:59], a[152:155], a[80:83]
    ds_read_b64_tr_b16 a[254:255], v4 offset:13824
    v_mfma_f32_16x16x32_bf16 a[76:79], v[56:59], a[148:151], a[76:79]
    v_mfma_f32_16x16x32_bf16 a[76:79], v[60:63], a[172:175], a[76:79]
    v_mfma_f32_16x16x32_bf16 a[72:75], v[60:63], a[168:171], a[72:75]
    v_mfma_f32_16x16x32_bf16 a[72:75], v[56:59], a[144:147], a[72:75]
    s_cmp_lg_u32 s28, 0
    s_cbranch_scc1 L_k2_fw288
    s_waitcnt vmcnt(24)
L_k2_fw288:
    s_waitcnt vmcnt(26)
    s_waitcnt lgkmcnt(4)
    v_mfma_f32_16x16x32_bf16 v[64:67], a[240:243], a[192:195], v[64:67]
    v_mfma_f32_16x16x32_bf16 v[64:67], a[244:247], a[216:219], v[64:67]
    ds_read_b64_tr_b16 v[56:57], v4 offset:2048
    v_mfma_f32_16x16x32_bf16 v[68:71], a[244:247], a[220:223], v[68:71]
    s_add_u32 s4, s4, 36864
    v_mfma_f32_16x16x32_bf16 v[68:71], a[240:243], a[196:199], v[68:71]
    ds_read_b64_tr_b16 v[58:59], v4 offset:2560
    s_add_u32 s29, s29, 12288
    s_add_u32 s5, s4, 4096
    s_add_u32 m0, s32, 24576
    v_mfma_f32_16x16x32_bf16 v[72:75], a[240:243], a[200:203], v[72:75]
    buffer_load_dwordx4 v1, s[8:11], s4 offen offset:0 nt lds
    v_mfma_f32_16x16x32_bf16 v[72:75], a[244:247], a[224:227], v[72:75]
    ds_read_b64_tr_b16 v[60:61], v4 offset:14336
    v_mfma_f32_16x16x32_bf16 v[76:79], a[244:247], a[228:231], v[76:79]
    v_mfma_f32_16x16x32_bf16 v[76:79], a[240:243], a[204:207], v[76:79]
    ds_read_b64_tr_b16 v[62:63], v4 offset:14848
    s_add_u32 m0, s32, 24576
    v_mfma_f32_16x16x32_bf16 v[80:83], a[240:243], a[208:211], v[80:83]
    buffer_load_dwordx4 v1, s[8:11], s4 offen offset:1024 nt lds
    v_mfma_f32_16x16x32_bf16 v[80:83], a[244:247], a[232:235], v[80:83]
    v_mfma_f32_16x16x32_bf16 v[84:87], a[244:247], a[236:239], v[84:87]
    v_mfma_f32_16x16x32_bf16 v[84:87], a[240:243], a[212:215], v[84:87]
    s_add_u32 m0, s32, 24576
    s_waitcnt lgkmcnt(4)
    v_mfma_f32_16x16x32_bf16 v[108:111], a[248:251], a[212:215], v[108:111]
    buffer_load_dwordx4 v1, s[8:11], s4 offen offset:2048 nt lds
    v_mfma_f32_16x16x32_bf16 v[108:111], a[252:255], a[236:239], v[108:111]
    ds_read_b64_tr_b16 a[240:241], v4 offset:3072
    v_mfma_f32_16x16x32_bf16 v[104:107], a[252:255], a[232:235], v[104:107]
    v_mfma_f32_16x16x32_bf16 v[104:107], a[248:251], a[208:211], v[104:107]
    ds_read_b64_tr_b16 a[242:243], v4 offset:3584
    s_add_u32 m0, s32, 24576
    v_mfma_f32_16x16x32_bf16 v[100:103], a[248:251], a[204:207], v[100:103]
    buffer_load_dwordx4 v1, s[8:11], s4 offen offset:3072 nt lds
    v_mfma_f32_16x16x32_bf16 v[100:103], a[252:255], a[228:231], v[100:103]
    ds_read_b64_tr_b16 a[244:245], v4 offset:15360
    v_mfma_f32_16x16x32_bf16 v[96:99], a[252:255], a[224:227], v[96:99]
    v_mfma_f32_16x16x32_bf16 v[96:99], a[248:251], a[200:203], v[96:99]
    ds_read_b64_tr_b16 a[246:247], v4 offset:15872
    s_add_u32 m0, s32, 28672
    v_mfma_f32_16x16x32_bf16 v[92:95], a[248:251], a[196:199], v[92:95]
    buffer_load_dwordx4 v1, s[8:11], s5 offen offset:0 nt lds
    v_mfma_f32_16x16x32_bf16 v[92:95], a[252:255], a[220:223], v[92:95]
    v_mfma_f32_16x16x32_bf16 v[88:91], a[252:255], a[216:219], v[88:91]
    v_mfma_f32_16x16x32_bf16 v[88:91], a[248:251], a[192:195], v[88:91]
    s_add_u32 m0, s32, 28672
    s_waitcnt lgkmcnt(4)
    v_mfma_f32_16x16x32_bf16 a[0:3], v[56:59], a[192:195], a[0:3]
    buffer_load_dwordx4 v1, s[8:11], s5 offen offset:1024 nt lds
    v_mfma_f32_16x16x32_bf16 a[0:3], v[60:63], a[216:219], a[0:3]
    ds_read_b64_tr_b16 a[248:249], v4 offset:4096
    v_mfma_f32_16x16x32_bf16 a[4:7], v[60:63], a[220:223], a[4:7]
    v_mfma_f32_16x16x32_bf16 a[4:7], v[56:59], a[196:199], a[4:7]
    ds_read_b64_tr_b16 a[250:251], v4 offset:4608
    v_mfma_f32_16x16x32_bf16 a[8:11], v[56:59], a[200:203], a[8:11]
    v_mfma_f32_16x16x32_bf16 a[8:11], v[60:63], a[224:227], a[8:11]
    ds_read_b64_tr_b16 a[252:253], v4 offset:16384
    v_mfma_f32_16x16x32_bf16 a[12:15], v[60:63], a[228:231], a[12:15]
    v_mfma_f32_16x16x32_bf16 a[12:15], v[56:59], a[204:207], a[12:15]
    ds_read_b64_tr_b16 a[254:255], v4 offset:16896
    v_mfma_f32_16x16x32_bf16 a[16:19], v[56:59], a[208:211], a[16:19]
    v_mfma_f32_16x16x32_bf16 a[16:19], v[60:63], a[232:235], a[16:19]
    v_mfma_f32_16x16x32_bf16 a[20:23], v[60:63], a[236:239], a[20:23]
    v_mfma_f32_16x16x32_bf16 a[20:23], v[56:59], a[212:215], a[20:23]
    s_waitcnt lgkmcnt(4)
    v_mfma_f32_16x16x32_bf16 v[132:135], a[240:243], a[212:215], v[132:135]
    v_mfma_f32_16x16x32_bf16 v[132:135], a[244:247], a[236:239], v[132:135]
    ds_read_b64_tr_b16 v[56:57], v4 offset:5120
    v_mfma_f32_16x16x32_bf16 v[128:131], a[244:247], a[232:235], v[128:131]
    v_mfma_f32_16x16x32_bf16 v[128:131], a[240:243], a[208:211], v[128:131]
    ds_read_b64_tr_b16 v[58:59], v4 offset:5632
    v_mfma_f32_16x16x32_bf16 v[124:127], a[240:243], a[204:207], v[124:127]
    v_mfma_f32_16x16x32_bf16 v[124:127], a[244:247], a[228:231], v[124:127]
    ds_read_b64_tr_b16 v[60:61], v4 offset:17408
    v_mfma_f32_16x16x32_bf16 v[120:123], a[244:247], a[224:227], v[120:123]
    v_mfma_f32_16x16x32_bf16 v[120:123], a[240:243], a[200:203], v[120:123]
    ds_read_b64_tr_b16 v[62:63], v4 offset:17920
    v_mfma_f32_16x16x32_bf16 v[116:119], a[240:243], a[196:199], v[116:119]
    v_mfma_f32_16x16x32_bf16 v[116:119], a[244:247], a[220:223], v[116:119]
    v_mfma_f32_16x16x32_bf16 v[112:115], a[244:247], a[216:219], v[112:115]
    v_mfma_f32_16x16x32_bf16 v[112:115], a[240:243], a[192:195], v[112:115]
    s_waitcnt lgkmcnt(4)
    v_mfma_f32_16x16x32_bf16 v[136:139], a[248:251], a[192:195], v[136:139]
    v_mfma_f32_16x16x32_bf16 v[136:139], a[252:255], a[216:219], v[136:139]
    ds_read_b64_tr_b16 a[240:241], v4 offset:6144
    v_mfma_f32_16x16x32_bf16 v[140:143], a[252:255], a[220:223], v[140:143]
    v_mfma_f32_16x16x32_bf16 v[140:143], a[248:251], a[196:199], v[140:143]
    ds_read_b64_tr_b16 a[242:243], v4 offset:6656
    s_mov_b32 s6, 196608
    v_mfma_f32_16x16x32_bf16 v[144:147], a[248:251], a[200:203], v[144:147]
    buffer_load_dwordx4 a[144:147], v2, s[52:55], s6 offen offset:0
    v_mfma_f32_16x16x32_bf16 v[144:147], a[252:255], a[224:227], v[144:147]
    ds_read_b64_tr_b16 a[244:245], v4 offset:18432
    v_mfma_f32_16x16x32_bf16 v[148:151], a[252:255], a[228:231], v[148:151]
    v_mfma_f32_16x16x32_bf16 v[148:151], a[248:251], a[204:207], v[148:151]
    ds_read_b64_tr_b16 a[246:247], v4 offset:18944
    v_mfma_f32_16x16x32_bf16 v[152:155], a[248:251], a[208:211], v[152:155]
    buffer_load_dwordx4 a[148:151], v2, s[52:55], s6 offen offset:1024
    v_mfma_f32_16x16x32_bf16 v[152:155], a[252:255], a[232:235], v[152:155]
    v_mfma_f32_16x16x32_bf16 v[156:159], a[252:255], a[236:239], v[156:159]
    v_mfma_f32_16x16x32_bf16 v[156:159], a[248:251], a[212:215], v[156:159]
    s_waitcnt lgkmcnt(4)
    v_mfma_f32_16x16x32_bf16 a[44:47], v[56:59], a[212:215], a[44:47]
    buffer_load_dwordx4 a[152:155], v2, s[52:55], s6 offen offset:2048
    v_mfma_f32_16x16x32_bf16 a[44:47], v[60:63], a[236:239], a[44:47]
    ds_read_b64_tr_b16 a[248:249], v4 offset:7168
    v_mfma_f32_16x16x32_bf16 a[40:43], v[60:63], a[232:235], a[40:43]
    v_mfma_f32_16x16x32_bf16 a[40:43], v[56:59], a[208:211], a[40:43]
    ds_read_b64_tr_b16 a[250:251], v4 offset:7680
    v_mfma_f32_16x16x32_bf16 a[36:39], v[56:59], a[204:207], a[36:39]
    buffer_load_dwordx4 a[156:159], v2, s[52:55], s6 offen offset:3072
    v_mfma_f32_16x16x32_bf16 a[36:39], v[60:63], a[228:231], a[36:39]
    ds_read_b64_tr_b16 a[252:253], v4 offset:19456
    v_mfma_f32_16x16x32_bf16 a[32:35], v[60:63], a[224:227], a[32:35]
    v_mfma_f32_16x16x32_bf16 a[32:35], v[56:59], a[200:203], a[32:35]
    ds_read_b64_tr_b16 a[254:255], v4 offset:19968
    s_mov_b32 s6, 200704
    v_mfma_f32_16x16x32_bf16 a[28:31], v[56:59], a[196:199], a[28:31]
    buffer_load_dwordx4 a[160:163], v2, s[52:55], s6 offen offset:0
    v_mfma_f32_16x16x32_bf16 a[28:31], v[60:63], a[220:223], a[28:31]
    v_mfma_f32_16x16x32_bf16 a[24:27], v[60:63], a[216:219], a[24:27]
    v_mfma_f32_16x16x32_bf16 a[24:27], v[56:59], a[192:195], a[24:27]
    s_waitcnt lgkmcnt(4)
    v_mfma_f32_16x16x32_bf16 v[160:163], a[240:243], a[192:195], v[160:163]
    buffer_load_dwordx4 a[164:167], v2, s[52:55], s6 offen offset:1024
    v_mfma_f32_16x16x32_bf16 v[160:163], a[244:247], a[216:219], v[160:163]
    ds_read_b64_tr_b16 v[56:57], v4 offset:8192
    v_mfma_f32_16x16x32_bf16 v[164:167], a[244:247], a[220:223], v[164:167]
    v_mfma_f32_16x16x32_bf16 v[164:167], a[240:243], a[196:199], v[164:167]
    ds_read_b64_tr_b16 v[58:59], v4 offset:8704
    v_mfma_f32_16x16x32_bf16 v[168:171], a[240:243], a[200:203], v[168:171]
    v_mfma_f32_16x16x32_bf16 v[168:171], a[244:247], a[224:227], v[168:171]
    ds_read_b64_tr_b16 v[60:61], v4 offset:20480
    v_mfma_f32_16x16x32_bf16 v[172:175], a[244:247], a[228:231], v[172:175]
    v_mfma_f32_16x16x32_bf16 v[172:175], a[240:243], a[204:207], v[172:175]
    ds_read_b64_tr_b16 v[62:63], v4 offset:20992
    v_mfma_f32_16x16x32_bf16 v[176:179], a[240:243], a[208:211], v[176:179]
    v_mfma_f32_16x16x32_bf16 v[176:179], a[244:247], a[232:235], v[176:179]
    v_mfma_f32_16x16x32_bf16 v[180:183], a[244:247], a[236:239], v[180:183]
    v_mfma_f32_16x16x32_bf16 v[180:183], a[240:243], a[212:215], v[180:183]
    s_waitcnt lgkmcnt(4)
    v_mfma_f32_16x16x32_bf16 v[204:207], a[248:251], a[212:215], v[204:207]
    v_mfma_f32_16x16x32_bf16 v[204:207], a[252:255], a[236:239], v[204:207]
    ds_read_b64_tr_b16 a[240:241], v4 offset:9216
    v_mfma_f32_16x16x32_bf16 v[200:203], a[252:255], a[232:235], v[200:203]
    v_mfma_f32_16x16x32_bf16 v[200:203], a[248:251], a[208:211], v[200:203]
    ds_read_b64_tr_b16 a[242:243], v4 offset:9728
    v_mfma_f32_16x16x32_bf16 v[196:199], a[248:251], a[204:207], v[196:199]
    v_mfma_f32_16x16x32_bf16 v[196:199], a[252:255], a[228:231], v[196:199]
    ds_read_b64_tr_b16 a[244:245], v4 offset:21504
    v_mfma_f32_16x16x32_bf16 v[192:195], a[252:255], a[224:227], v[192:195]
    v_mfma_f32_16x16x32_bf16 v[192:195], a[248:251], a[200:203], v[192:195]
    ds_read_b64_tr_b16 a[246:247], v4 offset:22016
    v_mfma_f32_16x16x32_bf16 v[188:191], a[248:251], a[196:199], v[188:191]
    v_mfma_f32_16x16x32_bf16 v[188:191], a[252:255], a[220:223], v[188:191]
    v_mfma_f32_16x16x32_bf16 v[184:187], a[252:255], a[216:219], v[184:187]
    v_mfma_f32_16x16x32_bf16 v[184:187], a[248:251], a[192:195], v[184:187]
    s_waitcnt lgkmcnt(4)
    v_mfma_f32_16x16x32_bf16 a[48:51], v[56:59], a[192:195], a[48:51]
    v_mfma_f32_16x16x32_bf16 a[48:51], v[60:63], a[216:219], a[48:51]
    ds_read_b64_tr_b16 a[248:249], v4 offset:10240
    v_mfma_f32_16x16x32_bf16 a[52:55], v[60:63], a[220:223], a[52:55]
    v_mfma_f32_16x16x32_bf16 a[52:55], v[56:59], a[196:199], a[52:55]
    ds_read_b64_tr_b16 a[250:251], v4 offset:10752
    v_mfma_f32_16x16x32_bf16 a[56:59], v[56:59], a[200:203], a[56:59]
    buffer_load_dwordx4 a[168:171], v2, s[52:55], s6 offen offset:2048
    v_mfma_f32_16x16x32_bf16 a[56:59], v[60:63], a[224:227], a[56:59]
    ds_read_b64_tr_b16 a[252:253], v4 offset:22528
    v_mfma_f32_16x16x32_bf16 a[60:63], v[60:63], a[228:231], a[60:63]
    ds_read_b128 v[36:39], v7 offset:12288
    v_mfma_f32_16x16x32_bf16 a[60:63], v[56:59], a[204:207], a[60:63]
    ds_read_b64_tr_b16 a[254:255], v4 offset:23040
    v_mfma_f32_16x16x32_bf16 a[64:67], v[56:59], a[208:211], a[64:67]
    buffer_load_dwordx4 a[172:175], v2, s[52:55], s6 offen offset:3072
    v_mfma_f32_16x16x32_bf16 a[64:67], v[60:63], a[232:235], a[64:67]
    ds_read_b128 v[40:43], v7 offset:13312
    v_mfma_f32_16x16x32_bf16 a[68:71], v[60:63], a[236:239], a[68:71]
    v_mfma_f32_16x16x32_bf16 a[68:71], v[56:59], a[212:215], a[68:71]
    s_mov_b32 s6, 204800
    s_waitcnt lgkmcnt(6)
    v_mfma_f32_16x16x32_bf16 v[228:231], a[240:243], a[212:215], v[228:231]
    buffer_load_dwordx4 a[176:179], v2, s[52:55], s6 offen offset:0
    v_mfma_f32_16x16x32_bf16 v[228:231], a[244:247], a[236:239], v[228:231]
    ds_read_b64_tr_b16 v[56:57], v4 offset:11264
    v_mfma_f32_16x16x32_bf16 v[224:227], a[244:247], a[232:235], v[224:227]
    ds_read_b128 v[44:47], v7 offset:14336
    v_mfma_f32_16x16x32_bf16 v[224:227], a[240:243], a[208:211], v[224:227]
    ds_read_b64_tr_b16 v[58:59], v4 offset:11776
    v_mfma_f32_16x16x32_bf16 v[220:223], a[240:243], a[204:207], v[220:223]
    buffer_load_dwordx4 a[180:183], v2, s[52:55], s6 offen offset:1024
    v_mfma_f32_16x16x32_bf16 v[220:223], a[244:247], a[228:231], v[220:223]
    ds_read_b64_tr_b16 v[60:61], v4 offset:23552
    v_mfma_f32_16x16x32_bf16 v[216:219], a[244:247], a[224:227], v[216:219]
    v_mfma_f32_16x16x32_bf16 v[216:219], a[240:243], a[200:203], v[216:219]
    ds_read_b64_tr_b16 v[62:63], v4 offset:24064
    v_mfma_f32_16x16x32_bf16 v[212:215], a[240:243], a[196:199], v[212:215]
    buffer_load_dwordx4 a[184:187], v2, s[52:55], s6 offen offset:2048
    v_mfma_f32_16x16x32_bf16 v[212:215], a[244:247], a[220:223], v[212:215]
    v_mfma_f32_16x16x32_bf16 v[208:211], a[244:247], a[216:219], v[208:211]
    v_mfma_f32_16x16x32_bf16 v[208:211], a[240:243], a[192:195], v[208:211]
    s_waitcnt vmcnt(34) lgkmcnt(0)
    s_barrier
    v_mfma_f32_16x16x32_bf16 v[232:235], a[248:251], a[192:195], v[232:235]
    buffer_load_dwordx4 a[188:191], v2, s[52:55], s6 offen offset:3072
    v_mfma_f32_16x16x32_bf16 v[232:235], a[252:255], a[216:219], v[232:235]
    ds_read_b64_tr_b16 a[240:241], v3 offset:0
    v_mfma_f32_16x16x32_bf16 v[236:239], a[252:255], a[220:223], v[236:239]
    v_mfma_f32_16x16x32_bf16 v[236:239], a[248:251], a[196:199], v[236:239]
    ds_read_b64_tr_b16 a[242:243], v3 offset:512
    v_mfma_f32_16x16x32_bf16 v[240:243], a[248:251], a[200:203], v[240:243]
    s_add_u32 s42, s44, 6144
    buffer_store_dwordx4 v[36:39], v1, s[16:19], s42 offen offset:0
    v_mfma_f32_16x16x32_bf16 v[240:243], a[252:255], a[224:227], v[240:243]
    ds_read_b64_tr_b16 a[244:245], v3 offset:12288
    v_mfma_f32_16x16x32_bf16 v[244:247], a[252:255], a[228:231], v[244:247]
    v_mfma_f32_16x16x32_bf16 v[244:247], a[248:251], a[204:207], v[244:247]
    ds_read_b64_tr_b16 a[246:247], v3 offset:12800
    v_mfma_f32_16x16x32_bf16 v[248:251], a[248:251], a[208:211], v[248:251]
    s_add_u32 s42, s44, 6144
    buffer_store_dwordx4 v[40:43], v1, s[16:19], s42 offen offset:1024
    v_mfma_f32_16x16x32_bf16 v[248:251], a[252:255], a[232:235], v[248:251]
    v_mfma_f32_16x16x32_bf16 v[252:255], a[252:255], a[236:239], v[252:255]
    v_mfma_f32_16x16x32_bf16 v[252:255], a[248:251], a[212:215], v[252:255]
    v_mfma_f32_16x16x32_bf16 a[92:95], v[56:59], a[212:215], a[92:95]
    s_add_u32 s42, s44, 6144
    buffer_store_dwordx4 v[44:47], v1, s[16:19], s42 offen offset:2048
    v_mfma_f32_16x16x32_bf16 a[92:95], v[60:63], a[236:239], a[92:95]
    ds_read_b64_tr_b16 a[248:249], v3 offset:1024
    v_mfma_f32_16x16x32_bf16 a[88:91], v[60:63], a[232:235], a[88:91]
    v_mfma_f32_16x16x32_bf16 a[88:91], v[56:59], a[208:211], a[88:91]
    ds_read_b64_tr_b16 a[250:251], v3 offset:1536
    v_mfma_f32_16x16x32_bf16 a[84:87], v[56:59], a[204:207], a[84:87]
    v_mfma_f32_16x16x32_bf16 a[84:87], v[60:63], a[228:231], a[84:87]
    ds_read_b64_tr_b16 a[252:253], v3 offset:13312
    v_mfma_f32_16x16x32_bf16 a[80:83], v[60:63], a[224:227], a[80:83]
    v_mfma_f32_16x16x32_bf16 a[80:83], v[56:59], a[200:203], a[80:83]
    ds_read_b64_tr_b16 a[254:255], v3 offset:13824
    v_mfma_f32_16x16x32_bf16 a[76:79], v[56:59], a[196:199], a[76:79]
    v_mfma_f32_16x16x32_bf16 a[76:79], v[60:63], a[220:223], a[76:79]
    v_mfma_f32_16x16x32_bf16 a[72:75], v[60:63], a[216:219], a[72:75]
    v_mfma_f32_16x16x32_bf16 a[72:75], v[56:59], a[192:195], a[72:75]
    s_waitcnt vmcnt(24)
    s_waitcnt lgkmcnt(4)
    v_mfma_f32_16x16x32_bf16 v[64:67], a[240:243], a[96:99], v[64:67]
    v_mfma_f32_16x16x32_bf16 v[64:67], a[244:247], a[120:123], v[64:67]
    ds_read_b64_tr_b16 v[56:57], v3 offset:2048
    v_mfma_f32_16x16x32_bf16 v[68:71], a[244:247], a[124:127], v[68:71]
    v_mfma_f32_16x16x32_bf16 v[68:71], a[240:243], a[100:103], v[68:71]
    ds_read_b64_tr_b16 v[58:59], v3 offset:2560
    s_add_u32 m0, s39, 49152
    v_mfma_f32_16x16x32_bf16 v[72:75], a[240:243], a[104:107], v[72:75]
    buffer_load_dwordx4 v1, s[56:59], s4 offen offset:0 nt lds
    v_mfma_f32_16x16x32_bf16 v[72:75], a[244:247], a[128:131], v[72:75]
    ds_read_b64_tr_b16 v[60:61], v3 offset:14336
    v_mfma_f32_16x16x32_bf16 v[76:79], a[244:247], a[132:135], v[76:79]
    v_mfma_f32_16x16x32_bf16 v[76:79], a[240:243], a[108:111], v[76:79]
    ds_read_b64_tr_b16 v[62:63], v3 offset:14848
    s_add_u32 m0, s39, 49152
    v_mfma_f32_16x16x32_bf16 v[80:83], a[240:243], a[112:115], v[80:83]
    buffer_load_dwordx4 v1, s[56:59], s4 offen offset:1024 nt lds
    v_mfma_f32_16x16x32_bf16 v[80:83], a[244:247], a[136:139], v[80:83]
    v_mfma_f32_16x16x32_bf16 v[84:87], a[244:247], a[140:143], v[84:87]
    v_mfma_f32_16x16x32_bf16 v[84:87], a[240:243], a[116:119], v[84:87]
    s_add_u32 m0, s39, 49152
    s_waitcnt lgkmcnt(4)
    v_mfma_f32_16x16x32_bf16 v[108:111], a[248:251], a[116:119], v[108:111]
    buffer_load_dwordx4 v1, s[56:59], s4 offen offset:2048 nt lds
    v_mfma_f32_16x16x32_bf16 v[108:111], a[252:255], a[140:143], v[108:111]
    ds_read_b64_tr_b16 a[240:241], v3 offset:3072
    v_mfma_f32_16x16x32_bf16 v[104:107], a[252:255], a[136:139], v[104:107]
    v_mfma_f32_16x16x32_bf16 v[104:107], a[248:251], a[112:115], v[104:107]
    ds_read_b64_tr_b16 a[242:243], v3 offset:3584
    s_add_u32 m0, s39, 61440
    v_mfma_f32_16x16x32_bf16 v[100:103], a[248:251], a[108:111], v[100:103]
    buffer_load_dwordx4 v1, s[60:63], s29 offen offset:0 nt lds
    v_mfma_f32_16x16x32_bf16 v[100:103], a[252:255], a[132:135], v[100:103]
    ds_read_b64_tr_b16 a[244:245], v3 offset:15360
    v_mfma_f32_16x16x32_bf16 v[96:99], a[252:255], a[128:131], v[96:99]
    v_mfma_f32_16x16x32_bf16 v[96:99], a[248:251], a[104:107], v[96:99]
    ds_read_b64_tr_b16 a[246:247], v3 offset:15872
    s_add_u32 m0, s39, 61440
    v_mfma_f32_16x16x32_bf16 v[92:95], a[248:251], a[100:103], v[92:95]
    buffer_load_dwordx4 v1, s[60:63], s29 offen offset:1024 nt lds
    v_mfma_f32_16x16x32_bf16 v[92:95], a[252:255], a[124:127], v[92:95]
    v_mfma_f32_16x16x32_bf16 v[88:91], a[252:255], a[120:123], v[88:91]
    v_mfma_f32_16x16x32_bf16 v[88:91], a[248:251], a[96:99], v[88:91]
    s_add_u32 m0, s39, 61440
    s_waitcnt lgkmcnt(4)
    v_mfma_f32_16x16x32_bf16 a[0:3], v[56:59], a[96:99], a[0:3]
    buffer_load_dwordx4 v1, s[60:63], s29 offen offset:2048 nt lds
    v_mfma_f32_16x16x32_bf16 a[0:3], v[60:63], a[120:123], a[0:3]
    ds_read_b64_tr_b16 a[248:249], v3 offset:4096
    v_mfma_f32_16x16x32_bf16 a[4:7], v[60:63], a[124:127], a[4:7]
    v_mfma_f32_16x16x32_bf16 a[4:7], v[56:59], a[100:103], a[4:7]
    ds_read_b64_tr_b16 a[250:251], v3 offset:4608
    v_mfma_f32_16x16x32_bf16 a[8:11], v[56:59], a[104:107], a[8:11]
    v_mfma_f32_16x16x32_bf16 a[8:11], v[60:63], a[128:131], a[8:11]
    ds_read_b64_tr_b16 a[252:253], v3 offset:16384
    v_mfma_f32_16x16x32_bf16 a[12:15], v[60:63], a[132:135], a[12:15]
    v_mfma_f32_16x16x32_bf16 a[12:15], v[56:59], a[108:111], a[12:15]
    ds_read_b64_tr_b16 a[254:255], v3 offset:16896
    v_mfma_f32_16x16x32_bf16 a[16:19], v[56:59], a[112:115], a[16:19]
    v_mfma_f32_16x16x32_bf16 a[16:19], v[60:63], a[136:139], a[16:19]
    v_mfma_f32_16x16x32_bf16 a[20:23], v[60:63], a[140:143], a[20:23]
    v_mfma_f32_16x16x32_bf16 a[20:23], v[56:59], a[116:119], a[20:23]
    s_waitcnt lgkmcnt(4)
    v_mfma_f32_16x16x32_bf16 v[132:135], a[240:243], a[116:119], v[132:135]
    v_mfma_f32_16x16x32_bf16 v[132:135], a[244:247], a[140:143], v[132:135]
    ds_read_b64_tr_b16 v[56:57], v3 offset:5120
    v_mfma_f32_16x16x32_bf16 v[128:131], a[244:247], a[136:139], v[128:131]
    v_mfma_f32_16x16x32_bf16 v[128:131], a[240:243], a[112:115], v[128:131]
    ds_read_b64_tr_b16 v[58:59], v3 offset:5632
    v_mfma_f32_16x16x32_bf16 v[124:127], a[240:243], a[108:111], v[124:127]
    v_mfma_f32_16x16x32_bf16 v[124:127], a[244:247], a[132:135], v[124:127]
    ds_read_b64_tr_b16 v[60:61], v3 offset:17408
    v_mfma_f32_16x16x32_bf16 v[120:123], a[244:247], a[128:131], v[120:123]
    v_mfma_f32_16x16x32_bf16 v[120:123], a[240:243], a[104:107], v[120:123]
    ds_read_b64_tr_b16 v[62:63], v3 offset:17920
    v_mfma_f32_16x16x32_bf16 v[116:119], a[240:243], a[100:103], v[116:119]
    v_mfma_f32_16x16x32_bf16 v[116:119], a[244:247], a[124:127], v[116:119]
    v_mfma_f32_16x16x32_bf16 v[112:115], a[244:247], a[120:123], v[112:115]
    v_mfma_f32_16x16x32_bf16 v[112:115], a[240:243], a[96:99], v[112:115]
    s_waitcnt lgkmcnt(4)
    v_mfma_f32_16x16x32_bf16 v[136:139], a[248:251], a[96:99], v[136:139]
    v_mfma_f32_16x16x32_bf16 v[136:139], a[252:255], a[120:123], v[136:139]
    ds_read_b64_tr_b16 a[240:241], v3 offset:6144
    v_mfma_f32_16x16x32_bf16 v[140:143], a[252:255], a[124:127], v[140:143]
    v_mfma_f32_16x16x32_bf16 v[140:143], a[248:251], a[100:103], v[140:143]
    ds_read_b64_tr_b16 a[242:243], v3 offset:6656
    s_mov_b32 s6, 245760
    v_mfma_f32_16x16x32_bf16 v[144:147], a[248:251], a[104:107], v[144:147]
    buffer_load_dwordx4 a[192:195], v2, s[52:55], s6 offen offset:0
    v_mfma_f32_16x16x32_bf16 v[144:147], a[252:255], a[128:131], v[144:147]
    ds_read_b64_tr_b16 a[244:245], v3 offset:18432
    v_mfma_f32_16x16x32_bf16 v[148:151], a[252:255], a[132:135], v[148:151]
    v_mfma_f32_16x16x32_bf16 v[148:151], a[248:251], a[108:111], v[148:151]
    ds_read_b64_tr_b16 a[246:247], v3 offset:18944
    v_mfma_f32_16x16x32_bf16 v[152:155], a[248:251], a[112:115], v[152:155]
    buffer_load_dwordx4 a[196:199], v2, s[52:55], s6 offen offset:1024
    v_mfma_f32_16x16x32_bf16 v[152:155], a[252:255], a[136:139], v[152:155]
    v_mfma_f32_16x16x32_bf16 v[156:159], a[252:255], a[140:143], v[156:159]
    v_mfma_f32_16x16x32_bf16 v[156:159], a[248:251], a[116:119], v[156:159]
    s_waitcnt lgkmcnt(4)
    v_mfma_f32_16x16x32_bf16 a[44:47], v[56:59], a[116:119], a[44:47]
    buffer_load_dwordx4 a[200:203], v2, s[52:55], s6 offen offset:2048
    v_mfma_f32_16x16x32_bf16 a[44:47], v[60:63], a[140:143], a[44:47]
    ds_read_b64_tr_b16 a[248:249], v3 offset:7168
    v_mfma_f32_16x16x32_bf16 a[40:43], v[60:63], a[136:139], a[40:43]
    v_mfma_f32_16x16x32_bf16 a[40:43], v[56:59], a[112:115], a[40:43]
    ds_read_b64_tr_b16 a[250:251], v3 offset:7680
    v_mfma_f32_16x16x32_bf16 a[36:39], v[56:59], a[108:111], a[36:39]
    buffer_load_dwordx4 a[204:207], v2, s[52:55], s6 offen offset:3072
    v_mfma_f32_16x16x32_bf16 a[36:39], v[60:63], a[132:135], a[36:39]
    ds_read_b64_tr_b16 a[252:253], v3 offset:19456
    v_mfma_f32_16x16x32_bf16 a[32:35], v[60:63], a[128:131], a[32:35]
    v_mfma_f32_16x16x32_bf16 a[32:35], v[56:59], a[104:107], a[32:35]
    ds_read_b64_tr_b16 a[254:255], v3 offset:19968
    s_mov_b32 s6, 249856
    v_mfma_f32_16x16x32_bf16 a[28:31], v[56:59], a[100:103], a[28:31]
    buffer_load_dwordx4 a[208:211], v2, s[52:55], s6 offen offset:0
    v_mfma_f32_16x16x32_bf16 a[28:31], v[60:63], a[124:127], a[28:31]
    v_mfma_f32_16x16x32_bf16 a[24:27], v[60:63], a[120:123], a[24:27]
    v_mfma_f32_16x16x32_bf16 a[24:27], v[56:59], a[96:99], a[24:27]
    s_waitcnt lgkmcnt(4)
    v_mfma_f32_16x16x32_bf16 v[160:163], a[240:243], a[96:99], v[160:163]
    buffer_load_dwordx4 a[212:215], v2, s[52:55], s6 offen offset:1024
    v_mfma_f32_16x16x32_bf16 v[160:163], a[244:247], a[120:123], v[160:163]
    ds_read_b64_tr_b16 v[56:57], v3 offset:8192
    v_mfma_f32_16x16x32_bf16 v[164:167], a[244:247], a[124:127], v[164:167]
    v_mfma_f32_16x16x32_bf16 v[164:167], a[240:243], a[100:103], v[164:167]
    ds_read_b64_tr_b16 v[58:59], v3 offset:8704
    v_mfma_f32_16x16x32_bf16 v[168:171], a[240:243], a[104:107], v[168:171]
    v_mfma_f32_16x16x32_bf16 v[168:171], a[244:247], a[128:131], v[168:171]
    ds_read_b64_tr_b16 v[60:61], v3 offset:20480
    v_mfma_f32_16x16x32_bf16 v[172:175], a[244:247], a[132:135], v[172:175]
    v_mfma_f32_16x16x32_bf16 v[172:175], a[240:243], a[108:111], v[172:175]
    ds_read_b64_tr_b16 v[62:63], v3 offset:20992
    v_mfma_f32_16x16x32_bf16 v[176:179], a[240:243], a[112:115], v[176:179]
    v_mfma_f32_16x16x32_bf16 v[176:179], a[244:247], a[136:139], v[176:179]
    v_mfma_f32_16x16x32_bf16 v[180:183], a[244:247], a[140:143], v[180:183]
    v_mfma_f32_16x16x32_bf16 v[180:183], a[240:243], a[116:119], v[180:183]
    s_waitcnt lgkmcnt(4)
    v_mfma_f32_16x16x32_bf16 v[204:207], a[248:251], a[116:119], v[204:207]
    v_mfma_f32_16x16x32_bf16 v[204:207], a[252:255], a[140:143], v[204:207]
    ds_read_b64_tr_b16 a[240:241], v3 offset:9216
    v_mfma_f32_16x16x32_bf16 v[200:203], a[252:255], a[136:139], v[200:203]
    v_mfma_f32_16x16x32_bf16 v[200:203], a[248:251], a[112:115], v[200:203]
    ds_read_b64_tr_b16 a[242:243], v3 offset:9728
    v_mfma_f32_16x16x32_bf16 v[196:199], a[248:251], a[108:111], v[196:199]
    v_mfma_f32_16x16x32_bf16 v[196:199], a[252:255], a[132:135], v[196:199]
    ds_read_b64_tr_b16 a[244:245], v3 offset:21504
    v_mfma_f32_16x16x32_bf16 v[192:195], a[252:255], a[128:131], v[192:195]
    v_mfma_f32_16x16x32_bf16 v[192:195], a[248:251], a[104:107], v[192:195]
    ds_read_b64_tr_b16 a[246:247], v3 offset:22016
    v_mfma_f32_16x16x32_bf16 v[188:191], a[248:251], a[100:103], v[188:191]
    v_mfma_f32_16x16x32_bf16 v[188:191], a[252:255], a[124:127], v[188:191]
    v_mfma_f32_16x16x32_bf16 v[184:187], a[252:255], a[120:123], v[184:187]
    v_mfma_f32_16x16x32_bf16 v[184:187], a[248:251], a[96:99], v[184:187]
    s_waitcnt lgkmcnt(4)
    v_mfma_f32_16x16x32_bf16 a[48:51], v[56:59], a[96:99], a[48:51]
    v_mfma_f32_16x16x32_bf16 a[48:51], v[60:63], a[120:123], a[48:51]
    ds_read_b64_tr_b16 a[248:249], v3 offset:10240
    v_mfma_f32_16x16x32_bf16 a[52:55], v[60:63], a[124:127], a[52:55]
    v_mfma_f32_16x16x32_bf16 a[52:55], v[56:59], a[100:103], a[52:55]
    ds_read_b64_tr_b16 a[250:251], v3 offset:10752
    v_mfma_f32_16x16x32_bf16 a[56:59], v[56:59], a[104:107], a[56:59]
    buffer_load_dwordx4 a[216:219], v2, s[52:55], s6 offen offset:2048
    v_mfma_f32_16x16x32_bf16 a[56:59], v[60:63], a[128:131], a[56:59]
    ds_read_b64_tr_b16 a[252:253], v3 offset:22528
    v_mfma_f32_16x16x32_bf16 a[60:63], v[60:63], a[132:135], a[60:63]
    ds_read_b128 v[48:51], v7 offset:24576
    v_mfma_f32_16x16x32_bf16 a[60:63], v[56:59], a[108:111], a[60:63]
    ds_read_b64_tr_b16 a[254:255], v3 offset:23040
    v_mfma_f32_16x16x32_bf16 a[64:67], v[56:59], a[112:115], a[64:67]
    buffer_load_dwordx4 a[220:223], v2, s[52:55], s6 offen offset:3072
    v_mfma_f32_16x16x32_bf16 a[64:67], v[60:63], a[136:139], a[64:67]
    ds_read_b128 v[52:55], v7 offset:25600
    v_mfma_f32_16x16x32_bf16 a[68:71], v[60:63], a[140:143], a[68:71]
    v_mfma_f32_16x16x32_bf16 a[68:71], v[56:59], a[116:119], a[68:71]
    s_mov_b32 s6, 253952
    s_waitcnt lgkmcnt(6)
    v_mfma_f32_16x16x32_bf16 v[228:231], a[240:243], a[116:119], v[228:231]
    buffer_load_dwordx4 a[224:227], v2, s[52:55], s6 offen offset:0
    v_mfma_f32_16x16x32_bf16 v[228:231], a[244:247], a[140:143], v[228:231]
    ds_read_b64_tr_b16 v[56:57], v3 offset:11264
    v_mfma_f32_16x16x32_bf16 v[224:227], a[244:247], a[136:139], v[224:227]
    ds_read_b128 v[24:27], v7 offset:26624
    v_mfma_f32_16x16x32_bf16 v[224:227], a[240:243], a[112:115], v[224:227]
    ds_read_b64_tr_b16 v[58:59], v3 offset:11776
    v_mfma_f32_16x16x32_bf16 v[220:223], a[240:243], a[108:111], v[220:223]
    buffer_load_dwordx4 a[228:231], v2, s[52:55], s6 offen offset:1024
    v_mfma_f32_16x16x32_bf16 v[220:223], a[244:247], a[132:135], v[220:223]
    ds_read_b64_tr_b16 v[60:61], v3 offset:23552
    v_mfma_f32_16x16x32_bf16 v[216:219], a[244:247], a[128:131], v[216:219]
    v_mfma_f32_16x16x32_bf16 v[216:219], a[240:243], a[104:107], v[216:219]
    ds_read_b64_tr_b16 v[62:63], v3 offset:24064
    v_mfma_f32_16x16x32_bf16 v[212:215], a[240:243], a[100:103], v[212:215]
    buffer_load_dwordx4 a[232:235], v2, s[52:55], s6 offen offset:2048
    v_mfma_f32_16x16x32_bf16 v[212:215], a[244:247], a[124:127], v[212:215]
    v_mfma_f32_16x16x32_bf16 v[208:211], a[244:247], a[120:123], v[208:211]
    v_mfma_f32_16x16x32_bf16 v[208:211], a[240:243], a[96:99], v[208:211]
    s_waitcnt vmcnt(32) lgkmcnt(0)
    s_barrier
    v_mfma_f32_16x16x32_bf16 v[232:235], a[248:251], a[96:99], v[232:235]
    buffer_load_dwordx4 a[236:239], v2, s[52:55], s6 offen offset:3072
    v_mfma_f32_16x16x32_bf16 v[232:235], a[252:255], a[120:123], v[232:235]
    ds_read_b64_tr_b16 a[240:241], v3 offset:24576
    v_mfma_f32_16x16x32_bf16 v[236:239], a[252:255], a[124:127], v[236:239]
    v_mfma_f32_16x16x32_bf16 v[236:239], a[248:251], a[100:103], v[236:239]
    ds_read_b64_tr_b16 a[242:243], v3 offset:25088
    v_mfma_f32_16x16x32_bf16 v[240:243], a[248:251], a[104:107], v[240:243]
    s_add_u32 s42, s44, 9216
    buffer_store_dwordx4 v[48:51], v1, s[16:19], s42 offen offset:0
    v_mfma_f32_16x16x32_bf16 v[240:243], a[252:255], a[128:131], v[240:243]
    ds_read_b64_tr_b16 a[244:245], v3 offset:36864
    v_mfma_f32_16x16x32_bf16 v[244:247], a[252:255], a[132:135], v[244:247]
    v_mfma_f32_16x16x32_bf16 v[244:247], a[248:251], a[108:111], v[244:247]
    ds_read_b64_tr_b16 a[246:247], v3 offset:37376
    v_mfma_f32_16x16x32_bf16 v[248:251], a[248:251], a[112:115], v[248:251]
    s_add_u32 s42, s44, 9216
    buffer_store_dwordx4 v[52:55], v1, s[16:19], s42 offen offset:1024
    v_mfma_f32_16x16x32_bf16 v[248:251], a[252:255], a[136:139], v[248:251]
    v_mfma_f32_16x16x32_bf16 v[252:255], a[252:255], a[140:143], v[252:255]
    v_mfma_f32_16x16x32_bf16 v[252:255], a[248:251], a[116:119], v[252:255]
    v_mfma_f32_16x16x32_bf16 a[92:95], v[56:59], a[116:119], a[92:95]
    s_add_u32 s42, s44, 9216
    buffer_store_dwordx4 v[24:27], v1, s[16:19], s42 offen offset:2048
    v_mfma_f32_16x16x32_bf16 a[92:95], v[60:63], a[140:143], a[92:95]
    ds_read_b64_tr_b16 a[248:249], v3 offset:25600
    v_mfma_f32_16x16x32_bf16 a[88:91], v[60:63], a[136:139], a[88:91]
    v_mfma_f32_16x16x32_bf16 a[88:91], v[56:59], a[112:115], a[88:91]
    ds_read_b64_tr_b16 a[250:251], v3 offset:26112
    v_mfma_f32_16x16x32_bf16 a[84:87], v[56:59], a[108:111], a[84:87]
    v_mfma_f32_16x16x32_bf16 a[84:87], v[60:63], a[132:135], a[84:87]
    ds_read_b64_tr_b16 a[252:253], v3 offset:37888
    v_mfma_f32_16x16x32_bf16 a[80:83], v[60:63], a[128:131], a[80:83]
    v_mfma_f32_16x16x32_bf16 a[80:83], v[56:59], a[104:107], a[80:83]
    ds_read_b64_tr_b16 a[254:255], v3 offset:38400
    v_mfma_f32_16x16x32_bf16 a[76:79], v[56:59], a[100:103], a[76:79]
    v_mfma_f32_16x16x32_bf16 a[76:79], v[60:63], a[124:127], a[76:79]
    v_mfma_f32_16x16x32_bf16 a[72:75], v[60:63], a[120:123], a[72:75]
    v_mfma_f32_16x16x32_bf16 a[72:75], v[56:59], a[96:99], a[72:75]
    s_waitcnt vmcnt(24)
    s_waitcnt lgkmcnt(4)
    v_mfma_f32_16x16x32_bf16 v[64:67], a[240:243], a[144:147], v[64:67]
    v_mfma_f32_16x16x32_bf16 v[64:67], a[244:247], a[168:171], v[64:67]
    ds_read_b64_tr_b16 v[56:57], v3 offset:26624
    v_mfma_f32_16x16x32_bf16 v[68:71], a[244:247], a[172:175], v[68:71]
    s_add_u32 s4, s4, 36864
    v_mfma_f32_16x16x32_bf16 v[68:71], a[240:243], a[148:151], v[68:71]
    ds_read_b64_tr_b16 v[58:59], v3 offset:27136
    s_add_u32 s29, s29, 12288
    s_add_u32 s5, s4, 4096
    s_add_u32 m0, s32, 0
    v_mfma_f32_16x16x32_bf16 v[72:75], a[240:243], a[152:155], v[72:75]
    buffer_load_dwordx4 v1, s[8:11], s4 offen offset:0 nt lds
    v_mfma_f32_16x16x32_bf16 v[72:75], a[244:247], a[176:179], v[72:75]
    ds_read_b64_tr_b16 v[60:61], v3 offset:38912
    v_mfma_f32_16x16x32_bf16 v[76:79], a[244:247], a[180:183], v[76:79]
    v_mfma_f32_16x16x32_bf16 v[76:79], a[240:243], a[156:159], v[76:79]
    ds_read_b64_tr_b16 v[62:63], v3 offset:39424
    s_add_u32 m0, s32, 0
    v_mfma_f32_16x16x32_bf16 v[80:83], a[240:243], a[160:163], v[80:83]
    buffer_load_dwordx4 v1, s[8:11], s4 offen offset:1024 nt lds
    v_mfma_f32_16x16x32_bf16 v[80:83], a[244:247], a[184:187], v[80:83]
    v_mfma_f32_16x16x32_bf16 v[84:87], a[244:247], a[188:191], v[84:87]
    v_mfma_f32_16x16x32_bf16 v[84:87], a[240:243], a[164:167], v[84:87]
    s_add_u32 m0, s32, 0
    s_waitcnt lgkmcnt(4)
    v_mfma_f32_16x16x32_bf16 v[108:111], a[248:251], a[164:167], v[108:111]
    buffer_load_dwordx4 v1, s[8:11], s4 offen offset:2048 nt lds
    v_mfma_f32_16x16x32_bf16 v[108:111], a[252:255], a[188:191], v[108:111]
    ds_read_b64_tr_b16 a[240:241], v3 offset:27648
    v_mfma_f32_16x16x32_bf16 v[104:107], a[252:255], a[184:187], v[104:107]
    v_mfma_f32_16x16x32_bf16 v[104:107], a[248:251], a[160:163], v[104:107]
    ds_read_b64_tr_b16 a[242:243], v3 offset:28160
    s_add_u32 m0, s32, 0
    v_mfma_f32_16x16x32_bf16 v[100:103], a[248:251], a[156:159], v[100:103]
    buffer_load_dwordx4 v1, s[8:11], s4 offen offset:3072 nt lds
    v_mfma_f32_16x16x32_bf16 v[100:103], a[252:255], a[180:183], v[100:103]
    ds_read_b64_tr_b16 a[244:245], v3 offset:39936
    v_mfma_f32_16x16x32_bf16 v[96:99], a[252:255], a[176:179], v[96:99]
    v_mfma_f32_16x16x32_bf16 v[96:99], a[248:251], a[152:155], v[96:99]
    ds_read_b64_tr_b16 a[246:247], v3 offset:40448
    s_add_u32 m0, s32, 4096
    v_mfma_f32_16x16x32_bf16 v[92:95], a[248:251], a[148:151], v[92:95]
    buffer_load_dwordx4 v1, s[8:11], s5 offen offset:0 nt lds
    v_mfma_f32_16x16x32_bf16 v[92:95], a[252:255], a[172:175], v[92:95]
    v_mfma_f32_16x16x32_bf16 v[88:91], a[252:255], a[168:171], v[88:91]
    v_mfma_f32_16x16x32_bf16 v[88:91], a[248:251], a[144:147], v[88:91]
    s_add_u32 m0, s32, 4096
    s_waitcnt lgkmcnt(4)
    v_mfma_f32_16x16x32_bf16 a[0:3], v[56:59], a[144:147], a[0:3]
    buffer_load_dwordx4 v1, s[8:11], s5 offen offset:1024 nt lds
    v_mfma_f32_16x16x32_bf16 a[0:3], v[60:63], a[168:171], a[0:3]
    ds_read_b64_tr_b16 a[248:249], v3 offset:28672
    v_mfma_f32_16x16x32_bf16 a[4:7], v[60:63], a[172:175], a[4:7]
    v_mfma_f32_16x16x32_bf16 a[4:7], v[56:59], a[148:151], a[4:7]
    ds_read_b64_tr_b16 a[250:251], v3 offset:29184
    v_mfma_f32_16x16x32_bf16 a[8:11], v[56:59], a[152:155], a[8:11]
    v_mfma_f32_16x16x32_bf16 a[8:11], v[60:63], a[176:179], a[8:11]
    ds_read_b64_tr_b16 a[252:253], v3 offset:40960
    v_mfma_f32_16x16x32_bf16 a[12:15], v[60:63], a[180:183], a[12:15]
    v_mfma_f32_16x16x32_bf16 a[12:15], v[56:59], a[156:159], a[12:15]
    ds_read_b64_tr_b16 a[254:255], v3 offset:41472
    v_mfma_f32_16x16x32_bf16 a[16:19], v[56:59], a[160:163], a[16:19]
    v_mfma_f32_16x16x32_bf16 a[16:19], v[60:63], a[184:187], a[16:19]
    v_mfma_f32_16x16x32_bf16 a[20:23], v[60:63], a[188:191], a[20:23]
    v_mfma_f32_16x16x32_bf16 a[20:23], v[56:59], a[164:167], a[20:23]
    s_waitcnt lgkmcnt(4)
    v_mfma_f32_16x16x32_bf16 v[132:135], a[240:243], a[164:167], v[132:135]
    v_mfma_f32_16x16x32_bf16 v[132:135], a[244:247], a[188:191], v[132:135]
    ds_read_b64_tr_b16 v[56:57], v3 offset:29696
    v_mfma_f32_16x16x32_bf16 v[128:131], a[244:247], a[184:187], v[128:131]
    v_mfma_f32_16x16x32_bf16 v[128:131], a[240:243], a[160:163], v[128:131]
    ds_read_b64_tr_b16 v[58:59], v3 offset:30208
    v_mfma_f32_16x16x32_bf16 v[124:127], a[240:243], a[156:159], v[124:127]
    v_mfma_f32_16x16x32_bf16 v[124:127], a[244:247], a[180:183], v[124:127]
    ds_read_b64_tr_b16 v[60:61], v3 offset:41984
    v_mfma_f32_16x16x32_bf16 v[120:123], a[244:247], a[176:179], v[120:123]
    v_mfma_f32_16x16x32_bf16 v[120:123], a[240:243], a[152:155], v[120:123]
    ds_read_b64_tr_b16 v[62:63], v3 offset:42496
    v_mfma_f32_16x16x32_bf16 v[116:119], a[240:243], a[148:151], v[116:119]
    v_mfma_f32_16x16x32_bf16 v[116:119], a[244:247], a[172:175], v[116:119]
    v_mfma_f32_16x16x32_bf16 v[112:115], a[244:247], a[168:171], v[112:115]
    v_mfma_f32_16x16x32_bf16 v[112:115], a[240:243], a[144:147], v[112:115]
    s_waitcnt lgkmcnt(4)
    v_mfma_f32_16x16x32_bf16 v[136:139], a[248:251], a[144:147], v[136:139]
    v_mfma_f32_16x16x32_bf16 v[136:139], a[252:255], a[168:171], v[136:139]
    ds_read_b64_tr_b16 a[240:241], v3 offset:30720
    v_mfma_f32_16x16x32_bf16 v[140:143], a[252:255], a[172:175], v[140:143]
    v_mfma_f32_16x16x32_bf16 v[140:143], a[248:251], a[148:151], v[140:143]
    ds_read_b64_tr_b16 a[242:243], v3 offset:31232
    s_mov_b32 s6, 294912
    v_mfma_f32_16x16x32_bf16 v[144:147], a[248:251], a[152:155], v[144:147]
    buffer_load_dwordx4 a[96:99], v2, s[52:55], s6 offen offset:0
    v_mfma_f32_16x16x32_bf16 v[144:147], a[252:255], a[176:179], v[144:147]
    ds_read_b64_tr_b16 a[244:245], v3 offset:43008
    v_mfma_f32_16x16x32_bf16 v[148:151], a[252:255], a[180:183], v[148:151]
    v_mfma_f32_16x16x32_bf16 v[148:151], a[248:251], a[156:159], v[148:151]
    ds_read_b64_tr_b16 a[246:247], v3 offset:43520
    v_mfma_f32_16x16x32_bf16 v[152:155], a[248:251], a[160:163], v[152:155]
    buffer_load_dwordx4 a[100:103], v2, s[52:55], s6 offen offset:1024
    v_mfma_f32_16x16x32_bf16 v[152:155], a[252:255], a[184:187], v[152:155]
    v_mfma_f32_16x16x32_bf16 v[156:159], a[252:255], a[188:191], v[156:159]
    v_mfma_f32_16x16x32_bf16 v[156:159], a[248:251], a[164:167], v[156:159]
    s_waitcnt lgkmcnt(4)
    v_mfma_f32_16x16x32_bf16 a[44:47], v[56:59], a[164:167], a[44:47]
    buffer_load_dwordx4 a[104:107], v2, s[52:55], s6 offen offset:2048
    v_mfma_f32_16x16x32_bf16 a[44:47], v[60:63], a[188:191], a[44:47]
    ds_read_b64_tr_b16 a[248:249], v3 offset:31744
    v_mfma_f32_16x16x32_bf16 a[40:43], v[60:63], a[184:187], a[40:43]
    v_mfma_f32_16x16x32_bf16 a[40:43], v[56:59], a[160:163], a[40:43]
    ds_read_b64_tr_b16 a[250:251], v3 offset:32256
    v_mfma_f32_16x16x32_bf16 a[36:39], v[56:59], a[156:159], a[36:39]
    buffer_load_dwordx4 a[108:111], v2, s[52:55], s6 offen offset:3072
    v_mfma_f32_16x16x32_bf16 a[36:39], v[60:63], a[180:183], a[36:39]
    ds_read_b64_tr_b16 a[252:253], v3 offset:44032
    v_mfma_f32_16x16x32_bf16 a[32:35], v[60:63], a[176:179], a[32:35]
    v_mfma_f32_16x16x32_bf16 a[32:35], v[56:59], a[152:155], a[32:35]
    ds_read_b64_tr_b16 a[254:255], v3 offset:44544
    s_mov_b32 s6, 299008
    v_mfma_f32_16x16x32_bf16 a[28:31], v[56:59], a[148:151], a[28:31]
    buffer_load_dwordx4 a[112:115], v2, s[52:55], s6 offen offset:0
    v_mfma_f32_16x16x32_bf16 a[28:31], v[60:63], a[172:175], a[28:31]
    v_mfma_f32_16x16x32_bf16 a[24:27], v[60:63], a[168:171], a[24:27]
    v_mfma_f32_16x16x32_bf16 a[24:27], v[56:59], a[144:147], a[24:27]
    s_waitcnt lgkmcnt(4)
    v_mfma_f32_16x16x32_bf16 v[160:163], a[240:243], a[144:147], v[160:163]
    buffer_load_dwordx4 a[116:119], v2, s[52:55], s6 offen offset:1024
    v_mfma_f32_16x16x32_bf16 v[160:163], a[244:247], a[168:171], v[160:163]
    ds_read_b64_tr_b16 v[56:57], v3 offset:32768
    v_mfma_f32_16x16x32_bf16 v[164:167], a[244:247], a[172:175], v[164:167]
    v_mfma_f32_16x16x32_bf16 v[164:167], a[240:243], a[148:151], v[164:167]
    ds_read_b64_tr_b16 v[58:59], v3 offset:33280
    v_mfma_f32_16x16x32_bf16 v[168:171], a[240:243], a[152:155], v[168:171]
    v_mfma_f32_16x16x32_bf16 v[168:171], a[244:247], a[176:179], v[168:171]
    ds_read_b64_tr_b16 v[60:61], v3 offset:45056
    v_mfma_f32_16x16x32_bf16 v[172:175], a[244:247], a[180:183], v[172:175]
    v_mfma_f32_16x16x32_bf16 v[172:175], a[240:243], a[156:159], v[172:175]
    ds_read_b64_tr_b16 v[62:63], v3 offset:45568
    v_mfma_f32_16x16x32_bf16 v[176:179], a[240:243], a[160:163], v[176:179]
    v_mfma_f32_16x16x32_bf16 v[176:179], a[244:247], a[184:187], v[176:179]
    v_mfma_f32_16x16x32_bf16 v[180:183], a[244:247], a[188:191], v[180:183]
    v_mfma_f32_16x16x32_bf16 v[180:183], a[240:243], a[164:167], v[180:183]
    s_waitcnt lgkmcnt(4)
    v_mfma_f32_16x16x32_bf16 v[204:207], a[248:251], a[164:167], v[204:207]
    v_mfma_f32_16x16x32_bf16 v[204:207], a[252:255], a[188:191], v[204:207]
    ds_read_b64_tr_b16 a[240:241], v3 offset:33792
    v_mfma_f32_16x16x32_bf16 v[200:203], a[252:255], a[184:187], v[200:203]
    v_mfma_f32_16x16x32_bf16 v[200:203], a[248:251], a[160:163], v[200:203]
    ds_read_b64_tr_b16 a[242:243], v3 offset:34304
    v_mfma_f32_16x16x32_bf16 v[196:199], a[248:251], a[156:159], v[196:199]
    v_mfma_f32_16x16x32_bf16 v[196:199], a[252:255], a[180:183], v[196:199]
    ds_read_b64_tr_b16 a[244:245], v3 offset:46080
    v_mfma_f32_16x16x32_bf16 v[192:195], a[252:255], a[176:179], v[192:195]
    v_mfma_f32_16x16x32_bf16 v[192:195], a[248:251], a[152:155], v[192:195]
    ds_read_b64_tr_b16 a[246:247], v3 offset:46592
    v_mfma_f32_16x16x32_bf16 v[188:191], a[248:251], a[148:151], v[188:191]
    v_mfma_f32_16x16x32_bf16 v[188:191], a[252:255], a[172:175], v[188:191]
    v_mfma_f32_16x16x32_bf16 v[184:187], a[252:255], a[168:171], v[184:187]
    v_mfma_f32_16x16x32_bf16 v[184:187], a[248:251], a[144:147], v[184:187]
    s_waitcnt lgkmcnt(4)
    v_mfma_f32_16x16x32_bf16 a[48:51], v[56:59], a[144:147], a[48:51]
    v_mfma_f32_16x16x32_bf16 a[48:51], v[60:63], a[168:171], a[48:51]
    ds_read_b64_tr_b16 a[248:249], v3 offset:34816
    v_mfma_f32_16x16x32_bf16 a[52:55], v[60:63], a[172:175], a[52:55]
    v_mfma_f32_16x16x32_bf16 a[52:55], v[56:59], a[148:151], a[52:55]
    ds_read_b64_tr_b16 a[250:251], v3 offset:35328
    v_mfma_f32_16x16x32_bf16 a[56:59], v[56:59], a[152:155], a[56:59]
    buffer_load_dwordx4 a[120:123], v2, s[52:55], s6 offen offset:2048
    v_mfma_f32_16x16x32_bf16 a[56:59], v[60:63], a[176:179], a[56:59]
    ds_read_b64_tr_b16 a[252:253], v3 offset:47104
    v_mfma_f32_16x16x32_bf16 a[60:63], v[60:63], a[180:183], a[60:63]
    ds_read_b128 v[28:31], v7 offset:36864
    v_mfma_f32_16x16x32_bf16 a[60:63], v[56:59], a[156:159], a[60:63]
    ds_read_b64_tr_b16 a[254:255], v3 offset:47616
    v_mfma_f32_16x16x32_bf16 a[64:67], v[56:59], a[160:163], a[64:67]
    buffer_load_dwordx4 a[124:127], v2, s[52:55], s6 offen offset:3072
    v_mfma_f32_16x16x32_bf16 a[64:67], v[60:63], a[184:187], a[64:67]
    ds_read_b128 v[32:35], v7 offset:37888
    v_mfma_f32_16x16x32_bf16 a[68:71], v[60:63], a[188:191], a[68:71]
    v_mfma_f32_16x16x32_bf16 a[68:71], v[56:59], a[164:167], a[68:71]
    s_mov_b32 s6, 303104
    s_waitcnt lgkmcnt(6)
    v_mfma_f32_16x16x32_bf16 v[228:231], a[240:243], a[164:167], v[228:231]
    buffer_load_dwordx4 a[128:131], v2, s[52:55], s6 offen offset:0
    v_mfma_f32_16x16x32_bf16 v[228:231], a[244:247], a[188:191], v[228:231]
    ds_read_b64_tr_b16 v[56:57], v3 offset:35840
    v_mfma_f32_16x16x32_bf16 v[224:227], a[244:247], a[184:187], v[224:227]
    ds_read_b128 v[36:39], v7 offset:38912
    v_mfma_f32_16x16x32_bf16 v[224:227], a[240:243], a[160:163], v[224:227]
    ds_read_b64_tr_b16 v[58:59], v3 offset:36352
    v_mfma_f32_16x16x32_bf16 v[220:223], a[240:243], a[156:159], v[220:223]
    buffer_load_dwordx4 a[132:135], v2, s[52:55], s6 offen offset:1024
    v_mfma_f32_16x16x32_bf16 v[220:223], a[244:247], a[180:183], v[220:223]
    ds_read_b64_tr_b16 v[60:61], v3 offset:48128
    v_mfma_f32_16x16x32_bf16 v[216:219], a[244:247], a[176:179], v[216:219]
    v_mfma_f32_16x16x32_bf16 v[216:219], a[240:243], a[152:155], v[216:219]
    ds_read_b64_tr_b16 v[62:63], v3 offset:48640
    v_mfma_f32_16x16x32_bf16 v[212:215], a[240:243], a[148:151], v[212:215]
    buffer_load_dwordx4 a[136:139], v2, s[52:55], s6 offen offset:2048
    v_mfma_f32_16x16x32_bf16 v[212:215], a[244:247], a[172:175], v[212:215]
    v_mfma_f32_16x16x32_bf16 v[208:211], a[244:247], a[168:171], v[208:211]
    v_mfma_f32_16x16x32_bf16 v[208:211], a[240:243], a[144:147], v[208:211]
    s_waitcnt vmcnt(32) lgkmcnt(0)
    s_barrier
    v_mfma_f32_16x16x32_bf16 v[232:235], a[248:251], a[144:147], v[232:235]
    buffer_load_dwordx4 a[140:143], v2, s[52:55], s6 offen offset:3072
    v_mfma_f32_16x16x32_bf16 v[232:235], a[252:255], a[168:171], v[232:235]
    ds_read_b64_tr_b16 a[240:241], v4 offset:0
    v_mfma_f32_16x16x32_bf16 v[236:239], a[252:255], a[172:175], v[236:239]
    v_mfma_f32_16x16x32_bf16 v[236:239], a[248:251], a[148:151], v[236:239]
    ds_read_b64_tr_b16 a[242:243], v4 offset:512
    v_mfma_f32_16x16x32_bf16 v[240:243], a[248:251], a[152:155], v[240:243]
    s_add_u32 s42, s44, 15360
    buffer_store_dwordx4 v[28:31], v1, s[16:19], s42 offen offset:0
    v_mfma_f32_16x16x32_bf16 v[240:243], a[252:255], a[176:179], v[240:243]
    ds_read_b64_tr_b16 a[244:245], v4 offset:12288
    v_mfma_f32_16x16x32_bf16 v[244:247], a[252:255], a[180:183], v[244:247]
    v_mfma_f32_16x16x32_bf16 v[244:247], a[248:251], a[156:159], v[244:247]
    ds_read_b64_tr_b16 a[246:247], v4 offset:12800
    v_mfma_f32_16x16x32_bf16 v[248:251], a[248:251], a[160:163], v[248:251]
    s_add_u32 s42, s44, 15360
    buffer_store_dwordx4 v[32:35], v1, s[16:19], s42 offen offset:1024
    v_mfma_f32_16x16x32_bf16 v[248:251], a[252:255], a[184:187], v[248:251]
    v_mfma_f32_16x16x32_bf16 v[252:255], a[252:255], a[188:191], v[252:255]
    v_mfma_f32_16x16x32_bf16 v[252:255], a[248:251], a[164:167], v[252:255]
    v_mfma_f32_16x16x32_bf16 a[92:95], v[56:59], a[164:167], a[92:95]
    s_add_u32 s42, s44, 15360
    buffer_store_dwordx4 v[36:39], v1, s[16:19], s42 offen offset:2048
    v_mfma_f32_16x16x32_bf16 a[92:95], v[60:63], a[188:191], a[92:95]
    ds_read_b64_tr_b16 a[248:249], v4 offset:1024
    v_mfma_f32_16x16x32_bf16 a[88:91], v[60:63], a[184:187], a[88:91]
    v_mfma_f32_16x16x32_bf16 a[88:91], v[56:59], a[160:163], a[88:91]
    ds_read_b64_tr_b16 a[250:251], v4 offset:1536
    v_mfma_f32_16x16x32_bf16 a[84:87], v[56:59], a[156:159], a[84:87]
    v_mfma_f32_16x16x32_bf16 a[84:87], v[60:63], a[180:183], a[84:87]
    ds_read_b64_tr_b16 a[252:253], v4 offset:13312
    v_mfma_f32_16x16x32_bf16 a[80:83], v[60:63], a[176:179], a[80:83]
    v_mfma_f32_16x16x32_bf16 a[80:83], v[56:59], a[152:155], a[80:83]
    ds_read_b64_tr_b16 a[254:255], v4 offset:13824
    v_mfma_f32_16x16x32_bf16 a[76:79], v[56:59], a[148:151], a[76:79]
    v_mfma_f32_16x16x32_bf16 a[76:79], v[60:63], a[172:175], a[76:79]
    v_mfma_f32_16x16x32_bf16 a[72:75], v[60:63], a[168:171], a[72:75]
    v_mfma_f32_16x16x32_bf16 a[72:75], v[56:59], a[144:147], a[72:75]
    s_waitcnt vmcnt(24)
    s_waitcnt lgkmcnt(4)
    v_mfma_f32_16x16x32_bf16 v[64:67], a[240:243], a[192:195], v[64:67]
    v_mfma_f32_16x16x32_bf16 v[64:67], a[244:247], a[216:219], v[64:67]
    ds_read_b64_tr_b16 v[56:57], v4 offset:2048
    v_mfma_f32_16x16x32_bf16 v[68:71], a[244:247], a[220:223], v[68:71]
    v_mfma_f32_16x16x32_bf16 v[68:71], a[240:243], a[196:199], v[68:71]
    ds_read_b64_tr_b16 v[58:59], v4 offset:2560
    s_add_u32 m0, s39, 24576
    v_mfma_f32_16x16x32_bf16 v[72:75], a[240:243], a[200:203], v[72:75]
    buffer_load_dwordx4 v1, s[56:59], s4 offen offset:0 nt lds
    v_mfma_f32_16x16x32_bf16 v[72:75], a[244:247], a[224:227], v[72:75]
    ds_read_b64_tr_b16 v[60:61], v4 offset:14336
    v_mfma_f32_16x16x32_bf16 v[76:79], a[244:247], a[228:231], v[76:79]
    v_mfma_f32_16x16x32_bf16 v[76:79], a[240:243], a[204:207], v[76:79]
    ds_read_b64_tr_b16 v[62:63], v4 offset:14848
    s_add_u32 m0, s39, 24576
    v_mfma_f32_16x16x32_bf16 v[80:83], a[240:243], a[208:211], v[80:83]
    buffer_load_dwordx4 v1, s[56:59], s4 offen offset:1024 nt lds
    v_mfma_f32_16x16x32_bf16 v[80:83], a[244:247], a[232:235], v[80:83]
    v_mfma_f32_16x16x32_bf16 v[84:87], a[244:247], a[236:239], v[84:87]
    v_mfma_f32_16x16x32_bf16 v[84:87], a[240:243], a[212:215], v[84:87]
    s_add_u32 m0, s39, 24576
    s_waitcnt lgkmcnt(4)
    v_mfma_f32_16x16x32_bf16 v[108:111], a[248:251], a[212:215], v[108:111]
    buffer_load_dwordx4 v1, s[56:59], s4 offen offset:2048 nt lds
    v_mfma_f32_16x16x32_bf16 v[108:111], a[252:255], a[236:239], v[108:111]
    ds_read_b64_tr_b16 a[240:241], v4 offset:3072
    v_mfma_f32_16x16x32_bf16 v[104:107], a[252:255], a[232:235], v[104:107]
    v_mfma_f32_16x16x32_bf16 v[104:107], a[248:251], a[208:211], v[104:107]
    ds_read_b64_tr_b16 a[242:243], v4 offset:3584
    s_add_u32 m0, s39, 36864
    v_mfma_f32_16x16x32_bf16 v[100:103], a[248:251], a[204:207], v[100:103]
    buffer_load_dwordx4 v1, s[60:63], s29 offen offset:0 nt lds
    v_mfma_f32_16x16x32_bf16 v[100:103], a[252:255], a[228:231], v[100:103]
    ds_read_b64_tr_b16 a[244:245], v4 offset:15360
    v_mfma_f32_16x16x32_bf16 v[96:99], a[252:255], a[224:227], v[96:99]
    v_mfma_f32_16x16x32_bf16 v[96:99], a[248:251], a[200:203], v[96:99]
    ds_read_b64_tr_b16 a[246:247], v4 offset:15872
    s_add_u32 m0, s39, 36864
    v_mfma_f32_16x16x32_bf16 v[92:95], a[248:251], a[196:199], v[92:95]
    buffer_load_dwordx4 v1, s[60:63], s29 offen offset:1024 nt lds
    v_mfma_f32_16x16x32_bf16 v[92:95], a[252:255], a[220:223], v[92:95]
    v_mfma_f32_16x16x32_bf16 v[88:91], a[252:255], a[216:219], v[88:91]
    v_mfma_f32_16x16x32_bf16 v[88:91], a[248:251], a[192:195], v[88:91]
    s_add_u32 m0, s39, 36864
    s_waitcnt lgkmcnt(4)
    v_mfma_f32_16x16x32_bf16 a[0:3], v[56:59], a[192:195], a[0:3]
    buffer_load_dwordx4 v1, s[60:63], s29 offen offset:2048 nt lds
    v_mfma_f32_16x16x32_bf16 a[0:3], v[60:63], a[216:219], a[0:3]
    ds_read_b64_tr_b16 a[248:249], v4 offset:4096
    v_mfma_f32_16x16x32_bf16 a[4:7], v[60:63], a[220:223], a[4:7]
    v_mfma_f32_16x16x32_bf16 a[4:7], v[56:59], a[196:199], a[4:7]
    ds_read_b64_tr_b16 a[250:251], v4 offset:4608
    v_mfma_f32_16x16x32_bf16 a[8:11], v[56:59], a[200:203], a[8:11]
    v_mfma_f32_16x16x32_bf16 a[8:11], v[60:63], a[224:227], a[8:11]
    ds_read_b64_tr_b16 a[252:253], v4 offset:16384
    v_mfma_f32_16x16x32_bf16 a[12:15], v[60:63], a[228:231], a[12:15]
    v_mfma_f32_16x16x32_bf16 a[12:15], v[56:59], a[204:207], a[12:15]
    ds_read_b64_tr_b16 a[254:255], v4 offset:16896
    v_mfma_f32_16x16x32_bf16 a[16:19], v[56:59], a[208:211], a[16:19]
    v_mfma_f32_16x16x32_bf16 a[16:19], v[60:63], a[232:235], a[16:19]
    v_mfma_f32_16x16x32_bf16 a[20:23], v[60:63], a[236:239], a[20:23]
    v_mfma_f32_16x16x32_bf16 a[20:23], v[56:59], a[212:215], a[20:23]
    s_waitcnt lgkmcnt(4)
    v_mfma_f32_16x16x32_bf16 v[132:135], a[240:243], a[212:215], v[132:135]
    v_mfma_f32_16x16x32_bf16 v[132:135], a[244:247], a[236:239], v[132:135]
    ds_read_b64_tr_b16 v[56:57], v4 offset:5120
    v_mfma_f32_16x16x32_bf16 v[128:131], a[244:247], a[232:235], v[128:131]
    v_mfma_f32_16x16x32_bf16 v[128:131], a[240:243], a[208:211], v[128:131]
    ds_read_b64_tr_b16 v[58:59], v4 offset:5632
    v_mfma_f32_16x16x32_bf16 v[124:127], a[240:243], a[204:207], v[124:127]
    v_mfma_f32_16x16x32_bf16 v[124:127], a[244:247], a[228:231], v[124:127]
    ds_read_b64_tr_b16 v[60:61], v4 offset:17408
    v_mfma_f32_16x16x32_bf16 v[120:123], a[244:247], a[224:227], v[120:123]
    v_mfma_f32_16x16x32_bf16 v[120:123], a[240:243], a[200:203], v[120:123]
    ds_read_b64_tr_b16 v[62:63], v4 offset:17920
    v_mfma_f32_16x16x32_bf16 v[116:119], a[240:243], a[196:199], v[116:119]
    v_mfma_f32_16x16x32_bf16 v[116:119], a[244:247], a[220:223], v[116:119]
    v_mfma_f32_16x16x32_bf16 v[112:115], a[244:247], a[216:219], v[112:115]
    v_mfma_f32_16x16x32_bf16 v[112:115], a[240:243], a[192:195], v[112:115]
    s_waitcnt lgkmcnt(4)
    v_mfma_f32_16x16x32_bf16 v[136:139], a[248:251], a[192:195], v[136:139]
    v_mfma_f32_16x16x32_bf16 v[136:139], a[252:255], a[216:219], v[136:139]
    ds_read_b64_tr_b16 a[240:241], v4 offset:6144
    v_mfma_f32_16x16x32_bf16 v[140:143], a[252:255], a[220:223], v[140:143]
    v_mfma_f32_16x16x32_bf16 v[140:143], a[248:251], a[196:199], v[140:143]
    ds_read_b64_tr_b16 a[242:243], v4 offset:6656
    s_mov_b32 s6, 344064
    v_mfma_f32_16x16x32_bf16 v[144:147], a[248:251], a[200:203], v[144:147]
    buffer_load_dwordx4 a[144:147], v2, s[52:55], s6 offen offset:0
    v_mfma_f32_16x16x32_bf16 v[144:147], a[252:255], a[224:227], v[144:147]
    ds_read_b64_tr_b16 a[244:245], v4 offset:18432
    v_mfma_f32_16x16x32_bf16 v[148:151], a[252:255], a[228:231], v[148:151]
    v_mfma_f32_16x16x32_bf16 v[148:151], a[248:251], a[204:207], v[148:151]
    ds_read_b64_tr_b16 a[246:247], v4 offset:18944
    v_mfma_f32_16x16x32_bf16 v[152:155], a[248:251], a[208:211], v[152:155]
    buffer_load_dwordx4 a[148:151], v2, s[52:55], s6 offen offset:1024
    v_mfma_f32_16x16x32_bf16 v[152:155], a[252:255], a[232:235], v[152:155]
    v_mfma_f32_16x16x32_bf16 v[156:159], a[252:255], a[236:239], v[156:159]
    v_mfma_f32_16x16x32_bf16 v[156:159], a[248:251], a[212:215], v[156:159]
    s_waitcnt lgkmcnt(4)
    v_mfma_f32_16x16x32_bf16 a[44:47], v[56:59], a[212:215], a[44:47]
    buffer_load_dwordx4 a[152:155], v2, s[52:55], s6 offen offset:2048
    v_mfma_f32_16x16x32_bf16 a[44:47], v[60:63], a[236:239], a[44:47]
    ds_read_b64_tr_b16 a[248:249], v4 offset:7168
    v_mfma_f32_16x16x32_bf16 a[40:43], v[60:63], a[232:235], a[40:43]
    v_mfma_f32_16x16x32_bf16 a[40:43], v[56:59], a[208:211], a[40:43]
    ds_read_b64_tr_b16 a[250:251], v4 offset:7680
    v_mfma_f32_16x16x32_bf16 a[36:39], v[56:59], a[204:207], a[36:39]
    buffer_load_dwordx4 a[156:159], v2, s[52:55], s6 offen offset:3072
    v_mfma_f32_16x16x32_bf16 a[36:39], v[60:63], a[228:231], a[36:39]
    ds_read_b64_tr_b16 a[252:253], v4 offset:19456
    v_mfma_f32_16x16x32_bf16 a[32:35], v[60:63], a[224:227], a[32:35]
    v_mfma_f32_16x16x32_bf16 a[32:35], v[56:59], a[200:203], a[32:35]
    ds_read_b64_tr_b16 a[254:255], v4 offset:19968
    s_mov_b32 s6, 348160
    v_mfma_f32_16x16x32_bf16 a[28:31], v[56:59], a[196:199], a[28:31]
    buffer_load_dwordx4 a[160:163], v2, s[52:55], s6 offen offset:0
    v_mfma_f32_16x16x32_bf16 a[28:31], v[60:63], a[220:223], a[28:31]
    v_mfma_f32_16x16x32_bf16 a[24:27], v[60:63], a[216:219], a[24:27]
    v_mfma_f32_16x16x32_bf16 a[24:27], v[56:59], a[192:195], a[24:27]
    s_waitcnt lgkmcnt(4)
    v_mfma_f32_16x16x32_bf16 v[160:163], a[240:243], a[192:195], v[160:163]
    buffer_load_dwordx4 a[164:167], v2, s[52:55], s6 offen offset:1024
    v_mfma_f32_16x16x32_bf16 v[160:163], a[244:247], a[216:219], v[160:163]
    ds_read_b64_tr_b16 v[56:57], v4 offset:8192
    v_mfma_f32_16x16x32_bf16 v[164:167], a[244:247], a[220:223], v[164:167]
    v_mfma_f32_16x16x32_bf16 v[164:167], a[240:243], a[196:199], v[164:167]
    ds_read_b64_tr_b16 v[58:59], v4 offset:8704
    v_mfma_f32_16x16x32_bf16 v[168:171], a[240:243], a[200:203], v[168:171]
    v_mfma_f32_16x16x32_bf16 v[168:171], a[244:247], a[224:227], v[168:171]
    ds_read_b64_tr_b16 v[60:61], v4 offset:20480
    v_mfma_f32_16x16x32_bf16 v[172:175], a[244:247], a[228:231], v[172:175]
    v_mfma_f32_16x16x32_bf16 v[172:175], a[240:243], a[204:207], v[172:175]
    ds_read_b64_tr_b16 v[62:63], v4 offset:20992
    v_mfma_f32_16x16x32_bf16 v[176:179], a[240:243], a[208:211], v[176:179]
    v_mfma_f32_16x16x32_bf16 v[176:179], a[244:247], a[232:235], v[176:179]
    v_mfma_f32_16x16x32_bf16 v[180:183], a[244:247], a[236:239], v[180:183]
    v_mfma_f32_16x16x32_bf16 v[180:183], a[240:243], a[212:215], v[180:183]
    s_waitcnt lgkmcnt(4)
    v_mfma_f32_16x16x32_bf16 v[204:207], a[248:251], a[212:215], v[204:207]
    v_mfma_f32_16x16x32_bf16 v[204:207], a[252:255], a[236:239], v[204:207]
    ds_read_b64_tr_b16 a[240:241], v4 offset:9216
    v_mfma_f32_16x16x32_bf16 v[200:203], a[252:255], a[232:235], v[200:203]
    v_mfma_f32_16x16x32_bf16 v[200:203], a[248:251], a[208:211], v[200:203]
    ds_read_b64_tr_b16 a[242:243], v4 offset:9728
    v_mfma_f32_16x16x32_bf16 v[196:199], a[248:251], a[204:207], v[196:199]
    v_mfma_f32_16x16x32_bf16 v[196:199], a[252:255], a[228:231], v[196:199]
    ds_read_b64_tr_b16 a[244:245], v4 offset:21504
    v_mfma_f32_16x16x32_bf16 v[192:195], a[252:255], a[224:227], v[192:195]
    v_mfma_f32_16x16x32_bf16 v[192:195], a[248:251], a[200:203], v[192:195]
    ds_read_b64_tr_b16 a[246:247], v4 offset:22016
    v_mfma_f32_16x16x32_bf16 v[188:191], a[248:251], a[196:199], v[188:191]
    v_mfma_f32_16x16x32_bf16 v[188:191], a[252:255], a[220:223], v[188:191]
    v_mfma_f32_16x16x32_bf16 v[184:187], a[252:255], a[216:219], v[184:187]
    v_mfma_f32_16x16x32_bf16 v[184:187], a[248:251], a[192:195], v[184:187]
    s_waitcnt lgkmcnt(4)
    v_mfma_f32_16x16x32_bf16 a[48:51], v[56:59], a[192:195], a[48:51]
    v_mfma_f32_16x16x32_bf16 a[48:51], v[60:63], a[216:219], a[48:51]
    ds_read_b64_tr_b16 a[248:249], v4 offset:10240
    v_mfma_f32_16x16x32_bf16 a[52:55], v[60:63], a[220:223], a[52:55]
    v_mfma_f32_16x16x32_bf16 a[52:55], v[56:59], a[196:199], a[52:55]
    ds_read_b64_tr_b16 a[250:251], v4 offset:10752
    v_mfma_f32_16x16x32_bf16 a[56:59], v[56:59], a[200:203], a[56:59]
    buffer_load_dwordx4 a[168:171], v2, s[52:55], s6 offen offset:2048
    v_mfma_f32_16x16x32_bf16 a[56:59], v[60:63], a[224:227], a[56:59]
    ds_read_b64_tr_b16 a[252:253], v4 offset:22528
    v_mfma_f32_16x16x32_bf16 a[60:63], v[60:63], a[228:231], a[60:63]
    ds_read_b128 v[40:43], v21 offset:0
    v_mfma_f32_16x16x32_bf16 a[60:63], v[56:59], a[204:207], a[60:63]
    ds_read_b64_tr_b16 a[254:255], v4 offset:23040
    v_mfma_f32_16x16x32_bf16 a[64:67], v[56:59], a[208:211], a[64:67]
    buffer_load_dwordx4 a[172:175], v2, s[52:55], s6 offen offset:3072
    v_mfma_f32_16x16x32_bf16 a[64:67], v[60:63], a[232:235], a[64:67]
    ds_read_b128 v[44:47], v21 offset:1024
    v_mfma_f32_16x16x32_bf16 a[68:71], v[60:63], a[236:239], a[68:71]
    v_mfma_f32_16x16x32_bf16 a[68:71], v[56:59], a[212:215], a[68:71]
    s_mov_b32 s6, 352256
    s_waitcnt lgkmcnt(6)
    v_mfma_f32_16x16x32_bf16 v[228:231], a[240:243], a[212:215], v[228:231]
    buffer_load_dwordx4 a[176:179], v2, s[52:55], s6 offen offset:0
    v_mfma_f32_16x16x32_bf16 v[228:231], a[244:247], a[236:239], v[228:231]
    ds_read_b64_tr_b16 v[56:57], v4 offset:11264
    v_mfma_f32_16x16x32_bf16 v[224:227], a[244:247], a[232:235], v[224:227]
    ds_read_b128 v[48:51], v21 offset:2048
    v_mfma_f32_16x16x32_bf16 v[224:227], a[240:243], a[208:211], v[224:227]
    ds_read_b64_tr_b16 v[58:59], v4 offset:11776
    v_mfma_f32_16x16x32_bf16 v[220:223], a[240:243], a[204:207], v[220:223]
    buffer_load_dwordx4 a[180:183], v2, s[52:55], s6 offen offset:1024
    v_mfma_f32_16x16x32_bf16 v[220:223], a[244:247], a[228:231], v[220:223]
    ds_read_b64_tr_b16 v[60:61], v4 offset:23552
    v_mfma_f32_16x16x32_bf16 v[216:219], a[244:247], a[224:227], v[216:219]
    v_mfma_f32_16x16x32_bf16 v[216:219], a[240:243], a[200:203], v[216:219]
    ds_read_b64_tr_b16 v[62:63], v4 offset:24064
    v_mfma_f32_16x16x32_bf16 v[212:215], a[240:243], a[196:199], v[212:215]
    buffer_load_dwordx4 a[184:187], v2, s[52:55], s6 offen offset:2048
    v_mfma_f32_16x16x32_bf16 v[212:215], a[244:247], a[220:223], v[212:215]
    v_mfma_f32_16x16x32_bf16 v[208:211], a[244:247], a[216:219], v[208:211]
    v_mfma_f32_16x16x32_bf16 v[208:211], a[240:243], a[192:195], v[208:211]
    s_waitcnt vmcnt(32) lgkmcnt(0)
    s_barrier
    v_mfma_f32_16x16x32_bf16 v[232:235], a[248:251], a[192:195], v[232:235]
    buffer_load_dwordx4 a[188:191], v2, s[52:55], s6 offen offset:3072
    v_mfma_f32_16x16x32_bf16 v[232:235], a[252:255], a[216:219], v[232:235]
    ds_read_b64_tr_b16 a[240:241], v3 offset:0
    v_mfma_f32_16x16x32_bf16 v[236:239], a[252:255], a[220:223], v[236:239]
    v_mfma_f32_16x16x32_bf16 v[236:239], a[248:251], a[196:199], v[236:239]
    ds_read_b64_tr_b16 a[242:243], v3 offset:512
    v_mfma_f32_16x16x32_bf16 v[240:243], a[248:251], a[200:203], v[240:243]
    s_add_u32 s42, s44, 73728
    buffer_store_dwordx4 v[40:43], v1, s[16:19], s42 offen offset:0
    v_mfma_f32_16x16x32_bf16 v[240:243], a[252:255], a[224:227], v[240:243]
    ds_read_b64_tr_b16 a[244:245], v3 offset:12288
    v_mfma_f32_16x16x32_bf16 v[244:247], a[252:255], a[228:231], v[244:247]
    v_mfma_f32_16x16x32_bf16 v[244:247], a[248:251], a[204:207], v[244:247]
    ds_read_b64_tr_b16 a[246:247], v3 offset:12800
    v_mfma_f32_16x16x32_bf16 v[248:251], a[248:251], a[208:211], v[248:251]
    s_add_u32 s42, s44, 73728
    buffer_store_dwordx4 v[44:47], v1, s[16:19], s42 offen offset:1024
    v_mfma_f32_16x16x32_bf16 v[248:251], a[252:255], a[232:235], v[248:251]
    v_mfma_f32_16x16x32_bf16 v[252:255], a[252:255], a[236:239], v[252:255]
    v_mfma_f32_16x16x32_bf16 v[252:255], a[248:251], a[212:215], v[252:255]
    v_mfma_f32_16x16x32_bf16 a[92:95], v[56:59], a[212:215], a[92:95]
    s_add_u32 s42, s44, 73728
    buffer_store_dwordx4 v[48:51], v1, s[16:19], s42 offen offset:2048
    v_mfma_f32_16x16x32_bf16 a[92:95], v[60:63], a[236:239], a[92:95]
    ds_read_b64_tr_b16 a[248:249], v3 offset:1024
    v_mfma_f32_16x16x32_bf16 a[88:91], v[60:63], a[232:235], a[88:91]
    v_mfma_f32_16x16x32_bf16 a[88:91], v[56:59], a[208:211], a[88:91]
    ds_read_b64_tr_b16 a[250:251], v3 offset:1536
    v_mfma_f32_16x16x32_bf16 a[84:87], v[56:59], a[204:207], a[84:87]
    v_mfma_f32_16x16x32_bf16 a[84:87], v[60:63], a[228:231], a[84:87]
    ds_read_b64_tr_b16 a[252:253], v3 offset:13312
    v_mfma_f32_16x16x32_bf16 a[80:83], v[60:63], a[224:227], a[80:83]
    v_mfma_f32_16x16x32_bf16 a[80:83], v[56:59], a[200:203], a[80:83]
    ds_read_b64_tr_b16 a[254:255], v3 offset:13824
    v_mfma_f32_16x16x32_bf16 a[76:79], v[56:59], a[196:199], a[76:79]
    v_mfma_f32_16x16x32_bf16 a[76:79], v[60:63], a[220:223], a[76:79]
    v_mfma_f32_16x16x32_bf16 a[72:75], v[60:63], a[216:219], a[72:75]
    v_mfma_f32_16x16x32_bf16 a[72:75], v[56:59], a[192:195], a[72:75]
    s_waitcnt vmcnt(24)
    s_waitcnt lgkmcnt(4)
    v_mfma_f32_16x16x32_bf16 v[64:67], a[240:243], a[96:99], v[64:67]
    v_mfma_f32_16x16x32_bf16 v[64:67], a[244:247], a[120:123], v[64:67]
    ds_read_b64_tr_b16 v[56:57], v3 offset:2048
    v_mfma_f32_16x16x32_bf16 v[68:71], a[244:247], a[124:127], v[68:71]
    s_add_u32 s4, s4, 36864
    v_mfma_f32_16x16x32_bf16 v[68:71], a[240:243], a[100:103], v[68:71]
    ds_read_b64_tr_b16 v[58:59], v3 offset:2560
    s_add_u32 s29, s29, 12288
    s_add_u32 s5, s4, 4096
    s_add_u32 m0, s32, 49152
    v_mfma_f32_16x16x32_bf16 v[72:75], a[240:243], a[104:107], v[72:75]
    buffer_load_dwordx4 v1, s[8:11], s4 offen offset:0 nt lds
    v_mfma_f32_16x16x32_bf16 v[72:75], a[244:247], a[128:131], v[72:75]
    ds_read_b64_tr_b16 v[60:61], v3 offset:14336
    v_mfma_f32_16x16x32_bf16 v[76:79], a[244:247], a[132:135], v[76:79]
    v_mfma_f32_16x16x32_bf16 v[76:79], a[240:243], a[108:111], v[76:79]
    ds_read_b64_tr_b16 v[62:63], v3 offset:14848
    s_add_u32 m0, s32, 49152
    v_mfma_f32_16x16x32_bf16 v[80:83], a[240:243], a[112:115], v[80:83]
    buffer_load_dwordx4 v1, s[8:11], s4 offen offset:1024 nt lds
    v_mfma_f32_16x16x32_bf16 v[80:83], a[244:247], a[136:139], v[80:83]
    v_mfma_f32_16x16x32_bf16 v[84:87], a[244:247], a[140:143], v[84:87]
    v_mfma_f32_16x16x32_bf16 v[84:87], a[240:243], a[116:119], v[84:87]
    s_add_u32 m0, s32, 49152
    s_waitcnt lgkmcnt(4)
    v_mfma_f32_16x16x32_bf16 v[108:111], a[248:251], a[116:119], v[108:111]
    buffer_load_dwordx4 v1, s[8:11], s4 offen offset:2048 nt lds
    v_mfma_f32_16x16x32_bf16 v[108:111], a[252:255], a[140:143], v[108:111]
    ds_read_b64_tr_b16 a[240:241], v3 offset:3072
    v_mfma_f32_16x16x32_bf16 v[104:107], a[252:255], a[136:139], v[104:107]
    v_mfma_f32_16x16x32_bf16 v[104:107], a[248:251], a[112:115], v[104:107]
    ds_read_b64_tr_b16 a[242:243], v3 offset:3584
    s_add_u32 m0, s32, 49152
    v_mfma_f32_16x16x32_bf16 v[100:103], a[248:251], a[108:111], v[100:103]
    buffer_load_dwordx4 v1, s[8:11], s4 offen offset:3072 nt lds
    v_mfma_f32_16x16x32_bf16 v[100:103], a[252:255], a[132:135], v[100:103]
    ds_read_b64_tr_b16 a[244:245], v3 offset:15360
    v_mfma_f32_16x16x32_bf16 v[96:99], a[252:255], a[128:131], v[96:99]
    v_mfma_f32_16x16x32_bf16 v[96:99], a[248:251], a[104:107], v[96:99]
    ds_read_b64_tr_b16 a[246:247], v3 offset:15872
    s_add_u32 m0, s32, 53248
    v_mfma_f32_16x16x32_bf16 v[92:95], a[248:251], a[100:103], v[92:95]
    buffer_load_dwordx4 v1, s[8:11], s5 offen offset:0 nt lds
    v_mfma_f32_16x16x32_bf16 v[92:95], a[252:255], a[124:127], v[92:95]
    v_mfma_f32_16x16x32_bf16 v[88:91], a[252:255], a[120:123], v[88:91]
    v_mfma_f32_16x16x32_bf16 v[88:91], a[248:251], a[96:99], v[88:91]
    s_add_u32 m0, s32, 53248
    s_waitcnt lgkmcnt(4)
    v_mfma_f32_16x16x32_bf16 a[0:3], v[56:59], a[96:99], a[0:3]
    buffer_load_dwordx4 v1, s[8:11], s5 offen offset:1024 nt lds
    v_mfma_f32_16x16x32_bf16 a[0:3], v[60:63], a[120:123], a[0:3]
    ds_read_b64_tr_b16 a[248:249], v3 offset:4096
    v_mfma_f32_16x16x32_bf16 a[4:7], v[60:63], a[124:127], a[4:7]
    v_mfma_f32_16x16x32_bf16 a[4:7], v[56:59], a[100:103], a[4:7]
    ds_read_b64_tr_b16 a[250:251], v3 offset:4608
    v_mfma_f32_16x16x32_bf16 a[8:11], v[56:59], a[104:107], a[8:11]
    v_mfma_f32_16x16x32_bf16 a[8:11], v[60:63], a[128:131], a[8:11]
    ds_read_b64_tr_b16 a[252:253], v3 offset:16384
    v_mfma_f32_16x16x32_bf16 a[12:15], v[60:63], a[132:135], a[12:15]
    v_mfma_f32_16x16x32_bf16 a[12:15], v[56:59], a[108:111], a[12:15]
    ds_read_b64_tr_b16 a[254:255], v3 offset:16896
    v_mfma_f32_16x16x32_bf16 a[16:19], v[56:59], a[112:115], a[16:19]
    v_mfma_f32_16x16x32_bf16 a[16:19], v[60:63], a[136:139], a[16:19]
    v_mfma_f32_16x16x32_bf16 a[20:23], v[60:63], a[140:143], a[20:23]
    v_mfma_f32_16x16x32_bf16 a[20:23], v[56:59], a[116:119], a[20:23]
    s_waitcnt lgkmcnt(4)
    v_mfma_f32_16x16x32_bf16 v[132:135], a[240:243], a[116:119], v[132:135]
    v_mfma_f32_16x16x32_bf16 v[132:135], a[244:247], a[140:143], v[132:135]
    ds_read_b64_tr_b16 v[56:57], v3 offset:5120
    v_mfma_f32_16x16x32_bf16 v[128:131], a[244:247], a[136:139], v[128:131]
    v_mfma_f32_16x16x32_bf16 v[128:131], a[240:243], a[112:115], v[128:131]
    ds_read_b64_tr_b16 v[58:59], v3 offset:5632
    v_mfma_f32_16x16x32_bf16 v[124:127], a[240:243], a[108:111], v[124:127]
    v_mfma_f32_16x16x32_bf16 v[124:127], a[244:247], a[132:135], v[124:127]
    ds_read_b64_tr_b16 v[60:61], v3 offset:17408
    v_mfma_f32_16x16x32_bf16 v[120:123], a[244:247], a[128:131], v[120:123]
    v_mfma_f32_16x16x32_bf16 v[120:123], a[240:243], a[104:107], v[120:123]
    ds_read_b64_tr_b16 v[62:63], v3 offset:17920
    v_mfma_f32_16x16x32_bf16 v[116:119], a[240:243], a[100:103], v[116:119]
    v_mfma_f32_16x16x32_bf16 v[116:119], a[244:247], a[124:127], v[116:119]
    v_mfma_f32_16x16x32_bf16 v[112:115], a[244:247], a[120:123], v[112:115]
    v_mfma_f32_16x16x32_bf16 v[112:115], a[240:243], a[96:99], v[112:115]
    s_waitcnt lgkmcnt(4)
    v_mfma_f32_16x16x32_bf16 v[136:139], a[248:251], a[96:99], v[136:139]
    v_mfma_f32_16x16x32_bf16 v[136:139], a[252:255], a[120:123], v[136:139]
    ds_read_b64_tr_b16 a[240:241], v3 offset:6144
    v_mfma_f32_16x16x32_bf16 v[140:143], a[252:255], a[124:127], v[140:143]
    v_mfma_f32_16x16x32_bf16 v[140:143], a[248:251], a[100:103], v[140:143]
    ds_read_b64_tr_b16 a[242:243], v3 offset:6656
    s_mov_b32 s6, 393216
    v_mfma_f32_16x16x32_bf16 v[144:147], a[248:251], a[104:107], v[144:147]
    buffer_load_dwordx4 a[192:195], v2, s[52:55], s6 offen offset:0
    v_mfma_f32_16x16x32_bf16 v[144:147], a[252:255], a[128:131], v[144:147]
    ds_read_b64_tr_b16 a[244:245], v3 offset:18432
    v_mfma_f32_16x16x32_bf16 v[148:151], a[252:255], a[132:135], v[148:151]
    v_mfma_f32_16x16x32_bf16 v[148:151], a[248:251], a[108:111], v[148:151]
    ds_read_b64_tr_b16 a[246:247], v3 offset:18944
    v_mfma_f32_16x16x32_bf16 v[152:155], a[248:251], a[112:115], v[152:155]
    buffer_load_dwordx4 a[196:199], v2, s[52:55], s6 offen offset:1024
    v_mfma_f32_16x16x32_bf16 v[152:155], a[252:255], a[136:139], v[152:155]
    v_mfma_f32_16x16x32_bf16 v[156:159], a[252:255], a[140:143], v[156:159]
    v_mfma_f32_16x16x32_bf16 v[156:159], a[248:251], a[116:119], v[156:159]
    s_waitcnt lgkmcnt(4)
    v_mfma_f32_16x16x32_bf16 a[44:47], v[56:59], a[116:119], a[44:47]
    buffer_load_dwordx4 a[200:203], v2, s[52:55], s6 offen offset:2048
    v_mfma_f32_16x16x32_bf16 a[44:47], v[60:63], a[140:143], a[44:47]
    ds_read_b64_tr_b16 a[248:249], v3 offset:7168
    v_mfma_f32_16x16x32_bf16 a[40:43], v[60:63], a[136:139], a[40:43]
    v_mfma_f32_16x16x32_bf16 a[40:43], v[56:59], a[112:115], a[40:43]
    ds_read_b64_tr_b16 a[250:251], v3 offset:7680
    v_mfma_f32_16x16x32_bf16 a[36:39], v[56:59], a[108:111], a[36:39]
    buffer_load_dwordx4 a[204:207], v2, s[52:55], s6 offen offset:3072
    v_mfma_f32_16x16x32_bf16 a[36:39], v[60:63], a[132:135], a[36:39]
    ds_read_b64_tr_b16 a[252:253], v3 offset:19456
    v_mfma_f32_16x16x32_bf16 a[32:35], v[60:63], a[128:131], a[32:35]
    v_mfma_f32_16x16x32_bf16 a[32:35], v[56:59], a[104:107], a[32:35]
    ds_read_b64_tr_b16 a[254:255], v3 offset:19968
    s_mov_b32 s6, 397312
    v_mfma_f32_16x16x32_bf16 a[28:31], v[56:59], a[100:103], a[28:31]
    buffer_load_dwordx4 a[208:211], v2, s[52:55], s6 offen offset:0
    v_mfma_f32_16x16x32_bf16 a[28:31], v[60:63], a[124:127], a[28:31]
    v_mfma_f32_16x16x32_bf16 a[24:27], v[60:63], a[120:123], a[24:27]
    v_mfma_f32_16x16x32_bf16 a[24:27], v[56:59], a[96:99], a[24:27]
    s_waitcnt lgkmcnt(4)
    v_mfma_f32_16x16x32_bf16 v[160:163], a[240:243], a[96:99], v[160:163]
    buffer_load_dwordx4 a[212:215], v2, s[52:55], s6 offen offset:1024
    v_mfma_f32_16x16x32_bf16 v[160:163], a[244:247], a[120:123], v[160:163]
    ds_read_b64_tr_b16 v[56:57], v3 offset:8192
    v_mfma_f32_16x16x32_bf16 v[164:167], a[244:247], a[124:127], v[164:167]
    v_mfma_f32_16x16x32_bf16 v[164:167], a[240:243], a[100:103], v[164:167]
    ds_read_b64_tr_b16 v[58:59], v3 offset:8704
    v_mfma_f32_16x16x32_bf16 v[168:171], a[240:243], a[104:107], v[168:171]
    v_mfma_f32_16x16x32_bf16 v[168:171], a[244:247], a[128:131], v[168:171]
    ds_read_b64_tr_b16 v[60:61], v3 offset:20480
    v_mfma_f32_16x16x32_bf16 v[172:175], a[244:247], a[132:135], v[172:175]
    v_mfma_f32_16x16x32_bf16 v[172:175], a[240:243], a[108:111], v[172:175]
    ds_read_b64_tr_b16 v[62:63], v3 offset:20992
    v_mfma_f32_16x16x32_bf16 v[176:179], a[240:243], a[112:115], v[176:179]
    v_mfma_f32_16x16x32_bf16 v[176:179], a[244:247], a[136:139], v[176:179]
    v_mfma_f32_16x16x32_bf16 v[180:183], a[244:247], a[140:143], v[180:183]
    v_mfma_f32_16x16x32_bf16 v[180:183], a[240:243], a[116:119], v[180:183]
    s_waitcnt lgkmcnt(4)
    v_mfma_f32_16x16x32_bf16 v[204:207], a[248:251], a[116:119], v[204:207]
    v_mfma_f32_16x16x32_bf16 v[204:207], a[252:255], a[140:143], v[204:207]
    ds_read_b64_tr_b16 a[240:241], v3 offset:9216
    v_mfma_f32_16x16x32_bf16 v[200:203], a[252:255], a[136:139], v[200:203]
    v_mfma_f32_16x16x32_bf16 v[200:203], a[248:251], a[112:115], v[200:203]
    ds_read_b64_tr_b16 a[242:243], v3 offset:9728
    v_mfma_f32_16x16x32_bf16 v[196:199], a[248:251], a[108:111], v[196:199]
    v_mfma_f32_16x16x32_bf16 v[196:199], a[252:255], a[132:135], v[196:199]
    ds_read_b64_tr_b16 a[244:245], v3 offset:21504
    v_mfma_f32_16x16x32_bf16 v[192:195], a[252:255], a[128:131], v[192:195]
    v_mfma_f32_16x16x32_bf16 v[192:195], a[248:251], a[104:107], v[192:195]
    ds_read_b64_tr_b16 a[246:247], v3 offset:22016
    v_mfma_f32_16x16x32_bf16 v[188:191], a[248:251], a[100:103], v[188:191]
    v_mfma_f32_16x16x32_bf16 v[188:191], a[252:255], a[124:127], v[188:191]
    v_mfma_f32_16x16x32_bf16 v[184:187], a[252:255], a[120:123], v[184:187]
    v_mfma_f32_16x16x32_bf16 v[184:187], a[248:251], a[96:99], v[184:187]
    s_waitcnt lgkmcnt(4)
    v_mfma_f32_16x16x32_bf16 a[48:51], v[56:59], a[96:99], a[48:51]
    v_mfma_f32_16x16x32_bf16 a[48:51], v[60:63], a[120:123], a[48:51]
    ds_read_b64_tr_b16 a[248:249], v3 offset:10240
    v_mfma_f32_16x16x32_bf16 a[52:55], v[60:63], a[124:127], a[52:55]
    v_mfma_f32_16x16x32_bf16 a[52:55], v[56:59], a[100:103], a[52:55]
    ds_read_b64_tr_b16 a[250:251], v3 offset:10752
    v_mfma_f32_16x16x32_bf16 a[56:59], v[56:59], a[104:107], a[56:59]
    buffer_load_dwordx4 a[216:219], v2, s[52:55], s6 offen offset:2048
    v_mfma_f32_16x16x32_bf16 a[56:59], v[60:63], a[128:131], a[56:59]
    ds_read_b64_tr_b16 a[252:253], v3 offset:22528
    v_mfma_f32_16x16x32_bf16 a[60:63], v[60:63], a[132:135], a[60:63]
    ds_read_b128 v[52:55], v21 offset:12288
    v_mfma_f32_16x16x32_bf16 a[60:63], v[56:59], a[108:111], a[60:63]
    ds_read_b64_tr_b16 a[254:255], v3 offset:23040
    v_mfma_f32_16x16x32_bf16 a[64:67], v[56:59], a[112:115], a[64:67]
    buffer_load_dwordx4 a[220:223], v2, s[52:55], s6 offen offset:3072
    v_mfma_f32_16x16x32_bf16 a[64:67], v[60:63], a[136:139], a[64:67]
    ds_read_b128 v[24:27], v21 offset:13312
    v_mfma_f32_16x16x32_bf16 a[68:71], v[60:63], a[140:143], a[68:71]
    v_mfma_f32_16x16x32_bf16 a[68:71], v[56:59], a[116:119], a[68:71]
    s_mov_b32 s6, 401408
    s_waitcnt lgkmcnt(6)
    v_mfma_f32_16x16x32_bf16 v[228:231], a[240:243], a[116:119], v[228:231]
    buffer_load_dwordx4 a[224:227], v2, s[52:55], s6 offen offset:0
    v_mfma_f32_16x16x32_bf16 v[228:231], a[244:247], a[140:143], v[228:231]
    ds_read_b64_tr_b16 v[56:57], v3 offset:11264
    v_mfma_f32_16x16x32_bf16 v[224:227], a[244:247], a[136:139], v[224:227]
    ds_read_b128 v[28:31], v21 offset:14336
    v_mfma_f32_16x16x32_bf16 v[224:227], a[240:243], a[112:115], v[224:227]
    ds_read_b64_tr_b16 v[58:59], v3 offset:11776
    v_mfma_f32_16x16x32_bf16 v[220:223], a[240:243], a[108:111], v[220:223]
    buffer_load_dwordx4 a[228:231], v2, s[52:55], s6 offen offset:1024
    v_mfma_f32_16x16x32_bf16 v[220:223], a[244:247], a[132:135], v[220:223]
    ds_read_b64_tr_b16 v[60:61], v3 offset:23552
    v_mfma_f32_16x16x32_bf16 v[216:219], a[244:247], a[128:131], v[216:219]
    v_mfma_f32_16x16x32_bf16 v[216:219], a[240:243], a[104:107], v[216:219]
    ds_read_b64_tr_b16 v[62:63], v3 offset:24064
    v_mfma_f32_16x16x32_bf16 v[212:215], a[240:243], a[100:103], v[212:215]
    buffer_load_dwordx4 a[232:235], v2, s[52:55], s6 offen offset:2048
    v_mfma_f32_16x16x32_bf16 v[212:215], a[244:247], a[124:127], v[212:215]
    v_mfma_f32_16x16x32_bf16 v[208:211], a[244:247], a[120:123], v[208:211]
    v_mfma_f32_16x16x32_bf16 v[208:211], a[240:243], a[96:99], v[208:211]
    s_waitcnt vmcnt(32) lgkmcnt(0)
    s_barrier
    v_mfma_f32_16x16x32_bf16 v[232:235], a[248:251], a[96:99], v[232:235]
    buffer_load_dwordx4 a[236:239], v2, s[52:55], s6 offen offset:3072
    v_mfma_f32_16x16x32_bf16 v[232:235], a[252:255], a[120:123], v[232:235]
    ds_read_b64_tr_b16 a[240:241], v3 offset:24576
    v_mfma_f32_16x16x32_bf16 v[236:239], a[252:255], a[124:127], v[236:239]
    v_mfma_f32_16x16x32_bf16 v[236:239], a[248:251], a[100:103], v[236:239]
    ds_read_b64_tr_b16 a[242:243], v3 offset:25088
    v_mfma_f32_16x16x32_bf16 v[240:243], a[248:251], a[104:107], v[240:243]
    s_add_u32 s42, s44, 79872
    buffer_store_dwordx4 v[52:55], v1, s[16:19], s42 offen offset:0
    v_mfma_f32_16x16x32_bf16 v[240:243], a[252:255], a[128:131], v[240:243]
    ds_read_b64_tr_b16 a[244:245], v3 offset:36864
    v_mfma_f32_16x16x32_bf16 v[244:247], a[252:255], a[132:135], v[244:247]
    v_mfma_f32_16x16x32_bf16 v[244:247], a[248:251], a[108:111], v[244:247]
    ds_read_b64_tr_b16 a[246:247], v3 offset:37376
    v_mfma_f32_16x16x32_bf16 v[248:251], a[248:251], a[112:115], v[248:251]
    s_add_u32 s42, s44, 79872
    buffer_store_dwordx4 v[24:27], v1, s[16:19], s42 offen offset:1024
    v_mfma_f32_16x16x32_bf16 v[248:251], a[252:255], a[136:139], v[248:251]
    v_mfma_f32_16x16x32_bf16 v[252:255], a[252:255], a[140:143], v[252:255]
    v_mfma_f32_16x16x32_bf16 v[252:255], a[248:251], a[116:119], v[252:255]
    v_mfma_f32_16x16x32_bf16 a[92:95], v[56:59], a[116:119], a[92:95]
    s_add_u32 s42, s44, 79872
    buffer_store_dwordx4 v[28:31], v1, s[16:19], s42 offen offset:2048
    v_mfma_f32_16x16x32_bf16 a[92:95], v[60:63], a[140:143], a[92:95]
    ds_read_b64_tr_b16 a[248:249], v3 offset:25600
    v_mfma_f32_16x16x32_bf16 a[88:91], v[60:63], a[136:139], a[88:91]
    v_mfma_f32_16x16x32_bf16 a[88:91], v[56:59], a[112:115], a[88:91]
    ds_read_b64_tr_b16 a[250:251], v3 offset:26112
    v_mfma_f32_16x16x32_bf16 a[84:87], v[56:59], a[108:111], a[84:87]
    v_mfma_f32_16x16x32_bf16 a[84:87], v[60:63], a[132:135], a[84:87]
    ds_read_b64_tr_b16 a[252:253], v3 offset:37888
    v_mfma_f32_16x16x32_bf16 a[80:83], v[60:63], a[128:131], a[80:83]
    v_mfma_f32_16x16x32_bf16 a[80:83], v[56:59], a[104:107], a[80:83]
    ds_read_b64_tr_b16 a[254:255], v3 offset:38400
    v_mfma_f32_16x16x32_bf16 a[76:79], v[56:59], a[100:103], a[76:79]
    v_mfma_f32_16x16x32_bf16 a[76:79], v[60:63], a[124:127], a[76:79]
    v_mfma_f32_16x16x32_bf16 a[72:75], v[60:63], a[120:123], a[72:75]
    v_mfma_f32_16x16x32_bf16 a[72:75], v[56:59], a[96:99], a[72:75]
    s_waitcnt vmcnt(24)
    s_waitcnt lgkmcnt(4)
    v_mfma_f32_16x16x32_bf16 v[64:67], a[240:243], a[144:147], v[64:67]
    v_mfma_f32_16x16x32_bf16 v[64:67], a[244:247], a[168:171], v[64:67]
    ds_read_b64_tr_b16 v[56:57], v3 offset:26624
    v_mfma_f32_16x16x32_bf16 v[68:71], a[244:247], a[172:175], v[68:71]
    v_mfma_f32_16x16x32_bf16 v[68:71], a[240:243], a[148:151], v[68:71]
    ds_read_b64_tr_b16 v[58:59], v3 offset:27136
    s_add_u32 m0, s39, 0
    v_mfma_f32_16x16x32_bf16 v[72:75], a[240:243], a[152:155], v[72:75]
    buffer_load_dwordx4 v1, s[56:59], s4 offen offset:0 nt lds
    v_mfma_f32_16x16x32_bf16 v[72:75], a[244:247], a[176:179], v[72:75]
    ds_read_b64_tr_b16 v[60:61], v3 offset:38912
    v_mfma_f32_16x16x32_bf16 v[76:79], a[244:247], a[180:183], v[76:79]
    v_mfma_f32_16x16x32_bf16 v[76:79], a[240:243], a[156:159], v[76:79]
    ds_read_b64_tr_b16 v[62:63], v3 offset:39424
    s_add_u32 m0, s39, 0
    v_mfma_f32_16x16x32_bf16 v[80:83], a[240:243], a[160:163], v[80:83]
    buffer_load_dwordx4 v1, s[56:59], s4 offen offset:1024 nt lds
    v_mfma_f32_16x16x32_bf16 v[80:83], a[244:247], a[184:187], v[80:83]
    v_mfma_f32_16x16x32_bf16 v[84:87], a[244:247], a[188:191], v[84:87]
    v_mfma_f32_16x16x32_bf16 v[84:87], a[240:243], a[164:167], v[84:87]
    s_add_u32 m0, s39, 0
    s_waitcnt lgkmcnt(4)
    v_mfma_f32_16x16x32_bf16 v[108:111], a[248:251], a[164:167], v[108:111]
    buffer_load_dwordx4 v1, s[56:59], s4 offen offset:2048 nt lds
    v_mfma_f32_16x16x32_bf16 v[108:111], a[252:255], a[188:191], v[108:111]
    ds_read_b64_tr_b16 a[240:241], v3 offset:27648
    v_mfma_f32_16x16x32_bf16 v[104:107], a[252:255], a[184:187], v[104:107]
    v_mfma_f32_16x16x32_bf16 v[104:107], a[248:251], a[160:163], v[104:107]
    ds_read_b64_tr_b16 a[242:243], v3 offset:28160
    s_add_u32 m0, s39, 12288
    v_mfma_f32_16x16x32_bf16 v[100:103], a[248:251], a[156:159], v[100:103]
    buffer_load_dwordx4 v1, s[60:63], s29 offen offset:0 nt lds
    v_mfma_f32_16x16x32_bf16 v[100:103], a[252:255], a[180:183], v[100:103]
    ds_read_b64_tr_b16 a[244:245], v3 offset:39936
    v_mfma_f32_16x16x32_bf16 v[96:99], a[252:255], a[176:179], v[96:99]
    v_mfma_f32_16x16x32_bf16 v[96:99], a[248:251], a[152:155], v[96:99]
    ds_read_b64_tr_b16 a[246:247], v3 offset:40448
    s_add_u32 m0, s39, 12288
    v_mfma_f32_16x16x32_bf16 v[92:95], a[248:251], a[148:151], v[92:95]
    buffer_load_dwordx4 v1, s[60:63], s29 offen offset:1024 nt lds
    v_mfma_f32_16x16x32_bf16 v[92:95], a[252:255], a[172:175], v[92:95]
    v_mfma_f32_16x16x32_bf16 v[88:91], a[252:255], a[168:171], v[88:91]
    v_mfma_f32_16x16x32_bf16 v[88:91], a[248:251], a[144:147], v[88:91]
    s_add_u32 m0, s39, 12288
    s_waitcnt lgkmcnt(4)
    v_mfma_f32_16x16x32_bf16 a[0:3], v[56:59], a[144:147], a[0:3]
    buffer_load_dwordx4 v1, s[60:63], s29 offen offset:2048 nt lds
    v_mfma_f32_16x16x32_bf16 a[0:3], v[60:63], a[168:171], a[0:3]
    ds_read_b64_tr_b16 a[248:249], v3 offset:28672
    v_mfma_f32_16x16x32_bf16 a[4:7], v[60:63], a[172:175], a[4:7]
    v_mfma_f32_16x16x32_bf16 a[4:7], v[56:59], a[148:151], a[4:7]
    ds_read_b64_tr_b16 a[250:251], v3 offset:29184
    v_mfma_f32_16x16x32_bf16 a[8:11], v[56:59], a[152:155], a[8:11]
    v_mfma_f32_16x16x32_bf16 a[8:11], v[60:63], a[176:179], a[8:11]
    ds_read_b64_tr_b16 a[252:253], v3 offset:40960
    v_mfma_f32_16x16x32_bf16 a[12:15], v[60:63], a[180:183], a[12:15]
    v_mfma_f32_16x16x32_bf16 a[12:15], v[56:59], a[156:159], a[12:15]
    ds_read_b64_tr_b16 a[254:255], v3 offset:41472
    v_mfma_f32_16x16x32_bf16 a[16:19], v[56:59], a[160:163], a[16:19]
    v_mfma_f32_16x16x32_bf16 a[16:19], v[60:63], a[184:187], a[16:19]
    v_mfma_f32_16x16x32_bf16 a[20:23], v[60:63], a[188:191], a[20:23]
    v_mfma_f32_16x16x32_bf16 a[20:23], v[56:59], a[164:167], a[20:23]
    s_waitcnt lgkmcnt(4)
    v_mfma_f32_16x16x32_bf16 v[132:135], a[240:243], a[164:167], v[132:135]
    v_mfma_f32_16x16x32_bf16 v[132:135], a[244:247], a[188:191], v[132:135]
    ds_read_b64_tr_b16 v[56:57], v3 offset:29696
    v_mfma_f32_16x16x32_bf16 v[128:131], a[244:247], a[184:187], v[128:131]
    v_mfma_f32_16x16x32_bf16 v[128:131], a[240:243], a[160:163], v[128:131]
    ds_read_b64_tr_b16 v[58:59], v3 offset:30208
    v_mfma_f32_16x16x32_bf16 v[124:127], a[240:243], a[156:159], v[124:127]
    v_mfma_f32_16x16x32_bf16 v[124:127], a[244:247], a[180:183], v[124:127]
    ds_read_b64_tr_b16 v[60:61], v3 offset:41984
    v_mfma_f32_16x16x32_bf16 v[120:123], a[244:247], a[176:179], v[120:123]
    v_mfma_f32_16x16x32_bf16 v[120:123], a[240:243], a[152:155], v[120:123]
    ds_read_b64_tr_b16 v[62:63], v3 offset:42496
    v_mfma_f32_16x16x32_bf16 v[116:119], a[240:243], a[148:151], v[116:119]
    v_mfma_f32_16x16x32_bf16 v[116:119], a[244:247], a[172:175], v[116:119]
    v_mfma_f32_16x16x32_bf16 v[112:115], a[244:247], a[168:171], v[112:115]
    v_mfma_f32_16x16x32_bf16 v[112:115], a[240:243], a[144:147], v[112:115]
    s_waitcnt lgkmcnt(4)
    v_mfma_f32_16x16x32_bf16 v[136:139], a[248:251], a[144:147], v[136:139]
    v_mfma_f32_16x16x32_bf16 v[136:139], a[252:255], a[168:171], v[136:139]
    ds_read_b64_tr_b16 a[240:241], v3 offset:30720
    v_mfma_f32_16x16x32_bf16 v[140:143], a[252:255], a[172:175], v[140:143]
    v_mfma_f32_16x16x32_bf16 v[140:143], a[248:251], a[148:151], v[140:143]
    ds_read_b64_tr_b16 a[242:243], v3 offset:31232
    s_mov_b32 s6, 442368
    v_mfma_f32_16x16x32_bf16 v[144:147], a[248:251], a[152:155], v[144:147]
    buffer_load_dwordx4 a[96:99], v2, s[52:55], s6 offen offset:0
    v_mfma_f32_16x16x32_bf16 v[144:147], a[252:255], a[176:179], v[144:147]
    ds_read_b64_tr_b16 a[244:245], v3 offset:43008
    v_mfma_f32_16x16x32_bf16 v[148:151], a[252:255], a[180:183], v[148:151]
    v_mfma_f32_16x16x32_bf16 v[148:151], a[248:251], a[156:159], v[148:151]
    ds_read_b64_tr_b16 a[246:247], v3 offset:43520
    v_mfma_f32_16x16x32_bf16 v[152:155], a[248:251], a[160:163], v[152:155]
    buffer_load_dwordx4 a[100:103], v2, s[52:55], s6 offen offset:1024
    v_mfma_f32_16x16x32_bf16 v[152:155], a[252:255], a[184:187], v[152:155]
    v_mfma_f32_16x16x32_bf16 v[156:159], a[252:255], a[188:191], v[156:159]
    v_mfma_f32_16x16x32_bf16 v[156:159], a[248:251], a[164:167], v[156:159]
    s_waitcnt lgkmcnt(4)
    v_mfma_f32_16x16x32_bf16 a[44:47], v[56:59], a[164:167], a[44:47]
    buffer_load_dwordx4 a[104:107], v2, s[52:55], s6 offen offset:2048
    v_mfma_f32_16x16x32_bf16 a[44:47], v[60:63], a[188:191], a[44:47]
    ds_read_b64_tr_b16 a[248:249], v3 offset:31744
    v_mfma_f32_16x16x32_bf16 a[40:43], v[60:63], a[184:187], a[40:43]
    v_mfma_f32_16x16x32_bf16 a[40:43], v[56:59], a[160:163], a[40:43]
    ds_read_b64_tr_b16 a[250:251], v3 offset:32256
    v_mfma_f32_16x16x32_bf16 a[36:39], v[56:59], a[156:159], a[36:39]
    buffer_load_dwordx4 a[108:111], v2, s[52:55], s6 offen offset:3072
    v_mfma_f32_16x16x32_bf16 a[36:39], v[60:63], a[180:183], a[36:39]
    ds_read_b64_tr_b16 a[252:253], v3 offset:44032
    v_mfma_f32_16x16x32_bf16 a[32:35], v[60:63], a[176:179], a[32:35]
    v_mfma_f32_16x16x32_bf16 a[32:35], v[56:59], a[152:155], a[32:35]
    ds_read_b64_tr_b16 a[254:255], v3 offset:44544
    s_mov_b32 s6, 446464
    v_mfma_f32_16x16x32_bf16 a[28:31], v[56:59], a[148:151], a[28:31]
    buffer_load_dwordx4 a[112:115], v2, s[52:55], s6 offen offset:0
    v_mfma_f32_16x16x32_bf16 a[28:31], v[60:63], a[172:175], a[28:31]
    v_mfma_f32_16x16x32_bf16 a[24:27], v[60:63], a[168:171], a[24:27]
    v_mfma_f32_16x16x32_bf16 a[24:27], v[56:59], a[144:147], a[24:27]
    s_waitcnt lgkmcnt(4)
    v_mfma_f32_16x16x32_bf16 v[160:163], a[240:243], a[144:147], v[160:163]
    buffer_load_dwordx4 a[116:119], v2, s[52:55], s6 offen offset:1024
    v_mfma_f32_16x16x32_bf16 v[160:163], a[244:247], a[168:171], v[160:163]
    ds_read_b64_tr_b16 v[56:57], v3 offset:32768
    v_mfma_f32_16x16x32_bf16 v[164:167], a[244:247], a[172:175], v[164:167]
    v_mfma_f32_16x16x32_bf16 v[164:167], a[240:243], a[148:151], v[164:167]
    ds_read_b64_tr_b16 v[58:59], v3 offset:33280
    v_mfma_f32_16x16x32_bf16 v[168:171], a[240:243], a[152:155], v[168:171]
    v_mfma_f32_16x16x32_bf16 v[168:171], a[244:247], a[176:179], v[168:171]
    ds_read_b64_tr_b16 v[60:61], v3 offset:45056
    v_mfma_f32_16x16x32_bf16 v[172:175], a[244:247], a[180:183], v[172:175]
    v_mfma_f32_16x16x32_bf16 v[172:175], a[240:243], a[156:159], v[172:175]
    ds_read_b64_tr_b16 v[62:63], v3 offset:45568
    v_mfma_f32_16x16x32_bf16 v[176:179], a[240:243], a[160:163], v[176:179]
    v_mfma_f32_16x16x32_bf16 v[176:179], a[244:247], a[184:187], v[176:179]
    v_mfma_f32_16x16x32_bf16 v[180:183], a[244:247], a[188:191], v[180:183]
    v_mfma_f32_16x16x32_bf16 v[180:183], a[240:243], a[164:167], v[180:183]
    s_waitcnt lgkmcnt(4)
    v_mfma_f32_16x16x32_bf16 v[204:207], a[248:251], a[164:167], v[204:207]
    v_mfma_f32_16x16x32_bf16 v[204:207], a[252:255], a[188:191], v[204:207]
    ds_read_b64_tr_b16 a[240:241], v3 offset:33792
    v_mfma_f32_16x16x32_bf16 v[200:203], a[252:255], a[184:187], v[200:203]
    v_mfma_f32_16x16x32_bf16 v[200:203], a[248:251], a[160:163], v[200:203]
    ds_read_b64_tr_b16 a[242:243], v3 offset:34304
    v_mfma_f32_16x16x32_bf16 v[196:199], a[248:251], a[156:159], v[196:199]
    v_mfma_f32_16x16x32_bf16 v[196:199], a[252:255], a[180:183], v[196:199]
    ds_read_b64_tr_b16 a[244:245], v3 offset:46080
    v_mfma_f32_16x16x32_bf16 v[192:195], a[252:255], a[176:179], v[192:195]
    v_mfma_f32_16x16x32_bf16 v[192:195], a[248:251], a[152:155], v[192:195]
    ds_read_b64_tr_b16 a[246:247], v3 offset:46592
    v_mfma_f32_16x16x32_bf16 v[188:191], a[248:251], a[148:151], v[188:191]
    v_mfma_f32_16x16x32_bf16 v[188:191], a[252:255], a[172:175], v[188:191]
    v_mfma_f32_16x16x32_bf16 v[184:187], a[252:255], a[168:171], v[184:187]
    v_mfma_f32_16x16x32_bf16 v[184:187], a[248:251], a[144:147], v[184:187]
    s_waitcnt lgkmcnt(4)
    v_mfma_f32_16x16x32_bf16 a[48:51], v[56:59], a[144:147], a[48:51]
    v_mfma_f32_16x16x32_bf16 a[48:51], v[60:63], a[168:171], a[48:51]
    ds_read_b64_tr_b16 a[248:249], v3 offset:34816
    v_mfma_f32_16x16x32_bf16 a[52:55], v[60:63], a[172:175], a[52:55]
    v_mfma_f32_16x16x32_bf16 a[52:55], v[56:59], a[148:151], a[52:55]
    ds_read_b64_tr_b16 a[250:251], v3 offset:35328
    v_mfma_f32_16x16x32_bf16 a[56:59], v[56:59], a[152:155], a[56:59]
    buffer_load_dwordx4 a[120:123], v2, s[52:55], s6 offen offset:2048
    v_mfma_f32_16x16x32_bf16 a[56:59], v[60:63], a[176:179], a[56:59]
    ds_read_b64_tr_b16 a[252:253], v3 offset:47104
    v_mfma_f32_16x16x32_bf16 a[60:63], v[60:63], a[180:183], a[60:63]
    ds_read_b128 v[32:35], v21 offset:24576
    v_mfma_f32_16x16x32_bf16 a[60:63], v[56:59], a[156:159], a[60:63]
    ds_read_b64_tr_b16 a[254:255], v3 offset:47616
    v_mfma_f32_16x16x32_bf16 a[64:67], v[56:59], a[160:163], a[64:67]
    buffer_load_dwordx4 a[124:127], v2, s[52:55], s6 offen offset:3072
    v_mfma_f32_16x16x32_bf16 a[64:67], v[60:63], a[184:187], a[64:67]
    ds_read_b128 v[36:39], v21 offset:25600
    v_mfma_f32_16x16x32_bf16 a[68:71], v[60:63], a[188:191], a[68:71]
    v_mfma_f32_16x16x32_bf16 a[68:71], v[56:59], a[164:167], a[68:71]
    s_mov_b32 s6, 450560
    s_waitcnt lgkmcnt(6)
    v_mfma_f32_16x16x32_bf16 v[228:231], a[240:243], a[164:167], v[228:231]
    buffer_load_dwordx4 a[128:131], v2, s[52:55], s6 offen offset:0
    v_mfma_f32_16x16x32_bf16 v[228:231], a[244:247], a[188:191], v[228:231]
    ds_read_b64_tr_b16 v[56:57], v3 offset:35840
    v_mfma_f32_16x16x32_bf16 v[224:227], a[244:247], a[184:187], v[224:227]
    ds_read_b128 v[40:43], v21 offset:26624
    v_mfma_f32_16x16x32_bf16 v[224:227], a[240:243], a[160:163], v[224:227]
    ds_read_b64_tr_b16 v[58:59], v3 offset:36352
    v_mfma_f32_16x16x32_bf16 v[220:223], a[240:243], a[156:159], v[220:223]
    buffer_load_dwordx4 a[132:135], v2, s[52:55], s6 offen offset:1024
    v_mfma_f32_16x16x32_bf16 v[220:223], a[244:247], a[180:183], v[220:223]
    ds_read_b64_tr_b16 v[60:61], v3 offset:48128
    v_mfma_f32_16x16x32_bf16 v[216:219], a[244:247], a[176:179], v[216:219]
    v_mfma_f32_16x16x32_bf16 v[216:219], a[240:243], a[152:155], v[216:219]
    ds_read_b64_tr_b16 v[62:63], v3 offset:48640
    v_mfma_f32_16x16x32_bf16 v[212:215], a[240:243], a[148:151], v[212:215]
    buffer_load_dwordx4 a[136:139], v2, s[52:55], s6 offen offset:2048
    v_mfma_f32_16x16x32_bf16 v[212:215], a[244:247], a[172:175], v[212:215]
    v_mfma_f32_16x16x32_bf16 v[208:211], a[244:247], a[168:171], v[208:211]
    v_mfma_f32_16x16x32_bf16 v[208:211], a[240:243], a[144:147], v[208:211]
    s_waitcnt vmcnt(32) lgkmcnt(0)
    s_barrier
    v_mfma_f32_16x16x32_bf16 v[232:235], a[248:251], a[144:147], v[232:235]
    buffer_load_dwordx4 a[140:143], v2, s[52:55], s6 offen offset:3072
    v_mfma_f32_16x16x32_bf16 v[232:235], a[252:255], a[168:171], v[232:235]
    ds_read_b64_tr_b16 a[240:241], v4 offset:0
    v_mfma_f32_16x16x32_bf16 v[236:239], a[252:255], a[172:175], v[236:239]
    v_mfma_f32_16x16x32_bf16 v[236:239], a[248:251], a[148:151], v[236:239]
    ds_read_b64_tr_b16 a[242:243], v4 offset:512
    v_mfma_f32_16x16x32_bf16 v[240:243], a[248:251], a[152:155], v[240:243]
    s_add_u32 s42, s44, 82944
    buffer_store_dwordx4 v[32:35], v1, s[16:19], s42 offen offset:0
    v_mfma_f32_16x16x32_bf16 v[240:243], a[252:255], a[176:179], v[240:243]
    ds_read_b64_tr_b16 a[244:245], v4 offset:12288
    v_mfma_f32_16x16x32_bf16 v[244:247], a[252:255], a[180:183], v[244:247]
    v_mfma_f32_16x16x32_bf16 v[244:247], a[248:251], a[156:159], v[244:247]
    ds_read_b64_tr_b16 a[246:247], v4 offset:12800
    v_mfma_f32_16x16x32_bf16 v[248:251], a[248:251], a[160:163], v[248:251]
    s_add_u32 s42, s44, 82944
    buffer_store_dwordx4 v[36:39], v1, s[16:19], s42 offen offset:1024
    v_mfma_f32_16x16x32_bf16 v[248:251], a[252:255], a[184:187], v[248:251]
    v_mfma_f32_16x16x32_bf16 v[252:255], a[252:255], a[188:191], v[252:255]
    v_mfma_f32_16x16x32_bf16 v[252:255], a[248:251], a[164:167], v[252:255]
    v_mfma_f32_16x16x32_bf16 a[92:95], v[56:59], a[164:167], a[92:95]
    s_add_u32 s42, s44, 82944
    buffer_store_dwordx4 v[40:43], v1, s[16:19], s42 offen offset:2048
    v_mfma_f32_16x16x32_bf16 a[92:95], v[60:63], a[188:191], a[92:95]
    ds_read_b64_tr_b16 a[248:249], v4 offset:1024
    v_mfma_f32_16x16x32_bf16 a[88:91], v[60:63], a[184:187], a[88:91]
    v_mfma_f32_16x16x32_bf16 a[88:91], v[56:59], a[160:163], a[88:91]
    ds_read_b64_tr_b16 a[250:251], v4 offset:1536
    v_mfma_f32_16x16x32_bf16 a[84:87], v[56:59], a[156:159], a[84:87]
    v_mfma_f32_16x16x32_bf16 a[84:87], v[60:63], a[180:183], a[84:87]
    ds_read_b64_tr_b16 a[252:253], v4 offset:13312
    v_mfma_f32_16x16x32_bf16 a[80:83], v[60:63], a[176:179], a[80:83]
    v_mfma_f32_16x16x32_bf16 a[80:83], v[56:59], a[152:155], a[80:83]
    ds_read_b64_tr_b16 a[254:255], v4 offset:13824
    v_mfma_f32_16x16x32_bf16 a[76:79], v[56:59], a[148:151], a[76:79]
    v_mfma_f32_16x16x32_bf16 a[76:79], v[60:63], a[172:175], a[76:79]
    v_mfma_f32_16x16x32_bf16 a[72:75], v[60:63], a[168:171], a[72:75]
    v_mfma_f32_16x16x32_bf16 a[72:75], v[56:59], a[144:147], a[72:75]
    s_waitcnt vmcnt(24)
    s_waitcnt lgkmcnt(4)
    v_mfma_f32_16x16x32_bf16 v[64:67], a[240:243], a[192:195], v[64:67]
    s_mul_i32 s40, s26, 147456
    s_add_u32 s40, s40, s34
    v_mfma_f32_16x16x32_bf16 v[64:67], a[244:247], a[216:219], v[64:67]
    ds_read_b64_tr_b16 v[56:57], v4 offset:2048
    v_mfma_f32_16x16x32_bf16 v[68:71], a[244:247], a[220:223], v[68:71]
    s_add_u32 s4, s4, 36864
    v_mfma_f32_16x16x32_bf16 v[68:71], a[240:243], a[196:199], v[68:71]
    ds_read_b64_tr_b16 v[58:59], v4 offset:2560
    s_add_u32 s29, s29, 12288
    s_add_u32 s5, s4, 4096
    s_add_u32 m0, s32, 24576
    v_mfma_f32_16x16x32_bf16 v[72:75], a[240:243], a[200:203], v[72:75]
    buffer_load_dwordx4 v1, s[8:11], s4 offen offset:0 nt lds
    v_mfma_f32_16x16x32_bf16 v[72:75], a[244:247], a[224:227], v[72:75]
    ds_read_b64_tr_b16 v[60:61], v4 offset:14336
    v_mfma_f32_16x16x32_bf16 v[76:79], a[244:247], a[228:231], v[76:79]
    v_mfma_f32_16x16x32_bf16 v[76:79], a[240:243], a[204:207], v[76:79]
    ds_read_b64_tr_b16 v[62:63], v4 offset:14848
    s_add_u32 m0, s32, 24576
    v_mfma_f32_16x16x32_bf16 v[80:83], a[240:243], a[208:211], v[80:83]
    buffer_load_dwordx4 v1, s[8:11], s4 offen offset:1024 nt lds
    v_mfma_f32_16x16x32_bf16 v[80:83], a[244:247], a[232:235], v[80:83]
    v_mfma_f32_16x16x32_bf16 v[84:87], a[244:247], a[236:239], v[84:87]
    v_mfma_f32_16x16x32_bf16 v[84:87], a[240:243], a[212:215], v[84:87]
    s_add_u32 m0, s32, 24576
    s_waitcnt lgkmcnt(4)
    v_mfma_f32_16x16x32_bf16 v[108:111], a[248:251], a[212:215], v[108:111]
    buffer_load_dwordx4 v1, s[8:11], s4 offen offset:2048 nt lds
    v_mfma_f32_16x16x32_bf16 v[108:111], a[252:255], a[236:239], v[108:111]
    ds_read_b64_tr_b16 a[240:241], v4 offset:3072
    v_mfma_f32_16x16x32_bf16 v[104:107], a[252:255], a[232:235], v[104:107]
    v_mfma_f32_16x16x32_bf16 v[104:107], a[248:251], a[208:211], v[104:107]
    ds_read_b64_tr_b16 a[242:243], v4 offset:3584
    s_add_u32 m0, s32, 24576
    v_mfma_f32_16x16x32_bf16 v[100:103], a[248:251], a[204:207], v[100:103]
    buffer_load_dwordx4 v1, s[8:11], s4 offen offset:3072 nt lds
    v_mfma_f32_16x16x32_bf16 v[100:103], a[252:255], a[228:231], v[100:103]
    ds_read_b64_tr_b16 a[244:245], v4 offset:15360
    v_mfma_f32_16x16x32_bf16 v[96:99], a[252:255], a[224:227], v[96:99]
    v_mfma_f32_16x16x32_bf16 v[96:99], a[248:251], a[200:203], v[96:99]
    ds_read_b64_tr_b16 a[246:247], v4 offset:15872
    s_add_u32 m0, s32, 28672
    v_mfma_f32_16x16x32_bf16 v[92:95], a[248:251], a[196:199], v[92:95]
    buffer_load_dwordx4 v1, s[8:11], s5 offen offset:0 nt lds
    v_mfma_f32_16x16x32_bf16 v[92:95], a[252:255], a[220:223], v[92:95]
    v_mfma_f32_16x16x32_bf16 v[88:91], a[252:255], a[216:219], v[88:91]
    v_mfma_f32_16x16x32_bf16 v[88:91], a[248:251], a[192:195], v[88:91]
    s_add_u32 m0, s32, 28672
    s_waitcnt lgkmcnt(4)
    v_mfma_f32_16x16x32_bf16 a[0:3], v[56:59], a[192:195], a[0:3]
    buffer_load_dwordx4 v1, s[8:11], s5 offen offset:1024 nt lds
    v_mfma_f32_16x16x32_bf16 a[0:3], v[60:63], a[216:219], a[0:3]
    ds_read_b64_tr_b16 a[248:249], v4 offset:4096
    v_mfma_f32_16x16x32_bf16 a[4:7], v[60:63], a[220:223], a[4:7]
    v_mfma_f32_16x16x32_bf16 a[4:7], v[56:59], a[196:199], a[4:7]
    ds_read_b64_tr_b16 a[250:251], v4 offset:4608
    v_mfma_f32_16x16x32_bf16 a[8:11], v[56:59], a[200:203], a[8:11]
    v_mfma_f32_16x16x32_bf16 a[8:11], v[60:63], a[224:227], a[8:11]
    ds_read_b64_tr_b16 a[252:253], v4 offset:16384
    v_mfma_f32_16x16x32_bf16 a[12:15], v[60:63], a[228:231], a[12:15]
    v_mfma_f32_16x16x32_bf16 a[12:15], v[56:59], a[204:207], a[12:15]
    ds_read_b64_tr_b16 a[254:255], v4 offset:16896
    v_mfma_f32_16x16x32_bf16 a[16:19], v[56:59], a[208:211], a[16:19]
    v_mfma_f32_16x16x32_bf16 a[16:19], v[60:63], a[232:235], a[16:19]
    v_mfma_f32_16x16x32_bf16 a[20:23], v[60:63], a[236:239], a[20:23]
    v_mfma_f32_16x16x32_bf16 a[20:23], v[56:59], a[212:215], a[20:23]
    s_waitcnt lgkmcnt(4)
    v_mfma_f32_16x16x32_bf16 v[132:135], a[240:243], a[212:215], v[132:135]
    v_mfma_f32_16x16x32_bf16 v[132:135], a[244:247], a[236:239], v[132:135]
    ds_read_b64_tr_b16 v[56:57], v4 offset:5120
    v_mfma_f32_16x16x32_bf16 v[128:131], a[244:247], a[232:235], v[128:131]
    v_mfma_f32_16x16x32_bf16 v[128:131], a[240:243], a[208:211], v[128:131]
    ds_read_b64_tr_b16 v[58:59], v4 offset:5632
    v_mfma_f32_16x16x32_bf16 v[124:127], a[240:243], a[204:207], v[124:127]
    v_mfma_f32_16x16x32_bf16 v[124:127], a[244:247], a[228:231], v[124:127]
    ds_read_b64_tr_b16 v[60:61], v4 offset:17408
    v_mfma_f32_16x16x32_bf16 v[120:123], a[244:247], a[224:227], v[120:123]
    v_mfma_f32_16x16x32_bf16 v[120:123], a[240:243], a[200:203], v[120:123]
    ds_read_b64_tr_b16 v[62:63], v4 offset:17920
    v_mfma_f32_16x16x32_bf16 v[116:119], a[240:243], a[196:199], v[116:119]
    v_mfma_f32_16x16x32_bf16 v[116:119], a[244:247], a[220:223], v[116:119]
    v_mfma_f32_16x16x32_bf16 v[112:115], a[244:247], a[216:219], v[112:115]
    v_mfma_f32_16x16x32_bf16 v[112:115], a[240:243], a[192:195], v[112:115]
    s_waitcnt lgkmcnt(4)
    v_mfma_f32_16x16x32_bf16 v[136:139], a[248:251], a[192:195], v[136:139]
    v_mfma_f32_16x16x32_bf16 v[136:139], a[252:255], a[216:219], v[136:139]
    ds_read_b64_tr_b16 a[240:241], v4 offset:6144
    v_mfma_f32_16x16x32_bf16 v[140:143], a[252:255], a[220:223], v[140:143]
    v_mfma_f32_16x16x32_bf16 v[140:143], a[248:251], a[196:199], v[140:143]
    ds_read_b64_tr_b16 a[242:243], v4 offset:6656
    s_mov_b32 s6, 491520
    v_mfma_f32_16x16x32_bf16 v[144:147], a[248:251], a[200:203], v[144:147]
    buffer_load_dwordx4 a[144:147], v2, s[52:55], s6 offen offset:0
    v_mfma_f32_16x16x32_bf16 v[144:147], a[252:255], a[224:227], v[144:147]
    ds_read_b64_tr_b16 a[244:245], v4 offset:18432
    v_mfma_f32_16x16x32_bf16 v[148:151], a[252:255], a[228:231], v[148:151]
    v_mfma_f32_16x16x32_bf16 v[148:151], a[248:251], a[204:207], v[148:151]
    ds_read_b64_tr_b16 a[246:247], v4 offset:18944
    v_mfma_f32_16x16x32_bf16 v[152:155], a[248:251], a[208:211], v[152:155]
    buffer_load_dwordx4 a[148:151], v2, s[52:55], s6 offen offset:1024
    v_mfma_f32_16x16x32_bf16 v[152:155], a[252:255], a[232:235], v[152:155]
    v_mfma_f32_16x16x32_bf16 v[156:159], a[252:255], a[236:239], v[156:159]
    v_mfma_f32_16x16x32_bf16 v[156:159], a[248:251], a[212:215], v[156:159]
    s_waitcnt lgkmcnt(4)
    v_mfma_f32_16x16x32_bf16 a[44:47], v[56:59], a[212:215], a[44:47]
    buffer_load_dwordx4 a[152:155], v2, s[52:55], s6 offen offset:2048
    v_mfma_f32_16x16x32_bf16 a[44:47], v[60:63], a[236:239], a[44:47]
    ds_read_b64_tr_b16 a[248:249], v4 offset:7168
    v_mfma_f32_16x16x32_bf16 a[40:43], v[60:63], a[232:235], a[40:43]
    v_mfma_f32_16x16x32_bf16 a[40:43], v[56:59], a[208:211], a[40:43]
    ds_read_b64_tr_b16 a[250:251], v4 offset:7680
    v_mfma_f32_16x16x32_bf16 a[36:39], v[56:59], a[204:207], a[36:39]
    buffer_load_dwordx4 a[156:159], v2, s[52:55], s6 offen offset:3072
    v_mfma_f32_16x16x32_bf16 a[36:39], v[60:63], a[228:231], a[36:39]
    ds_read_b64_tr_b16 a[252:253], v4 offset:19456
    v_mfma_f32_16x16x32_bf16 a[32:35], v[60:63], a[224:227], a[32:35]
    v_mfma_f32_16x16x32_bf16 a[32:35], v[56:59], a[200:203], a[32:35]
    ds_read_b64_tr_b16 a[254:255], v4 offset:19968
    s_mov_b32 s6, 495616
    v_mfma_f32_16x16x32_bf16 a[28:31], v[56:59], a[196:199], a[28:31]
    buffer_load_dwordx4 a[160:163], v2, s[52:55], s6 offen offset:0
    v_mfma_f32_16x16x32_bf16 a[28:31], v[60:63], a[220:223], a[28:31]
    v_mfma_f32_16x16x32_bf16 a[24:27], v[60:63], a[216:219], a[24:27]
    v_mfma_f32_16x16x32_bf16 a[24:27], v[56:59], a[192:195], a[24:27]
    s_waitcnt lgkmcnt(4)
    v_mfma_f32_16x16x32_bf16 v[160:163], a[240:243], a[192:195], v[160:163]
    buffer_load_dwordx4 a[164:167], v2, s[52:55], s6 offen offset:1024
    v_mfma_f32_16x16x32_bf16 v[160:163], a[244:247], a[216:219], v[160:163]
    ds_read_b64_tr_b16 v[56:57], v4 offset:8192
    v_mfma_f32_16x16x32_bf16 v[164:167], a[244:247], a[220:223], v[164:167]
    v_mfma_f32_16x16x32_bf16 v[164:167], a[240:243], a[196:199], v[164:167]
    ds_read_b64_tr_b16 v[58:59], v4 offset:8704
    v_mfma_f32_16x16x32_bf16 v[168:171], a[240:243], a[200:203], v[168:171]
    s_add_u32 s43, s40, 73728
    buffer_load_dwordx3 v[40:42], v0, s[12:15], s43 offen offset:0
    v_mfma_f32_16x16x32_bf16 v[168:171], a[244:247], a[224:227], v[168:171]
    ds_read_b64_tr_b16 v[60:61], v4 offset:20480
    v_mfma_f32_16x16x32_bf16 v[172:175], a[244:247], a[228:231], v[172:175]
    v_mfma_f32_16x16x32_bf16 v[172:175], a[240:243], a[204:207], v[172:175]
    ds_read_b64_tr_b16 v[62:63], v4 offset:20992
    v_mfma_f32_16x16x32_bf16 v[176:179], a[240:243], a[208:211], v[176:179]
    s_add_u32 s43, s40, 82944
    buffer_load_dwordx3 v[44:46], v0, s[12:15], s43 offen offset:0
    v_mfma_f32_16x16x32_bf16 v[176:179], a[244:247], a[232:235], v[176:179]
    v_mfma_f32_16x16x32_bf16 v[180:183], a[244:247], a[236:239], v[180:183]
    v_mfma_f32_16x16x32_bf16 v[180:183], a[240:243], a[212:215], v[180:183]
    s_waitcnt lgkmcnt(4)
    v_mfma_f32_16x16x32_bf16 v[204:207], a[248:251], a[212:215], v[204:207]
    s_add_u32 s43, s40, 0
    buffer_load_dwordx3 v[48:50], v0, s[12:15], s43 offen offset:0
    v_mfma_f32_16x16x32_bf16 v[204:207], a[252:255], a[236:239], v[204:207]
    ds_read_b64_tr_b16 a[240:241], v4 offset:9216
    v_mfma_f32_16x16x32_bf16 v[200:203], a[252:255], a[232:235], v[200:203]
    v_mfma_f32_16x16x32_bf16 v[200:203], a[248:251], a[208:211], v[200:203]
    ds_read_b64_tr_b16 a[242:243], v4 offset:9728
    v_mfma_f32_16x16x32_bf16 v[196:199], a[248:251], a[204:207], v[196:199]
    s_add_u32 s43, s40, 9216
    buffer_load_dwordx3 v[52:54], v0, s[12:15], s43 offen offset:0
    v_mfma_f32_16x16x32_bf16 v[196:199], a[252:255], a[228:231], v[196:199]
    ds_read_b64_tr_b16 a[244:245], v4 offset:21504
    v_mfma_f32_16x16x32_bf16 v[192:195], a[252:255], a[224:227], v[192:195]
    v_mfma_f32_16x16x32_bf16 v[192:195], a[248:251], a[200:203], v[192:195]
    ds_read_b64_tr_b16 a[246:247], v4 offset:22016
    v_mfma_f32_16x16x32_bf16 v[188:191], a[248:251], a[196:199], v[188:191]
    v_mfma_f32_16x16x32_bf16 v[188:191], a[252:255], a[220:223], v[188:191]
    v_mfma_f32_16x16x32_bf16 v[184:187], a[252:255], a[216:219], v[184:187]
    v_mfma_f32_16x16x32_bf16 v[184:187], a[248:251], a[192:195], v[184:187]
    s_waitcnt lgkmcnt(4)
    v_mfma_f32_16x16x32_bf16 a[48:51], v[56:59], a[192:195], a[48:51]
    v_mfma_f32_16x16x32_bf16 a[48:51], v[60:63], a[216:219], a[48:51]
    ds_read_b64_tr_b16 a[248:249], v4 offset:10240
    v_mfma_f32_16x16x32_bf16 a[52:55], v[60:63], a[220:223], a[52:55]
    v_mfma_f32_16x16x32_bf16 a[52:55], v[56:59], a[196:199], a[52:55]
    ds_read_b64_tr_b16 a[250:251], v4 offset:10752
    v_mfma_f32_16x16x32_bf16 a[56:59], v[56:59], a[200:203], a[56:59]
    buffer_load_dwordx4 a[168:171], v2, s[52:55], s6 offen offset:2048
    v_mfma_f32_16x16x32_bf16 a[56:59], v[60:63], a[224:227], a[56:59]
    ds_read_b64_tr_b16 a[252:253], v4 offset:22528
    v_mfma_f32_16x16x32_bf16 a[60:63], v[60:63], a[228:231], a[60:63]
    v_mfma_f32_16x16x32_bf16 a[60:63], v[56:59], a[204:207], a[60:63]
    ds_read_b64_tr_b16 a[254:255], v4 offset:23040
    v_mfma_f32_16x16x32_bf16 a[64:67], v[56:59], a[208:211], a[64:67]
    buffer_load_dwordx4 a[172:175], v2, s[52:55], s6 offen offset:3072
    v_mfma_f32_16x16x32_bf16 a[64:67], v[60:63], a[232:235], a[64:67]
    v_mfma_f32_16x16x32_bf16 a[68:71], v[60:63], a[236:239], a[68:71]
    v_mfma_f32_16x16x32_bf16 a[68:71], v[56:59], a[212:215], a[68:71]
    s_mov_b32 s6, 499712
    s_waitcnt lgkmcnt(4)
    v_mfma_f32_16x16x32_bf16 v[228:231], a[240:243], a[212:215], v[228:231]
    buffer_load_dwordx4 a[176:179], v2, s[52:55], s6 offen offset:0
    v_mfma_f32_16x16x32_bf16 v[228:231], a[244:247], a[236:239], v[228:231]
    ds_read_b64_tr_b16 v[56:57], v4 offset:11264
    v_mfma_f32_16x16x32_bf16 v[224:227], a[244:247], a[232:235], v[224:227]
    v_mfma_f32_16x16x32_bf16 v[224:227], a[240:243], a[208:211], v[224:227]
    ds_read_b64_tr_b16 v[58:59], v4 offset:11776
    v_mfma_f32_16x16x32_bf16 v[220:223], a[240:243], a[204:207], v[220:223]
    buffer_load_dwordx4 a[180:183], v2, s[52:55], s6 offen offset:1024
    v_mfma_f32_16x16x32_bf16 v[220:223], a[244:247], a[228:231], v[220:223]
    ds_read_b64_tr_b16 v[60:61], v4 offset:23552
    v_mfma_f32_16x16x32_bf16 v[216:219], a[244:247], a[224:227], v[216:219]
    v_mfma_f32_16x16x32_bf16 v[216:219], a[240:243], a[200:203], v[216:219]
    ds_read_b64_tr_b16 v[62:63], v4 offset:24064
    v_mfma_f32_16x16x32_bf16 v[212:215], a[240:243], a[196:199], v[212:215]
    buffer_load_dwordx4 a[184:187], v2, s[52:55], s6 offen offset:2048
    v_mfma_f32_16x16x32_bf16 v[212:215], a[244:247], a[220:223], v[212:215]
    v_mfma_f32_16x16x32_bf16 v[208:211], a[244:247], a[216:219], v[208:211]
    v_mfma_f32_16x16x32_bf16 v[208:211], a[240:243], a[192:195], v[208:211]
    s_waitcnt vmcnt(36) lgkmcnt(0)
    s_barrier
    v_mfma_f32_16x16x32_bf16 v[232:235], a[248:251], a[192:195], v[232:235]
    buffer_load_dwordx4 a[188:191], v2, s[52:55], s6 offen offset:3072
    v_mfma_f32_16x16x32_bf16 v[232:235], a[252:255], a[216:219], v[232:235]
    ds_read_b64_tr_b16 a[240:241], v3 offset:0
    v_mfma_f32_16x16x32_bf16 v[236:239], a[252:255], a[220:223], v[236:239]
    v_mfma_f32_16x16x32_bf16 v[236:239], a[248:251], a[196:199], v[236:239]
    ds_read_b64_tr_b16 a[242:243], v3 offset:512
    v_mfma_f32_16x16x32_bf16 v[240:243], a[248:251], a[200:203], v[240:243]
    v_mfma_f32_16x16x32_bf16 v[240:243], a[252:255], a[224:227], v[240:243]
    ds_read_b64_tr_b16 a[244:245], v3 offset:12288
    v_mfma_f32_16x16x32_bf16 v[244:247], a[252:255], a[228:231], v[244:247]
    v_mfma_f32_16x16x32_bf16 v[244:247], a[248:251], a[204:207], v[244:247]
    ds_read_b64_tr_b16 a[246:247], v3 offset:12800
    v_mfma_f32_16x16x32_bf16 v[248:251], a[248:251], a[208:211], v[248:251]
    v_mfma_f32_16x16x32_bf16 v[248:251], a[252:255], a[232:235], v[248:251]
    v_mfma_f32_16x16x32_bf16 v[252:255], a[252:255], a[236:239], v[252:255]
    v_mfma_f32_16x16x32_bf16 v[252:255], a[248:251], a[212:215], v[252:255]
    v_mfma_f32_16x16x32_bf16 a[92:95], v[56:59], a[212:215], a[92:95]
    v_mfma_f32_16x16x32_bf16 a[92:95], v[60:63], a[236:239], a[92:95]
    ds_read_b64_tr_b16 a[248:249], v3 offset:1024
    v_mfma_f32_16x16x32_bf16 a[88:91], v[60:63], a[232:235], a[88:91]
    v_mfma_f32_16x16x32_bf16 a[88:91], v[56:59], a[208:211], a[88:91]
    ds_read_b64_tr_b16 a[250:251], v3 offset:1536
    v_mfma_f32_16x16x32_bf16 a[84:87], v[56:59], a[204:207], a[84:87]
    v_mfma_f32_16x16x32_bf16 a[84:87], v[60:63], a[228:231], a[84:87]
    ds_read_b64_tr_b16 a[252:253], v3 offset:13312
    v_mfma_f32_16x16x32_bf16 a[80:83], v[60:63], a[224:227], a[80:83]
    v_mfma_f32_16x16x32_bf16 a[80:83], v[56:59], a[200:203], a[80:83]
    ds_read_b64_tr_b16 a[254:255], v3 offset:13824
    v_mfma_f32_16x16x32_bf16 a[76:79], v[56:59], a[196:199], a[76:79]
    v_mfma_f32_16x16x32_bf16 a[76:79], v[60:63], a[220:223], a[76:79]
    v_mfma_f32_16x16x32_bf16 a[72:75], v[60:63], a[216:219], a[72:75]
    v_mfma_f32_16x16x32_bf16 a[72:75], v[56:59], a[192:195], a[72:75]
    s_waitcnt vmcnt(25)
    s_waitcnt lgkmcnt(4)
    v_mfma_f32_16x16x32_bf16 v[64:67], a[240:243], a[96:99], v[64:67]
    v_mfma_f32_16x16x32_bf16 v[64:67], a[244:247], a[120:123], v[64:67]
    ds_read_b64_tr_b16 v[56:57], v3 offset:2048
    v_mfma_f32_16x16x32_bf16 v[68:71], a[244:247], a[124:127], v[68:71]
    v_mfma_f32_16x16x32_bf16 v[68:71], a[240:243], a[100:103], v[68:71]
    ds_read_b64_tr_b16 v[58:59], v3 offset:2560
    s_add_u32 m0, s39, 49152
    v_mfma_f32_16x16x32_bf16 v[72:75], a[240:243], a[104:107], v[72:75]
    buffer_load_dwordx4 v1, s[56:59], s4 offen offset:0 nt lds
    v_mfma_f32_16x16x32_bf16 v[72:75], a[244:247], a[128:131], v[72:75]
    ds_read_b64_tr_b16 v[60:61], v3 offset:14336
    v_mfma_f32_16x16x32_bf16 v[76:79], a[244:247], a[132:135], v[76:79]
    v_mfma_f32_16x16x32_bf16 v[76:79], a[240:243], a[108:111], v[76:79]
    ds_read_b64_tr_b16 v[62:63], v3 offset:14848
    s_add_u32 m0, s39, 49152
    v_mfma_f32_16x16x32_bf16 v[80:83], a[240:243], a[112:115], v[80:83]
    buffer_load_dwordx4 v1, s[56:59], s4 offen offset:1024 nt lds
    v_mfma_f32_16x16x32_bf16 v[80:83], a[244:247], a[136:139], v[80:83]
    v_mfma_f32_16x16x32_bf16 v[84:87], a[244:247], a[140:143], v[84:87]
    v_mfma_f32_16x16x32_bf16 v[84:87], a[240:243], a[116:119], v[84:87]
    s_add_u32 m0, s39, 49152
    s_waitcnt lgkmcnt(4)
    v_mfma_f32_16x16x32_bf16 v[108:111], a[248:251], a[116:119], v[108:111]
    buffer_load_dwordx4 v1, s[56:59], s4 offen offset:2048 nt lds
    v_mfma_f32_16x16x32_bf16 v[108:111], a[252:255], a[140:143], v[108:111]
    ds_read_b64_tr_b16 a[240:241], v3 offset:3072
    v_mfma_f32_16x16x32_bf16 v[104:107], a[252:255], a[136:139], v[104:107]
    v_mfma_f32_16x16x32_bf16 v[104:107], a[248:251], a[112:115], v[104:107]
    ds_read_b64_tr_b16 a[242:243], v3 offset:3584
    s_add_u32 m0, s39, 61440
    v_mfma_f32_16x16x32_bf16 v[100:103], a[248:251], a[108:111], v[100:103]
    buffer_load_dwordx4 v1, s[60:63], s29 offen offset:0 nt lds
    v_mfma_f32_16x16x32_bf16 v[100:103], a[252:255], a[132:135], v[100:103]
    ds_read_b64_tr_b16 a[244:245], v3 offset:15360
    v_mfma_f32_16x16x32_bf16 v[96:99], a[252:255], a[128:131], v[96:99]
    v_mfma_f32_16x16x32_bf16 v[96:99], a[248:251], a[104:107], v[96:99]
    ds_read_b64_tr_b16 a[246:247], v3 offset:15872
    s_add_u32 m0, s39, 61440
    v_mfma_f32_16x16x32_bf16 v[92:95], a[248:251], a[100:103], v[92:95]
    buffer_load_dwordx4 v1, s[60:63], s29 offen offset:1024 nt lds
    v_mfma_f32_16x16x32_bf16 v[92:95], a[252:255], a[124:127], v[92:95]
    v_mfma_f32_16x16x32_bf16 v[88:91], a[252:255], a[120:123], v[88:91]
    v_mfma_f32_16x16x32_bf16 v[88:91], a[248:251], a[96:99], v[88:91]
    s_add_u32 m0, s39, 61440
    s_waitcnt lgkmcnt(4)
    v_mfma_f32_16x16x32_bf16 a[0:3], v[56:59], a[96:99], a[0:3]
    buffer_load_dwordx4 v1, s[60:63], s29 offen offset:2048 nt lds
    v_mfma_f32_16x16x32_bf16 a[0:3], v[60:63], a[120:123], a[0:3]
    ds_read_b64_tr_b16 a[248:249], v3 offset:4096
    v_mfma_f32_16x16x32_bf16 a[4:7], v[60:63], a[124:127], a[4:7]
    s_waitcnt vmcnt(15)
    v_lshlrev_b32 v14, 16, v40
    v_mfma_f32_16x16x32_bf16 a[4:7], v[56:59], a[100:103], a[4:7]
    ds_read_b64_tr_b16 a[250:251], v3 offset:4608
    v_mfma_f32_16x16x32_bf16 a[8:11], v[56:59], a[104:107], a[8:11]
    v_and_b32 v15, s36, v40
    v_mfma_f32_16x16x32_bf16 a[8:11], v[60:63], a[128:131], a[8:11]
    ds_read_b64_tr_b16 a[252:253], v3 offset:16384
    v_mfma_f32_16x16x32_bf16 a[12:15], v[60:63], a[132:135], a[12:15]
    v_lshlrev_b32 v16, 16, v41
    v_mfma_f32_16x16x32_bf16 a[12:15], v[56:59], a[108:111], a[12:15]
    ds_read_b64_tr_b16 a[254:255], v3 offset:16896
    v_mfma_f32_16x16x32_bf16 a[16:19], v[56:59], a[112:115], a[16:19]
    v_add_f32 v14, v14, v8
    v_mfma_f32_16x16x32_bf16 a[16:19], v[60:63], a[136:139], a[16:19]
    v_add_f32 v15, v15, v9
    v_mfma_f32_16x16x32_bf16 a[20:23], v[60:63], a[140:143], a[20:23]
    v_add_f32 v16, v16, v10
    v_mfma_f32_16x16x32_bf16 a[20:23], v[56:59], a[116:119], a[20:23]
    v_add_f32 v160, v14, v160
    s_waitcnt lgkmcnt(4)
    v_mfma_f32_16x16x32_bf16 v[132:135], a[240:243], a[116:119], v[132:135]
    v_add_f32 v164, v15, v164
    v_mfma_f32_16x16x32_bf16 v[132:135], a[244:247], a[140:143], v[132:135]
    ds_read_b64_tr_b16 v[56:57], v3 offset:5120
    v_mfma_f32_16x16x32_bf16 v[128:131], a[244:247], a[136:139], v[128:131]
    v_add_f32 v168, v16, v168
    v_mfma_f32_16x16x32_bf16 v[128:131], a[240:243], a[112:115], v[128:131]
    ds_read_b64_tr_b16 v[58:59], v3 offset:5632
    v_mfma_f32_16x16x32_bf16 v[124:127], a[240:243], a[108:111], v[124:127]
    v_and_b32 v14, s36, v41
    v_mfma_f32_16x16x32_bf16 v[124:127], a[244:247], a[132:135], v[124:127]
    ds_read_b64_tr_b16 v[60:61], v3 offset:17408
    v_mfma_f32_16x16x32_bf16 v[120:123], a[244:247], a[128:131], v[120:123]
    v_lshlrev_b32 v15, 16, v42
    v_mfma_f32_16x16x32_bf16 v[120:123], a[240:243], a[104:107], v[120:123]
    ds_read_b64_tr_b16 v[62:63], v3 offset:17920
    v_mfma_f32_16x16x32_bf16 v[116:119], a[240:243], a[100:103], v[116:119]
    v_and_b32 v16, s36, v42
    v_mfma_f32_16x16x32_bf16 v[116:119], a[244:247], a[124:127], v[116:119]
    v_add_f32 v14, v14, v11
    v_mfma_f32_16x16x32_bf16 v[112:115], a[244:247], a[120:123], v[112:115]
    v_add_f32 v15, v15, v12
    v_mfma_f32_16x16x32_bf16 v[112:115], a[240:243], a[96:99], v[112:115]
    v_add_f32 v16, v16, v13
    s_waitcnt lgkmcnt(4)
    v_mfma_f32_16x16x32_bf16 v[136:139], a[248:251], a[96:99], v[136:139]
    v_add_f32 v172, v14, v172
    v_mfma_f32_16x16x32_bf16 v[136:139], a[252:255], a[120:123], v[136:139]
    ds_read_b64_tr_b16 a[240:241], v3 offset:6144
    v_mfma_f32_16x16x32_bf16 v[140:143], a[252:255], a[124:127], v[140:143]
    v_add_f32 v176, v15, v176
    v_mfma_f32_16x16x32_bf16 v[140:143], a[248:251], a[100:103], v[140:143]
    ds_read_b64_tr_b16 a[242:243], v3 offset:6656
    s_mov_b32 s6, 540672
    v_mfma_f32_16x16x32_bf16 v[144:147], a[248:251], a[104:107], v[144:147]
    buffer_load_dwordx4 a[192:195], v2, s[52:55], s6 offen offset:0
    v_mfma_f32_16x16x32_bf16 v[144:147], a[252:255], a[128:131], v[144:147]
    ds_read_b64_tr_b16 a[244:245], v3 offset:18432
    v_mfma_f32_16x16x32_bf16 v[148:151], a[252:255], a[132:135], v[148:151]
    v_add_f32 v180, v16, v180
    v_mfma_f32_16x16x32_bf16 v[148:151], a[248:251], a[108:111], v[148:151]
    ds_read_b64_tr_b16 a[246:247], v3 offset:18944
    v_mfma_f32_16x16x32_bf16 v[152:155], a[248:251], a[112:115], v[152:155]
    buffer_load_dwordx4 a[196:199], v2, s[52:55], s6 offen offset:1024
    v_mfma_f32_16x16x32_bf16 v[152:155], a[252:255], a[136:139], v[152:155]
    v_mfma_f32_16x16x32_bf16 v[156:159], a[252:255], a[140:143], v[156:159]
    v_mfma_f32_16x16x32_bf16 v[156:159], a[248:251], a[116:119], v[156:159]
    s_waitcnt lgkmcnt(4)
    v_mfma_f32_16x16x32_bf16 a[44:47], v[56:59], a[116:119], a[44:47]
    buffer_load_dwordx4 a[200:203], v2, s[52:55], s6 offen offset:2048
    v_mfma_f32_16x16x32_bf16 a[44:47], v[60:63], a[140:143], a[44:47]
    ds_read_b64_tr_b16 a[248:249], v3 offset:7168
    v_mfma_f32_16x16x32_bf16 a[40:43], v[60:63], a[136:139], a[40:43]
    s_waitcnt vmcnt(17)
    v_lshlrev_b32 v14, 16, v44
    v_mfma_f32_16x16x32_bf16 a[40:43], v[56:59], a[112:115], a[40:43]
    ds_read_b64_tr_b16 a[250:251], v3 offset:7680
    v_mfma_f32_16x16x32_bf16 a[36:39], v[56:59], a[108:111], a[36:39]
    buffer_load_dwordx4 a[204:207], v2, s[52:55], s6 offen offset:3072
    v_mfma_f32_16x16x32_bf16 a[36:39], v[60:63], a[132:135], a[36:39]
    ds_read_b64_tr_b16 a[252:253], v3 offset:19456
    v_mfma_f32_16x16x32_bf16 a[32:35], v[60:63], a[128:131], a[32:35]
    v_and_b32 v15, s36, v44
    v_mfma_f32_16x16x32_bf16 a[32:35], v[56:59], a[104:107], a[32:35]
    ds_read_b64_tr_b16 a[254:255], v3 offset:19968
    s_mov_b32 s6, 544768
    v_mfma_f32_16x16x32_bf16 a[28:31], v[56:59], a[100:103], a[28:31]
    buffer_load_dwordx4 a[208:211], v2, s[52:55], s6 offen offset:0
    v_mfma_f32_16x16x32_bf16 a[28:31], v[60:63], a[124:127], a[28:31]
    v_lshlrev_b32 v16, 16, v45
    v_mfma_f32_16x16x32_bf16 a[24:27], v[60:63], a[120:123], a[24:27]
    v_add_f32 v14, v14, v8
    v_mfma_f32_16x16x32_bf16 a[24:27], v[56:59], a[96:99], a[24:27]
    v_add_f32 v15, v15, v9
    s_waitcnt lgkmcnt(4)
    v_mfma_f32_16x16x32_bf16 v[160:163], a[240:243], a[96:99], v[160:163]
    buffer_load_dwordx4 a[212:215], v2, s[52:55], s6 offen offset:1024
    v_mfma_f32_16x16x32_bf16 v[160:163], a[244:247], a[120:123], v[160:163]
    ds_read_b64_tr_b16 v[56:57], v3 offset:8192
    v_mfma_f32_16x16x32_bf16 v[164:167], a[244:247], a[124:127], v[164:167]
    v_add_f32 v16, v16, v10
    v_mfma_f32_16x16x32_bf16 v[164:167], a[240:243], a[100:103], v[164:167]
    ds_read_b64_tr_b16 v[58:59], v3 offset:8704
    v_mfma_f32_16x16x32_bf16 v[168:171], a[240:243], a[104:107], v[168:171]
    v_add_f32 v208, v14, v208
    s_add_u32 s43, s40, 76800
    buffer_load_dwordx3 v[24:26], v0, s[12:15], s43 offen offset:0
    v_mfma_f32_16x16x32_bf16 v[168:171], a[244:247], a[128:131], v[168:171]
    ds_read_b64_tr_b16 v[60:61], v3 offset:20480
    v_mfma_f32_16x16x32_bf16 v[172:175], a[244:247], a[132:135], v[172:175]
    v_add_f32 v212, v15, v212
    v_mfma_f32_16x16x32_bf16 v[172:175], a[240:243], a[108:111], v[172:175]
    ds_read_b64_tr_b16 v[62:63], v3 offset:20992
    v_mfma_f32_16x16x32_bf16 v[176:179], a[240:243], a[112:115], v[176:179]
    v_add_f32 v216, v16, v216
    s_add_u32 s43, s40, 86016
    buffer_load_dwordx3 v[28:30], v0, s[12:15], s43 offen offset:0
    v_mfma_f32_16x16x32_bf16 v[176:179], a[244:247], a[136:139], v[176:179]
    v_and_b32 v14, s36, v45
    v_mfma_f32_16x16x32_bf16 v[180:183], a[244:247], a[140:143], v[180:183]
    v_lshlrev_b32 v15, 16, v46
    v_mfma_f32_16x16x32_bf16 v[180:183], a[240:243], a[116:119], v[180:183]
    v_and_b32 v16, s36, v46
    s_waitcnt lgkmcnt(4)
    v_mfma_f32_16x16x32_bf16 v[204:207], a[248:251], a[116:119], v[204:207]
    v_add_f32 v14, v14, v11
    s_add_u32 s43, s40, 3072
    buffer_load_dwordx3 v[32:34], v0, s[12:15], s43 offen offset:0
    v_mfma_f32_16x16x32_bf16 v[204:207], a[252:255], a[140:143], v[204:207]
    ds_read_b64_tr_b16 a[240:241], v3 offset:9216
    v_mfma_f32_16x16x32_bf16 v[200:203], a[252:255], a[136:139], v[200:203]
    v_add_f32 v15, v15, v12
    v_mfma_f32_16x16x32_bf16 v[200:203], a[248:251], a[112:115], v[200:203]
    ds_read_b64_tr_b16 a[242:243], v3 offset:9728
    v_mfma_f32_16x16x32_bf16 v[196:199], a[248:251], a[108:111], v[196:199]
    v_add_f32 v16, v16, v13
    s_add_u32 s43, s40, 12288
    buffer_load_dwordx3 v[36:38], v0, s[12:15], s43 offen offset:0
    v_mfma_f32_16x16x32_bf16 v[196:199], a[252:255], a[132:135], v[196:199]
    ds_read_b64_tr_b16 a[244:245], v3 offset:21504
    v_mfma_f32_16x16x32_bf16 v[192:195], a[252:255], a[128:131], v[192:195]
    v_add_f32 v220, v14, v220
    v_mfma_f32_16x16x32_bf16 v[192:195], a[248:251], a[104:107], v[192:195]
    ds_read_b64_tr_b16 a[246:247], v3 offset:22016
    v_mfma_f32_16x16x32_bf16 v[188:191], a[248:251], a[100:103], v[188:191]
    v_add_f32 v224, v15, v224
    v_mfma_f32_16x16x32_bf16 v[188:191], a[252:255], a[124:127], v[188:191]
    v_add_f32 v228, v16, v228
    v_mfma_f32_16x16x32_bf16 v[184:187], a[252:255], a[120:123], v[184:187]
    v_mfma_f32_16x16x32_bf16 v[184:187], a[248:251], a[96:99], v[184:187]
    s_waitcnt lgkmcnt(4)
    v_mfma_f32_16x16x32_bf16 a[48:51], v[56:59], a[96:99], a[48:51]
    s_waitcnt vmcnt(23)
    v_lshlrev_b32 v14, 16, v48
    v_mfma_f32_16x16x32_bf16 a[48:51], v[60:63], a[120:123], a[48:51]
    ds_read_b64_tr_b16 a[248:249], v3 offset:10240
    v_mfma_f32_16x16x32_bf16 a[52:55], v[60:63], a[124:127], a[52:55]
    v_and_b32 v15, s36, v48
    v_mfma_f32_16x16x32_bf16 a[52:55], v[56:59], a[100:103], a[52:55]
    ds_read_b64_tr_b16 a[250:251], v3 offset:10752
    v_mfma_f32_16x16x32_bf16 a[56:59], v[56:59], a[104:107], a[56:59]
    buffer_load_dwordx4 a[216:219], v2, s[52:55], s6 offen offset:2048
    v_mfma_f32_16x16x32_bf16 a[56:59], v[60:63], a[128:131], a[56:59]
    ds_read_b64_tr_b16 a[252:253], v3 offset:22528
    v_mfma_f32_16x16x32_bf16 a[60:63], v[60:63], a[132:135], a[60:63]
    v_lshlrev_b32 v16, 16, v49
    v_mfma_f32_16x16x32_bf16 a[60:63], v[56:59], a[108:111], a[60:63]
    ds_read_b64_tr_b16 a[254:255], v3 offset:23040
    v_mfma_f32_16x16x32_bf16 a[64:67], v[56:59], a[112:115], a[64:67]
    buffer_load_dwordx4 a[220:223], v2, s[52:55], s6 offen offset:3072
    v_mfma_f32_16x16x32_bf16 a[64:67], v[60:63], a[136:139], a[64:67]
    v_add_f32 v14, v14, v8
    v_mfma_f32_16x16x32_bf16 a[68:71], v[60:63], a[140:143], a[68:71]
    v_add_f32 v15, v15, v9
    v_mfma_f32_16x16x32_bf16 a[68:71], v[56:59], a[116:119], a[68:71]
    s_mov_b32 s6, 548864
    v_add_f32 v16, v16, v10
    s_waitcnt lgkmcnt(4)
    v_mfma_f32_16x16x32_bf16 v[228:231], a[240:243], a[116:119], v[228:231]
    buffer_load_dwordx4 a[224:227], v2, s[52:55], s6 offen offset:0
    v_mfma_f32_16x16x32_bf16 v[228:231], a[244:247], a[140:143], v[228:231]
    ds_read_b64_tr_b16 v[56:57], v3 offset:11264
    v_mfma_f32_16x16x32_bf16 v[224:227], a[244:247], a[136:139], v[224:227]
    v_add_f32 v64, v14, v64
    v_mfma_f32_16x16x32_bf16 v[224:227], a[240:243], a[112:115], v[224:227]
    ds_read_b64_tr_b16 v[58:59], v3 offset:11776
    v_mfma_f32_16x16x32_bf16 v[220:223], a[240:243], a[108:111], v[220:223]
    buffer_load_dwordx4 a[228:231], v2, s[52:55], s6 offen offset:1024
    v_mfma_f32_16x16x32_bf16 v[220:223], a[244:247], a[132:135], v[220:223]
    ds_read_b64_tr_b16 v[60:61], v3 offset:23552
    v_mfma_f32_16x16x32_bf16 v[216:219], a[244:247], a[128:131], v[216:219]
    v_add_f32 v68, v15, v68
    v_mfma_f32_16x16x32_bf16 v[216:219], a[240:243], a[104:107], v[216:219]
    ds_read_b64_tr_b16 v[62:63], v3 offset:24064
    v_mfma_f32_16x16x32_bf16 v[212:215], a[240:243], a[100:103], v[212:215]
    buffer_load_dwordx4 a[232:235], v2, s[52:55], s6 offen offset:2048
    v_mfma_f32_16x16x32_bf16 v[212:215], a[244:247], a[124:127], v[212:215]
    v_add_f32 v72, v16, v72
    v_mfma_f32_16x16x32_bf16 v[208:211], a[244:247], a[120:123], v[208:211]
    v_and_b32 v14, s36, v49
    v_mfma_f32_16x16x32_bf16 v[208:211], a[240:243], a[96:99], v[208:211]
    v_lshlrev_b32 v15, 16, v50
    s_waitcnt lgkmcnt(0)
    s_barrier
    v_mfma_f32_16x16x32_bf16 v[232:235], a[248:251], a[96:99], v[232:235]
    buffer_load_dwordx4 a[236:239], v2, s[52:55], s6 offen offset:3072
    v_mfma_f32_16x16x32_bf16 v[232:235], a[252:255], a[120:123], v[232:235]
    ds_read_b64_tr_b16 a[240:241], v3 offset:24576
    v_mfma_f32_16x16x32_bf16 v[236:239], a[252:255], a[124:127], v[236:239]
    v_and_b32 v16, s36, v50
    v_mfma_f32_16x16x32_bf16 v[236:239], a[248:251], a[100:103], v[236:239]
    ds_read_b64_tr_b16 a[242:243], v3 offset:25088
    v_mfma_f32_16x16x32_bf16 v[240:243], a[248:251], a[104:107], v[240:243]
    v_add_f32 v14, v14, v11
    v_mfma_f32_16x16x32_bf16 v[240:243], a[252:255], a[128:131], v[240:243]
    ds_read_b64_tr_b16 a[244:245], v3 offset:36864
    v_mfma_f32_16x16x32_bf16 v[244:247], a[252:255], a[132:135], v[244:247]
    v_add_f32 v15, v15, v12
    v_mfma_f32_16x16x32_bf16 v[244:247], a[248:251], a[108:111], v[244:247]
    ds_read_b64_tr_b16 a[246:247], v3 offset:37376
    v_mfma_f32_16x16x32_bf16 v[248:251], a[248:251], a[112:115], v[248:251]
    v_add_f32 v16, v16, v13
    v_mfma_f32_16x16x32_bf16 v[248:251], a[252:255], a[136:139], v[248:251]
    v_add_f32 v76, v14, v76
    v_mfma_f32_16x16x32_bf16 v[252:255], a[252:255], a[140:143], v[252:255]
    v_add_f32 v80, v15, v80
    v_mfma_f32_16x16x32_bf16 v[252:255], a[248:251], a[116:119], v[252:255]
    v_add_f32 v84, v16, v84
    v_mfma_f32_16x16x32_bf16 a[92:95], v[56:59], a[116:119], a[92:95]
    s_waitcnt vmcnt(28)
    v_lshlrev_b32 v14, 16, v52
    v_mfma_f32_16x16x32_bf16 a[92:95], v[60:63], a[140:143], a[92:95]
    ds_read_b64_tr_b16 a[248:249], v3 offset:25600
    v_mfma_f32_16x16x32_bf16 a[88:91], v[60:63], a[136:139], a[88:91]
    v_and_b32 v15, s36, v52
    v_mfma_f32_16x16x32_bf16 a[88:91], v[56:59], a[112:115], a[88:91]
    ds_read_b64_tr_b16 a[250:251], v3 offset:26112
    v_mfma_f32_16x16x32_bf16 a[84:87], v[56:59], a[108:111], a[84:87]
    v_lshlrev_b32 v16, 16, v53
    v_mfma_f32_16x16x32_bf16 a[84:87], v[60:63], a[132:135], a[84:87]
    ds_read_b64_tr_b16 a[252:253], v3 offset:37888
    v_mfma_f32_16x16x32_bf16 a[80:83], v[60:63], a[128:131], a[80:83]
    v_add_f32 v14, v14, v8
    v_mfma_f32_16x16x32_bf16 a[80:83], v[56:59], a[104:107], a[80:83]
    ds_read_b64_tr_b16 a[254:255], v3 offset:38400
    v_mfma_f32_16x16x32_bf16 a[76:79], v[56:59], a[100:103], a[76:79]
    v_add_f32 v15, v15, v9
    v_mfma_f32_16x16x32_bf16 a[76:79], v[60:63], a[124:127], a[76:79]
    v_add_f32 v16, v16, v10
    v_mfma_f32_16x16x32_bf16 a[72:75], v[60:63], a[120:123], a[72:75]
    v_add_f32 v112, v14, v112
    v_mfma_f32_16x16x32_bf16 a[72:75], v[56:59], a[96:99], a[72:75]
    v_add_f32 v116, v15, v116
    s_waitcnt vmcnt(22)
    s_waitcnt lgkmcnt(4)
    v_mfma_f32_16x16x32_bf16 v[64:67], a[240:243], a[144:147], v[64:67]
    v_add_f32 v120, v16, v120
    v_mfma_f32_16x16x32_bf16 v[64:67], a[244:247], a[168:171], v[64:67]
    ds_read_b64_tr_b16 v[56:57], v3 offset:26624
    v_mfma_f32_16x16x32_bf16 v[68:71], a[244:247], a[172:175], v[68:71]
    s_add_u32 s4, s4, 36864
    v_and_b32 v14, s36, v53
    v_mfma_f32_16x16x32_bf16 v[68:71], a[240:243], a[148:151], v[68:71]
    ds_read_b64_tr_b16 v[58:59], v3 offset:27136
    s_add_u32 s29, s29, 12288
    s_add_u32 s5, s4, 4096
    s_add_u32 m0, s32, 0
    v_mfma_f32_16x16x32_bf16 v[72:75], a[240:243], a[152:155], v[72:75]
    buffer_load_dwordx4 v1, s[8:11], s4 offen offset:0 nt lds
    v_mfma_f32_16x16x32_bf16 v[72:75], a[244:247], a[176:179], v[72:75]
    ds_read_b64_tr_b16 v[60:61], v3 offset:38912
    v_mfma_f32_16x16x32_bf16 v[76:79], a[244:247], a[180:183], v[76:79]
    v_lshlrev_b32 v15, 16, v54
    v_mfma_f32_16x16x32_bf16 v[76:79], a[240:243], a[156:159], v[76:79]
    ds_read_b64_tr_b16 v[62:63], v3 offset:39424
    s_add_u32 m0, s32, 0
    v_mfma_f32_16x16x32_bf16 v[80:83], a[240:243], a[160:163], v[80:83]
    buffer_load_dwordx4 v1, s[8:11], s4 offen offset:1024 nt lds
    v_mfma_f32_16x16x32_bf16 v[80:83], a[244:247], a[184:187], v[80:83]
    v_and_b32 v16, s36, v54
    v_mfma_f32_16x16x32_bf16 v[84:87], a[244:247], a[188:191], v[84:87]
    v_add_f32 v14, v14, v11
    v_mfma_f32_16x16x32_bf16 v[84:87], a[240:243], a[164:167], v[84:87]
    s_add_u32 m0, s32, 0
    v_add_f32 v15, v15, v12
    s_waitcnt lgkmcnt(4)
    v_mfma_f32_16x16x32_bf16 v[108:111], a[248:251], a[164:167], v[108:111]
    buffer_load_dwordx4 v1, s[8:11], s4 offen offset:2048 nt lds
    v_mfma_f32_16x16x32_bf16 v[108:111], a[252:255], a[188:191], v[108:111]
    ds_read_b64_tr_b16 a[240:241], v3 offset:27648
    v_mfma_f32_16x16x32_bf16 v[104:107], a[252:255], a[184:187], v[104:107]
    v_add_f32 v16, v16, v13
    v_mfma_f32_16x16x32_bf16 v[104:107], a[248:251], a[160:163], v[104:107]
    ds_read_b64_tr_b16 a[242:243], v3 offset:28160
    s_add_u32 m0, s32, 0
    v_mfma_f32_16x16x32_bf16 v[100:103], a[248:251], a[156:159], v[100:103]
    buffer_load_dwordx4 v1, s[8:11], s4 offen offset:3072 nt lds
    v_mfma_f32_16x16x32_bf16 v[100:103], a[252:255], a[180:183], v[100:103]
    ds_read_b64_tr_b16 a[244:245], v3 offset:39936
    v_mfma_f32_16x16x32_bf16 v[96:99], a[252:255], a[176:179], v[96:99]
    v_add_f32 v124, v14, v124
    v_mfma_f32_16x16x32_bf16 v[96:99], a[248:251], a[152:155], v[96:99]
    ds_read_b64_tr_b16 a[246:247], v3 offset:40448
    s_add_u32 m0, s32, 4096
    v_mfma_f32_16x16x32_bf16 v[92:95], a[248:251], a[148:151], v[92:95]
    buffer_load_dwordx4 v1, s[8:11], s5 offen offset:0 nt lds
    v_mfma_f32_16x16x32_bf16 v[92:95], a[252:255], a[172:175], v[92:95]
    v_add_f32 v128, v15, v128
    v_mfma_f32_16x16x32_bf16 v[88:91], a[252:255], a[168:171], v[88:91]
    v_add_f32 v132, v16, v132
    v_mfma_f32_16x16x32_bf16 v[88:91], a[248:251], a[144:147], v[88:91]
    s_add_u32 m0, s32, 4096
    s_waitcnt lgkmcnt(4)
    v_mfma_f32_16x16x32_bf16 a[0:3], v[56:59], a[144:147], a[0:3]
    buffer_load_dwordx4 v1, s[8:11], s5 offen offset:1024 nt lds
    v_mfma_f32_16x16x32_bf16 a[0:3], v[60:63], a[168:171], a[0:3]
    ds_read_b64_tr_b16 a[248:249], v3 offset:28672
    v_mfma_f32_16x16x32_bf16 a[4:7], v[60:63], a[172:175], a[4:7]
    s_waitcnt vmcnt(15)
    v_lshlrev_b32 v14, 16, v24
    v_mfma_f32_16x16x32_bf16 a[4:7], v[56:59], a[148:151], a[4:7]
    ds_read_b64_tr_b16 a[250:251], v3 offset:29184
    v_mfma_f32_16x16x32_bf16 a[8:11], v[56:59], a[152:155], a[8:11]
    v_and_b32 v15, s36, v24
    v_mfma_f32_16x16x32_bf16 a[8:11], v[60:63], a[176:179], a[8:11]
    ds_read_b64_tr_b16 a[252:253], v3 offset:40960
    v_mfma_f32_16x16x32_bf16 a[12:15], v[60:63], a[180:183], a[12:15]
    v_lshlrev_b32 v16, 16, v25
    v_mfma_f32_16x16x32_bf16 a[12:15], v[56:59], a[156:159], a[12:15]
    ds_read_b64_tr_b16 a[254:255], v3 offset:41472
    v_mfma_f32_16x16x32_bf16 a[16:19], v[56:59], a[160:163], a[16:19]
    v_add_f32 v14, v14, v8
    v_mfma_f32_16x16x32_bf16 a[16:19], v[60:63], a[184:187], a[16:19]
    v_add_f32 v15, v15, v9
    v_mfma_f32_16x16x32_bf16 a[20:23], v[60:63], a[188:191], a[20:23]
    v_add_f32 v16, v16, v10
    v_mfma_f32_16x16x32_bf16 a[20:23], v[56:59], a[164:167], a[20:23]
    v_add_f32 v184, v14, v184
    s_waitcnt lgkmcnt(4)
    v_mfma_f32_16x16x32_bf16 v[132:135], a[240:243], a[164:167], v[132:135]
    v_add_f32 v188, v15, v188
    v_mfma_f32_16x16x32_bf16 v[132:135], a[244:247], a[188:191], v[132:135]
    ds_read_b64_tr_b16 v[56:57], v3 offset:29696
    v_mfma_f32_16x16x32_bf16 v[128:131], a[244:247], a[184:187], v[128:131]
    v_add_f32 v192, v16, v192
    v_mfma_f32_16x16x32_bf16 v[128:131], a[240:243], a[160:163], v[128:131]
    ds_read_b64_tr_b16 v[58:59], v3 offset:30208
    v_mfma_f32_16x16x32_bf16 v[124:127], a[240:243], a[156:159], v[124:127]
    v_and_b32 v14, s36, v25
    v_mfma_f32_16x16x32_bf16 v[124:127], a[244:247], a[180:183], v[124:127]
    ds_read_b64_tr_b16 v[60:61], v3 offset:41984
    v_mfma_f32_16x16x32_bf16 v[120:123], a[244:247], a[176:179], v[120:123]
    v_lshlrev_b32 v15, 16, v26
    v_mfma_f32_16x16x32_bf16 v[120:123], a[240:243], a[152:155], v[120:123]
    ds_read_b64_tr_b16 v[62:63], v3 offset:42496
    v_mfma_f32_16x16x32_bf16 v[116:119], a[240:243], a[148:151], v[116:119]
    v_and_b32 v16, s36, v26
    v_mfma_f32_16x16x32_bf16 v[116:119], a[244:247], a[172:175], v[116:119]
    v_add_f32 v14, v14, v11
    v_mfma_f32_16x16x32_bf16 v[112:115], a[244:247], a[168:171], v[112:115]
    v_add_f32 v15, v15, v12
    v_mfma_f32_16x16x32_bf16 v[112:115], a[240:243], a[144:147], v[112:115]
    v_add_f32 v16, v16, v13
    s_waitcnt lgkmcnt(4)
    v_mfma_f32_16x16x32_bf16 v[136:139], a[248:251], a[144:147], v[136:139]
    v_add_f32 v196, v14, v196
    v_mfma_f32_16x16x32_bf16 v[136:139], a[252:255], a[168:171], v[136:139]
    ds_read_b64_tr_b16 a[240:241], v3 offset:30720
    v_mfma_f32_16x16x32_bf16 v[140:143], a[252:255], a[172:175], v[140:143]
    v_add_f32 v200, v15, v200
    v_mfma_f32_16x16x32_bf16 v[140:143], a[248:251], a[148:151], v[140:143]
    ds_read_b64_tr_b16 a[242:243], v3 offset:31232
    s_mov_b32 s6, 589824
    v_mfma_f32_16x16x32_bf16 v[144:147], a[248:251], a[152:155], v[144:147]
    buffer_load_dwordx4 a[96:99], v2, s[52:55], s6 offen offset:0
    v_mfma_f32_16x16x32_bf16 v[144:147], a[252:255], a[176:179], v[144:147]
    ds_read_b64_tr_b16 a[244:245], v3 offset:43008
    v_mfma_f32_16x16x32_bf16 v[148:151], a[252:255], a[180:183], v[148:151]
    v_add_f32 v204, v16, v204
    v_mfma_f32_16x16x32_bf16 v[148:151], a[248:251], a[156:159], v[148:151]
    ds_read_b64_tr_b16 a[246:247], v3 offset:43520
    v_mfma_f32_16x16x32_bf16 v[152:155], a[248:251], a[160:163], v[152:155]
    buffer_load_dwordx4 a[100:103], v2, s[52:55], s6 offen offset:1024
    v_mfma_f32_16x16x32_bf16 v[152:155], a[252:255], a[184:187], v[152:155]
    v_mfma_f32_16x16x32_bf16 v[156:159], a[252:255], a[188:191], v[156:159]
    v_mfma_f32_16x16x32_bf16 v[156:159], a[248:251], a[164:167], v[156:159]
    s_waitcnt lgkmcnt(4)
    v_mfma_f32_16x16x32_bf16 a[44:47], v[56:59], a[164:167], a[44:47]
    buffer_load_dwordx4 a[104:107], v2, s[52:55], s6 offen offset:2048
    v_mfma_f32_16x16x32_bf16 a[44:47], v[60:63], a[188:191], a[44:47]
    ds_read_b64_tr_b16 a[248:249], v3 offset:31744
    v_mfma_f32_16x16x32_bf16 a[40:43], v[60:63], a[184:187], a[40:43]
    s_waitcnt vmcnt(17)
    v_lshlrev_b32 v14, 16, v28
    v_mfma_f32_16x16x32_bf16 a[40:43], v[56:59], a[160:163], a[40:43]
    ds_read_b64_tr_b16 a[250:251], v3 offset:32256
    v_mfma_f32_16x16x32_bf16 a[36:39], v[56:59], a[156:159], a[36:39]
    buffer_load_dwordx4 a[108:111], v2, s[52:55], s6 offen offset:3072
    v_mfma_f32_16x16x32_bf16 a[36:39], v[60:63], a[180:183], a[36:39]
    ds_read_b64_tr_b16 a[252:253], v3 offset:44032
    v_mfma_f32_16x16x32_bf16 a[32:35], v[60:63], a[176:179], a[32:35]
    v_and_b32 v15, s36, v28
    v_mfma_f32_16x16x32_bf16 a[32:35], v[56:59], a[152:155], a[32:35]
    ds_read_b64_tr_b16 a[254:255], v3 offset:44544
    s_mov_b32 s6, 593920
    v_mfma_f32_16x16x32_bf16 a[28:31], v[56:59], a[148:151], a[28:31]
    buffer_load_dwordx4 a[112:115], v2, s[52:55], s6 offen offset:0
    v_mfma_f32_16x16x32_bf16 a[28:31], v[60:63], a[172:175], a[28:31]
    v_lshlrev_b32 v16, 16, v29
    v_mfma_f32_16x16x32_bf16 a[24:27], v[60:63], a[168:171], a[24:27]
    v_add_f32 v14, v14, v8
    v_mfma_f32_16x16x32_bf16 a[24:27], v[56:59], a[144:147], a[24:27]
    v_add_f32 v15, v15, v9
    s_waitcnt lgkmcnt(4)
    v_mfma_f32_16x16x32_bf16 v[160:163], a[240:243], a[144:147], v[160:163]
    buffer_load_dwordx4 a[116:119], v2, s[52:55], s6 offen offset:1024
    v_mfma_f32_16x16x32_bf16 v[160:163], a[244:247], a[168:171], v[160:163]
    ds_read_b64_tr_b16 v[56:57], v3 offset:32768
    v_mfma_f32_16x16x32_bf16 v[164:167], a[244:247], a[172:175], v[164:167]
    v_add_f32 v16, v16, v10
    v_mfma_f32_16x16x32_bf16 v[164:167], a[240:243], a[148:151], v[164:167]
    ds_read_b64_tr_b16 v[58:59], v3 offset:33280
    v_mfma_f32_16x16x32_bf16 v[168:171], a[240:243], a[152:155], v[168:171]
    v_add_f32 v232, v14, v232
    s_add_u32 s43, s40, 79872
    buffer_load_dwordx3 v[40:42], v0, s[12:15], s43 offen offset:0
    v_mfma_f32_16x16x32_bf16 v[168:171], a[244:247], a[176:179], v[168:171]
    ds_read_b64_tr_b16 v[60:61], v3 offset:45056
    v_mfma_f32_16x16x32_bf16 v[172:175], a[244:247], a[180:183], v[172:175]
    v_add_f32 v236, v15, v236
    v_mfma_f32_16x16x32_bf16 v[172:175], a[240:243], a[156:159], v[172:175]
    ds_read_b64_tr_b16 v[62:63], v3 offset:45568
    v_mfma_f32_16x16x32_bf16 v[176:179], a[240:243], a[160:163], v[176:179]
    v_add_f32 v240, v16, v240
    s_add_u32 s43, s40, 89088
    buffer_load_dwordx3 v[44:46], v0, s[12:15], s43 offen offset:0
    v_mfma_f32_16x16x32_bf16 v[176:179], a[244:247], a[184:187], v[176:179]
    v_and_b32 v14, s36, v29
    v_mfma_f32_16x16x32_bf16 v[180:183], a[244:247], a[188:191], v[180:183]
    v_lshlrev_b32 v15, 16, v30
    v_mfma_f32_16x16x32_bf16 v[180:183], a[240:243], a[164:167], v[180:183]
    v_and_b32 v16, s36, v30
    s_waitcnt lgkmcnt(4)
    v_mfma_f32_16x16x32_bf16 v[204:207], a[248:251], a[164:167], v[204:207]
    v_add_f32 v14, v14, v11
    s_add_u32 s43, s40, 6144
    buffer_load_dwordx3 v[48:50], v0, s[12:15], s43 offen offset:0
    v_mfma_f32_16x16x32_bf16 v[204:207], a[252:255], a[188:191], v[204:207]
    ds_read_b64_tr_b16 a[240:241], v3 offset:33792
    v_mfma_f32_16x16x32_bf16 v[200:203], a[252:255], a[184:187], v[200:203]
    v_add_f32 v15, v15, v12
    v_mfma_f32_16x16x32_bf16 v[200:203], a[248:251], a[160:163], v[200:203]
    ds_read_b64_tr_b16 a[242:243], v3 offset:34304
    v_mfma_f32_16x16x32_bf16 v[196:199], a[248:251], a[156:159], v[196:199]
    v_add_f32 v16, v16, v13
    s_add_u32 s43, s40, 15360
    buffer_load_dwordx3 v[52:54], v0, s[12:15], s43 offen offset:0
    v_mfma_f32_16x16x32_bf16 v[196:199], a[252:255], a[180:183], v[196:199]
    ds_read_b64_tr_b16 a[244:245], v3 offset:46080
    v_mfma_f32_16x16x32_bf16 v[192:195], a[252:255], a[176:179], v[192:195]
    v_add_f32 v244, v14, v244
    v_mfma_f32_16x16x32_bf16 v[192:195], a[248:251], a[152:155], v[192:195]
    ds_read_b64_tr_b16 a[246:247], v3 offset:46592
    v_mfma_f32_16x16x32_bf16 v[188:191], a[248:251], a[148:151], v[188:191]
    v_add_f32 v248, v15, v248
    v_mfma_f32_16x16x32_bf16 v[188:191], a[252:255], a[172:175], v[188:191]
    v_add_f32 v252, v16, v252
    v_mfma_f32_16x16x32_bf16 v[184:187], a[252:255], a[168:171], v[184:187]
    v_mfma_f32_16x16x32_bf16 v[184:187], a[248:251], a[144:147], v[184:187]
    s_waitcnt lgkmcnt(4)
    v_mfma_f32_16x16x32_bf16 a[48:51], v[56:59], a[144:147], a[48:51]
    s_waitcnt vmcnt(23)
    v_lshlrev_b32 v14, 16, v32
    v_mfma_f32_16x16x32_bf16 a[48:51], v[60:63], a[168:171], a[48:51]
    ds_read_b64_tr_b16 a[248:249], v3 offset:34816
    v_mfma_f32_16x16x32_bf16 a[52:55], v[60:63], a[172:175], a[52:55]
    v_and_b32 v15, s36, v32
    v_mfma_f32_16x16x32_bf16 a[52:55], v[56:59], a[148:151], a[52:55]
    ds_read_b64_tr_b16 a[250:251], v3 offset:35328
    v_mfma_f32_16x16x32_bf16 a[56:59], v[56:59], a[152:155], a[56:59]
    buffer_load_dwordx4 a[120:123], v2, s[52:55], s6 offen offset:2048
    v_mfma_f32_16x16x32_bf16 a[56:59], v[60:63], a[176:179], a[56:59]
    ds_read_b64_tr_b16 a[252:253], v3 offset:47104
    v_mfma_f32_16x16x32_bf16 a[60:63], v[60:63], a[180:183], a[60:63]
    v_lshlrev_b32 v16, 16, v33
    v_mfma_f32_16x16x32_bf16 a[60:63], v[56:59], a[156:159], a[60:63]
    ds_read_b64_tr_b16 a[254:255], v3 offset:47616
    v_mfma_f32_16x16x32_bf16 a[64:67], v[56:59], a[160:163], a[64:67]
    buffer_load_dwordx4 a[124:127], v2, s[52:55], s6 offen offset:3072
    v_mfma_f32_16x16x32_bf16 a[64:67], v[60:63], a[184:187], a[64:67]
    v_add_f32 v14, v14, v8
    v_mfma_f32_16x16x32_bf16 a[68:71], v[60:63], a[188:191], a[68:71]
    v_add_f32 v15, v15, v9
    v_mfma_f32_16x16x32_bf16 a[68:71], v[56:59], a[164:167], a[68:71]
    s_mov_b32 s6, 598016
    v_add_f32 v16, v16, v10
    s_waitcnt lgkmcnt(4)
    v_mfma_f32_16x16x32_bf16 v[228:231], a[240:243], a[164:167], v[228:231]
    buffer_load_dwordx4 a[128:131], v2, s[52:55], s6 offen offset:0
    v_mfma_f32_16x16x32_bf16 v[228:231], a[244:247], a[188:191], v[228:231]
    ds_read_b64_tr_b16 v[56:57], v3 offset:35840
    v_mfma_f32_16x16x32_bf16 v[224:227], a[244:247], a[184:187], v[224:227]
    v_add_f32 v88, v14, v88
    v_mfma_f32_16x16x32_bf16 v[224:227], a[240:243], a[160:163], v[224:227]
    ds_read_b64_tr_b16 v[58:59], v3 offset:36352
    v_mfma_f32_16x16x32_bf16 v[220:223], a[240:243], a[156:159], v[220:223]
    buffer_load_dwordx4 a[132:135], v2, s[52:55], s6 offen offset:1024
    v_mfma_f32_16x16x32_bf16 v[220:223], a[244:247], a[180:183], v[220:223]
    ds_read_b64_tr_b16 v[60:61], v3 offset:48128
    v_mfma_f32_16x16x32_bf16 v[216:219], a[244:247], a[176:179], v[216:219]
    v_add_f32 v92, v15, v92
    v_mfma_f32_16x16x32_bf16 v[216:219], a[240:243], a[152:155], v[216:219]
    ds_read_b64_tr_b16 v[62:63], v3 offset:48640
    v_mfma_f32_16x16x32_bf16 v[212:215], a[240:243], a[148:151], v[212:215]
    buffer_load_dwordx4 a[136:139], v2, s[52:55], s6 offen offset:2048
    v_mfma_f32_16x16x32_bf16 v[212:215], a[244:247], a[172:175], v[212:215]
    v_add_f32 v96, v16, v96
    v_mfma_f32_16x16x32_bf16 v[208:211], a[244:247], a[168:171], v[208:211]
    v_and_b32 v14, s36, v33
    v_mfma_f32_16x16x32_bf16 v[208:211], a[240:243], a[144:147], v[208:211]
    v_lshlrev_b32 v15, 16, v34
    s_waitcnt lgkmcnt(0)
    s_barrier
    v_mfma_f32_16x16x32_bf16 v[232:235], a[248:251], a[144:147], v[232:235]
    buffer_load_dwordx4 a[140:143], v2, s[52:55], s6 offen offset:3072
    v_mfma_f32_16x16x32_bf16 v[232:235], a[252:255], a[168:171], v[232:235]
    ds_read_b64_tr_b16 a[240:241], v4 offset:0
    v_mfma_f32_16x16x32_bf16 v[236:239], a[252:255], a[172:175], v[236:239]
    v_and_b32 v16, s36, v34
    v_mfma_f32_16x16x32_bf16 v[236:239], a[248:251], a[148:151], v[236:239]
    ds_read_b64_tr_b16 a[242:243], v4 offset:512
    v_mfma_f32_16x16x32_bf16 v[240:243], a[248:251], a[152:155], v[240:243]
    v_add_f32 v14, v14, v11
    v_mfma_f32_16x16x32_bf16 v[240:243], a[252:255], a[176:179], v[240:243]
    ds_read_b64_tr_b16 a[244:245], v4 offset:12288
    v_mfma_f32_16x16x32_bf16 v[244:247], a[252:255], a[180:183], v[244:247]
    v_add_f32 v15, v15, v12
    v_mfma_f32_16x16x32_bf16 v[244:247], a[248:251], a[156:159], v[244:247]
    ds_read_b64_tr_b16 a[246:247], v4 offset:12800
    v_mfma_f32_16x16x32_bf16 v[248:251], a[248:251], a[160:163], v[248:251]
    v_add_f32 v16, v16, v13
    v_mfma_f32_16x16x32_bf16 v[248:251], a[252:255], a[184:187], v[248:251]
    v_add_f32 v100, v14, v100
    v_mfma_f32_16x16x32_bf16 v[252:255], a[252:255], a[188:191], v[252:255]
    v_add_f32 v104, v15, v104
    v_mfma_f32_16x16x32_bf16 v[252:255], a[248:251], a[164:167], v[252:255]
    v_add_f32 v108, v16, v108
    v_mfma_f32_16x16x32_bf16 a[92:95], v[56:59], a[164:167], a[92:95]
    s_waitcnt vmcnt(28)
    v_lshlrev_b32 v14, 16, v36
    v_mfma_f32_16x16x32_bf16 a[92:95], v[60:63], a[188:191], a[92:95]
    ds_read_b64_tr_b16 a[248:249], v4 offset:1024
    v_mfma_f32_16x16x32_bf16 a[88:91], v[60:63], a[184:187], a[88:91]
    v_and_b32 v15, s36, v36
    v_mfma_f32_16x16x32_bf16 a[88:91], v[56:59], a[160:163], a[88:91]
    ds_read_b64_tr_b16 a[250:251], v4 offset:1536
    v_mfma_f32_16x16x32_bf16 a[84:87], v[56:59], a[156:159], a[84:87]
    v_lshlrev_b32 v16, 16, v37
    v_mfma_f32_16x16x32_bf16 a[84:87], v[60:63], a[180:183], a[84:87]
    ds_read_b64_tr_b16 a[252:253], v4 offset:13312
    v_mfma_f32_16x16x32_bf16 a[80:83], v[60:63], a[176:179], a[80:83]
    v_add_f32 v14, v14, v8
    v_mfma_f32_16x16x32_bf16 a[80:83], v[56:59], a[152:155], a[80:83]
    ds_read_b64_tr_b16 a[254:255], v4 offset:13824
    v_mfma_f32_16x16x32_bf16 a[76:79], v[56:59], a[148:151], a[76:79]
    v_add_f32 v15, v15, v9
    v_mfma_f32_16x16x32_bf16 a[76:79], v[60:63], a[172:175], a[76:79]
    v_add_f32 v16, v16, v10
    v_mfma_f32_16x16x32_bf16 a[72:75], v[60:63], a[168:171], a[72:75]
    v_add_f32 v136, v14, v136
    v_mfma_f32_16x16x32_bf16 a[72:75], v[56:59], a[144:147], a[72:75]
    v_add_f32 v140, v15, v140
    s_waitcnt vmcnt(22)
    s_waitcnt lgkmcnt(4)
    v_mfma_f32_16x16x32_bf16 v[64:67], a[240:243], a[192:195], v[64:67]
    v_add_f32 v144, v16, v144
    v_mfma_f32_16x16x32_bf16 v[64:67], a[244:247], a[216:219], v[64:67]
    ds_read_b64_tr_b16 v[56:57], v4 offset:2048
    v_mfma_f32_16x16x32_bf16 v[68:71], a[244:247], a[220:223], v[68:71]
    v_and_b32 v14, s36, v37
    v_mfma_f32_16x16x32_bf16 v[68:71], a[240:243], a[196:199], v[68:71]
    ds_read_b64_tr_b16 v[58:59], v4 offset:2560
    s_add_u32 m0, s39, 24576
    v_mfma_f32_16x16x32_bf16 v[72:75], a[240:243], a[200:203], v[72:75]
    buffer_load_dwordx4 v1, s[56:59], s4 offen offset:0 nt lds
    v_mfma_f32_16x16x32_bf16 v[72:75], a[244:247], a[224:227], v[72:75]
    ds_read_b64_tr_b16 v[60:61], v4 offset:14336
    v_mfma_f32_16x16x32_bf16 v[76:79], a[244:247], a[228:231], v[76:79]
    v_lshlrev_b32 v15, 16, v38
    v_mfma_f32_16x16x32_bf16 v[76:79], a[240:243], a[204:207], v[76:79]
    ds_read_b64_tr_b16 v[62:63], v4 offset:14848
    s_add_u32 m0, s39, 24576
    v_mfma_f32_16x16x32_bf16 v[80:83], a[240:243], a[208:211], v[80:83]
    buffer_load_dwordx4 v1, s[56:59], s4 offen offset:1024 nt lds
    v_mfma_f32_16x16x32_bf16 v[80:83], a[244:247], a[232:235], v[80:83]
    v_and_b32 v16, s36, v38
    v_mfma_f32_16x16x32_bf16 v[84:87], a[244:247], a[236:239], v[84:87]
    v_add_f32 v14, v14, v11
    v_mfma_f32_16x16x32_bf16 v[84:87], a[240:243], a[212:215], v[84:87]
    s_add_u32 m0, s39, 24576
    v_add_f32 v15, v15, v12
    s_waitcnt lgkmcnt(4)
    v_mfma_f32_16x16x32_bf16 v[108:111], a[248:251], a[212:215], v[108:111]
    buffer_load_dwordx4 v1, s[56:59], s4 offen offset:2048 nt lds
    v_mfma_f32_16x16x32_bf16 v[108:111], a[252:255], a[236:239], v[108:111]
    ds_read_b64_tr_b16 a[240:241], v4 offset:3072
    v_mfma_f32_16x16x32_bf16 v[104:107], a[252:255], a[232:235], v[104:107]
    v_add_f32 v16, v16, v13
    v_mfma_f32_16x16x32_bf16 v[104:107], a[248:251], a[208:211], v[104:107]
    ds_read_b64_tr_b16 a[242:243], v4 offset:3584
    s_add_u32 m0, s39, 36864
    v_mfma_f32_16x16x32_bf16 v[100:103], a[248:251], a[204:207], v[100:103]
    buffer_load_dwordx4 v1, s[60:63], s29 offen offset:0 nt lds
    v_mfma_f32_16x16x32_bf16 v[100:103], a[252:255], a[228:231], v[100:103]
    ds_read_b64_tr_b16 a[244:245], v4 offset:15360
    v_mfma_f32_16x16x32_bf16 v[96:99], a[252:255], a[224:227], v[96:99]
    v_add_f32 v148, v14, v148
    v_mfma_f32_16x16x32_bf16 v[96:99], a[248:251], a[200:203], v[96:99]
    ds_read_b64_tr_b16 a[246:247], v4 offset:15872
    s_add_u32 m0, s39, 36864
    v_mfma_f32_16x16x32_bf16 v[92:95], a[248:251], a[196:199], v[92:95]
    buffer_load_dwordx4 v1, s[60:63], s29 offen offset:1024 nt lds
    v_mfma_f32_16x16x32_bf16 v[92:95], a[252:255], a[220:223], v[92:95]
    v_add_f32 v152, v15, v152
    v_mfma_f32_16x16x32_bf16 v[88:91], a[252:255], a[216:219], v[88:91]
    v_add_f32 v156, v16, v156
    v_mfma_f32_16x16x32_bf16 v[88:91], a[248:251], a[192:195], v[88:91]
    s_add_u32 m0, s39, 36864
    s_waitcnt lgkmcnt(4)
    v_mfma_f32_16x16x32_bf16 a[0:3], v[56:59], a[192:195], a[0:3]
    buffer_load_dwordx4 v1, s[60:63], s29 offen offset:2048 nt lds
    s_waitcnt vmcnt(15)
    v_lshlrev_b32 v14, 16, v40
    v_mfma_f32_16x16x32_bf16 a[0:3], v[60:63], a[216:219], a[0:3]
    ds_read_b64_tr_b16 a[248:249], v4 offset:4096
    v_and_b32 v15, s36, v40
    v_mfma_f32_16x16x32_bf16 a[4:7], v[60:63], a[220:223], a[4:7]
    v_lshlrev_b32 v16, 16, v41
    v_accvgpr_read_b32 v18, a48
    v_mfma_f32_16x16x32_bf16 a[4:7], v[56:59], a[196:199], a[4:7]
    ds_read_b64_tr_b16 a[250:251], v4 offset:4608
    v_accvgpr_read_b32 v19, a52
    v_mfma_f32_16x16x32_bf16 a[8:11], v[56:59], a[200:203], a[8:11]
    v_accvgpr_read_b32 v20, a56
    v_add_f32 v14, v14, v8
    v_mfma_f32_16x16x32_bf16 a[8:11], v[60:63], a[224:227], a[8:11]
    ds_read_b64_tr_b16 a[252:253], v4 offset:16384
    v_add_f32 v15, v15, v9
    v_mfma_f32_16x16x32_bf16 a[12:15], v[60:63], a[228:231], a[12:15]
    v_add_f32 v16, v16, v10
    v_add_f32 v14, v14, v18
    v_mfma_f32_16x16x32_bf16 a[12:15], v[56:59], a[204:207], a[12:15]
    ds_read_b64_tr_b16 a[254:255], v4 offset:16896
    v_add_f32 v15, v15, v19
    v_mfma_f32_16x16x32_bf16 a[16:19], v[56:59], a[208:211], a[16:19]
    v_add_f32 v16, v16, v20
    v_accvgpr_write_b32 a48, v14
    v_mfma_f32_16x16x32_bf16 a[16:19], v[60:63], a[232:235], a[16:19]
    v_accvgpr_write_b32 a52, v15
    v_accvgpr_write_b32 a56, v16
    v_mfma_f32_16x16x32_bf16 a[20:23], v[60:63], a[236:239], a[20:23]
    v_and_b32 v14, s36, v41
    v_lshlrev_b32 v15, 16, v42
    v_mfma_f32_16x16x32_bf16 a[20:23], v[56:59], a[212:215], a[20:23]
    v_and_b32 v16, s36, v42
    v_accvgpr_read_b32 v18, a60
    s_waitcnt lgkmcnt(4)
    v_mfma_f32_16x16x32_bf16 v[132:135], a[240:243], a[212:215], v[132:135]
    v_accvgpr_read_b32 v19, a64
    v_accvgpr_read_b32 v20, a68
    v_mfma_f32_16x16x32_bf16 v[132:135], a[244:247], a[236:239], v[132:135]
    ds_read_b64_tr_b16 v[56:57], v4 offset:5120
    v_add_f32 v14, v14, v11
    v_mfma_f32_16x16x32_bf16 v[128:131], a[244:247], a[232:235], v[128:131]
    v_add_f32 v15, v15, v12
    v_add_f32 v16, v16, v13
    v_mfma_f32_16x16x32_bf16 v[128:131], a[240:243], a[208:211], v[128:131]
    ds_read_b64_tr_b16 v[58:59], v4 offset:5632
    v_add_f32 v14, v14, v18
    v_mfma_f32_16x16x32_bf16 v[124:127], a[240:243], a[204:207], v[124:127]
    v_add_f32 v15, v15, v19
    v_add_f32 v16, v16, v20
    v_mfma_f32_16x16x32_bf16 v[124:127], a[244:247], a[228:231], v[124:127]
    ds_read_b64_tr_b16 v[60:61], v4 offset:17408
    v_accvgpr_write_b32 a60, v14
    v_mfma_f32_16x16x32_bf16 v[120:123], a[244:247], a[224:227], v[120:123]
    v_accvgpr_write_b32 a64, v15
    v_accvgpr_write_b32 a68, v16
    v_mfma_f32_16x16x32_bf16 v[120:123], a[240:243], a[200:203], v[120:123]
    ds_read_b64_tr_b16 v[62:63], v4 offset:17920
    v_mfma_f32_16x16x32_bf16 v[116:119], a[240:243], a[196:199], v[116:119]
    v_mfma_f32_16x16x32_bf16 v[116:119], a[244:247], a[220:223], v[116:119]
    v_mfma_f32_16x16x32_bf16 v[112:115], a[244:247], a[216:219], v[112:115]
    v_mfma_f32_16x16x32_bf16 v[112:115], a[240:243], a[192:195], v[112:115]
    s_waitcnt lgkmcnt(4)
    v_mfma_f32_16x16x32_bf16 v[136:139], a[248:251], a[192:195], v[136:139]
    v_mfma_f32_16x16x32_bf16 v[136:139], a[252:255], a[216:219], v[136:139]
    ds_read_b64_tr_b16 a[240:241], v4 offset:6144
    v_mfma_f32_16x16x32_bf16 v[140:143], a[252:255], a[220:223], v[140:143]
    v_mfma_f32_16x16x32_bf16 v[140:143], a[248:251], a[196:199], v[140:143]
    ds_read_b64_tr_b16 a[242:243], v4 offset:6656
    s_mov_b32 s6, 638976
    v_mfma_f32_16x16x32_bf16 v[144:147], a[248:251], a[200:203], v[144:147]
    buffer_load_dwordx4 a[144:147], v2, s[52:55], s6 offen offset:0
    v_mfma_f32_16x16x32_bf16 v[144:147], a[252:255], a[224:227], v[144:147]
    ds_read_b64_tr_b16 a[244:245], v4 offset:18432
    v_mfma_f32_16x16x32_bf16 v[148:151], a[252:255], a[228:231], v[148:151]
    v_mfma_f32_16x16x32_bf16 v[148:151], a[248:251], a[204:207], v[148:151]
    ds_read_b64_tr_b16 a[246:247], v4 offset:18944
    v_mfma_f32_16x16x32_bf16 v[152:155], a[248:251], a[208:211], v[152:155]
    buffer_load_dwordx4 a[148:151], v2, s[52:55], s6 offen offset:1024
    v_mfma_f32_16x16x32_bf16 v[152:155], a[252:255], a[232:235], v[152:155]
    v_mfma_f32_16x16x32_bf16 v[156:159], a[252:255], a[236:239], v[156:159]
    v_mfma_f32_16x16x32_bf16 v[156:159], a[248:251], a[212:215], v[156:159]
    s_waitcnt lgkmcnt(4)
    v_mfma_f32_16x16x32_bf16 a[44:47], v[56:59], a[212:215], a[44:47]
    buffer_load_dwordx4 a[152:155], v2, s[52:55], s6 offen offset:2048
    s_waitcnt vmcnt(17)
    v_lshlrev_b32 v14, 16, v44
    v_mfma_f32_16x16x32_bf16 a[44:47], v[60:63], a[236:239], a[44:47]
    ds_read_b64_tr_b16 a[248:249], v4 offset:7168
    v_and_b32 v15, s36, v44
    v_mfma_f32_16x16x32_bf16 a[40:43], v[60:63], a[232:235], a[40:43]
    v_lshlrev_b32 v16, 16, v45
    v_accvgpr_read_b32 v18, a72
    v_mfma_f32_16x16x32_bf16 a[40:43], v[56:59], a[208:211], a[40:43]
    ds_read_b64_tr_b16 a[250:251], v4 offset:7680
    v_accvgpr_read_b32 v19, a76
    v_mfma_f32_16x16x32_bf16 a[36:39], v[56:59], a[204:207], a[36:39]
    buffer_load_dwordx4 a[156:159], v2, s[52:55], s6 offen offset:3072
    v_accvgpr_read_b32 v20, a80
    v_mfma_f32_16x16x32_bf16 a[36:39], v[60:63], a[228:231], a[36:39]
    ds_read_b64_tr_b16 a[252:253], v4 offset:19456
    v_add_f32 v14, v14, v8
    v_mfma_f32_16x16x32_bf16 a[32:35], v[60:63], a[224:227], a[32:35]
    v_add_f32 v15, v15, v9
    v_add_f32 v16, v16, v10
    v_mfma_f32_16x16x32_bf16 a[32:35], v[56:59], a[200:203], a[32:35]
    ds_read_b64_tr_b16 a[254:255], v4 offset:19968
    s_mov_b32 s6, 643072
    v_add_f32 v14, v14, v18
    v_mfma_f32_16x16x32_bf16 a[28:31], v[56:59], a[196:199], a[28:31]
    buffer_load_dwordx4 a[160:163], v2, s[52:55], s6 offen offset:0
    v_add_f32 v15, v15, v19
    v_mfma_f32_16x16x32_bf16 a[28:31], v[60:63], a[220:223], a[28:31]
    v_add_f32 v16, v16, v20
    v_accvgpr_write_b32 a72, v14
    v_mfma_f32_16x16x32_bf16 a[24:27], v[60:63], a[216:219], a[24:27]
    v_accvgpr_write_b32 a76, v15
    v_accvgpr_write_b32 a80, v16
    v_mfma_f32_16x16x32_bf16 a[24:27], v[56:59], a[192:195], a[24:27]
    v_and_b32 v14, s36, v45
    v_lshlrev_b32 v15, 16, v46
    s_waitcnt lgkmcnt(4)
    v_mfma_f32_16x16x32_bf16 v[160:163], a[240:243], a[192:195], v[160:163]
    buffer_load_dwordx4 a[164:167], v2, s[52:55], s6 offen offset:1024
    v_and_b32 v16, s36, v46
    v_mfma_f32_16x16x32_bf16 v[160:163], a[244:247], a[216:219], v[160:163]
    ds_read_b64_tr_b16 v[56:57], v4 offset:8192
    v_accvgpr_read_b32 v18, a84
    v_mfma_f32_16x16x32_bf16 v[164:167], a[244:247], a[220:223], v[164:167]
    v_accvgpr_read_b32 v19, a88
    v_accvgpr_read_b32 v20, a92
    v_mfma_f32_16x16x32_bf16 v[164:167], a[240:243], a[196:199], v[164:167]
    ds_read_b64_tr_b16 v[58:59], v4 offset:8704
    v_add_f32 v14, v14, v11
    v_mfma_f32_16x16x32_bf16 v[168:171], a[240:243], a[200:203], v[168:171]
    v_add_f32 v15, v15, v12
    v_add_f32 v16, v16, v13
    s_add_u32 s43, s40, 73728
    buffer_load_dwordx3 v[24:26], v0, s[12:15], s43 offen offset:768
    v_mfma_f32_16x16x32_bf16 v[168:171], a[244:247], a[224:227], v[168:171]
    ds_read_b64_tr_b16 v[60:61], v4 offset:20480
    v_add_f32 v14, v14, v18
    v_mfma_f32_16x16x32_bf16 v[172:175], a[244:247], a[228:231], v[172:175]
    v_add_f32 v15, v15, v19
    v_add_f32 v16, v16, v20
    v_mfma_f32_16x16x32_bf16 v[172:175], a[240:243], a[204:207], v[172:175]
    ds_read_b64_tr_b16 v[62:63], v4 offset:20992
    v_accvgpr_write_b32 a84, v14
    v_mfma_f32_16x16x32_bf16 v[176:179], a[240:243], a[208:211], v[176:179]
    v_accvgpr_write_b32 a88, v15
    v_accvgpr_write_b32 a92, v16
    v_mfma_f32_16x16x32_bf16 v[176:179], a[244:247], a[232:235], v[176:179]
    s_add_u32 s43, s40, 82944
    buffer_load_dwordx3 v[28:30], v0, s[12:15], s43 offen offset:768
    v_mfma_f32_16x16x32_bf16 v[180:183], a[244:247], a[236:239], v[180:183]
    v_mfma_f32_16x16x32_bf16 v[180:183], a[240:243], a[212:215], v[180:183]
    s_waitcnt lgkmcnt(4)
    v_mfma_f32_16x16x32_bf16 v[204:207], a[248:251], a[212:215], v[204:207]
    s_add_u32 s43, s40, 0
    buffer_load_dwordx3 v[32:34], v0, s[12:15], s43 offen offset:768
    v_mfma_f32_16x16x32_bf16 v[204:207], a[252:255], a[236:239], v[204:207]
    ds_read_b64_tr_b16 a[240:241], v4 offset:9216
    v_mfma_f32_16x16x32_bf16 v[200:203], a[252:255], a[232:235], v[200:203]
    v_mfma_f32_16x16x32_bf16 v[200:203], a[248:251], a[208:211], v[200:203]
    ds_read_b64_tr_b16 a[242:243], v4 offset:9728
    v_mfma_f32_16x16x32_bf16 v[196:199], a[248:251], a[204:207], v[196:199]
    s_add_u32 s43, s40, 9216
    buffer_load_dwordx3 v[36:38], v0, s[12:15], s43 offen offset:768
    v_mfma_f32_16x16x32_bf16 v[196:199], a[252:255], a[228:231], v[196:199]
    ds_read_b64_tr_b16 a[244:245], v4 offset:21504
    v_mfma_f32_16x16x32_bf16 v[192:195], a[252:255], a[224:227], v[192:195]
    v_mfma_f32_16x16x32_bf16 v[192:195], a[248:251], a[200:203], v[192:195]
    ds_read_b64_tr_b16 a[246:247], v4 offset:22016
    v_mfma_f32_16x16x32_bf16 v[188:191], a[248:251], a[196:199], v[188:191]
    v_mfma_f32_16x16x32_bf16 v[188:191], a[252:255], a[220:223], v[188:191]
    v_mfma_f32_16x16x32_bf16 v[184:187], a[252:255], a[216:219], v[184:187]
    v_mfma_f32_16x16x32_bf16 v[184:187], a[248:251], a[192:195], v[184:187]
    s_waitcnt lgkmcnt(4)
    v_mfma_f32_16x16x32_bf16 a[48:51], v[56:59], a[192:195], a[48:51]
    s_waitcnt vmcnt(23)
    v_lshlrev_b32 v14, 16, v48
    v_and_b32 v15, s36, v48
    v_mfma_f32_16x16x32_bf16 a[48:51], v[60:63], a[216:219], a[48:51]
    ds_read_b64_tr_b16 a[248:249], v4 offset:10240
    v_lshlrev_b32 v16, 16, v49
    v_mfma_f32_16x16x32_bf16 a[52:55], v[60:63], a[220:223], a[52:55]
    v_accvgpr_read_b32 v18, a0
    v_accvgpr_read_b32 v19, a4
    v_mfma_f32_16x16x32_bf16 a[52:55], v[56:59], a[196:199], a[52:55]
    ds_read_b64_tr_b16 a[250:251], v4 offset:10752
    v_accvgpr_read_b32 v20, a8
    v_mfma_f32_16x16x32_bf16 a[56:59], v[56:59], a[200:203], a[56:59]
    buffer_load_dwordx4 a[168:171], v2, s[52:55], s6 offen offset:2048
    v_add_f32 v14, v14, v8
    v_mfma_f32_16x16x32_bf16 a[56:59], v[60:63], a[224:227], a[56:59]
    ds_read_b64_tr_b16 a[252:253], v4 offset:22528
    v_add_f32 v15, v15, v9
    v_mfma_f32_16x16x32_bf16 a[60:63], v[60:63], a[228:231], a[60:63]
    v_add_f32 v16, v16, v10
    v_add_f32 v14, v14, v18
    v_mfma_f32_16x16x32_bf16 a[60:63], v[56:59], a[204:207], a[60:63]
    ds_read_b64_tr_b16 a[254:255], v4 offset:23040
    v_add_f32 v15, v15, v19
    v_mfma_f32_16x16x32_bf16 a[64:67], v[56:59], a[208:211], a[64:67]
    buffer_load_dwordx4 a[172:175], v2, s[52:55], s6 offen offset:3072
    v_add_f32 v16, v16, v20
    v_mfma_f32_16x16x32_bf16 a[64:67], v[60:63], a[232:235], a[64:67]
    v_accvgpr_write_b32 a0, v14
    v_accvgpr_write_b32 a4, v15
    v_mfma_f32_16x16x32_bf16 a[68:71], v[60:63], a[236:239], a[68:71]
    v_accvgpr_write_b32 a8, v16
    v_and_b32 v14, s36, v49
    v_mfma_f32_16x16x32_bf16 a[68:71], v[56:59], a[212:215], a[68:71]
    s_mov_b32 s6, 647168
    v_lshlrev_b32 v15, 16, v50
    v_and_b32 v16, s36, v50
    s_waitcnt lgkmcnt(4)
    v_mfma_f32_16x16x32_bf16 v[228:231], a[240:243], a[212:215], v[228:231]
    buffer_load_dwordx4 a[176:179], v2, s[52:55], s6 offen offset:0
    v_accvgpr_read_b32 v18, a12
    v_mfma_f32_16x16x32_bf16 v[228:231], a[244:247], a[236:239], v[228:231]
    ds_read_b64_tr_b16 v[56:57], v4 offset:11264
    v_accvgpr_read_b32 v19, a16
    v_mfma_f32_16x16x32_bf16 v[224:227], a[244:247], a[232:235], v[224:227]
    v_accvgpr_read_b32 v20, a20
    v_add_f32 v14, v14, v11
    v_mfma_f32_16x16x32_bf16 v[224:227], a[240:243], a[208:211], v[224:227]
    ds_read_b64_tr_b16 v[58:59], v4 offset:11776
    v_add_f32 v15, v15, v12
    v_mfma_f32_16x16x32_bf16 v[220:223], a[240:243], a[204:207], v[220:223]
    buffer_load_dwordx4 a[180:183], v2, s[52:55], s6 offen offset:1024
    v_add_f32 v16, v16, v13
    v_mfma_f32_16x16x32_bf16 v[220:223], a[244:247], a[228:231], v[220:223]
    ds_read_b64_tr_b16 v[60:61], v4 offset:23552
    v_add_f32 v14, v14, v18
    v_mfma_f32_16x16x32_bf16 v[216:219], a[244:247], a[224:227], v[216:219]
    v_add_f32 v15, v15, v19
    v_add_f32 v16, v16, v20
    v_mfma_f32_16x16x32_bf16 v[216:219], a[240:243], a[200:203], v[216:219]
    ds_read_b64_tr_b16 v[62:63], v4 offset:24064
    v_accvgpr_write_b32 a12, v14
    v_mfma_f32_16x16x32_bf16 v[212:215], a[240:243], a[196:199], v[212:215]
    buffer_load_dwordx4 a[184:187], v2, s[52:55], s6 offen offset:2048
    v_accvgpr_write_b32 a16, v15
    v_mfma_f32_16x16x32_bf16 v[212:215], a[244:247], a[220:223], v[212:215]
    v_accvgpr_write_b32 a20, v16
    v_mfma_f32_16x16x32_bf16 v[208:211], a[244:247], a[216:219], v[208:211]
    v_mfma_f32_16x16x32_bf16 v[208:211], a[240:243], a[192:195], v[208:211]
    s_waitcnt lgkmcnt(0)
    s_barrier
    v_mfma_f32_16x16x32_bf16 v[232:235], a[248:251], a[192:195], v[232:235]
    buffer_load_dwordx4 a[188:191], v2, s[52:55], s6 offen offset:3072
    v_mfma_f32_16x16x32_bf16 v[232:235], a[252:255], a[216:219], v[232:235]
    ds_read_b64_tr_b16 a[240:241], v3 offset:0
    v_mfma_f32_16x16x32_bf16 v[236:239], a[252:255], a[220:223], v[236:239]
    v_mfma_f32_16x16x32_bf16 v[236:239], a[248:251], a[196:199], v[236:239]
    ds_read_b64_tr_b16 a[242:243], v3 offset:512
    v_mfma_f32_16x16x32_bf16 v[240:243], a[248:251], a[200:203], v[240:243]
    v_mfma_f32_16x16x32_bf16 v[240:243], a[252:255], a[224:227], v[240:243]
    ds_read_b64_tr_b16 a[244:245], v3 offset:12288
    v_mfma_f32_16x16x32_bf16 v[244:247], a[252:255], a[228:231], v[244:247]
    v_mfma_f32_16x16x32_bf16 v[244:247], a[248:251], a[204:207], v[244:247]
    ds_read_b64_tr_b16 a[246:247], v3 offset:12800
    v_mfma_f32_16x16x32_bf16 v[248:251], a[248:251], a[208:211], v[248:251]
    v_mfma_f32_16x16x32_bf16 v[248:251], a[252:255], a[232:235], v[248:251]
    v_mfma_f32_16x16x32_bf16 v[252:255], a[252:255], a[236:239], v[252:255]
    v_mfma_f32_16x16x32_bf16 v[252:255], a[248:251], a[212:215], v[252:255]
    v_mfma_f32_16x16x32_bf16 a[92:95], v[56:59], a[212:215], a[92:95]
    s_waitcnt vmcnt(28)
    v_lshlrev_b32 v14, 16, v52
    v_and_b32 v15, s36, v52
    v_mfma_f32_16x16x32_bf16 a[92:95], v[60:63], a[236:239], a[92:95]
    ds_read_b64_tr_b16 a[248:249], v3 offset:1024
    v_lshlrev_b32 v16, 16, v53
    v_mfma_f32_16x16x32_bf16 a[88:91], v[60:63], a[232:235], a[88:91]
    v_accvgpr_read_b32 v18, a24
    v_accvgpr_read_b32 v19, a28
    v_mfma_f32_16x16x32_bf16 a[88:91], v[56:59], a[208:211], a[88:91]
    ds_read_b64_tr_b16 a[250:251], v3 offset:1536
    v_accvgpr_read_b32 v20, a32
    v_mfma_f32_16x16x32_bf16 a[84:87], v[56:59], a[204:207], a[84:87]
    v_add_f32 v14, v14, v8
    v_add_f32 v15, v15, v9
    v_mfma_f32_16x16x32_bf16 a[84:87], v[60:63], a[228:231], a[84:87]
    ds_read_b64_tr_b16 a[252:253], v3 offset:13312
    v_add_f32 v16, v16, v10
    v_mfma_f32_16x16x32_bf16 a[80:83], v[60:63], a[224:227], a[80:83]
    v_add_f32 v14, v14, v18
    v_add_f32 v15, v15, v19
    v_mfma_f32_16x16x32_bf16 a[80:83], v[56:59], a[200:203], a[80:83]
    ds_read_b64_tr_b16 a[254:255], v3 offset:13824
    v_add_f32 v16, v16, v20
    v_mfma_f32_16x16x32_bf16 a[76:79], v[56:59], a[196:199], a[76:79]
    v_accvgpr_write_b32 a24, v14
    v_accvgpr_write_b32 a28, v15
    v_mfma_f32_16x16x32_bf16 a[76:79], v[60:63], a[220:223], a[76:79]
    v_accvgpr_write_b32 a32, v16
    v_and_b32 v14, s36, v53
    v_mfma_f32_16x16x32_bf16 a[72:75], v[60:63], a[216:219], a[72:75]
    v_lshlrev_b32 v15, 16, v54
    v_and_b32 v16, s36, v54
    v_mfma_f32_16x16x32_bf16 a[72:75], v[56:59], a[192:195], a[72:75]
    v_accvgpr_read_b32 v18, a36
    v_accvgpr_read_b32 v19, a40
    s_waitcnt vmcnt(22)
    s_waitcnt lgkmcnt(4)
    v_mfma_f32_16x16x32_bf16 v[64:67], a[240:243], a[96:99], v[64:67]
    v_accvgpr_read_b32 v20, a44
    v_add_f32 v14, v14, v11
    v_mfma_f32_16x16x32_bf16 v[64:67], a[244:247], a[120:123], v[64:67]
    ds_read_b64_tr_b16 v[56:57], v3 offset:2048
    v_add_f32 v15, v15, v12
    v_mfma_f32_16x16x32_bf16 v[68:71], a[244:247], a[124:127], v[68:71]
    s_add_u32 s4, s4, 36864
    v_add_f32 v16, v16, v13
    v_add_f32 v14, v14, v18
    v_mfma_f32_16x16x32_bf16 v[68:71], a[240:243], a[100:103], v[68:71]
    ds_read_b64_tr_b16 v[58:59], v3 offset:2560
    s_add_u32 s29, s29, 12288
    s_add_u32 s5, s4, 4096
    s_add_u32 m0, s32, 49152
    v_add_f32 v15, v15, v19
    v_mfma_f32_16x16x32_bf16 v[72:75], a[240:243], a[104:107], v[72:75]
    buffer_load_dwordx4 v1, s[8:11], s4 offen offset:0 nt lds
    v_add_f32 v16, v16, v20
    v_mfma_f32_16x16x32_bf16 v[72:75], a[244:247], a[128:131], v[72:75]
    ds_read_b64_tr_b16 v[60:61], v3 offset:14336
    v_accvgpr_write_b32 a36, v14
    v_mfma_f32_16x16x32_bf16 v[76:79], a[244:247], a[132:135], v[76:79]
    v_accvgpr_write_b32 a40, v15
    v_accvgpr_write_b32 a44, v16
    v_mfma_f32_16x16x32_bf16 v[76:79], a[240:243], a[108:111], v[76:79]
    ds_read_b64_tr_b16 v[62:63], v3 offset:14848
    s_add_u32 m0, s32, 49152
    v_mfma_f32_16x16x32_bf16 v[80:83], a[240:243], a[112:115], v[80:83]
    buffer_load_dwordx4 v1, s[8:11], s4 offen offset:1024 nt lds
    v_mfma_f32_16x16x32_bf16 v[80:83], a[244:247], a[136:139], v[80:83]
    v_mfma_f32_16x16x32_bf16 v[84:87], a[244:247], a[140:143], v[84:87]
    v_mfma_f32_16x16x32_bf16 v[84:87], a[240:243], a[116:119], v[84:87]
    s_add_u32 m0, s32, 49152
    s_waitcnt lgkmcnt(4)
    v_mfma_f32_16x16x32_bf16 v[108:111], a[248:251], a[116:119], v[108:111]
    buffer_load_dwordx4 v1, s[8:11], s4 offen offset:2048 nt lds
    v_mfma_f32_16x16x32_bf16 v[108:111], a[252:255], a[140:143], v[108:111]
    ds_read_b64_tr_b16 a[240:241], v3 offset:3072
    v_mfma_f32_16x16x32_bf16 v[104:107], a[252:255], a[136:139], v[104:107]
    v_mfma_f32_16x16x32_bf16 v[104:107], a[248:251], a[112:115], v[104:107]
    ds_read_b64_tr_b16 a[242:243], v3 offset:3584
    s_add_u32 m0, s32, 49152
    v_mfma_f32_16x16x32_bf16 v[100:103], a[248:251], a[108:111], v[100:103]
    buffer_load_dwordx4 v1, s[8:11], s4 offen offset:3072 nt lds
    v_mfma_f32_16x16x32_bf16 v[100:103], a[252:255], a[132:135], v[100:103]
    ds_read_b64_tr_b16 a[244:245], v3 offset:15360
    v_mfma_f32_16x16x32_bf16 v[96:99], a[252:255], a[128:131], v[96:99]
    v_mfma_f32_16x16x32_bf16 v[96:99], a[248:251], a[104:107], v[96:99]
    ds_read_b64_tr_b16 a[246:247], v3 offset:15872
    s_add_u32 m0, s32, 53248
    v_mfma_f32_16x16x32_bf16 v[92:95], a[248:251], a[100:103], v[92:95]
    buffer_load_dwordx4 v1, s[8:11], s5 offen offset:0 nt lds
    v_mfma_f32_16x16x32_bf16 v[92:95], a[252:255], a[124:127], v[92:95]
    v_mfma_f32_16x16x32_bf16 v[88:91], a[252:255], a[120:123], v[88:91]
    v_mfma_f32_16x16x32_bf16 v[88:91], a[248:251], a[96:99], v[88:91]
    s_add_u32 m0, s32, 53248
    s_waitcnt lgkmcnt(4)
    v_mfma_f32_16x16x32_bf16 a[0:3], v[56:59], a[96:99], a[0:3]
    buffer_load_dwordx4 v1, s[8:11], s5 offen offset:1024 nt lds
    v_mfma_f32_16x16x32_bf16 a[0:3], v[60:63], a[120:123], a[0:3]
    ds_read_b64_tr_b16 a[248:249], v3 offset:4096
    v_mfma_f32_16x16x32_bf16 a[4:7], v[60:63], a[124:127], a[4:7]
    s_waitcnt vmcnt(15)
    v_lshlrev_b32 v14, 16, v24
    v_mfma_f32_16x16x32_bf16 a[4:7], v[56:59], a[100:103], a[4:7]
    ds_read_b64_tr_b16 a[250:251], v3 offset:4608
    v_mfma_f32_16x16x32_bf16 a[8:11], v[56:59], a[104:107], a[8:11]
    v_and_b32 v15, s36, v24
    v_mfma_f32_16x16x32_bf16 a[8:11], v[60:63], a[128:131], a[8:11]
    ds_read_b64_tr_b16 a[252:253], v3 offset:16384
    v_mfma_f32_16x16x32_bf16 a[12:15], v[60:63], a[132:135], a[12:15]
    v_lshlrev_b32 v16, 16, v25
    v_mfma_f32_16x16x32_bf16 a[12:15], v[56:59], a[108:111], a[12:15]
    ds_read_b64_tr_b16 a[254:255], v3 offset:16896
    v_mfma_f32_16x16x32_bf16 a[16:19], v[56:59], a[112:115], a[16:19]
    v_add_f32 v14, v14, v8
    v_mfma_f32_16x16x32_bf16 a[16:19], v[60:63], a[136:139], a[16:19]
    v_add_f32 v15, v15, v9
    v_mfma_f32_16x16x32_bf16 a[20:23], v[60:63], a[140:143], a[20:23]
    v_add_f32 v16, v16, v10
    v_mfma_f32_16x16x32_bf16 a[20:23], v[56:59], a[116:119], a[20:23]
    v_add_f32 v161, v14, v161
    s_waitcnt lgkmcnt(4)
    v_mfma_f32_16x16x32_bf16 v[132:135], a[240:243], a[116:119], v[132:135]
    v_add_f32 v165, v15, v165
    v_mfma_f32_16x16x32_bf16 v[132:135], a[244:247], a[140:143], v[132:135]
    ds_read_b64_tr_b16 v[56:57], v3 offset:5120
    v_mfma_f32_16x16x32_bf16 v[128:131], a[244:247], a[136:139], v[128:131]
    v_add_f32 v169, v16, v169
    v_mfma_f32_16x16x32_bf16 v[128:131], a[240:243], a[112:115], v[128:131]
    ds_read_b64_tr_b16 v[58:59], v3 offset:5632
    v_mfma_f32_16x16x32_bf16 v[124:127], a[240:243], a[108:111], v[124:127]
    v_and_b32 v14, s36, v25
    v_mfma_f32_16x16x32_bf16 v[124:127], a[244:247], a[132:135], v[124:127]
    ds_read_b64_tr_b16 v[60:61], v3 offset:17408
    v_mfma_f32_16x16x32_bf16 v[120:123], a[244:247], a[128:131], v[120:123]
    v_lshlrev_b32 v15, 16, v26
    v_mfma_f32_16x16x32_bf16 v[120:123], a[240:243], a[104:107], v[120:123]
    ds_read_b64_tr_b16 v[62:63], v3 offset:17920
    v_mfma_f32_16x16x32_bf16 v[116:119], a[240:243], a[100:103], v[116:119]
    v_and_b32 v16, s36, v26
    v_mfma_f32_16x16x32_bf16 v[116:119], a[244:247], a[124:127], v[116:119]
    v_add_f32 v14, v14, v11
    v_mfma_f32_16x16x32_bf16 v[112:115], a[244:247], a[120:123], v[112:115]
    v_add_f32 v15, v15, v12
    v_mfma_f32_16x16x32_bf16 v[112:115], a[240:243], a[96:99], v[112:115]
    v_add_f32 v16, v16, v13
    s_waitcnt lgkmcnt(4)
    v_mfma_f32_16x16x32_bf16 v[136:139], a[248:251], a[96:99], v[136:139]
    v_add_f32 v173, v14, v173
    v_mfma_f32_16x16x32_bf16 v[136:139], a[252:255], a[120:123], v[136:139]
    ds_read_b64_tr_b16 a[240:241], v3 offset:6144
    v_mfma_f32_16x16x32_bf16 v[140:143], a[252:255], a[124:127], v[140:143]
    v_add_f32 v177, v15, v177
    v_mfma_f32_16x16x32_bf16 v[140:143], a[248:251], a[100:103], v[140:143]
    ds_read_b64_tr_b16 a[242:243], v3 offset:6656
    s_mov_b32 s6, 688128
    v_mfma_f32_16x16x32_bf16 v[144:147], a[248:251], a[104:107], v[144:147]
    buffer_load_dwordx4 a[192:195], v2, s[52:55], s6 offen offset:0
    v_mfma_f32_16x16x32_bf16 v[144:147], a[252:255], a[128:131], v[144:147]
    ds_read_b64_tr_b16 a[244:245], v3 offset:18432
    v_mfma_f32_16x16x32_bf16 v[148:151], a[252:255], a[132:135], v[148:151]
    v_add_f32 v181, v16, v181
    v_mfma_f32_16x16x32_bf16 v[148:151], a[248:251], a[108:111], v[148:151]
    ds_read_b64_tr_b16 a[246:247], v3 offset:18944
    v_mfma_f32_16x16x32_bf16 v[152:155], a[248:251], a[112:115], v[152:155]
    buffer_load_dwordx4 a[196:199], v2, s[52:55], s6 offen offset:1024
    v_mfma_f32_16x16x32_bf16 v[152:155], a[252:255], a[136:139], v[152:155]
    v_mfma_f32_16x16x32_bf16 v[156:159], a[252:255], a[140:143], v[156:159]
    v_mfma_f32_16x16x32_bf16 v[156:159], a[248:251], a[116:119], v[156:159]
    s_waitcnt lgkmcnt(4)
    v_mfma_f32_16x16x32_bf16 a[44:47], v[56:59], a[116:119], a[44:47]
    buffer_load_dwordx4 a[200:203], v2, s[52:55], s6 offen offset:2048
    v_mfma_f32_16x16x32_bf16 a[44:47], v[60:63], a[140:143], a[44:47]
    ds_read_b64_tr_b16 a[248:249], v3 offset:7168
    v_mfma_f32_16x16x32_bf16 a[40:43], v[60:63], a[136:139], a[40:43]
    s_waitcnt vmcnt(17)
    v_lshlrev_b32 v14, 16, v28
    v_mfma_f32_16x16x32_bf16 a[40:43], v[56:59], a[112:115], a[40:43]
    ds_read_b64_tr_b16 a[250:251], v3 offset:7680
    v_mfma_f32_16x16x32_bf16 a[36:39], v[56:59], a[108:111], a[36:39]
    buffer_load_dwordx4 a[204:207], v2, s[52:55], s6 offen offset:3072
    v_mfma_f32_16x16x32_bf16 a[36:39], v[60:63], a[132:135], a[36:39]
    ds_read_b64_tr_b16 a[252:253], v3 offset:19456
    v_mfma_f32_16x16x32_bf16 a[32:35], v[60:63], a[128:131], a[32:35]
    v_and_b32 v15, s36, v28
    v_mfma_f32_16x16x32_bf16 a[32:35], v[56:59], a[104:107], a[32:35]
    ds_read_b64_tr_b16 a[254:255], v3 offset:19968
    s_mov_b32 s6, 692224
    v_mfma_f32_16x16x32_bf16 a[28:31], v[56:59], a[100:103], a[28:31]
    buffer_load_dwordx4 a[208:211], v2, s[52:55], s6 offen offset:0
    v_mfma_f32_16x16x32_bf16 a[28:31], v[60:63], a[124:127], a[28:31]
    v_lshlrev_b32 v16, 16, v29
    v_mfma_f32_16x16x32_bf16 a[24:27], v[60:63], a[120:123], a[24:27]
    v_add_f32 v14, v14, v8
    v_mfma_f32_16x16x32_bf16 a[24:27], v[56:59], a[96:99], a[24:27]
    v_add_f32 v15, v15, v9
    s_waitcnt lgkmcnt(4)
    v_mfma_f32_16x16x32_bf16 v[160:163], a[240:243], a[96:99], v[160:163]
    buffer_load_dwordx4 a[212:215], v2, s[52:55], s6 offen offset:1024
    v_mfma_f32_16x16x32_bf16 v[160:163], a[244:247], a[120:123], v[160:163]
    ds_read_b64_tr_b16 v[56:57], v3 offset:8192
    v_mfma_f32_16x16x32_bf16 v[164:167], a[244:247], a[124:127], v[164:167]
    v_add_f32 v16, v16, v10
    v_mfma_f32_16x16x32_bf16 v[164:167], a[240:243], a[100:103], v[164:167]
    ds_read_b64_tr_b16 v[58:59], v3 offset:8704
    v_mfma_f32_16x16x32_bf16 v[168:171], a[240:243], a[104:107], v[168:171]
    v_add_f32 v209, v14, v209
    s_add_u32 s43, s40, 76800
    buffer_load_dwordx3 v[40:42], v0, s[12:15], s43 offen offset:768
    v_mfma_f32_16x16x32_bf16 v[168:171], a[244:247], a[128:131], v[168:171]
    ds_read_b64_tr_b16 v[60:61], v3 offset:20480
    v_mfma_f32_16x16x32_bf16 v[172:175], a[244:247], a[132:135], v[172:175]
    v_add_f32 v213, v15, v213
    v_mfma_f32_16x16x32_bf16 v[172:175], a[240:243], a[108:111], v[172:175]
    ds_read_b64_tr_b16 v[62:63], v3 offset:20992
    v_mfma_f32_16x16x32_bf16 v[176:179], a[240:243], a[112:115], v[176:179]
    v_add_f32 v217, v16, v217
    s_add_u32 s43, s40, 86016
    buffer_load_dwordx3 v[44:46], v0, s[12:15], s43 offen offset:768
    v_mfma_f32_16x16x32_bf16 v[176:179], a[244:247], a[136:139], v[176:179]
    v_and_b32 v14, s36, v29
    v_mfma_f32_16x16x32_bf16 v[180:183], a[244:247], a[140:143], v[180:183]
    v_lshlrev_b32 v15, 16, v30
    v_mfma_f32_16x16x32_bf16 v[180:183], a[240:243], a[116:119], v[180:183]
    v_and_b32 v16, s36, v30
    s_waitcnt lgkmcnt(4)
    v_mfma_f32_16x16x32_bf16 v[204:207], a[248:251], a[116:119], v[204:207]
    v_add_f32 v14, v14, v11
    s_add_u32 s43, s40, 3072
    buffer_load_dwordx3 v[48:50], v0, s[12:15], s43 offen offset:768
    v_mfma_f32_16x16x32_bf16 v[204:207], a[252:255], a[140:143], v[204:207]
    ds_read_b64_tr_b16 a[240:241], v3 offset:9216
    v_mfma_f32_16x16x32_bf16 v[200:203], a[252:255], a[136:139], v[200:203]
    v_add_f32 v15, v15, v12
    v_mfma_f32_16x16x32_bf16 v[200:203], a[248:251], a[112:115], v[200:203]
    ds_read_b64_tr_b16 a[242:243], v3 offset:9728
    v_mfma_f32_16x16x32_bf16 v[196:199], a[248:251], a[108:111], v[196:199]
    v_add_f32 v16, v16, v13
    s_add_u32 s43, s40, 12288
    buffer_load_dwordx3 v[52:54], v0, s[12:15], s43 offen offset:768
    v_mfma_f32_16x16x32_bf16 v[196:199], a[252:255], a[132:135], v[196:199]
    ds_read_b64_tr_b16 a[244:245], v3 offset:21504
    v_mfma_f32_16x16x32_bf16 v[192:195], a[252:255], a[128:131], v[192:195]
    v_add_f32 v221, v14, v221
    v_mfma_f32_16x16x32_bf16 v[192:195], a[248:251], a[104:107], v[192:195]
    ds_read_b64_tr_b16 a[246:247], v3 offset:22016
    v_mfma_f32_16x16x32_bf16 v[188:191], a[248:251], a[100:103], v[188:191]
    v_add_f32 v225, v15, v225
    v_mfma_f32_16x16x32_bf16 v[188:191], a[252:255], a[124:127], v[188:191]
    v_add_f32 v229, v16, v229
    v_mfma_f32_16x16x32_bf16 v[184:187], a[252:255], a[120:123], v[184:187]
    v_mfma_f32_16x16x32_bf16 v[184:187], a[248:251], a[96:99], v[184:187]
    s_waitcnt lgkmcnt(4)
    v_mfma_f32_16x16x32_bf16 a[48:51], v[56:59], a[96:99], a[48:51]
    s_waitcnt vmcnt(23)
    v_lshlrev_b32 v14, 16, v32
    v_mfma_f32_16x16x32_bf16 a[48:51], v[60:63], a[120:123], a[48:51]
    ds_read_b64_tr_b16 a[248:249], v3 offset:10240
    v_mfma_f32_16x16x32_bf16 a[52:55], v[60:63], a[124:127], a[52:55]
    v_and_b32 v15, s36, v32
    v_mfma_f32_16x16x32_bf16 a[52:55], v[56:59], a[100:103], a[52:55]
    ds_read_b64_tr_b16 a[250:251], v3 offset:10752
    v_mfma_f32_16x16x32_bf16 a[56:59], v[56:59], a[104:107], a[56:59]
    buffer_load_dwordx4 a[216:219], v2, s[52:55], s6 offen offset:2048
    v_mfma_f32_16x16x32_bf16 a[56:59], v[60:63], a[128:131], a[56:59]
    ds_read_b64_tr_b16 a[252:253], v3 offset:22528
    v_mfma_f32_16x16x32_bf16 a[60:63], v[60:63], a[132:135], a[60:63]
    v_lshlrev_b32 v16, 16, v33
    v_mfma_f32_16x16x32_bf16 a[60:63], v[56:59], a[108:111], a[60:63]
    ds_read_b64_tr_b16 a[254:255], v3 offset:23040
    v_mfma_f32_16x16x32_bf16 a[64:67], v[56:59], a[112:115], a[64:67]
    buffer_load_dwordx4 a[220:223], v2, s[52:55], s6 offen offset:3072
    v_mfma_f32_16x16x32_bf16 a[64:67], v[60:63], a[136:139], a[64:67]
    v_add_f32 v14, v14, v8
    v_mfma_f32_16x16x32_bf16 a[68:71], v[60:63], a[140:143], a[68:71]
    v_add_f32 v15, v15, v9
    v_mfma_f32_16x16x32_bf16 a[68:71], v[56:59], a[116:119], a[68:71]
    s_mov_b32 s6, 696320
    v_add_f32 v16, v16, v10
    s_waitcnt lgkmcnt(4)
    v_mfma_f32_16x16x32_bf16 v[228:231], a[240:243], a[116:119], v[228:231]
    buffer_load_dwordx4 a[224:227], v2, s[52:55], s6 offen offset:0
    v_mfma_f32_16x16x32_bf16 v[228:231], a[244:247], a[140:143], v[228:231]
    ds_read_b64_tr_b16 v[56:57], v3 offset:11264
    v_mfma_f32_16x16x32_bf16 v[224:227], a[244:247], a[136:139], v[224:227]
    v_add_f32 v65, v14, v65
    v_mfma_f32_16x16x32_bf16 v[224:227], a[240:243], a[112:115], v[224:227]
    ds_read_b64_tr_b16 v[58:59], v3 offset:11776
    v_mfma_f32_16x16x32_bf16 v[220:223], a[240:243], a[108:111], v[220:223]
    buffer_load_dwordx4 a[228:231], v2, s[52:55], s6 offen offset:1024
    v_mfma_f32_16x16x32_bf16 v[220:223], a[244:247], a[132:135], v[220:223]
    ds_read_b64_tr_b16 v[60:61], v3 offset:23552
    v_mfma_f32_16x16x32_bf16 v[216:219], a[244:247], a[128:131], v[216:219]
    v_add_f32 v69, v15, v69
    v_mfma_f32_16x16x32_bf16 v[216:219], a[240:243], a[104:107], v[216:219]
    ds_read_b64_tr_b16 v[62:63], v3 offset:24064
    v_mfma_f32_16x16x32_bf16 v[212:215], a[240:243], a[100:103], v[212:215]
    buffer_load_dwordx4 a[232:235], v2, s[52:55], s6 offen offset:2048
    v_mfma_f32_16x16x32_bf16 v[212:215], a[244:247], a[124:127], v[212:215]
    v_add_f32 v73, v16, v73
    v_mfma_f32_16x16x32_bf16 v[208:211], a[244:247], a[120:123], v[208:211]
    v_and_b32 v14, s36, v33
    v_mfma_f32_16x16x32_bf16 v[208:211], a[240:243], a[96:99], v[208:211]
    v_lshlrev_b32 v15, 16, v34
    s_waitcnt lgkmcnt(0)
    s_barrier
    v_mfma_f32_16x16x32_bf16 v[232:235], a[248:251], a[96:99], v[232:235]
    buffer_load_dwordx4 a[236:239], v2, s[52:55], s6 offen offset:3072
    v_mfma_f32_16x16x32_bf16 v[232:235], a[252:255], a[120:123], v[232:235]
    ds_read_b64_tr_b16 a[240:241], v3 offset:24576
    v_mfma_f32_16x16x32_bf16 v[236:239], a[252:255], a[124:127], v[236:239]
    v_and_b32 v16, s36, v34
    v_mfma_f32_16x16x32_bf16 v[236:239], a[248:251], a[100:103], v[236:239]
    ds_read_b64_tr_b16 a[242:243], v3 offset:25088
    v_mfma_f32_16x16x32_bf16 v[240:243], a[248:251], a[104:107], v[240:243]
    v_add_f32 v14, v14, v11
    v_mfma_f32_16x16x32_bf16 v[240:243], a[252:255], a[128:131], v[240:243]
    ds_read_b64_tr_b16 a[244:245], v3 offset:36864
    v_mfma_f32_16x16x32_bf16 v[244:247], a[252:255], a[132:135], v[244:247]
    v_add_f32 v15, v15, v12
    v_mfma_f32_16x16x32_bf16 v[244:247], a[248:251], a[108:111], v[244:247]
    ds_read_b64_tr_b16 a[246:247], v3 offset:37376
    v_mfma_f32_16x16x32_bf16 v[248:251], a[248:251], a[112:115], v[248:251]
    v_add_f32 v16, v16, v13
    v_mfma_f32_16x16x32_bf16 v[248:251], a[252:255], a[136:139], v[248:251]
    v_add_f32 v77, v14, v77
    v_mfma_f32_16x16x32_bf16 v[252:255], a[252:255], a[140:143], v[252:255]
    v_add_f32 v81, v15, v81
    v_mfma_f32_16x16x32_bf16 v[252:255], a[248:251], a[116:119], v[252:255]
    v_add_f32 v85, v16, v85
    v_mfma_f32_16x16x32_bf16 a[92:95], v[56:59], a[116:119], a[92:95]
    s_waitcnt vmcnt(28)
    v_lshlrev_b32 v14, 16, v36
    v_mfma_f32_16x16x32_bf16 a[92:95], v[60:63], a[140:143], a[92:95]
    ds_read_b64_tr_b16 a[248:249], v3 offset:25600
    v_mfma_f32_16x16x32_bf16 a[88:91], v[60:63], a[136:139], a[88:91]
    v_and_b32 v15, s36, v36
    v_mfma_f32_16x16x32_bf16 a[88:91], v[56:59], a[112:115], a[88:91]
    ds_read_b64_tr_b16 a[250:251], v3 offset:26112
    v_mfma_f32_16x16x32_bf16 a[84:87], v[56:59], a[108:111], a[84:87]
    v_lshlrev_b32 v16, 16, v37
    v_mfma_f32_16x16x32_bf16 a[84:87], v[60:63], a[132:135], a[84:87]
    ds_read_b64_tr_b16 a[252:253], v3 offset:37888
    v_mfma_f32_16x16x32_bf16 a[80:83], v[60:63], a[128:131], a[80:83]
    v_add_f32 v14, v14, v8
    v_mfma_f32_16x16x32_bf16 a[80:83], v[56:59], a[104:107], a[80:83]
    ds_read_b64_tr_b16 a[254:255], v3 offset:38400
    v_mfma_f32_16x16x32_bf16 a[76:79], v[56:59], a[100:103], a[76:79]
    v_add_f32 v15, v15, v9
    v_mfma_f32_16x16x32_bf16 a[76:79], v[60:63], a[124:127], a[76:79]
    v_add_f32 v16, v16, v10
    v_mfma_f32_16x16x32_bf16 a[72:75], v[60:63], a[120:123], a[72:75]
    v_add_f32 v113, v14, v113
    v_mfma_f32_16x16x32_bf16 a[72:75], v[56:59], a[96:99], a[72:75]
    v_add_f32 v117, v15, v117
    s_waitcnt vmcnt(22)
    s_waitcnt lgkmcnt(4)
    v_mfma_f32_16x16x32_bf16 v[64:67], a[240:243], a[144:147], v[64:67]
    v_add_f32 v121, v16, v121
    v_mfma_f32_16x16x32_bf16 v[64:67], a[244:247], a[168:171], v[64:67]
    ds_read_b64_tr_b16 v[56:57], v3 offset:26624
    v_mfma_f32_16x16x32_bf16 v[68:71], a[244:247], a[172:175], v[68:71]
    v_and_b32 v14, s36, v37
    v_mfma_f32_16x16x32_bf16 v[68:71], a[240:243], a[148:151], v[68:71]
    ds_read_b64_tr_b16 v[58:59], v3 offset:27136
    s_add_u32 m0, s39, 0
    v_mfma_f32_16x16x32_bf16 v[72:75], a[240:243], a[152:155], v[72:75]
    buffer_load_dwordx4 v1, s[56:59], s4 offen offset:0 nt lds
    v_mfma_f32_16x16x32_bf16 v[72:75], a[244:247], a[176:179], v[72:75]
    ds_read_b64_tr_b16 v[60:61], v3 offset:38912
    v_mfma_f32_16x16x32_bf16 v[76:79], a[244:247], a[180:183], v[76:79]
    v_lshlrev_b32 v15, 16, v38
    v_mfma_f32_16x16x32_bf16 v[76:79], a[240:243], a[156:159], v[76:79]
    ds_read_b64_tr_b16 v[62:63], v3 offset:39424
    s_add_u32 m0, s39, 0
    v_mfma_f32_16x16x32_bf16 v[80:83], a[240:243], a[160:163], v[80:83]
    buffer_load_dwordx4 v1, s[56:59], s4 offen offset:1024 nt lds
    v_mfma_f32_16x16x32_bf16 v[80:83], a[244:247], a[184:187], v[80:83]
    v_and_b32 v16, s36, v38
    v_mfma_f32_16x16x32_bf16 v[84:87], a[244:247], a[188:191], v[84:87]
    v_add_f32 v14, v14, v11
    v_mfma_f32_16x16x32_bf16 v[84:87], a[240:243], a[164:167], v[84:87]
    s_add_u32 m0, s39, 0
    v_add_f32 v15, v15, v12
    s_waitcnt lgkmcnt(4)
    v_mfma_f32_16x16x32_bf16 v[108:111], a[248:251], a[164:167], v[108:111]
    buffer_load_dwordx4 v1, s[56:59], s4 offen offset:2048 nt lds
    v_mfma_f32_16x16x32_bf16 v[108:111], a[252:255], a[188:191], v[108:111]
    ds_read_b64_tr_b16 a[240:241], v3 offset:27648
    v_mfma_f32_16x16x32_bf16 v[104:107], a[252:255], a[184:187], v[104:107]
    v_add_f32 v16, v16, v13
    v_mfma_f32_16x16x32_bf16 v[104:107], a[248:251], a[160:163], v[104:107]
    ds_read_b64_tr_b16 a[242:243], v3 offset:28160
    s_add_u32 m0, s39, 12288
    v_mfma_f32_16x16x32_bf16 v[100:103], a[248:251], a[156:159], v[100:103]
    buffer_load_dwordx4 v1, s[60:63], s29 offen offset:0 nt lds
    v_mfma_f32_16x16x32_bf16 v[100:103], a[252:255], a[180:183], v[100:103]
    ds_read_b64_tr_b16 a[244:245], v3 offset:39936
    v_mfma_f32_16x16x32_bf16 v[96:99], a[252:255], a[176:179], v[96:99]
    v_add_f32 v125, v14, v125
    v_mfma_f32_16x16x32_bf16 v[96:99], a[248:251], a[152:155], v[96:99]
    ds_read_b64_tr_b16 a[246:247], v3 offset:40448
    s_add_u32 m0, s39, 12288
    v_mfma_f32_16x16x32_bf16 v[92:95], a[248:251], a[148:151], v[92:95]
    buffer_load_dwordx4 v1, s[60:63], s29 offen offset:1024 nt lds
    v_mfma_f32_16x16x32_bf16 v[92:95], a[252:255], a[172:175], v[92:95]
    v_add_f32 v129, v15, v129
    v_mfma_f32_16x16x32_bf16 v[88:91], a[252:255], a[168:171], v[88:91]
    v_add_f32 v133, v16, v133
    v_mfma_f32_16x16x32_bf16 v[88:91], a[248:251], a[144:147], v[88:91]
    s_add_u32 m0, s39, 12288
    s_waitcnt lgkmcnt(4)
    v_mfma_f32_16x16x32_bf16 a[0:3], v[56:59], a[144:147], a[0:3]
    buffer_load_dwordx4 v1, s[60:63], s29 offen offset:2048 nt lds
    v_mfma_f32_16x16x32_bf16 a[0:3], v[60:63], a[168:171], a[0:3]
    ds_read_b64_tr_b16 a[248:249], v3 offset:28672
    v_mfma_f32_16x16x32_bf16 a[4:7], v[60:63], a[172:175], a[4:7]
    s_waitcnt vmcnt(15)
    v_lshlrev_b32 v14, 16, v40
    v_mfma_f32_16x16x32_bf16 a[4:7], v[56:59], a[148:151], a[4:7]
    ds_read_b64_tr_b16 a[250:251], v3 offset:29184
    v_mfma_f32_16x16x32_bf16 a[8:11], v[56:59], a[152:155], a[8:11]
    v_and_b32 v15, s36, v40
    v_mfma_f32_16x16x32_bf16 a[8:11], v[60:63], a[176:179], a[8:11]
    ds_read_b64_tr_b16 a[252:253], v3 offset:40960
    v_mfma_f32_16x16x32_bf16 a[12:15], v[60:63], a[180:183], a[12:15]
    v_lshlrev_b32 v16, 16, v41
    v_mfma_f32_16x16x32_bf16 a[12:15], v[56:59], a[156:159], a[12:15]
    ds_read_b64_tr_b16 a[254:255], v3 offset:41472
    v_mfma_f32_16x16x32_bf16 a[16:19], v[56:59], a[160:163], a[16:19]
    v_add_f32 v14, v14, v8
    v_mfma_f32_16x16x32_bf16 a[16:19], v[60:63], a[184:187], a[16:19]
    v_add_f32 v15, v15, v9
    v_mfma_f32_16x16x32_bf16 a[20:23], v[60:63], a[188:191], a[20:23]
    v_add_f32 v16, v16, v10
    v_mfma_f32_16x16x32_bf16 a[20:23], v[56:59], a[164:167], a[20:23]
    v_add_f32 v185, v14, v185
    s_waitcnt lgkmcnt(4)
    v_mfma_f32_16x16x32_bf16 v[132:135], a[240:243], a[164:167], v[132:135]
    v_add_f32 v189, v15, v189
    v_mfma_f32_16x16x32_bf16 v[132:135], a[244:247], a[188:191], v[132:135]
    ds_read_b64_tr_b16 v[56:57], v3 offset:29696
    v_mfma_f32_16x16x32_bf16 v[128:131], a[244:247], a[184:187], v[128:131]
    v_add_f32 v193, v16, v193
    v_mfma_f32_16x16x32_bf16 v[128:131], a[240:243], a[160:163], v[128:131]
    ds_read_b64_tr_b16 v[58:59], v3 offset:30208
    v_mfma_f32_16x16x32_bf16 v[124:127], a[240:243], a[156:159], v[124:127]
    v_and_b32 v14, s36, v41
    v_mfma_f32_16x16x32_bf16 v[124:127], a[244:247], a[180:183], v[124:127]
    ds_read_b64_tr_b16 v[60:61], v3 offset:41984
    v_mfma_f32_16x16x32_bf16 v[120:123], a[244:247], a[176:179], v[120:123]
    v_lshlrev_b32 v15, 16, v42
    v_mfma_f32_16x16x32_bf16 v[120:123], a[240:243], a[152:155], v[120:123]
    ds_read_b64_tr_b16 v[62:63], v3 offset:42496
    v_mfma_f32_16x16x32_bf16 v[116:119], a[240:243], a[148:151], v[116:119]
    v_and_b32 v16, s36, v42
    v_mfma_f32_16x16x32_bf16 v[116:119], a[244:247], a[172:175], v[116:119]
    v_add_f32 v14, v14, v11
    v_mfma_f32_16x16x32_bf16 v[112:115], a[244:247], a[168:171], v[112:115]
    v_add_f32 v15, v15, v12
    v_mfma_f32_16x16x32_bf16 v[112:115], a[240:243], a[144:147], v[112:115]
    v_add_f32 v16, v16, v13
    s_waitcnt lgkmcnt(4)
    v_mfma_f32_16x16x32_bf16 v[136:139], a[248:251], a[144:147], v[136:139]
    v_add_f32 v197, v14, v197
    v_mfma_f32_16x16x32_bf16 v[136:139], a[252:255], a[168:171], v[136:139]
    ds_read_b64_tr_b16 a[240:241], v3 offset:30720
    v_mfma_f32_16x16x32_bf16 v[140:143], a[252:255], a[172:175], v[140:143]
    v_add_f32 v201, v15, v201
    v_mfma_f32_16x16x32_bf16 v[140:143], a[248:251], a[148:151], v[140:143]
    ds_read_b64_tr_b16 a[242:243], v3 offset:31232
    s_mov_b32 s6, 737280
    v_mfma_f32_16x16x32_bf16 v[144:147], a[248:251], a[152:155], v[144:147]
    buffer_load_dwordx4 a[96:99], v2, s[52:55], s6 offen offset:0
    v_mfma_f32_16x16x32_bf16 v[144:147], a[252:255], a[176:179], v[144:147]
    ds_read_b64_tr_b16 a[244:245], v3 offset:43008
    v_mfma_f32_16x16x32_bf16 v[148:151], a[252:255], a[180:183], v[148:151]
    v_add_f32 v205, v16, v205
    v_mfma_f32_16x16x32_bf16 v[148:151], a[248:251], a[156:159], v[148:151]
    ds_read_b64_tr_b16 a[246:247], v3 offset:43520
    v_mfma_f32_16x16x32_bf16 v[152:155], a[248:251], a[160:163], v[152:155]
    buffer_load_dwordx4 a[100:103], v2, s[52:55], s6 offen offset:1024
    v_mfma_f32_16x16x32_bf16 v[152:155], a[252:255], a[184:187], v[152:155]
    v_mfma_f32_16x16x32_bf16 v[156:159], a[252:255], a[188:191], v[156:159]
    v_mfma_f32_16x16x32_bf16 v[156:159], a[248:251], a[164:167], v[156:159]
    s_waitcnt lgkmcnt(4)
    v_mfma_f32_16x16x32_bf16 a[44:47], v[56:59], a[164:167], a[44:47]
    buffer_load_dwordx4 a[104:107], v2, s[52:55], s6 offen offset:2048
    v_mfma_f32_16x16x32_bf16 a[44:47], v[60:63], a[188:191], a[44:47]
    ds_read_b64_tr_b16 a[248:249], v3 offset:31744
    v_mfma_f32_16x16x32_bf16 a[40:43], v[60:63], a[184:187], a[40:43]
    s_waitcnt vmcnt(17)
    v_lshlrev_b32 v14, 16, v44
    v_mfma_f32_16x16x32_bf16 a[40:43], v[56:59], a[160:163], a[40:43]
    ds_read_b64_tr_b16 a[250:251], v3 offset:32256
    v_mfma_f32_16x16x32_bf16 a[36:39], v[56:59], a[156:159], a[36:39]
    buffer_load_dwordx4 a[108:111], v2, s[52:55], s6 offen offset:3072
    v_mfma_f32_16x16x32_bf16 a[36:39], v[60:63], a[180:183], a[36:39]
    ds_read_b64_tr_b16 a[252:253], v3 offset:44032
    v_mfma_f32_16x16x32_bf16 a[32:35], v[60:63], a[176:179], a[32:35]
    v_and_b32 v15, s36, v44
    v_mfma_f32_16x16x32_bf16 a[32:35], v[56:59], a[152:155], a[32:35]
    ds_read_b64_tr_b16 a[254:255], v3 offset:44544
    s_mov_b32 s6, 741376
    v_mfma_f32_16x16x32_bf16 a[28:31], v[56:59], a[148:151], a[28:31]
    buffer_load_dwordx4 a[112:115], v2, s[52:55], s6 offen offset:0
    v_mfma_f32_16x16x32_bf16 a[28:31], v[60:63], a[172:175], a[28:31]
    v_lshlrev_b32 v16, 16, v45
    v_mfma_f32_16x16x32_bf16 a[24:27], v[60:63], a[168:171], a[24:27]
    v_add_f32 v14, v14, v8
    v_mfma_f32_16x16x32_bf16 a[24:27], v[56:59], a[144:147], a[24:27]
    v_add_f32 v15, v15, v9
    s_waitcnt lgkmcnt(4)
    v_mfma_f32_16x16x32_bf16 v[160:163], a[240:243], a[144:147], v[160:163]
    buffer_load_dwordx4 a[116:119], v2, s[52:55], s6 offen offset:1024
    v_mfma_f32_16x16x32_bf16 v[160:163], a[244:247], a[168:171], v[160:163]
    ds_read_b64_tr_b16 v[56:57], v3 offset:32768
    v_mfma_f32_16x16x32_bf16 v[164:167], a[244:247], a[172:175], v[164:167]
    v_add_f32 v16, v16, v10
    v_mfma_f32_16x16x32_bf16 v[164:167], a[240:243], a[148:151], v[164:167]
    ds_read_b64_tr_b16 v[58:59], v3 offset:33280
    v_mfma_f32_16x16x32_bf16 v[168:171], a[240:243], a[152:155], v[168:171]
    v_add_f32 v233, v14, v233
    s_add_u32 s43, s40, 79872
    buffer_load_dwordx3 v[24:26], v0, s[12:15], s43 offen offset:768
    v_mfma_f32_16x16x32_bf16 v[168:171], a[244:247], a[176:179], v[168:171]
    ds_read_b64_tr_b16 v[60:61], v3 offset:45056
    v_mfma_f32_16x16x32_bf16 v[172:175], a[244:247], a[180:183], v[172:175]
    v_add_f32 v237, v15, v237
    v_mfma_f32_16x16x32_bf16 v[172:175], a[240:243], a[156:159], v[172:175]
    ds_read_b64_tr_b16 v[62:63], v3 offset:45568
    v_mfma_f32_16x16x32_bf16 v[176:179], a[240:243], a[160:163], v[176:179]
    v_add_f32 v241, v16, v241
    s_add_u32 s43, s40, 89088
    buffer_load_dwordx3 v[28:30], v0, s[12:15], s43 offen offset:768
    v_mfma_f32_16x16x32_bf16 v[176:179], a[244:247], a[184:187], v[176:179]
    v_and_b32 v14, s36, v45
    v_mfma_f32_16x16x32_bf16 v[180:183], a[244:247], a[188:191], v[180:183]
    v_lshlrev_b32 v15, 16, v46
    v_mfma_f32_16x16x32_bf16 v[180:183], a[240:243], a[164:167], v[180:183]
    v_and_b32 v16, s36, v46
    s_waitcnt lgkmcnt(4)
    v_mfma_f32_16x16x32_bf16 v[204:207], a[248:251], a[164:167], v[204:207]
    v_add_f32 v14, v14, v11
    s_add_u32 s43, s40, 6144
    buffer_load_dwordx3 v[32:34], v0, s[12:15], s43 offen offset:768
    v_mfma_f32_16x16x32_bf16 v[204:207], a[252:255], a[188:191], v[204:207]
    ds_read_b64_tr_b16 a[240:241], v3 offset:33792
    v_mfma_f32_16x16x32_bf16 v[200:203], a[252:255], a[184:187], v[200:203]
    v_add_f32 v15, v15, v12
    v_mfma_f32_16x16x32_bf16 v[200:203], a[248:251], a[160:163], v[200:203]
    ds_read_b64_tr_b16 a[242:243], v3 offset:34304
    v_mfma_f32_16x16x32_bf16 v[196:199], a[248:251], a[156:159], v[196:199]
    v_add_f32 v16, v16, v13
    s_add_u32 s43, s40, 15360
    buffer_load_dwordx3 v[36:38], v0, s[12:15], s43 offen offset:768
    v_mfma_f32_16x16x32_bf16 v[196:199], a[252:255], a[180:183], v[196:199]
    ds_read_b64_tr_b16 a[244:245], v3 offset:46080
    v_mfma_f32_16x16x32_bf16 v[192:195], a[252:255], a[176:179], v[192:195]
    v_add_f32 v245, v14, v245
    v_mfma_f32_16x16x32_bf16 v[192:195], a[248:251], a[152:155], v[192:195]
    ds_read_b64_tr_b16 a[246:247], v3 offset:46592
    v_mfma_f32_16x16x32_bf16 v[188:191], a[248:251], a[148:151], v[188:191]
    v_add_f32 v249, v15, v249
    v_mfma_f32_16x16x32_bf16 v[188:191], a[252:255], a[172:175], v[188:191]
    v_add_f32 v253, v16, v253
    v_mfma_f32_16x16x32_bf16 v[184:187], a[252:255], a[168:171], v[184:187]
    v_mfma_f32_16x16x32_bf16 v[184:187], a[248:251], a[144:147], v[184:187]
    s_waitcnt lgkmcnt(4)
    v_mfma_f32_16x16x32_bf16 a[48:51], v[56:59], a[144:147], a[48:51]
    s_waitcnt vmcnt(23)
    v_lshlrev_b32 v14, 16, v48
    v_mfma_f32_16x16x32_bf16 a[48:51], v[60:63], a[168:171], a[48:51]
    ds_read_b64_tr_b16 a[248:249], v3 offset:34816
    v_mfma_f32_16x16x32_bf16 a[52:55], v[60:63], a[172:175], a[52:55]
    v_and_b32 v15, s36, v48
    v_mfma_f32_16x16x32_bf16 a[52:55], v[56:59], a[148:151], a[52:55]
    ds_read_b64_tr_b16 a[250:251], v3 offset:35328
    v_mfma_f32_16x16x32_bf16 a[56:59], v[56:59], a[152:155], a[56:59]
    buffer_load_dwordx4 a[120:123], v2, s[52:55], s6 offen offset:2048
    v_mfma_f32_16x16x32_bf16 a[56:59], v[60:63], a[176:179], a[56:59]
    ds_read_b64_tr_b16 a[252:253], v3 offset:47104
    v_mfma_f32_16x16x32_bf16 a[60:63], v[60:63], a[180:183], a[60:63]
    v_lshlrev_b32 v16, 16, v49
    v_mfma_f32_16x16x32_bf16 a[60:63], v[56:59], a[156:159], a[60:63]
    ds_read_b64_tr_b16 a[254:255], v3 offset:47616
    v_mfma_f32_16x16x32_bf16 a[64:67], v[56:59], a[160:163], a[64:67]
    buffer_load_dwordx4 a[124:127], v2, s[52:55], s6 offen offset:3072
    v_mfma_f32_16x16x32_bf16 a[64:67], v[60:63], a[184:187], a[64:67]
    v_add_f32 v14, v14, v8
    v_mfma_f32_16x16x32_bf16 a[68:71], v[60:63], a[188:191], a[68:71]
    v_add_f32 v15, v15, v9
    v_mfma_f32_16x16x32_bf16 a[68:71], v[56:59], a[164:167], a[68:71]
    s_mov_b32 s6, 745472
    v_add_f32 v16, v16, v10
    s_waitcnt lgkmcnt(4)
    v_mfma_f32_16x16x32_bf16 v[228:231], a[240:243], a[164:167], v[228:231]
    buffer_load_dwordx4 a[128:131], v2, s[52:55], s6 offen offset:0
    v_mfma_f32_16x16x32_bf16 v[228:231], a[244:247], a[188:191], v[228:231]
    ds_read_b64_tr_b16 v[56:57], v3 offset:35840
    v_mfma_f32_16x16x32_bf16 v[224:227], a[244:247], a[184:187], v[224:227]
    v_add_f32 v89, v14, v89
    v_mfma_f32_16x16x32_bf16 v[224:227], a[240:243], a[160:163], v[224:227]
    ds_read_b64_tr_b16 v[58:59], v3 offset:36352
    v_mfma_f32_16x16x32_bf16 v[220:223], a[240:243], a[156:159], v[220:223]
    buffer_load_dwordx4 a[132:135], v2, s[52:55], s6 offen offset:1024
    v_mfma_f32_16x16x32_bf16 v[220:223], a[244:247], a[180:183], v[220:223]
    ds_read_b64_tr_b16 v[60:61], v3 offset:48128
    v_mfma_f32_16x16x32_bf16 v[216:219], a[244:247], a[176:179], v[216:219]
    v_add_f32 v93, v15, v93
    v_mfma_f32_16x16x32_bf16 v[216:219], a[240:243], a[152:155], v[216:219]
    ds_read_b64_tr_b16 v[62:63], v3 offset:48640
    v_mfma_f32_16x16x32_bf16 v[212:215], a[240:243], a[148:151], v[212:215]
    buffer_load_dwordx4 a[136:139], v2, s[52:55], s6 offen offset:2048
    v_mfma_f32_16x16x32_bf16 v[212:215], a[244:247], a[172:175], v[212:215]
    v_add_f32 v97, v16, v97
    v_mfma_f32_16x16x32_bf16 v[208:211], a[244:247], a[168:171], v[208:211]
    v_and_b32 v14, s36, v49
    v_mfma_f32_16x16x32_bf16 v[208:211], a[240:243], a[144:147], v[208:211]
    v_lshlrev_b32 v15, 16, v50
    s_waitcnt lgkmcnt(0)
    s_barrier
    v_mfma_f32_16x16x32_bf16 v[232:235], a[248:251], a[144:147], v[232:235]
    buffer_load_dwordx4 a[140:143], v2, s[52:55], s6 offen offset:3072
    v_mfma_f32_16x16x32_bf16 v[232:235], a[252:255], a[168:171], v[232:235]
    ds_read_b64_tr_b16 a[240:241], v4 offset:0
    v_mfma_f32_16x16x32_bf16 v[236:239], a[252:255], a[172:175], v[236:239]
    v_and_b32 v16, s36, v50
    v_mfma_f32_16x16x32_bf16 v[236:239], a[248:251], a[148:151], v[236:239]
    ds_read_b64_tr_b16 a[242:243], v4 offset:512
    v_mfma_f32_16x16x32_bf16 v[240:243], a[248:251], a[152:155], v[240:243]
    v_add_f32 v14, v14, v11
    v_mfma_f32_16x16x32_bf16 v[240:243], a[252:255], a[176:179], v[240:243]
    ds_read_b64_tr_b16 a[244:245], v4 offset:12288
    v_mfma_f32_16x16x32_bf16 v[244:247], a[252:255], a[180:183], v[244:247]
    v_add_f32 v15, v15, v12
    v_mfma_f32_16x16x32_bf16 v[244:247], a[248:251], a[156:159], v[244:247]
    ds_read_b64_tr_b16 a[246:247], v4 offset:12800
    v_mfma_f32_16x16x32_bf16 v[248:251], a[248:251], a[160:163], v[248:251]
    v_add_f32 v16, v16, v13
    v_mfma_f32_16x16x32_bf16 v[248:251], a[252:255], a[184:187], v[248:251]
    v_add_f32 v101, v14, v101
    v_mfma_f32_16x16x32_bf16 v[252:255], a[252:255], a[188:191], v[252:255]
    v_add_f32 v105, v15, v105
    v_mfma_f32_16x16x32_bf16 v[252:255], a[248:251], a[164:167], v[252:255]
    v_add_f32 v109, v16, v109
    v_mfma_f32_16x16x32_bf16 a[92:95], v[56:59], a[164:167], a[92:95]
    s_waitcnt vmcnt(28)
    v_lshlrev_b32 v14, 16, v52
    v_mfma_f32_16x16x32_bf16 a[92:95], v[60:63], a[188:191], a[92:95]
    ds_read_b64_tr_b16 a[248:249], v4 offset:1024
    v_mfma_f32_16x16x32_bf16 a[88:91], v[60:63], a[184:187], a[88:91]
    v_and_b32 v15, s36, v52
    v_mfma_f32_16x16x32_bf16 a[88:91], v[56:59], a[160:163], a[88:91]
    ds_read_b64_tr_b16 a[250:251], v4 offset:1536
    v_mfma_f32_16x16x32_bf16 a[84:87], v[56:59], a[156:159], a[84:87]
    v_lshlrev_b32 v16, 16, v53
    v_mfma_f32_16x16x32_bf16 a[84:87], v[60:63], a[180:183], a[84:87]
    ds_read_b64_tr_b16 a[252:253], v4 offset:13312
    v_mfma_f32_16x16x32_bf16 a[80:83], v[60:63], a[176:179], a[80:83]
    v_add_f32 v14, v14, v8
    v_mfma_f32_16x16x32_bf16 a[80:83], v[56:59], a[152:155], a[80:83]
    ds_read_b64_tr_b16 a[254:255], v4 offset:13824
    v_mfma_f32_16x16x32_bf16 a[76:79], v[56:59], a[148:151], a[76:79]
    v_add_f32 v15, v15, v9
    v_mfma_f32_16x16x32_bf16 a[76:79], v[60:63], a[172:175], a[76:79]
    v_add_f32 v16, v16, v10
    v_mfma_f32_16x16x32_bf16 a[72:75], v[60:63], a[168:171], a[72:75]
    v_add_f32 v137, v14, v137
    v_mfma_f32_16x16x32_bf16 a[72:75], v[56:59], a[144:147], a[72:75]
    v_add_f32 v141, v15, v141
    s_waitcnt vmcnt(22)
    s_waitcnt lgkmcnt(4)
    v_mfma_f32_16x16x32_bf16 v[64:67], a[240:243], a[192:195], v[64:67]
    v_add_f32 v145, v16, v145
    v_mfma_f32_16x16x32_bf16 v[64:67], a[244:247], a[216:219], v[64:67]
    ds_read_b64_tr_b16 v[56:57], v4 offset:2048
    v_mfma_f32_16x16x32_bf16 v[68:71], a[244:247], a[220:223], v[68:71]
    s_add_u32 s4, s4, 36864
    v_and_b32 v14, s36, v53
    v_mfma_f32_16x16x32_bf16 v[68:71], a[240:243], a[196:199], v[68:71]
    ds_read_b64_tr_b16 v[58:59], v4 offset:2560
    s_add_u32 s29, s29, 12288
    s_add_u32 s5, s4, 4096
    s_add_u32 m0, s32, 24576
    v_mfma_f32_16x16x32_bf16 v[72:75], a[240:243], a[200:203], v[72:75]
    buffer_load_dwordx4 v1, s[8:11], s4 offen offset:0 nt lds
    v_mfma_f32_16x16x32_bf16 v[72:75], a[244:247], a[224:227], v[72:75]
    ds_read_b64_tr_b16 v[60:61], v4 offset:14336
    v_mfma_f32_16x16x32_bf16 v[76:79], a[244:247], a[228:231], v[76:79]
    v_lshlrev_b32 v15, 16, v54
    v_mfma_f32_16x16x32_bf16 v[76:79], a[240:243], a[204:207], v[76:79]
    ds_read_b64_tr_b16 v[62:63], v4 offset:14848
    s_add_u32 m0, s32, 24576
    v_mfma_f32_16x16x32_bf16 v[80:83], a[240:243], a[208:211], v[80:83]
    buffer_load_dwordx4 v1, s[8:11], s4 offen offset:1024 nt lds
    v_mfma_f32_16x16x32_bf16 v[80:83], a[244:247], a[232:235], v[80:83]
    v_and_b32 v16, s36, v54
    v_mfma_f32_16x16x32_bf16 v[84:87], a[244:247], a[236:239], v[84:87]
    v_add_f32 v14, v14, v11
    v_mfma_f32_16x16x32_bf16 v[84:87], a[240:243], a[212:215], v[84:87]
    s_add_u32 m0, s32, 24576
    v_add_f32 v15, v15, v12
    s_waitcnt lgkmcnt(4)
    v_mfma_f32_16x16x32_bf16 v[108:111], a[248:251], a[212:215], v[108:111]
    buffer_load_dwordx4 v1, s[8:11], s4 offen offset:2048 nt lds
    v_mfma_f32_16x16x32_bf16 v[108:111], a[252:255], a[236:239], v[108:111]
    ds_read_b64_tr_b16 a[240:241], v4 offset:3072
    v_mfma_f32_16x16x32_bf16 v[104:107], a[252:255], a[232:235], v[104:107]
    v_add_f32 v16, v16, v13
    v_mfma_f32_16x16x32_bf16 v[104:107], a[248:251], a[208:211], v[104:107]
    ds_read_b64_tr_b16 a[242:243], v4 offset:3584
    s_add_u32 m0, s32, 24576
    v_mfma_f32_16x16x32_bf16 v[100:103], a[248:251], a[204:207], v[100:103]
    buffer_load_dwordx4 v1, s[8:11], s4 offen offset:3072 nt lds
    v_mfma_f32_16x16x32_bf16 v[100:103], a[252:255], a[228:231], v[100:103]
    ds_read_b64_tr_b16 a[244:245], v4 offset:15360
    v_mfma_f32_16x16x32_bf16 v[96:99], a[252:255], a[224:227], v[96:99]
    v_add_f32 v149, v14, v149
    v_mfma_f32_16x16x32_bf16 v[96:99], a[248:251], a[200:203], v[96:99]
    ds_read_b64_tr_b16 a[246:247], v4 offset:15872
    s_add_u32 m0, s32, 28672
    v_mfma_f32_16x16x32_bf16 v[92:95], a[248:251], a[196:199], v[92:95]
    buffer_load_dwordx4 v1, s[8:11], s5 offen offset:0 nt lds
    v_mfma_f32_16x16x32_bf16 v[92:95], a[252:255], a[220:223], v[92:95]
    v_add_f32 v153, v15, v153
    v_mfma_f32_16x16x32_bf16 v[88:91], a[252:255], a[216:219], v[88:91]
    v_add_f32 v157, v16, v157
    v_mfma_f32_16x16x32_bf16 v[88:91], a[248:251], a[192:195], v[88:91]
    s_add_u32 m0, s32, 28672
    s_waitcnt lgkmcnt(4)
    v_mfma_f32_16x16x32_bf16 a[0:3], v[56:59], a[192:195], a[0:3]
    buffer_load_dwordx4 v1, s[8:11], s5 offen offset:1024 nt lds
    s_waitcnt vmcnt(15)
    v_lshlrev_b32 v14, 16, v24
    v_mfma_f32_16x16x32_bf16 a[0:3], v[60:63], a[216:219], a[0:3]
    ds_read_b64_tr_b16 a[248:249], v4 offset:4096
    v_and_b32 v15, s36, v24
    v_mfma_f32_16x16x32_bf16 a[4:7], v[60:63], a[220:223], a[4:7]
    v_lshlrev_b32 v16, 16, v25
    v_accvgpr_read_b32 v18, a49
    v_mfma_f32_16x16x32_bf16 a[4:7], v[56:59], a[196:199], a[4:7]
    ds_read_b64_tr_b16 a[250:251], v4 offset:4608
    v_accvgpr_read_b32 v19, a53
    v_mfma_f32_16x16x32_bf16 a[8:11], v[56:59], a[200:203], a[8:11]
    v_accvgpr_read_b32 v20, a57
    v_add_f32 v14, v14, v8
    v_mfma_f32_16x16x32_bf16 a[8:11], v[60:63], a[224:227], a[8:11]
    ds_read_b64_tr_b16 a[252:253], v4 offset:16384
    v_add_f32 v15, v15, v9
    v_mfma_f32_16x16x32_bf16 a[12:15], v[60:63], a[228:231], a[12:15]
    v_add_f32 v16, v16, v10
    v_add_f32 v14, v14, v18
    v_mfma_f32_16x16x32_bf16 a[12:15], v[56:59], a[204:207], a[12:15]
    ds_read_b64_tr_b16 a[254:255], v4 offset:16896
    v_add_f32 v15, v15, v19
    v_mfma_f32_16x16x32_bf16 a[16:19], v[56:59], a[208:211], a[16:19]
    v_add_f32 v16, v16, v20
    v_accvgpr_write_b32 a49, v14
    v_mfma_f32_16x16x32_bf16 a[16:19], v[60:63], a[232:235], a[16:19]
    v_accvgpr_write_b32 a53, v15
    v_accvgpr_write_b32 a57, v16
    v_mfma_f32_16x16x32_bf16 a[20:23], v[60:63], a[236:239], a[20:23]
    v_and_b32 v14, s36, v25
    v_lshlrev_b32 v15, 16, v26
    v_mfma_f32_16x16x32_bf16 a[20:23], v[56:59], a[212:215], a[20:23]
    v_and_b32 v16, s36, v26
    v_accvgpr_read_b32 v18, a61
    s_waitcnt lgkmcnt(4)
    v_mfma_f32_16x16x32_bf16 v[132:135], a[240:243], a[212:215], v[132:135]
    v_accvgpr_read_b32 v19, a65
    v_accvgpr_read_b32 v20, a69
    v_mfma_f32_16x16x32_bf16 v[132:135], a[244:247], a[236:239], v[132:135]
    ds_read_b64_tr_b16 v[56:57], v4 offset:5120
    v_add_f32 v14, v14, v11
    v_mfma_f32_16x16x32_bf16 v[128:131], a[244:247], a[232:235], v[128:131]
    v_add_f32 v15, v15, v12
    v_add_f32 v16, v16, v13
    v_mfma_f32_16x16x32_bf16 v[128:131], a[240:243], a[208:211], v[128:131]
    ds_read_b64_tr_b16 v[58:59], v4 offset:5632
    v_add_f32 v14, v14, v18
    v_mfma_f32_16x16x32_bf16 v[124:127], a[240:243], a[204:207], v[124:127]
    v_add_f32 v15, v15, v19
    v_add_f32 v16, v16, v20
    v_mfma_f32_16x16x32_bf16 v[124:127], a[244:247], a[228:231], v[124:127]
    ds_read_b64_tr_b16 v[60:61], v4 offset:17408
    v_accvgpr_write_b32 a61, v14
    v_mfma_f32_16x16x32_bf16 v[120:123], a[244:247], a[224:227], v[120:123]
    v_accvgpr_write_b32 a65, v15
    v_accvgpr_write_b32 a69, v16
    v_mfma_f32_16x16x32_bf16 v[120:123], a[240:243], a[200:203], v[120:123]
    ds_read_b64_tr_b16 v[62:63], v4 offset:17920
    v_mfma_f32_16x16x32_bf16 v[116:119], a[240:243], a[196:199], v[116:119]
    v_mfma_f32_16x16x32_bf16 v[116:119], a[244:247], a[220:223], v[116:119]
    v_mfma_f32_16x16x32_bf16 v[112:115], a[244:247], a[216:219], v[112:115]
    v_mfma_f32_16x16x32_bf16 v[112:115], a[240:243], a[192:195], v[112:115]
    s_waitcnt lgkmcnt(4)
    v_mfma_f32_16x16x32_bf16 v[136:139], a[248:251], a[192:195], v[136:139]
    v_mfma_f32_16x16x32_bf16 v[136:139], a[252:255], a[216:219], v[136:139]
    ds_read_b64_tr_b16 a[240:241], v4 offset:6144
    v_mfma_f32_16x16x32_bf16 v[140:143], a[252:255], a[220:223], v[140:143]
    v_mfma_f32_16x16x32_bf16 v[140:143], a[248:251], a[196:199], v[140:143]
    ds_read_b64_tr_b16 a[242:243], v4 offset:6656
    s_mov_b32 s6, 786432
    v_mfma_f32_16x16x32_bf16 v[144:147], a[248:251], a[200:203], v[144:147]
    buffer_load_dwordx4 a[144:147], v2, s[52:55], s6 offen offset:0
    v_mfma_f32_16x16x32_bf16 v[144:147], a[252:255], a[224:227], v[144:147]
    ds_read_b64_tr_b16 a[244:245], v4 offset:18432
    v_mfma_f32_16x16x32_bf16 v[148:151], a[252:255], a[228:231], v[148:151]
    v_mfma_f32_16x16x32_bf16 v[148:151], a[248:251], a[204:207], v[148:151]
    ds_read_b64_tr_b16 a[246:247], v4 offset:18944
    v_mfma_f32_16x16x32_bf16 v[152:155], a[248:251], a[208:211], v[152:155]
    buffer_load_dwordx4 a[148:151], v2, s[52:55], s6 offen offset:1024
    v_mfma_f32_16x16x32_bf16 v[152:155], a[252:255], a[232:235], v[152:155]
    v_mfma_f32_16x16x32_bf16 v[156:159], a[252:255], a[236:239], v[156:159]
    v_mfma_f32_16x16x32_bf16 v[156:159], a[248:251], a[212:215], v[156:159]
    s_waitcnt lgkmcnt(4)
    v_mfma_f32_16x16x32_bf16 a[44:47], v[56:59], a[212:215], a[44:47]
    buffer_load_dwordx4 a[152:155], v2, s[52:55], s6 offen offset:2048
    s_waitcnt vmcnt(17)
    v_lshlrev_b32 v14, 16, v28
    v_mfma_f32_16x16x32_bf16 a[44:47], v[60:63], a[236:239], a[44:47]
    ds_read_b64_tr_b16 a[248:249], v4 offset:7168
    v_and_b32 v15, s36, v28
    v_mfma_f32_16x16x32_bf16 a[40:43], v[60:63], a[232:235], a[40:43]
    v_lshlrev_b32 v16, 16, v29
    v_accvgpr_read_b32 v18, a73
    v_mfma_f32_16x16x32_bf16 a[40:43], v[56:59], a[208:211], a[40:43]
    ds_read_b64_tr_b16 a[250:251], v4 offset:7680
    v_accvgpr_read_b32 v19, a77
    v_mfma_f32_16x16x32_bf16 a[36:39], v[56:59], a[204:207], a[36:39]
    buffer_load_dwordx4 a[156:159], v2, s[52:55], s6 offen offset:3072
    v_accvgpr_read_b32 v20, a81
    v_mfma_f32_16x16x32_bf16 a[36:39], v[60:63], a[228:231], a[36:39]
    ds_read_b64_tr_b16 a[252:253], v4 offset:19456
    v_add_f32 v14, v14, v8
    v_mfma_f32_16x16x32_bf16 a[32:35], v[60:63], a[224:227], a[32:35]
    v_add_f32 v15, v15, v9
    v_add_f32 v16, v16, v10
    v_mfma_f32_16x16x32_bf16 a[32:35], v[56:59], a[200:203], a[32:35]
    ds_read_b64_tr_b16 a[254:255], v4 offset:19968
    s_mov_b32 s6, 790528
    v_add_f32 v14, v14, v18
    v_mfma_f32_16x16x32_bf16 a[28:31], v[56:59], a[196:199], a[28:31]
    buffer_load_dwordx4 a[160:163], v2, s[52:55], s6 offen offset:0
    v_add_f32 v15, v15, v19
    v_mfma_f32_16x16x32_bf16 a[28:31], v[60:63], a[220:223], a[28:31]
    v_add_f32 v16, v16, v20
    v_accvgpr_write_b32 a73, v14
    v_mfma_f32_16x16x32_bf16 a[24:27], v[60:63], a[216:219], a[24:27]
    v_accvgpr_write_b32 a77, v15
    v_accvgpr_write_b32 a81, v16
    v_mfma_f32_16x16x32_bf16 a[24:27], v[56:59], a[192:195], a[24:27]
    v_and_b32 v14, s36, v29
    v_lshlrev_b32 v15, 16, v30
    s_waitcnt lgkmcnt(4)
    v_mfma_f32_16x16x32_bf16 v[160:163], a[240:243], a[192:195], v[160:163]
    buffer_load_dwordx4 a[164:167], v2, s[52:55], s6 offen offset:1024
    v_and_b32 v16, s36, v30
    v_mfma_f32_16x16x32_bf16 v[160:163], a[244:247], a[216:219], v[160:163]
    ds_read_b64_tr_b16 v[56:57], v4 offset:8192
    v_accvgpr_read_b32 v18, a85
    v_mfma_f32_16x16x32_bf16 v[164:167], a[244:247], a[220:223], v[164:167]
    v_accvgpr_read_b32 v19, a89
    v_accvgpr_read_b32 v20, a93
    v_mfma_f32_16x16x32_bf16 v[164:167], a[240:243], a[196:199], v[164:167]
    ds_read_b64_tr_b16 v[58:59], v4 offset:8704
    v_add_f32 v14, v14, v11
    v_mfma_f32_16x16x32_bf16 v[168:171], a[240:243], a[200:203], v[168:171]
    v_add_f32 v15, v15, v12
    v_add_f32 v16, v16, v13
    s_add_u32 s43, s40, 73728
    buffer_load_dwordx3 v[40:42], v0, s[12:15], s43 offen offset:1536
    v_mfma_f32_16x16x32_bf16 v[168:171], a[244:247], a[224:227], v[168:171]
    ds_read_b64_tr_b16 v[60:61], v4 offset:20480
    v_add_f32 v14, v14, v18
    v_mfma_f32_16x16x32_bf16 v[172:175], a[244:247], a[228:231], v[172:175]
    v_add_f32 v15, v15, v19
    v_add_f32 v16, v16, v20
    v_mfma_f32_16x16x32_bf16 v[172:175], a[240:243], a[204:207], v[172:175]
    ds_read_b64_tr_b16 v[62:63], v4 offset:20992
    v_accvgpr_write_b32 a85, v14
    v_mfma_f32_16x16x32_bf16 v[176:179], a[240:243], a[208:211], v[176:179]
    v_accvgpr_write_b32 a89, v15
    v_accvgpr_write_b32 a93, v16
    v_mfma_f32_16x16x32_bf16 v[176:179], a[244:247], a[232:235], v[176:179]
    s_add_u32 s43, s40, 82944
    buffer_load_dwordx3 v[44:46], v0, s[12:15], s43 offen offset:1536
    v_mfma_f32_16x16x32_bf16 v[180:183], a[244:247], a[236:239], v[180:183]
    v_mfma_f32_16x16x32_bf16 v[180:183], a[240:243], a[212:215], v[180:183]
    s_waitcnt lgkmcnt(4)
    v_mfma_f32_16x16x32_bf16 v[204:207], a[248:251], a[212:215], v[204:207]
    s_add_u32 s43, s40, 0
    buffer_load_dwordx3 v[48:50], v0, s[12:15], s43 offen offset:1536
    v_mfma_f32_16x16x32_bf16 v[204:207], a[252:255], a[236:239], v[204:207]
    ds_read_b64_tr_b16 a[240:241], v4 offset:9216
    v_mfma_f32_16x16x32_bf16 v[200:203], a[252:255], a[232:235], v[200:203]
    v_mfma_f32_16x16x32_bf16 v[200:203], a[248:251], a[208:211], v[200:203]
    ds_read_b64_tr_b16 a[242:243], v4 offset:9728
    v_mfma_f32_16x16x32_bf16 v[196:199], a[248:251], a[204:207], v[196:199]
    s_add_u32 s43, s40, 9216
    buffer_load_dwordx3 v[52:54], v0, s[12:15], s43 offen offset:1536
    v_mfma_f32_16x16x32_bf16 v[196:199], a[252:255], a[228:231], v[196:199]
    ds_read_b64_tr_b16 a[244:245], v4 offset:21504
    v_mfma_f32_16x16x32_bf16 v[192:195], a[252:255], a[224:227], v[192:195]
    v_mfma_f32_16x16x32_bf16 v[192:195], a[248:251], a[200:203], v[192:195]
    ds_read_b64_tr_b16 a[246:247], v4 offset:22016
    v_mfma_f32_16x16x32_bf16 v[188:191], a[248:251], a[196:199], v[188:191]
    v_mfma_f32_16x16x32_bf16 v[188:191], a[252:255], a[220:223], v[188:191]
    v_mfma_f32_16x16x32_bf16 v[184:187], a[252:255], a[216:219], v[184:187]
    v_mfma_f32_16x16x32_bf16 v[184:187], a[248:251], a[192:195], v[184:187]
    s_waitcnt lgkmcnt(4)
    v_mfma_f32_16x16x32_bf16 a[48:51], v[56:59], a[192:195], a[48:51]
    s_waitcnt vmcnt(23)
    v_lshlrev_b32 v14, 16, v32
    v_and_b32 v15, s36, v32
    v_mfma_f32_16x16x32_bf16 a[48:51], v[60:63], a[216:219], a[48:51]
    ds_read_b64_tr_b16 a[248:249], v4 offset:10240
    v_lshlrev_b32 v16, 16, v33
    v_mfma_f32_16x16x32_bf16 a[52:55], v[60:63], a[220:223], a[52:55]
    v_accvgpr_read_b32 v18, a1
    v_accvgpr_read_b32 v19, a5
    v_mfma_f32_16x16x32_bf16 a[52:55], v[56:59], a[196:199], a[52:55]
    ds_read_b64_tr_b16 a[250:251], v4 offset:10752
    v_accvgpr_read_b32 v20, a9
    v_mfma_f32_16x16x32_bf16 a[56:59], v[56:59], a[200:203], a[56:59]
    buffer_load_dwordx4 a[168:171], v2, s[52:55], s6 offen offset:2048
    v_add_f32 v14, v14, v8
    v_mfma_f32_16x16x32_bf16 a[56:59], v[60:63], a[224:227], a[56:59]
    ds_read_b64_tr_b16 a[252:253], v4 offset:22528
    v_add_f32 v15, v15, v9
    v_mfma_f32_16x16x32_bf16 a[60:63], v[60:63], a[228:231], a[60:63]
    v_add_f32 v16, v16, v10
    v_add_f32 v14, v14, v18
    v_mfma_f32_16x16x32_bf16 a[60:63], v[56:59], a[204:207], a[60:63]
    ds_read_b64_tr_b16 a[254:255], v4 offset:23040
    v_add_f32 v15, v15, v19
    v_mfma_f32_16x16x32_bf16 a[64:67], v[56:59], a[208:211], a[64:67]
    buffer_load_dwordx4 a[172:175], v2, s[52:55], s6 offen offset:3072
    v_add_f32 v16, v16, v20
    v_mfma_f32_16x16x32_bf16 a[64:67], v[60:63], a[232:235], a[64:67]
    v_accvgpr_write_b32 a1, v14
    v_accvgpr_write_b32 a5, v15
    v_mfma_f32_16x16x32_bf16 a[68:71], v[60:63], a[236:239], a[68:71]
    v_accvgpr_write_b32 a9, v16
    v_and_b32 v14, s36, v33
    v_mfma_f32_16x16x32_bf16 a[68:71], v[56:59], a[212:215], a[68:71]
    s_mov_b32 s6, 794624
    v_lshlrev_b32 v15, 16, v34
    v_and_b32 v16, s36, v34
    s_waitcnt lgkmcnt(4)
    v_mfma_f32_16x16x32_bf16 v[228:231], a[240:243], a[212:215], v[228:231]
    buffer_load_dwordx4 a[176:179], v2, s[52:55], s6 offen offset:0
    v_accvgpr_read_b32 v18, a13
    v_mfma_f32_16x16x32_bf16 v[228:231], a[244:247], a[236:239], v[228:231]
    ds_read_b64_tr_b16 v[56:57], v4 offset:11264
    v_accvgpr_read_b32 v19, a17
    v_mfma_f32_16x16x32_bf16 v[224:227], a[244:247], a[232:235], v[224:227]
    v_accvgpr_read_b32 v20, a21
    v_add_f32 v14, v14, v11
    v_mfma_f32_16x16x32_bf16 v[224:227], a[240:243], a[208:211], v[224:227]
    ds_read_b64_tr_b16 v[58:59], v4 offset:11776
    v_add_f32 v15, v15, v12
    v_mfma_f32_16x16x32_bf16 v[220:223], a[240:243], a[204:207], v[220:223]
    buffer_load_dwordx4 a[180:183], v2, s[52:55], s6 offen offset:1024
    v_add_f32 v16, v16, v13
    v_mfma_f32_16x16x32_bf16 v[220:223], a[244:247], a[228:231], v[220:223]
    ds_read_b64_tr_b16 v[60:61], v4 offset:23552
    v_add_f32 v14, v14, v18
    v_mfma_f32_16x16x32_bf16 v[216:219], a[244:247], a[224:227], v[216:219]
    v_add_f32 v15, v15, v19
    v_add_f32 v16, v16, v20
    v_mfma_f32_16x16x32_bf16 v[216:219], a[240:243], a[200:203], v[216:219]
    ds_read_b64_tr_b16 v[62:63], v4 offset:24064
    v_accvgpr_write_b32 a13, v14
    v_mfma_f32_16x16x32_bf16 v[212:215], a[240:243], a[196:199], v[212:215]
    buffer_load_dwordx4 a[184:187], v2, s[52:55], s6 offen offset:2048
    v_accvgpr_write_b32 a17, v15
    v_mfma_f32_16x16x32_bf16 v[212:215], a[244:247], a[220:223], v[212:215]
    v_accvgpr_write_b32 a21, v16
    v_mfma_f32_16x16x32_bf16 v[208:211], a[244:247], a[216:219], v[208:211]
    v_mfma_f32_16x16x32_bf16 v[208:211], a[240:243], a[192:195], v[208:211]
    s_waitcnt lgkmcnt(0)
    s_barrier
    v_mfma_f32_16x16x32_bf16 v[232:235], a[248:251], a[192:195], v[232:235]
    buffer_load_dwordx4 a[188:191], v2, s[52:55], s6 offen offset:3072
    v_mfma_f32_16x16x32_bf16 v[232:235], a[252:255], a[216:219], v[232:235]
    ds_read_b64_tr_b16 a[240:241], v3 offset:0
    v_mfma_f32_16x16x32_bf16 v[236:239], a[252:255], a[220:223], v[236:239]
    v_mfma_f32_16x16x32_bf16 v[236:239], a[248:251], a[196:199], v[236:239]
    ds_read_b64_tr_b16 a[242:243], v3 offset:512
    v_mfma_f32_16x16x32_bf16 v[240:243], a[248:251], a[200:203], v[240:243]
    v_mfma_f32_16x16x32_bf16 v[240:243], a[252:255], a[224:227], v[240:243]
    ds_read_b64_tr_b16 a[244:245], v3 offset:12288
    v_mfma_f32_16x16x32_bf16 v[244:247], a[252:255], a[228:231], v[244:247]
    v_mfma_f32_16x16x32_bf16 v[244:247], a[248:251], a[204:207], v[244:247]
    ds_read_b64_tr_b16 a[246:247], v3 offset:12800
    v_mfma_f32_16x16x32_bf16 v[248:251], a[248:251], a[208:211], v[248:251]
    v_mfma_f32_16x16x32_bf16 v[248:251], a[252:255], a[232:235], v[248:251]
    v_mfma_f32_16x16x32_bf16 v[252:255], a[252:255], a[236:239], v[252:255]
    v_mfma_f32_16x16x32_bf16 v[252:255], a[248:251], a[212:215], v[252:255]
    v_mfma_f32_16x16x32_bf16 a[92:95], v[56:59], a[212:215], a[92:95]
    s_waitcnt vmcnt(28)
    v_lshlrev_b32 v14, 16, v36
    v_and_b32 v15, s36, v36
    v_mfma_f32_16x16x32_bf16 a[92:95], v[60:63], a[236:239], a[92:95]
    ds_read_b64_tr_b16 a[248:249], v3 offset:1024
    v_lshlrev_b32 v16, 16, v37
    v_mfma_f32_16x16x32_bf16 a[88:91], v[60:63], a[232:235], a[88:91]
    v_accvgpr_read_b32 v18, a25
    v_accvgpr_read_b32 v19, a29
    v_mfma_f32_16x16x32_bf16 a[88:91], v[56:59], a[208:211], a[88:91]
    ds_read_b64_tr_b16 a[250:251], v3 offset:1536
    v_accvgpr_read_b32 v20, a33
    v_mfma_f32_16x16x32_bf16 a[84:87], v[56:59], a[204:207], a[84:87]
    v_add_f32 v14, v14, v8
    v_add_f32 v15, v15, v9
    v_mfma_f32_16x16x32_bf16 a[84:87], v[60:63], a[228:231], a[84:87]
    ds_read_b64_tr_b16 a[252:253], v3 offset:13312
    v_add_f32 v16, v16, v10
    v_mfma_f32_16x16x32_bf16 a[80:83], v[60:63], a[224:227], a[80:83]
    v_add_f32 v14, v14, v18
    v_add_f32 v15, v15, v19
    v_mfma_f32_16x16x32_bf16 a[80:83], v[56:59], a[200:203], a[80:83]
    ds_read_b64_tr_b16 a[254:255], v3 offset:13824
    v_add_f32 v16, v16, v20
    v_mfma_f32_16x16x32_bf16 a[76:79], v[56:59], a[196:199], a[76:79]
    v_accvgpr_write_b32 a25, v14
    v_accvgpr_write_b32 a29, v15
    v_mfma_f32_16x16x32_bf16 a[76:79], v[60:63], a[220:223], a[76:79]
    v_accvgpr_write_b32 a33, v16
    v_and_b32 v14, s36, v37
    v_mfma_f32_16x16x32_bf16 a[72:75], v[60:63], a[216:219], a[72:75]
    v_lshlrev_b32 v15, 16, v38
    v_and_b32 v16, s36, v38
    v_mfma_f32_16x16x32_bf16 a[72:75], v[56:59], a[192:195], a[72:75]
    v_accvgpr_read_b32 v18, a37
    v_accvgpr_read_b32 v19, a41
    s_waitcnt vmcnt(22)
    s_waitcnt lgkmcnt(4)
    v_mfma_f32_16x16x32_bf16 v[64:67], a[240:243], a[96:99], v[64:67]
    v_accvgpr_read_b32 v20, a45
    v_add_f32 v14, v14, v11
    v_mfma_f32_16x16x32_bf16 v[64:67], a[244:247], a[120:123], v[64:67]
    ds_read_b64_tr_b16 v[56:57], v3 offset:2048
    v_add_f32 v15, v15, v12
    v_mfma_f32_16x16x32_bf16 v[68:71], a[244:247], a[124:127], v[68:71]
    v_add_f32 v16, v16, v13
    v_add_f32 v14, v14, v18
    v_mfma_f32_16x16x32_bf16 v[68:71], a[240:243], a[100:103], v[68:71]
    ds_read_b64_tr_b16 v[58:59], v3 offset:2560
    s_add_u32 m0, s39, 49152
    v_add_f32 v15, v15, v19
    v_mfma_f32_16x16x32_bf16 v[72:75], a[240:243], a[104:107], v[72:75]
    buffer_load_dwordx4 v1, s[56:59], s4 offen offset:0 nt lds
    v_add_f32 v16, v16, v20
    v_mfma_f32_16x16x32_bf16 v[72:75], a[244:247], a[128:131], v[72:75]
    ds_read_b64_tr_b16 v[60:61], v3 offset:14336
    v_accvgpr_write_b32 a37, v14
    v_mfma_f32_16x16x32_bf16 v[76:79], a[244:247], a[132:135], v[76:79]
    v_accvgpr_write_b32 a41, v15
    v_accvgpr_write_b32 a45, v16
    v_mfma_f32_16x16x32_bf16 v[76:79], a[240:243], a[108:111], v[76:79]
    ds_read_b64_tr_b16 v[62:63], v3 offset:14848
    s_add_u32 m0, s39, 49152
    v_mfma_f32_16x16x32_bf16 v[80:83], a[240:243], a[112:115], v[80:83]
    buffer_load_dwordx4 v1, s[56:59], s4 offen offset:1024 nt lds
    v_mfma_f32_16x16x32_bf16 v[80:83], a[244:247], a[136:139], v[80:83]
    v_mfma_f32_16x16x32_bf16 v[84:87], a[244:247], a[140:143], v[84:87]
    v_mfma_f32_16x16x32_bf16 v[84:87], a[240:243], a[116:119], v[84:87]
    s_add_u32 m0, s39, 49152
    s_waitcnt lgkmcnt(4)
    v_mfma_f32_16x16x32_bf16 v[108:111], a[248:251], a[116:119], v[108:111]
    buffer_load_dwordx4 v1, s[56:59], s4 offen offset:2048 nt lds
    v_mfma_f32_16x16x32_bf16 v[108:111], a[252:255], a[140:143], v[108:111]
    ds_read_b64_tr_b16 a[240:241], v3 offset:3072
    v_mfma_f32_16x16x32_bf16 v[104:107], a[252:255], a[136:139], v[104:107]
    v_mfma_f32_16x16x32_bf16 v[104:107], a[248:251], a[112:115], v[104:107]
    ds_read_b64_tr_b16 a[242:243], v3 offset:3584
    s_add_u32 m0, s39, 61440
    v_mfma_f32_16x16x32_bf16 v[100:103], a[248:251], a[108:111], v[100:103]
    buffer_load_dwordx4 v1, s[60:63], s29 offen offset:0 nt lds
    v_mfma_f32_16x16x32_bf16 v[100:103], a[252:255], a[132:135], v[100:103]
    ds_read_b64_tr_b16 a[244:245], v3 offset:15360
    v_mfma_f32_16x16x32_bf16 v[96:99], a[252:255], a[128:131], v[96:99]
    v_mfma_f32_16x16x32_bf16 v[96:99], a[248:251], a[104:107], v[96:99]
    ds_read_b64_tr_b16 a[246:247], v3 offset:15872
    s_add_u32 m0, s39, 61440
    v_mfma_f32_16x16x32_bf16 v[92:95], a[248:251], a[100:103], v[92:95]
    buffer_load_dwordx4 v1, s[60:63], s29 offen offset:1024 nt lds
    v_mfma_f32_16x16x32_bf16 v[92:95], a[252:255], a[124:127], v[92:95]
    v_mfma_f32_16x16x32_bf16 v[88:91], a[252:255], a[120:123], v[88:91]
    v_mfma_f32_16x16x32_bf16 v[88:91], a[248:251], a[96:99], v[88:91]
    s_add_u32 m0, s39, 61440
    s_waitcnt lgkmcnt(4)
    v_mfma_f32_16x16x32_bf16 a[0:3], v[56:59], a[96:99], a[0:3]
    buffer_load_dwordx4 v1, s[60:63], s29 offen offset:2048 nt lds
    v_mfma_f32_16x16x32_bf16 a[0:3], v[60:63], a[120:123], a[0:3]
    ds_read_b64_tr_b16 a[248:249], v3 offset:4096
    v_mfma_f32_16x16x32_bf16 a[4:7], v[60:63], a[124:127], a[4:7]
    s_waitcnt vmcnt(15)
    v_lshlrev_b32 v14, 16, v40
    v_mfma_f32_16x16x32_bf16 a[4:7], v[56:59], a[100:103], a[4:7]
    ds_read_b64_tr_b16 a[250:251], v3 offset:4608
    v_mfma_f32_16x16x32_bf16 a[8:11], v[56:59], a[104:107], a[8:11]
    v_and_b32 v15, s36, v40
    v_mfma_f32_16x16x32_bf16 a[8:11], v[60:63], a[128:131], a[8:11]
    ds_read_b64_tr_b16 a[252:253], v3 offset:16384
    v_mfma_f32_16x16x32_bf16 a[12:15], v[60:63], a[132:135], a[12:15]
    v_lshlrev_b32 v16, 16, v41
    v_mfma_f32_16x16x32_bf16 a[12:15], v[56:59], a[108:111], a[12:15]
    ds_read_b64_tr_b16 a[254:255], v3 offset:16896
    v_mfma_f32_16x16x32_bf16 a[16:19], v[56:59], a[112:115], a[16:19]
    v_add_f32 v14, v14, v8
    v_mfma_f32_16x16x32_bf16 a[16:19], v[60:63], a[136:139], a[16:19]
    v_add_f32 v15, v15, v9
    v_mfma_f32_16x16x32_bf16 a[20:23], v[60:63], a[140:143], a[20:23]
    v_add_f32 v16, v16, v10
    v_mfma_f32_16x16x32_bf16 a[20:23], v[56:59], a[116:119], a[20:23]
    v_add_f32 v162, v14, v162
    s_waitcnt lgkmcnt(4)
    v_mfma_f32_16x16x32_bf16 v[132:135], a[240:243], a[116:119], v[132:135]
    v_add_f32 v166, v15, v166
    v_mfma_f32_16x16x32_bf16 v[132:135], a[244:247], a[140:143], v[132:135]
    ds_read_b64_tr_b16 v[56:57], v3 offset:5120
    v_mfma_f32_16x16x32_bf16 v[128:131], a[244:247], a[136:139], v[128:131]
    v_add_f32 v170, v16, v170
    v_mfma_f32_16x16x32_bf16 v[128:131], a[240:243], a[112:115], v[128:131]
    ds_read_b64_tr_b16 v[58:59], v3 offset:5632
    v_mfma_f32_16x16x32_bf16 v[124:127], a[240:243], a[108:111], v[124:127]
    v_and_b32 v14, s36, v41
    v_mfma_f32_16x16x32_bf16 v[124:127], a[244:247], a[132:135], v[124:127]
    ds_read_b64_tr_b16 v[60:61], v3 offset:17408
    v_mfma_f32_16x16x32_bf16 v[120:123], a[244:247], a[128:131], v[120:123]
    v_lshlrev_b32 v15, 16, v42
    v_mfma_f32_16x16x32_bf16 v[120:123], a[240:243], a[104:107], v[120:123]
    ds_read_b64_tr_b16 v[62:63], v3 offset:17920
    v_mfma_f32_16x16x32_bf16 v[116:119], a[240:243], a[100:103], v[116:119]
    v_and_b32 v16, s36, v42
    v_mfma_f32_16x16x32_bf16 v[116:119], a[244:247], a[124:127], v[116:119]
    v_add_f32 v14, v14, v11
    v_mfma_f32_16x16x32_bf16 v[112:115], a[244:247], a[120:123], v[112:115]
    v_add_f32 v15, v15, v12
    v_mfma_f32_16x16x32_bf16 v[112:115], a[240:243], a[96:99], v[112:115]
    v_add_f32 v16, v16, v13
    s_waitcnt lgkmcnt(4)
    v_mfma_f32_16x16x32_bf16 v[136:139], a[248:251], a[96:99], v[136:139]
    v_add_f32 v174, v14, v174
    v_mfma_f32_16x16x32_bf16 v[136:139], a[252:255], a[120:123], v[136:139]
    ds_read_b64_tr_b16 a[240:241], v3 offset:6144
    v_mfma_f32_16x16x32_bf16 v[140:143], a[252:255], a[124:127], v[140:143]
    v_add_f32 v178, v15, v178
    v_mfma_f32_16x16x32_bf16 v[140:143], a[248:251], a[100:103], v[140:143]
    ds_read_b64_tr_b16 a[242:243], v3 offset:6656
    s_mov_b32 s6, 835584
    v_mfma_f32_16x16x32_bf16 v[144:147], a[248:251], a[104:107], v[144:147]
    buffer_load_dwordx4 a[192:195], v2, s[52:55], s6 offen offset:0
    v_mfma_f32_16x16x32_bf16 v[144:147], a[252:255], a[128:131], v[144:147]
    ds_read_b64_tr_b16 a[244:245], v3 offset:18432
    v_mfma_f32_16x16x32_bf16 v[148:151], a[252:255], a[132:135], v[148:151]
    v_add_f32 v182, v16, v182
    v_mfma_f32_16x16x32_bf16 v[148:151], a[248:251], a[108:111], v[148:151]
    ds_read_b64_tr_b16 a[246:247], v3 offset:18944
    v_mfma_f32_16x16x32_bf16 v[152:155], a[248:251], a[112:115], v[152:155]
    buffer_load_dwordx4 a[196:199], v2, s[52:55], s6 offen offset:1024
    v_mfma_f32_16x16x32_bf16 v[152:155], a[252:255], a[136:139], v[152:155]
    v_mfma_f32_16x16x32_bf16 v[156:159], a[252:255], a[140:143], v[156:159]
    v_mfma_f32_16x16x32_bf16 v[156:159], a[248:251], a[116:119], v[156:159]
    s_waitcnt lgkmcnt(4)
    v_mfma_f32_16x16x32_bf16 a[44:47], v[56:59], a[116:119], a[44:47]
    buffer_load_dwordx4 a[200:203], v2, s[52:55], s6 offen offset:2048
    v_mfma_f32_16x16x32_bf16 a[44:47], v[60:63], a[140:143], a[44:47]
    ds_read_b64_tr_b16 a[248:249], v3 offset:7168
    v_mfma_f32_16x16x32_bf16 a[40:43], v[60:63], a[136:139], a[40:43]
    s_waitcnt vmcnt(17)
    v_lshlrev_b32 v14, 16, v44
    v_mfma_f32_16x16x32_bf16 a[40:43], v[56:59], a[112:115], a[40:43]
    ds_read_b64_tr_b16 a[250:251], v3 offset:7680
    v_mfma_f32_16x16x32_bf16 a[36:39], v[56:59], a[108:111], a[36:39]
    buffer_load_dwordx4 a[204:207], v2, s[52:55], s6 offen offset:3072
    v_mfma_f32_16x16x32_bf16 a[36:39], v[60:63], a[132:135], a[36:39]
    ds_read_b64_tr_b16 a[252:253], v3 offset:19456
    v_mfma_f32_16x16x32_bf16 a[32:35], v[60:63], a[128:131], a[32:35]
    v_and_b32 v15, s36, v44
    v_mfma_f32_16x16x32_bf16 a[32:35], v[56:59], a[104:107], a[32:35]
    ds_read_b64_tr_b16 a[254:255], v3 offset:19968
    s_mov_b32 s6, 839680
    v_mfma_f32_16x16x32_bf16 a[28:31], v[56:59], a[100:103], a[28:31]
    buffer_load_dwordx4 a[208:211], v2, s[52:55], s6 offen offset:0
    v_mfma_f32_16x16x32_bf16 a[28:31], v[60:63], a[124:127], a[28:31]
    v_lshlrev_b32 v16, 16, v45
    v_mfma_f32_16x16x32_bf16 a[24:27], v[60:63], a[120:123], a[24:27]
    v_add_f32 v14, v14, v8
    v_mfma_f32_16x16x32_bf16 a[24:27], v[56:59], a[96:99], a[24:27]
    v_add_f32 v15, v15, v9
    s_waitcnt lgkmcnt(4)
    v_mfma_f32_16x16x32_bf16 v[160:163], a[240:243], a[96:99], v[160:163]
    buffer_load_dwordx4 a[212:215], v2, s[52:55], s6 offen offset:1024
    v_mfma_f32_16x16x32_bf16 v[160:163], a[244:247], a[120:123], v[160:163]
    ds_read_b64_tr_b16 v[56:57], v3 offset:8192
    v_mfma_f32_16x16x32_bf16 v[164:167], a[244:247], a[124:127], v[164:167]
    v_add_f32 v16, v16, v10
    v_mfma_f32_16x16x32_bf16 v[164:167], a[240:243], a[100:103], v[164:167]
    ds_read_b64_tr_b16 v[58:59], v3 offset:8704
    v_mfma_f32_16x16x32_bf16 v[168:171], a[240:243], a[104:107], v[168:171]
    v_add_f32 v210, v14, v210
    s_add_u32 s43, s40, 76800
    buffer_load_dwordx3 v[24:26], v0, s[12:15], s43 offen offset:1536
    v_mfma_f32_16x16x32_bf16 v[168:171], a[244:247], a[128:131], v[168:171]
    ds_read_b64_tr_b16 v[60:61], v3 offset:20480
    v_mfma_f32_16x16x32_bf16 v[172:175], a[244:247], a[132:135], v[172:175]
    v_add_f32 v214, v15, v214
    v_mfma_f32_16x16x32_bf16 v[172:175], a[240:243], a[108:111], v[172:175]
    ds_read_b64_tr_b16 v[62:63], v3 offset:20992
    v_mfma_f32_16x16x32_bf16 v[176:179], a[240:243], a[112:115], v[176:179]
    v_add_f32 v218, v16, v218
    s_add_u32 s43, s40, 86016
    buffer_load_dwordx3 v[28:30], v0, s[12:15], s43 offen offset:1536
    v_mfma_f32_16x16x32_bf16 v[176:179], a[244:247], a[136:139], v[176:179]
    v_and_b32 v14, s36, v45
    v_mfma_f32_16x16x32_bf16 v[180:183], a[244:247], a[140:143], v[180:183]
    v_lshlrev_b32 v15, 16, v46
    v_mfma_f32_16x16x32_bf16 v[180:183], a[240:243], a[116:119], v[180:183]
    v_and_b32 v16, s36, v46
    s_waitcnt lgkmcnt(4)
    v_mfma_f32_16x16x32_bf16 v[204:207], a[248:251], a[116:119], v[204:207]
    v_add_f32 v14, v14, v11
    s_add_u32 s43, s40, 3072
    buffer_load_dwordx3 v[32:34], v0, s[12:15], s43 offen offset:1536
    v_mfma_f32_16x16x32_bf16 v[204:207], a[252:255], a[140:143], v[204:207]
    ds_read_b64_tr_b16 a[240:241], v3 offset:9216
    v_mfma_f32_16x16x32_bf16 v[200:203], a[252:255], a[136:139], v[200:203]
    v_add_f32 v15, v15, v12
    v_mfma_f32_16x16x32_bf16 v[200:203], a[248:251], a[112:115], v[200:203]
    ds_read_b64_tr_b16 a[242:243], v3 offset:9728
    v_mfma_f32_16x16x32_bf16 v[196:199], a[248:251], a[108:111], v[196:199]
    v_add_f32 v16, v16, v13
    s_add_u32 s43, s40, 12288
    buffer_load_dwordx3 v[36:38], v0, s[12:15], s43 offen offset:1536
    v_mfma_f32_16x16x32_bf16 v[196:199], a[252:255], a[132:135], v[196:199]
    ds_read_b64_tr_b16 a[244:245], v3 offset:21504
    v_mfma_f32_16x16x32_bf16 v[192:195], a[252:255], a[128:131], v[192:195]
    v_add_f32 v222, v14, v222
    v_mfma_f32_16x16x32_bf16 v[192:195], a[248:251], a[104:107], v[192:195]
    ds_read_b64_tr_b16 a[246:247], v3 offset:22016
    v_mfma_f32_16x16x32_bf16 v[188:191], a[248:251], a[100:103], v[188:191]
    v_add_f32 v226, v15, v226
    v_mfma_f32_16x16x32_bf16 v[188:191], a[252:255], a[124:127], v[188:191]
    v_add_f32 v230, v16, v230
    v_mfma_f32_16x16x32_bf16 v[184:187], a[252:255], a[120:123], v[184:187]
    v_mfma_f32_16x16x32_bf16 v[184:187], a[248:251], a[96:99], v[184:187]
    s_waitcnt lgkmcnt(4)
    v_mfma_f32_16x16x32_bf16 a[48:51], v[56:59], a[96:99], a[48:51]
    s_waitcnt vmcnt(23)
    v_lshlrev_b32 v14, 16, v48
    v_mfma_f32_16x16x32_bf16 a[48:51], v[60:63], a[120:123], a[48:51]
    ds_read_b64_tr_b16 a[248:249], v3 offset:10240
    v_mfma_f32_16x16x32_bf16 a[52:55], v[60:63], a[124:127], a[52:55]
    v_and_b32 v15, s36, v48
    v_mfma_f32_16x16x32_bf16 a[52:55], v[56:59], a[100:103], a[52:55]
    ds_read_b64_tr_b16 a[250:251], v3 offset:10752
    v_mfma_f32_16x16x32_bf16 a[56:59], v[56:59], a[104:107], a[56:59]
    buffer_load_dwordx4 a[216:219], v2, s[52:55], s6 offen offset:2048
    v_mfma_f32_16x16x32_bf16 a[56:59], v[60:63], a[128:131], a[56:59]
    ds_read_b64_tr_b16 a[252:253], v3 offset:22528
    v_mfma_f32_16x16x32_bf16 a[60:63], v[60:63], a[132:135], a[60:63]
    v_lshlrev_b32 v16, 16, v49
    v_mfma_f32_16x16x32_bf16 a[60:63], v[56:59], a[108:111], a[60:63]
    ds_read_b64_tr_b16 a[254:255], v3 offset:23040
    v_mfma_f32_16x16x32_bf16 a[64:67], v[56:59], a[112:115], a[64:67]
    buffer_load_dwordx4 a[220:223], v2, s[52:55], s6 offen offset:3072
    v_mfma_f32_16x16x32_bf16 a[64:67], v[60:63], a[136:139], a[64:67]
    v_add_f32 v14, v14, v8
    v_mfma_f32_16x16x32_bf16 a[68:71], v[60:63], a[140:143], a[68:71]
    v_add_f32 v15, v15, v9
    v_mfma_f32_16x16x32_bf16 a[68:71], v[56:59], a[116:119], a[68:71]
    s_mov_b32 s6, 843776
    v_add_f32 v16, v16, v10
    s_waitcnt lgkmcnt(4)
    v_mfma_f32_16x16x32_bf16 v[228:231], a[240:243], a[116:119], v[228:231]
    buffer_load_dwordx4 a[224:227], v2, s[52:55], s6 offen offset:0
    v_mfma_f32_16x16x32_bf16 v[228:231], a[244:247], a[140:143], v[228:231]
    ds_read_b64_tr_b16 v[56:57], v3 offset:11264
    v_mfma_f32_16x16x32_bf16 v[224:227], a[244:247], a[136:139], v[224:227]
    v_add_f32 v66, v14, v66
    v_mfma_f32_16x16x32_bf16 v[224:227], a[240:243], a[112:115], v[224:227]
    ds_read_b64_tr_b16 v[58:59], v3 offset:11776
    v_mfma_f32_16x16x32_bf16 v[220:223], a[240:243], a[108:111], v[220:223]
    buffer_load_dwordx4 a[228:231], v2, s[52:55], s6 offen offset:1024
    v_mfma_f32_16x16x32_bf16 v[220:223], a[244:247], a[132:135], v[220:223]
    ds_read_b64_tr_b16 v[60:61], v3 offset:23552
    v_mfma_f32_16x16x32_bf16 v[216:219], a[244:247], a[128:131], v[216:219]
    v_add_f32 v70, v15, v70
    v_mfma_f32_16x16x32_bf16 v[216:219], a[240:243], a[104:107], v[216:219]
    ds_read_b64_tr_b16 v[62:63], v3 offset:24064
    v_mfma_f32_16x16x32_bf16 v[212:215], a[240:243], a[100:103], v[212:215]
    buffer_load_dwordx4 a[232:235], v2, s[52:55], s6 offen offset:2048
    v_mfma_f32_16x16x32_bf16 v[212:215], a[244:247], a[124:127], v[212:215]
    v_add_f32 v74, v16, v74
    v_mfma_f32_16x16x32_bf16 v[208:211], a[244:247], a[120:123], v[208:211]
    v_and_b32 v14, s36, v49
    v_mfma_f32_16x16x32_bf16 v[208:211], a[240:243], a[96:99], v[208:211]
    v_lshlrev_b32 v15, 16, v50
    s_waitcnt lgkmcnt(0)
    s_barrier
    v_mfma_f32_16x16x32_bf16 v[232:235], a[248:251], a[96:99], v[232:235]
    buffer_load_dwordx4 a[236:239], v2, s[52:55], s6 offen offset:3072
    v_mfma_f32_16x16x32_bf16 v[232:235], a[252:255], a[120:123], v[232:235]
    ds_read_b64_tr_b16 a[240:241], v3 offset:24576
    v_mfma_f32_16x16x32_bf16 v[236:239], a[252:255], a[124:127], v[236:239]
    v_and_b32 v16, s36, v50
    v_mfma_f32_16x16x32_bf16 v[236:239], a[248:251], a[100:103], v[236:239]
    ds_read_b64_tr_b16 a[242:243], v3 offset:25088
    v_mfma_f32_16x16x32_bf16 v[240:243], a[248:251], a[104:107], v[240:243]
    v_add_f32 v14, v14, v11
    v_mfma_f32_16x16x32_bf16 v[240:243], a[252:255], a[128:131], v[240:243]
    ds_read_b64_tr_b16 a[244:245], v3 offset:36864
    v_mfma_f32_16x16x32_bf16 v[244:247], a[252:255], a[132:135], v[244:247]
    v_add_f32 v15, v15, v12
    v_mfma_f32_16x16x32_bf16 v[244:247], a[248:251], a[108:111], v[244:247]
    ds_read_b64_tr_b16 a[246:247], v3 offset:37376
    v_mfma_f32_16x16x32_bf16 v[248:251], a[248:251], a[112:115], v[248:251]
    v_add_f32 v16, v16, v13
    v_mfma_f32_16x16x32_bf16 v[248:251], a[252:255], a[136:139], v[248:251]
    v_add_f32 v78, v14, v78
    v_mfma_f32_16x16x32_bf16 v[252:255], a[252:255], a[140:143], v[252:255]
    v_add_f32 v82, v15, v82
    v_mfma_f32_16x16x32_bf16 v[252:255], a[248:251], a[116:119], v[252:255]
    v_add_f32 v86, v16, v86
    v_mfma_f32_16x16x32_bf16 a[92:95], v[56:59], a[116:119], a[92:95]
    s_waitcnt vmcnt(28)
    v_lshlrev_b32 v14, 16, v52
    v_mfma_f32_16x16x32_bf16 a[92:95], v[60:63], a[140:143], a[92:95]
    ds_read_b64_tr_b16 a[248:249], v3 offset:25600
    v_mfma_f32_16x16x32_bf16 a[88:91], v[60:63], a[136:139], a[88:91]
    v_and_b32 v15, s36, v52
    v_mfma_f32_16x16x32_bf16 a[88:91], v[56:59], a[112:115], a[88:91]
    ds_read_b64_tr_b16 a[250:251], v3 offset:26112
    v_mfma_f32_16x16x32_bf16 a[84:87], v[56:59], a[108:111], a[84:87]
    v_lshlrev_b32 v16, 16, v53
    v_mfma_f32_16x16x32_bf16 a[84:87], v[60:63], a[132:135], a[84:87]
    ds_read_b64_tr_b16 a[252:253], v3 offset:37888
    v_mfma_f32_16x16x32_bf16 a[80:83], v[60:63], a[128:131], a[80:83]
    v_add_f32 v14, v14, v8
    v_mfma_f32_16x16x32_bf16 a[80:83], v[56:59], a[104:107], a[80:83]
    ds_read_b64_tr_b16 a[254:255], v3 offset:38400
    v_mfma_f32_16x16x32_bf16 a[76:79], v[56:59], a[100:103], a[76:79]
    v_add_f32 v15, v15, v9
    v_mfma_f32_16x16x32_bf16 a[76:79], v[60:63], a[124:127], a[76:79]
    v_add_f32 v16, v16, v10
    v_mfma_f32_16x16x32_bf16 a[72:75], v[60:63], a[120:123], a[72:75]
    v_add_f32 v114, v14, v114
    v_mfma_f32_16x16x32_bf16 a[72:75], v[56:59], a[96:99], a[72:75]
    v_add_f32 v118, v15, v118
    s_waitcnt vmcnt(22)
    s_waitcnt lgkmcnt(4)
    v_mfma_f32_16x16x32_bf16 v[64:67], a[240:243], a[144:147], v[64:67]
    v_add_f32 v122, v16, v122
    v_mfma_f32_16x16x32_bf16 v[64:67], a[244:247], a[168:171], v[64:67]
    ds_read_b64_tr_b16 v[56:57], v3 offset:26624
    v_mfma_f32_16x16x32_bf16 v[68:71], a[244:247], a[172:175], v[68:71]
    s_add_u32 s4, s4, 36864
    v_and_b32 v14, s36, v53
    v_mfma_f32_16x16x32_bf16 v[68:71], a[240:243], a[148:151], v[68:71]
    ds_read_b64_tr_b16 v[58:59], v3 offset:27136
    s_add_u32 s29, s29, 12288
    s_add_u32 s5, s4, 4096
    s_add_u32 m0, s32, 0
    v_mfma_f32_16x16x32_bf16 v[72:75], a[240:243], a[152:155], v[72:75]
    buffer_load_dwordx4 v1, s[8:11], s4 offen offset:0 nt lds
    v_mfma_f32_16x16x32_bf16 v[72:75], a[244:247], a[176:179], v[72:75]
    ds_read_b64_tr_b16 v[60:61], v3 offset:38912
    v_mfma_f32_16x16x32_bf16 v[76:79], a[244:247], a[180:183], v[76:79]
    v_lshlrev_b32 v15, 16, v54
    v_mfma_f32_16x16x32_bf16 v[76:79], a[240:243], a[156:159], v[76:79]
    ds_read_b64_tr_b16 v[62:63], v3 offset:39424
    s_add_u32 m0, s32, 0
    v_mfma_f32_16x16x32_bf16 v[80:83], a[240:243], a[160:163], v[80:83]
    buffer_load_dwordx4 v1, s[8:11], s4 offen offset:1024 nt lds
    v_mfma_f32_16x16x32_bf16 v[80:83], a[244:247], a[184:187], v[80:83]
    v_and_b32 v16, s36, v54
    v_mfma_f32_16x16x32_bf16 v[84:87], a[244:247], a[188:191], v[84:87]
    v_add_f32 v14, v14, v11
    v_mfma_f32_16x16x32_bf16 v[84:87], a[240:243], a[164:167], v[84:87]
    s_add_u32 m0, s32, 0
    v_add_f32 v15, v15, v12
    s_waitcnt lgkmcnt(4)
    v_mfma_f32_16x16x32_bf16 v[108:111], a[248:251], a[164:167], v[108:111]
    buffer_load_dwordx4 v1, s[8:11], s4 offen offset:2048 nt lds
    v_mfma_f32_16x16x32_bf16 v[108:111], a[252:255], a[188:191], v[108:111]
    ds_read_b64_tr_b16 a[240:241], v3 offset:27648
    v_mfma_f32_16x16x32_bf16 v[104:107], a[252:255], a[184:187], v[104:107]
    v_add_f32 v16, v16, v13
    v_mfma_f32_16x16x32_bf16 v[104:107], a[248:251], a[160:163], v[104:107]
    ds_read_b64_tr_b16 a[242:243], v3 offset:28160
    s_add_u32 m0, s32, 0
    v_mfma_f32_16x16x32_bf16 v[100:103], a[248:251], a[156:159], v[100:103]
    buffer_load_dwordx4 v1, s[8:11], s4 offen offset:3072 nt lds
    v_mfma_f32_16x16x32_bf16 v[100:103], a[252:255], a[180:183], v[100:103]
    ds_read_b64_tr_b16 a[244:245], v3 offset:39936
    v_mfma_f32_16x16x32_bf16 v[96:99], a[252:255], a[176:179], v[96:99]
    v_add_f32 v126, v14, v126
    v_mfma_f32_16x16x32_bf16 v[96:99], a[248:251], a[152:155], v[96:99]
    ds_read_b64_tr_b16 a[246:247], v3 offset:40448
    s_add_u32 m0, s32, 4096
    v_mfma_f32_16x16x32_bf16 v[92:95], a[248:251], a[148:151], v[92:95]
    buffer_load_dwordx4 v1, s[8:11], s5 offen offset:0 nt lds
    v_mfma_f32_16x16x32_bf16 v[92:95], a[252:255], a[172:175], v[92:95]
    v_add_f32 v130, v15, v130
    v_mfma_f32_16x16x32_bf16 v[88:91], a[252:255], a[168:171], v[88:91]
    v_add_f32 v134, v16, v134
    v_mfma_f32_16x16x32_bf16 v[88:91], a[248:251], a[144:147], v[88:91]
    s_add_u32 m0, s32, 4096
    s_waitcnt lgkmcnt(4)
    v_mfma_f32_16x16x32_bf16 a[0:3], v[56:59], a[144:147], a[0:3]
    buffer_load_dwordx4 v1, s[8:11], s5 offen offset:1024 nt lds
    v_mfma_f32_16x16x32_bf16 a[0:3], v[60:63], a[168:171], a[0:3]
    ds_read_b64_tr_b16 a[248:249], v3 offset:28672
    v_mfma_f32_16x16x32_bf16 a[4:7], v[60:63], a[172:175], a[4:7]
    s_waitcnt vmcnt(15)
    v_lshlrev_b32 v14, 16, v24
    v_mfma_f32_16x16x32_bf16 a[4:7], v[56:59], a[148:151], a[4:7]
    ds_read_b64_tr_b16 a[250:251], v3 offset:29184
    v_mfma_f32_16x16x32_bf16 a[8:11], v[56:59], a[152:155], a[8:11]
    v_and_b32 v15, s36, v24
    v_mfma_f32_16x16x32_bf16 a[8:11], v[60:63], a[176:179], a[8:11]
    ds_read_b64_tr_b16 a[252:253], v3 offset:40960
    v_mfma_f32_16x16x32_bf16 a[12:15], v[60:63], a[180:183], a[12:15]
    v_lshlrev_b32 v16, 16, v25
    v_mfma_f32_16x16x32_bf16 a[12:15], v[56:59], a[156:159], a[12:15]
    ds_read_b64_tr_b16 a[254:255], v3 offset:41472
    v_mfma_f32_16x16x32_bf16 a[16:19], v[56:59], a[160:163], a[16:19]
    v_add_f32 v14, v14, v8
    v_mfma_f32_16x16x32_bf16 a[16:19], v[60:63], a[184:187], a[16:19]
    v_add_f32 v15, v15, v9
    v_mfma_f32_16x16x32_bf16 a[20:23], v[60:63], a[188:191], a[20:23]
    v_add_f32 v16, v16, v10
    v_mfma_f32_16x16x32_bf16 a[20:23], v[56:59], a[164:167], a[20:23]
    v_add_f32 v186, v14, v186
    s_waitcnt lgkmcnt(4)
    v_mfma_f32_16x16x32_bf16 v[132:135], a[240:243], a[164:167], v[132:135]
    v_add_f32 v190, v15, v190
    v_mfma_f32_16x16x32_bf16 v[132:135], a[244:247], a[188:191], v[132:135]
    ds_read_b64_tr_b16 v[56:57], v3 offset:29696
    v_mfma_f32_16x16x32_bf16 v[128:131], a[244:247], a[184:187], v[128:131]
    v_add_f32 v194, v16, v194
    v_mfma_f32_16x16x32_bf16 v[128:131], a[240:243], a[160:163], v[128:131]
    ds_read_b64_tr_b16 v[58:59], v3 offset:30208
    v_mfma_f32_16x16x32_bf16 v[124:127], a[240:243], a[156:159], v[124:127]
    v_and_b32 v14, s36, v25
    v_mfma_f32_16x16x32_bf16 v[124:127], a[244:247], a[180:183], v[124:127]
    ds_read_b64_tr_b16 v[60:61], v3 offset:41984
    v_mfma_f32_16x16x32_bf16 v[120:123], a[244:247], a[176:179], v[120:123]
    v_lshlrev_b32 v15, 16, v26
    v_mfma_f32_16x16x32_bf16 v[120:123], a[240:243], a[152:155], v[120:123]
    ds_read_b64_tr_b16 v[62:63], v3 offset:42496
    v_mfma_f32_16x16x32_bf16 v[116:119], a[240:243], a[148:151], v[116:119]
    v_and_b32 v16, s36, v26
    v_mfma_f32_16x16x32_bf16 v[116:119], a[244:247], a[172:175], v[116:119]
    v_add_f32 v14, v14, v11
    v_mfma_f32_16x16x32_bf16 v[112:115], a[244:247], a[168:171], v[112:115]
    v_add_f32 v15, v15, v12
    v_mfma_f32_16x16x32_bf16 v[112:115], a[240:243], a[144:147], v[112:115]
    v_add_f32 v16, v16, v13
    s_waitcnt lgkmcnt(4)
    v_mfma_f32_16x16x32_bf16 v[136:139], a[248:251], a[144:147], v[136:139]
    v_add_f32 v198, v14, v198
    v_mfma_f32_16x16x32_bf16 v[136:139], a[252:255], a[168:171], v[136:139]
    ds_read_b64_tr_b16 a[240:241], v3 offset:30720
    v_mfma_f32_16x16x32_bf16 v[140:143], a[252:255], a[172:175], v[140:143]
    v_add_f32 v202, v15, v202
    v_mfma_f32_16x16x32_bf16 v[140:143], a[248:251], a[148:151], v[140:143]
    ds_read_b64_tr_b16 a[242:243], v3 offset:31232
    s_mov_b32 s6, 884736
    v_mfma_f32_16x16x32_bf16 v[144:147], a[248:251], a[152:155], v[144:147]
    buffer_load_dwordx4 a[96:99], v2, s[52:55], s6 offen offset:0
    v_mfma_f32_16x16x32_bf16 v[144:147], a[252:255], a[176:179], v[144:147]
    ds_read_b64_tr_b16 a[244:245], v3 offset:43008
    v_mfma_f32_16x16x32_bf16 v[148:151], a[252:255], a[180:183], v[148:151]
    v_add_f32 v206, v16, v206
    v_mfma_f32_16x16x32_bf16 v[148:151], a[248:251], a[156:159], v[148:151]
    ds_read_b64_tr_b16 a[246:247], v3 offset:43520
    v_mfma_f32_16x16x32_bf16 v[152:155], a[248:251], a[160:163], v[152:155]
    buffer_load_dwordx4 a[100:103], v2, s[52:55], s6 offen offset:1024
    v_mfma_f32_16x16x32_bf16 v[152:155], a[252:255], a[184:187], v[152:155]
    v_mfma_f32_16x16x32_bf16 v[156:159], a[252:255], a[188:191], v[156:159]
    v_mfma_f32_16x16x32_bf16 v[156:159], a[248:251], a[164:167], v[156:159]
    s_waitcnt lgkmcnt(4)
    v_mfma_f32_16x16x32_bf16 a[44:47], v[56:59], a[164:167], a[44:47]
    buffer_load_dwordx4 a[104:107], v2, s[52:55], s6 offen offset:2048
    v_mfma_f32_16x16x32_bf16 a[44:47], v[60:63], a[188:191], a[44:47]
    ds_read_b64_tr_b16 a[248:249], v3 offset:31744
    v_mfma_f32_16x16x32_bf16 a[40:43], v[60:63], a[184:187], a[40:43]
    s_waitcnt vmcnt(17)
    v_lshlrev_b32 v14, 16, v28
    v_mfma_f32_16x16x32_bf16 a[40:43], v[56:59], a[160:163], a[40:43]
    ds_read_b64_tr_b16 a[250:251], v3 offset:32256
    v_mfma_f32_16x16x32_bf16 a[36:39], v[56:59], a[156:159], a[36:39]
    buffer_load_dwordx4 a[108:111], v2, s[52:55], s6 offen offset:3072
    v_mfma_f32_16x16x32_bf16 a[36:39], v[60:63], a[180:183], a[36:39]
    ds_read_b64_tr_b16 a[252:253], v3 offset:44032
    v_mfma_f32_16x16x32_bf16 a[32:35], v[60:63], a[176:179], a[32:35]
    v_and_b32 v15, s36, v28
    v_mfma_f32_16x16x32_bf16 a[32:35], v[56:59], a[152:155], a[32:35]
    ds_read_b64_tr_b16 a[254:255], v3 offset:44544
    s_mov_b32 s6, 888832
    v_mfma_f32_16x16x32_bf16 a[28:31], v[56:59], a[148:151], a[28:31]
    buffer_load_dwordx4 a[112:115], v2, s[52:55], s6 offen offset:0
    v_mfma_f32_16x16x32_bf16 a[28:31], v[60:63], a[172:175], a[28:31]
    v_lshlrev_b32 v16, 16, v29
    v_mfma_f32_16x16x32_bf16 a[24:27], v[60:63], a[168:171], a[24:27]
    v_add_f32 v14, v14, v8
    v_mfma_f32_16x16x32_bf16 a[24:27], v[56:59], a[144:147], a[24:27]
    v_add_f32 v15, v15, v9
    s_waitcnt lgkmcnt(4)
    v_mfma_f32_16x16x32_bf16 v[160:163], a[240:243], a[144:147], v[160:163]
    buffer_load_dwordx4 a[116:119], v2, s[52:55], s6 offen offset:1024
    v_mfma_f32_16x16x32_bf16 v[160:163], a[244:247], a[168:171], v[160:163]
    ds_read_b64_tr_b16 v[56:57], v3 offset:32768
    v_mfma_f32_16x16x32_bf16 v[164:167], a[244:247], a[172:175], v[164:167]
    v_add_f32 v16, v16, v10
    v_mfma_f32_16x16x32_bf16 v[164:167], a[240:243], a[148:151], v[164:167]
    ds_read_b64_tr_b16 v[58:59], v3 offset:33280
    v_mfma_f32_16x16x32_bf16 v[168:171], a[240:243], a[152:155], v[168:171]
    v_add_f32 v234, v14, v234
    s_add_u32 s43, s40, 79872
    buffer_load_dwordx3 v[40:42], v0, s[12:15], s43 offen offset:1536
    v_mfma_f32_16x16x32_bf16 v[168:171], a[244:247], a[176:179], v[168:171]
    ds_read_b64_tr_b16 v[60:61], v3 offset:45056
    v_mfma_f32_16x16x32_bf16 v[172:175], a[244:247], a[180:183], v[172:175]
    v_add_f32 v238, v15, v238
    v_mfma_f32_16x16x32_bf16 v[172:175], a[240:243], a[156:159], v[172:175]
    ds_read_b64_tr_b16 v[62:63], v3 offset:45568
    v_mfma_f32_16x16x32_bf16 v[176:179], a[240:243], a[160:163], v[176:179]
    v_add_f32 v242, v16, v242
    s_add_u32 s43, s40, 89088
    buffer_load_dwordx3 v[44:46], v0, s[12:15], s43 offen offset:1536
    v_mfma_f32_16x16x32_bf16 v[176:179], a[244:247], a[184:187], v[176:179]
    v_and_b32 v14, s36, v29
    v_mfma_f32_16x16x32_bf16 v[180:183], a[244:247], a[188:191], v[180:183]
    v_lshlrev_b32 v15, 16, v30
    v_mfma_f32_16x16x32_bf16 v[180:183], a[240:243], a[164:167], v[180:183]
    v_and_b32 v16, s36, v30
    s_waitcnt lgkmcnt(4)
    v_mfma_f32_16x16x32_bf16 v[204:207], a[248:251], a[164:167], v[204:207]
    v_add_f32 v14, v14, v11
    s_add_u32 s43, s40, 6144
    buffer_load_dwordx3 v[48:50], v0, s[12:15], s43 offen offset:1536
    v_mfma_f32_16x16x32_bf16 v[204:207], a[252:255], a[188:191], v[204:207]
    ds_read_b64_tr_b16 a[240:241], v3 offset:33792
    v_mfma_f32_16x16x32_bf16 v[200:203], a[252:255], a[184:187], v[200:203]
    v_add_f32 v15, v15, v12
    v_mfma_f32_16x16x32_bf16 v[200:203], a[248:251], a[160:163], v[200:203]
    ds_read_b64_tr_b16 a[242:243], v3 offset:34304
    v_mfma_f32_16x16x32_bf16 v[196:199], a[248:251], a[156:159], v[196:199]
    v_add_f32 v16, v16, v13
    s_add_u32 s43, s40, 15360
    buffer_load_dwordx3 v[52:54], v0, s[12:15], s43 offen offset:1536
    v_mfma_f32_16x16x32_bf16 v[196:199], a[252:255], a[180:183], v[196:199]
    ds_read_b64_tr_b16 a[244:245], v3 offset:46080
    v_mfma_f32_16x16x32_bf16 v[192:195], a[252:255], a[176:179], v[192:195]
    v_add_f32 v246, v14, v246
    v_mfma_f32_16x16x32_bf16 v[192:195], a[248:251], a[152:155], v[192:195]
    ds_read_b64_tr_b16 a[246:247], v3 offset:46592
    v_mfma_f32_16x16x32_bf16 v[188:191], a[248:251], a[148:151], v[188:191]
    v_add_f32 v250, v15, v250
    v_mfma_f32_16x16x32_bf16 v[188:191], a[252:255], a[172:175], v[188:191]
    v_add_f32 v254, v16, v254
    v_mfma_f32_16x16x32_bf16 v[184:187], a[252:255], a[168:171], v[184:187]
    v_mfma_f32_16x16x32_bf16 v[184:187], a[248:251], a[144:147], v[184:187]
    s_waitcnt lgkmcnt(4)
    v_mfma_f32_16x16x32_bf16 a[48:51], v[56:59], a[144:147], a[48:51]
    s_waitcnt vmcnt(23)
    v_lshlrev_b32 v14, 16, v32
    v_mfma_f32_16x16x32_bf16 a[48:51], v[60:63], a[168:171], a[48:51]
    ds_read_b64_tr_b16 a[248:249], v3 offset:34816
    v_mfma_f32_16x16x32_bf16 a[52:55], v[60:63], a[172:175], a[52:55]
    v_and_b32 v15, s36, v32
    v_mfma_f32_16x16x32_bf16 a[52:55], v[56:59], a[148:151], a[52:55]
    ds_read_b64_tr_b16 a[250:251], v3 offset:35328
    v_mfma_f32_16x16x32_bf16 a[56:59], v[56:59], a[152:155], a[56:59]
    buffer_load_dwordx4 a[120:123], v2, s[52:55], s6 offen offset:2048
    v_mfma_f32_16x16x32_bf16 a[56:59], v[60:63], a[176:179], a[56:59]
    ds_read_b64_tr_b16 a[252:253], v3 offset:47104
    v_mfma_f32_16x16x32_bf16 a[60:63], v[60:63], a[180:183], a[60:63]
    v_lshlrev_b32 v16, 16, v33
    v_mfma_f32_16x16x32_bf16 a[60:63], v[56:59], a[156:159], a[60:63]
    ds_read_b64_tr_b16 a[254:255], v3 offset:47616
    v_mfma_f32_16x16x32_bf16 a[64:67], v[56:59], a[160:163], a[64:67]
    buffer_load_dwordx4 a[124:127], v2, s[52:55], s6 offen offset:3072
    v_mfma_f32_16x16x32_bf16 a[64:67], v[60:63], a[184:187], a[64:67]
    v_add_f32 v14, v14, v8
    v_mfma_f32_16x16x32_bf16 a[68:71], v[60:63], a[188:191], a[68:71]
    v_add_f32 v15, v15, v9
    v_mfma_f32_16x16x32_bf16 a[68:71], v[56:59], a[164:167], a[68:71]
    s_mov_b32 s6, 892928
    v_add_f32 v16, v16, v10
    s_waitcnt lgkmcnt(4)
    v_mfma_f32_16x16x32_bf16 v[228:231], a[240:243], a[164:167], v[228:231]
    buffer_load_dwordx4 a[128:131], v2, s[52:55], s6 offen offset:0
    v_mfma_f32_16x16x32_bf16 v[228:231], a[244:247], a[188:191], v[228:231]
    ds_read_b64_tr_b16 v[56:57], v3 offset:35840
    v_mfma_f32_16x16x32_bf16 v[224:227], a[244:247], a[184:187], v[224:227]
    v_add_f32 v90, v14, v90
    v_mfma_f32_16x16x32_bf16 v[224:227], a[240:243], a[160:163], v[224:227]
    ds_read_b64_tr_b16 v[58:59], v3 offset:36352
    v_mfma_f32_16x16x32_bf16 v[220:223], a[240:243], a[156:159], v[220:223]
    buffer_load_dwordx4 a[132:135], v2, s[52:55], s6 offen offset:1024
    v_mfma_f32_16x16x32_bf16 v[220:223], a[244:247], a[180:183], v[220:223]
    ds_read_b64_tr_b16 v[60:61], v3 offset:48128
    v_mfma_f32_16x16x32_bf16 v[216:219], a[244:247], a[176:179], v[216:219]
    v_add_f32 v94, v15, v94
    v_mfma_f32_16x16x32_bf16 v[216:219], a[240:243], a[152:155], v[216:219]
    ds_read_b64_tr_b16 v[62:63], v3 offset:48640
    v_mfma_f32_16x16x32_bf16 v[212:215], a[240:243], a[148:151], v[212:215]
    buffer_load_dwordx4 a[136:139], v2, s[52:55], s6 offen offset:2048
    v_mfma_f32_16x16x32_bf16 v[212:215], a[244:247], a[172:175], v[212:215]
    v_add_f32 v98, v16, v98
    v_mfma_f32_16x16x32_bf16 v[208:211], a[244:247], a[168:171], v[208:211]
    v_and_b32 v14, s36, v33
    v_mfma_f32_16x16x32_bf16 v[208:211], a[240:243], a[144:147], v[208:211]
    v_lshlrev_b32 v15, 16, v34
    s_waitcnt lgkmcnt(0)
    s_barrier
    v_mfma_f32_16x16x32_bf16 v[232:235], a[248:251], a[144:147], v[232:235]
    buffer_load_dwordx4 a[140:143], v2, s[52:55], s6 offen offset:3072
    v_mfma_f32_16x16x32_bf16 v[232:235], a[252:255], a[168:171], v[232:235]
    ds_read_b64_tr_b16 a[240:241], v4 offset:0
    v_mfma_f32_16x16x32_bf16 v[236:239], a[252:255], a[172:175], v[236:239]
    v_and_b32 v16, s36, v34
    v_mfma_f32_16x16x32_bf16 v[236:239], a[248:251], a[148:151], v[236:239]
    ds_read_b64_tr_b16 a[242:243], v4 offset:512
    v_mfma_f32_16x16x32_bf16 v[240:243], a[248:251], a[152:155], v[240:243]
    v_add_f32 v14, v14, v11
    v_mfma_f32_16x16x32_bf16 v[240:243], a[252:255], a[176:179], v[240:243]
    ds_read_b64_tr_b16 a[244:245], v4 offset:12288
    v_mfma_f32_16x16x32_bf16 v[244:247], a[252:255], a[180:183], v[244:247]
    v_add_f32 v15, v15, v12
    v_mfma_f32_16x16x32_bf16 v[244:247], a[248:251], a[156:159], v[244:247]
    ds_read_b64_tr_b16 a[246:247], v4 offset:12800
    v_mfma_f32_16x16x32_bf16 v[248:251], a[248:251], a[160:163], v[248:251]
    v_add_f32 v16, v16, v13
    v_mfma_f32_16x16x32_bf16 v[248:251], a[252:255], a[184:187], v[248:251]
    v_add_f32 v102, v14, v102
    v_mfma_f32_16x16x32_bf16 v[252:255], a[252:255], a[188:191], v[252:255]
    v_add_f32 v106, v15, v106
    v_mfma_f32_16x16x32_bf16 v[252:255], a[248:251], a[164:167], v[252:255]
    v_add_f32 v110, v16, v110
    v_mfma_f32_16x16x32_bf16 a[92:95], v[56:59], a[164:167], a[92:95]
    s_waitcnt vmcnt(28)
    v_lshlrev_b32 v14, 16, v36
    v_mfma_f32_16x16x32_bf16 a[92:95], v[60:63], a[188:191], a[92:95]
    ds_read_b64_tr_b16 a[248:249], v4 offset:1024
    v_mfma_f32_16x16x32_bf16 a[88:91], v[60:63], a[184:187], a[88:91]
    v_and_b32 v15, s36, v36
    v_mfma_f32_16x16x32_bf16 a[88:91], v[56:59], a[160:163], a[88:91]
    ds_read_b64_tr_b16 a[250:251], v4 offset:1536
    v_mfma_f32_16x16x32_bf16 a[84:87], v[56:59], a[156:159], a[84:87]
    v_lshlrev_b32 v16, 16, v37
    v_mfma_f32_16x16x32_bf16 a[84:87], v[60:63], a[180:183], a[84:87]
    ds_read_b64_tr_b16 a[252:253], v4 offset:13312
    v_mfma_f32_16x16x32_bf16 a[80:83], v[60:63], a[176:179], a[80:83]
    v_add_f32 v14, v14, v8
    v_mfma_f32_16x16x32_bf16 a[80:83], v[56:59], a[152:155], a[80:83]
    ds_read_b64_tr_b16 a[254:255], v4 offset:13824
    v_mfma_f32_16x16x32_bf16 a[76:79], v[56:59], a[148:151], a[76:79]
    v_add_f32 v15, v15, v9
    v_mfma_f32_16x16x32_bf16 a[76:79], v[60:63], a[172:175], a[76:79]
    v_add_f32 v16, v16, v10
    v_mfma_f32_16x16x32_bf16 a[72:75], v[60:63], a[168:171], a[72:75]
    v_add_f32 v138, v14, v138
    v_mfma_f32_16x16x32_bf16 a[72:75], v[56:59], a[144:147], a[72:75]
    v_add_f32 v142, v15, v142
    s_waitcnt vmcnt(22)
    s_waitcnt lgkmcnt(4)
    v_mfma_f32_16x16x32_bf16 v[64:67], a[240:243], a[192:195], v[64:67]
    v_add_f32 v146, v16, v146
    v_mfma_f32_16x16x32_bf16 v[64:67], a[244:247], a[216:219], v[64:67]
    ds_read_b64_tr_b16 v[56:57], v4 offset:2048
    v_mfma_f32_16x16x32_bf16 v[68:71], a[244:247], a[220:223], v[68:71]
    v_and_b32 v14, s36, v37
    v_mfma_f32_16x16x32_bf16 v[68:71], a[240:243], a[196:199], v[68:71]
    ds_read_b64_tr_b16 v[58:59], v4 offset:2560
    s_add_u32 m0, s39, 24576
    v_mfma_f32_16x16x32_bf16 v[72:75], a[240:243], a[200:203], v[72:75]
    buffer_load_dwordx4 v1, s[56:59], s4 offen offset:0 nt lds
    v_mfma_f32_16x16x32_bf16 v[72:75], a[244:247], a[224:227], v[72:75]
    ds_read_b64_tr_b16 v[60:61], v4 offset:14336
    v_mfma_f32_16x16x32_bf16 v[76:79], a[244:247], a[228:231], v[76:79]
    v_lshlrev_b32 v15, 16, v38
    v_mfma_f32_16x16x32_bf16 v[76:79], a[240:243], a[204:207], v[76:79]
    ds_read_b64_tr_b16 v[62:63], v4 offset:14848
    s_add_u32 m0, s39, 24576
    v_mfma_f32_16x16x32_bf16 v[80:83], a[240:243], a[208:211], v[80:83]
    buffer_load_dwordx4 v1, s[56:59], s4 offen offset:1024 nt lds
    v_mfma_f32_16x16x32_bf16 v[80:83], a[244:247], a[232:235], v[80:83]
    v_and_b32 v16, s36, v38
    v_mfma_f32_16x16x32_bf16 v[84:87], a[244:247], a[236:239], v[84:87]
    v_add_f32 v14, v14, v11
    v_mfma_f32_16x16x32_bf16 v[84:87], a[240:243], a[212:215], v[84:87]
    s_add_u32 m0, s39, 24576
    v_add_f32 v15, v15, v12
    s_waitcnt lgkmcnt(4)
    v_mfma_f32_16x16x32_bf16 v[108:111], a[248:251], a[212:215], v[108:111]
    buffer_load_dwordx4 v1, s[56:59], s4 offen offset:2048 nt lds
    v_mfma_f32_16x16x32_bf16 v[108:111], a[252:255], a[236:239], v[108:111]
    ds_read_b64_tr_b16 a[240:241], v4 offset:3072
    v_mfma_f32_16x16x32_bf16 v[104:107], a[252:255], a[232:235], v[104:107]
    v_add_f32 v16, v16, v13
    v_mfma_f32_16x16x32_bf16 v[104:107], a[248:251], a[208:211], v[104:107]
    ds_read_b64_tr_b16 a[242:243], v4 offset:3584
    s_add_u32 m0, s39, 36864
    v_mfma_f32_16x16x32_bf16 v[100:103], a[248:251], a[204:207], v[100:103]
    buffer_load_dwordx4 v1, s[60:63], s29 offen offset:0 nt lds
    v_mfma_f32_16x16x32_bf16 v[100:103], a[252:255], a[228:231], v[100:103]
    ds_read_b64_tr_b16 a[244:245], v4 offset:15360
    v_mfma_f32_16x16x32_bf16 v[96:99], a[252:255], a[224:227], v[96:99]
    v_add_f32 v150, v14, v150
    v_mfma_f32_16x16x32_bf16 v[96:99], a[248:251], a[200:203], v[96:99]
    ds_read_b64_tr_b16 a[246:247], v4 offset:15872
    s_add_u32 m0, s39, 36864
    v_mfma_f32_16x16x32_bf16 v[92:95], a[248:251], a[196:199], v[92:95]
    buffer_load_dwordx4 v1, s[60:63], s29 offen offset:1024 nt lds
    v_mfma_f32_16x16x32_bf16 v[92:95], a[252:255], a[220:223], v[92:95]
    v_add_f32 v154, v15, v154
    v_mfma_f32_16x16x32_bf16 v[88:91], a[252:255], a[216:219], v[88:91]
    v_add_f32 v158, v16, v158
    v_mfma_f32_16x16x32_bf16 v[88:91], a[248:251], a[192:195], v[88:91]
    s_add_u32 m0, s39, 36864
    s_waitcnt lgkmcnt(4)
    v_mfma_f32_16x16x32_bf16 a[0:3], v[56:59], a[192:195], a[0:3]
    buffer_load_dwordx4 v1, s[60:63], s29 offen offset:2048 nt lds
    s_waitcnt vmcnt(15)
    v_lshlrev_b32 v14, 16, v40
    v_mfma_f32_16x16x32_bf16 a[0:3], v[60:63], a[216:219], a[0:3]
    ds_read_b64_tr_b16 a[248:249], v4 offset:4096
    v_and_b32 v15, s36, v40
    v_mfma_f32_16x16x32_bf16 a[4:7], v[60:63], a[220:223], a[4:7]
    v_lshlrev_b32 v16, 16, v41
    v_accvgpr_read_b32 v18, a50
    v_mfma_f32_16x16x32_bf16 a[4:7], v[56:59], a[196:199], a[4:7]
    ds_read_b64_tr_b16 a[250:251], v4 offset:4608
    v_accvgpr_read_b32 v19, a54
    v_mfma_f32_16x16x32_bf16 a[8:11], v[56:59], a[200:203], a[8:11]
    v_accvgpr_read_b32 v20, a58
    v_add_f32 v14, v14, v8
    v_mfma_f32_16x16x32_bf16 a[8:11], v[60:63], a[224:227], a[8:11]
    ds_read_b64_tr_b16 a[252:253], v4 offset:16384
    v_add_f32 v15, v15, v9
    v_mfma_f32_16x16x32_bf16 a[12:15], v[60:63], a[228:231], a[12:15]
    v_add_f32 v16, v16, v10
    v_add_f32 v14, v14, v18
    v_mfma_f32_16x16x32_bf16 a[12:15], v[56:59], a[204:207], a[12:15]
    ds_read_b64_tr_b16 a[254:255], v4 offset:16896
    v_add_f32 v15, v15, v19
    v_mfma_f32_16x16x32_bf16 a[16:19], v[56:59], a[208:211], a[16:19]
    v_add_f32 v16, v16, v20
    v_accvgpr_write_b32 a50, v14
    v_mfma_f32_16x16x32_bf16 a[16:19], v[60:63], a[232:235], a[16:19]
    v_accvgpr_write_b32 a54, v15
    v_accvgpr_write_b32 a58, v16
    v_mfma_f32_16x16x32_bf16 a[20:23], v[60:63], a[236:239], a[20:23]
    v_and_b32 v14, s36, v41
    v_lshlrev_b32 v15, 16, v42
    v_mfma_f32_16x16x32_bf16 a[20:23], v[56:59], a[212:215], a[20:23]
    v_and_b32 v16, s36, v42
    v_accvgpr_read_b32 v18, a62
    s_waitcnt lgkmcnt(4)
    v_mfma_f32_16x16x32_bf16 v[132:135], a[240:243], a[212:215], v[132:135]
    v_accvgpr_read_b32 v19, a66
    v_accvgpr_read_b32 v20, a70
    v_mfma_f32_16x16x32_bf16 v[132:135], a[244:247], a[236:239], v[132:135]
    ds_read_b64_tr_b16 v[56:57], v4 offset:5120
    v_add_f32 v14, v14, v11
    v_mfma_f32_16x16x32_bf16 v[128:131], a[244:247], a[232:235], v[128:131]
    v_add_f32 v15, v15, v12
    v_add_f32 v16, v16, v13
    v_mfma_f32_16x16x32_bf16 v[128:131], a[240:243], a[208:211], v[128:131]
    ds_read_b64_tr_b16 v[58:59], v4 offset:5632
    v_add_f32 v14, v14, v18
    v_mfma_f32_16x16x32_bf16 v[124:127], a[240:243], a[204:207], v[124:127]
    v_add_f32 v15, v15, v19
    v_add_f32 v16, v16, v20
    v_mfma_f32_16x16x32_bf16 v[124:127], a[244:247], a[228:231], v[124:127]
    ds_read_b64_tr_b16 v[60:61], v4 offset:17408
    v_accvgpr_write_b32 a62, v14
    v_mfma_f32_16x16x32_bf16 v[120:123], a[244:247], a[224:227], v[120:123]
    v_accvgpr_write_b32 a66, v15
    v_accvgpr_write_b32 a70, v16
    v_mfma_f32_16x16x32_bf16 v[120:123], a[240:243], a[200:203], v[120:123]
    ds_read_b64_tr_b16 v[62:63], v4 offset:17920
    v_mfma_f32_16x16x32_bf16 v[116:119], a[240:243], a[196:199], v[116:119]
    v_mfma_f32_16x16x32_bf16 v[116:119], a[244:247], a[220:223], v[116:119]
    v_mfma_f32_16x16x32_bf16 v[112:115], a[244:247], a[216:219], v[112:115]
    v_mfma_f32_16x16x32_bf16 v[112:115], a[240:243], a[192:195], v[112:115]
    s_waitcnt lgkmcnt(4)
    v_mfma_f32_16x16x32_bf16 v[136:139], a[248:251], a[192:195], v[136:139]
    v_mfma_f32_16x16x32_bf16 v[136:139], a[252:255], a[216:219], v[136:139]
    ds_read_b64_tr_b16 a[240:241], v4 offset:6144
    v_mfma_f32_16x16x32_bf16 v[140:143], a[252:255], a[220:223], v[140:143]
    v_mfma_f32_16x16x32_bf16 v[140:143], a[248:251], a[196:199], v[140:143]
    ds_read_b64_tr_b16 a[242:243], v4 offset:6656
    s_mov_b32 s6, 933888
    v_mfma_f32_16x16x32_bf16 v[144:147], a[248:251], a[200:203], v[144:147]
    buffer_load_dwordx4 a[144:147], v2, s[52:55], s6 offen offset:0
    v_mfma_f32_16x16x32_bf16 v[144:147], a[252:255], a[224:227], v[144:147]
    ds_read_b64_tr_b16 a[244:245], v4 offset:18432
    v_mfma_f32_16x16x32_bf16 v[148:151], a[252:255], a[228:231], v[148:151]
    v_mfma_f32_16x16x32_bf16 v[148:151], a[248:251], a[204:207], v[148:151]
    ds_read_b64_tr_b16 a[246:247], v4 offset:18944
    v_mfma_f32_16x16x32_bf16 v[152:155], a[248:251], a[208:211], v[152:155]
    buffer_load_dwordx4 a[148:151], v2, s[52:55], s6 offen offset:1024
    v_mfma_f32_16x16x32_bf16 v[152:155], a[252:255], a[232:235], v[152:155]
    v_mfma_f32_16x16x32_bf16 v[156:159], a[252:255], a[236:239], v[156:159]
    v_mfma_f32_16x16x32_bf16 v[156:159], a[248:251], a[212:215], v[156:159]
    s_waitcnt lgkmcnt(4)
    v_mfma_f32_16x16x32_bf16 a[44:47], v[56:59], a[212:215], a[44:47]
    buffer_load_dwordx4 a[152:155], v2, s[52:55], s6 offen offset:2048
    s_waitcnt vmcnt(17)
    v_lshlrev_b32 v14, 16, v44
    v_mfma_f32_16x16x32_bf16 a[44:47], v[60:63], a[236:239], a[44:47]
    ds_read_b64_tr_b16 a[248:249], v4 offset:7168
    v_and_b32 v15, s36, v44
    v_mfma_f32_16x16x32_bf16 a[40:43], v[60:63], a[232:235], a[40:43]
    v_lshlrev_b32 v16, 16, v45
    v_accvgpr_read_b32 v18, a74
    v_mfma_f32_16x16x32_bf16 a[40:43], v[56:59], a[208:211], a[40:43]
    ds_read_b64_tr_b16 a[250:251], v4 offset:7680
    v_accvgpr_read_b32 v19, a78
    v_mfma_f32_16x16x32_bf16 a[36:39], v[56:59], a[204:207], a[36:39]
    buffer_load_dwordx4 a[156:159], v2, s[52:55], s6 offen offset:3072
    v_accvgpr_read_b32 v20, a82
    v_mfma_f32_16x16x32_bf16 a[36:39], v[60:63], a[228:231], a[36:39]
    ds_read_b64_tr_b16 a[252:253], v4 offset:19456
    v_add_f32 v14, v14, v8
    v_mfma_f32_16x16x32_bf16 a[32:35], v[60:63], a[224:227], a[32:35]
    v_add_f32 v15, v15, v9
    v_add_f32 v16, v16, v10
    v_mfma_f32_16x16x32_bf16 a[32:35], v[56:59], a[200:203], a[32:35]
    ds_read_b64_tr_b16 a[254:255], v4 offset:19968
    s_mov_b32 s6, 937984
    v_add_f32 v14, v14, v18
    v_mfma_f32_16x16x32_bf16 a[28:31], v[56:59], a[196:199], a[28:31]
    buffer_load_dwordx4 a[160:163], v2, s[52:55], s6 offen offset:0
    v_add_f32 v15, v15, v19
    v_mfma_f32_16x16x32_bf16 a[28:31], v[60:63], a[220:223], a[28:31]
    v_add_f32 v16, v16, v20
    v_accvgpr_write_b32 a74, v14
    v_mfma_f32_16x16x32_bf16 a[24:27], v[60:63], a[216:219], a[24:27]
    v_accvgpr_write_b32 a78, v15
    v_accvgpr_write_b32 a82, v16
    v_mfma_f32_16x16x32_bf16 a[24:27], v[56:59], a[192:195], a[24:27]
    v_and_b32 v14, s36, v45
    v_lshlrev_b32 v15, 16, v46
    s_waitcnt lgkmcnt(4)
    v_mfma_f32_16x16x32_bf16 v[160:163], a[240:243], a[192:195], v[160:163]
    buffer_load_dwordx4 a[164:167], v2, s[52:55], s6 offen offset:1024
    v_and_b32 v16, s36, v46
    v_mfma_f32_16x16x32_bf16 v[160:163], a[244:247], a[216:219], v[160:163]
    ds_read_b64_tr_b16 v[56:57], v4 offset:8192
    v_accvgpr_read_b32 v18, a86
    v_mfma_f32_16x16x32_bf16 v[164:167], a[244:247], a[220:223], v[164:167]
    v_accvgpr_read_b32 v19, a90
    v_accvgpr_read_b32 v20, a94
    v_mfma_f32_16x16x32_bf16 v[164:167], a[240:243], a[196:199], v[164:167]
    ds_read_b64_tr_b16 v[58:59], v4 offset:8704
    v_add_f32 v14, v14, v11
    v_mfma_f32_16x16x32_bf16 v[168:171], a[240:243], a[200:203], v[168:171]
    v_add_f32 v15, v15, v12
    v_add_f32 v16, v16, v13
    s_add_u32 s43, s40, 73728
    buffer_load_dwordx3 v[24:26], v0, s[12:15], s43 offen offset:2304
    v_mfma_f32_16x16x32_bf16 v[168:171], a[244:247], a[224:227], v[168:171]
    ds_read_b64_tr_b16 v[60:61], v4 offset:20480
    v_add_f32 v14, v14, v18
    v_mfma_f32_16x16x32_bf16 v[172:175], a[244:247], a[228:231], v[172:175]
    v_add_f32 v15, v15, v19
    v_add_f32 v16, v16, v20
    v_mfma_f32_16x16x32_bf16 v[172:175], a[240:243], a[204:207], v[172:175]
    ds_read_b64_tr_b16 v[62:63], v4 offset:20992
    v_accvgpr_write_b32 a86, v14
    v_mfma_f32_16x16x32_bf16 v[176:179], a[240:243], a[208:211], v[176:179]
    v_accvgpr_write_b32 a90, v15
    v_accvgpr_write_b32 a94, v16
    v_mfma_f32_16x16x32_bf16 v[176:179], a[244:247], a[232:235], v[176:179]
    s_add_u32 s43, s40, 82944
    buffer_load_dwordx3 v[28:30], v0, s[12:15], s43 offen offset:2304
    v_mfma_f32_16x16x32_bf16 v[180:183], a[244:247], a[236:239], v[180:183]
    v_mfma_f32_16x16x32_bf16 v[180:183], a[240:243], a[212:215], v[180:183]
    s_waitcnt lgkmcnt(4)
    v_mfma_f32_16x16x32_bf16 v[204:207], a[248:251], a[212:215], v[204:207]
    s_add_u32 s43, s40, 0
    buffer_load_dwordx3 v[32:34], v0, s[12:15], s43 offen offset:2304
    v_mfma_f32_16x16x32_bf16 v[204:207], a[252:255], a[236:239], v[204:207]
    ds_read_b64_tr_b16 a[240:241], v4 offset:9216
    v_mfma_f32_16x16x32_bf16 v[200:203], a[252:255], a[232:235], v[200:203]
    v_mfma_f32_16x16x32_bf16 v[200:203], a[248:251], a[208:211], v[200:203]
    ds_read_b64_tr_b16 a[242:243], v4 offset:9728
    v_mfma_f32_16x16x32_bf16 v[196:199], a[248:251], a[204:207], v[196:199]
    s_add_u32 s43, s40, 9216
    buffer_load_dwordx3 v[36:38], v0, s[12:15], s43 offen offset:2304
    v_mfma_f32_16x16x32_bf16 v[196:199], a[252:255], a[228:231], v[196:199]
    ds_read_b64_tr_b16 a[244:245], v4 offset:21504
    v_mfma_f32_16x16x32_bf16 v[192:195], a[252:255], a[224:227], v[192:195]
    v_mfma_f32_16x16x32_bf16 v[192:195], a[248:251], a[200:203], v[192:195]
    ds_read_b64_tr_b16 a[246:247], v4 offset:22016
    v_mfma_f32_16x16x32_bf16 v[188:191], a[248:251], a[196:199], v[188:191]
    v_mfma_f32_16x16x32_bf16 v[188:191], a[252:255], a[220:223], v[188:191]
    v_mfma_f32_16x16x32_bf16 v[184:187], a[252:255], a[216:219], v[184:187]
    v_mfma_f32_16x16x32_bf16 v[184:187], a[248:251], a[192:195], v[184:187]
    s_waitcnt lgkmcnt(4)
    v_mfma_f32_16x16x32_bf16 a[48:51], v[56:59], a[192:195], a[48:51]
    s_waitcnt vmcnt(23)
    v_lshlrev_b32 v14, 16, v48
    v_and_b32 v15, s36, v48
    v_mfma_f32_16x16x32_bf16 a[48:51], v[60:63], a[216:219], a[48:51]
    ds_read_b64_tr_b16 a[248:249], v4 offset:10240
    v_lshlrev_b32 v16, 16, v49
    v_mfma_f32_16x16x32_bf16 a[52:55], v[60:63], a[220:223], a[52:55]
    v_accvgpr_read_b32 v18, a2
    v_accvgpr_read_b32 v19, a6
    v_mfma_f32_16x16x32_bf16 a[52:55], v[56:59], a[196:199], a[52:55]
    ds_read_b64_tr_b16 a[250:251], v4 offset:10752
    v_accvgpr_read_b32 v20, a10
    v_mfma_f32_16x16x32_bf16 a[56:59], v[56:59], a[200:203], a[56:59]
    buffer_load_dwordx4 a[168:171], v2, s[52:55], s6 offen offset:2048
    v_add_f32 v14, v14, v8
    v_mfma_f32_16x16x32_bf16 a[56:59], v[60:63], a[224:227], a[56:59]
    ds_read_b64_tr_b16 a[252:253], v4 offset:22528
    v_add_f32 v15, v15, v9
    v_mfma_f32_16x16x32_bf16 a[60:63], v[60:63], a[228:231], a[60:63]
    v_add_f32 v16, v16, v10
    v_add_f32 v14, v14, v18
    v_mfma_f32_16x16x32_bf16 a[60:63], v[56:59], a[204:207], a[60:63]
    ds_read_b64_tr_b16 a[254:255], v4 offset:23040
    v_add_f32 v15, v15, v19
    v_mfma_f32_16x16x32_bf16 a[64:67], v[56:59], a[208:211], a[64:67]
    buffer_load_dwordx4 a[172:175], v2, s[52:55], s6 offen offset:3072
    v_add_f32 v16, v16, v20
    v_mfma_f32_16x16x32_bf16 a[64:67], v[60:63], a[232:235], a[64:67]
    v_accvgpr_write_b32 a2, v14
    v_accvgpr_write_b32 a6, v15
    v_mfma_f32_16x16x32_bf16 a[68:71], v[60:63], a[236:239], a[68:71]
    v_accvgpr_write_b32 a10, v16
    v_and_b32 v14, s36, v49
    v_mfma_f32_16x16x32_bf16 a[68:71], v[56:59], a[212:215], a[68:71]
    s_mov_b32 s6, 942080
    v_lshlrev_b32 v15, 16, v50
    v_and_b32 v16, s36, v50
    s_waitcnt lgkmcnt(4)
    v_mfma_f32_16x16x32_bf16 v[228:231], a[240:243], a[212:215], v[228:231]
    buffer_load_dwordx4 a[176:179], v2, s[52:55], s6 offen offset:0
    v_accvgpr_read_b32 v18, a14
    v_mfma_f32_16x16x32_bf16 v[228:231], a[244:247], a[236:239], v[228:231]
    ds_read_b64_tr_b16 v[56:57], v4 offset:11264
    v_accvgpr_read_b32 v19, a18
    v_mfma_f32_16x16x32_bf16 v[224:227], a[244:247], a[232:235], v[224:227]
    v_accvgpr_read_b32 v20, a22
    v_add_f32 v14, v14, v11
    v_mfma_f32_16x16x32_bf16 v[224:227], a[240:243], a[208:211], v[224:227]
    ds_read_b64_tr_b16 v[58:59], v4 offset:11776
    v_add_f32 v15, v15, v12
    v_mfma_f32_16x16x32_bf16 v[220:223], a[240:243], a[204:207], v[220:223]
    buffer_load_dwordx4 a[180:183], v2, s[52:55], s6 offen offset:1024
    v_add_f32 v16, v16, v13
    v_mfma_f32_16x16x32_bf16 v[220:223], a[244:247], a[228:231], v[220:223]
    ds_read_b64_tr_b16 v[60:61], v4 offset:23552
    v_add_f32 v14, v14, v18
    v_mfma_f32_16x16x32_bf16 v[216:219], a[244:247], a[224:227], v[216:219]
    v_add_f32 v15, v15, v19
    v_add_f32 v16, v16, v20
    v_mfma_f32_16x16x32_bf16 v[216:219], a[240:243], a[200:203], v[216:219]
    ds_read_b64_tr_b16 v[62:63], v4 offset:24064
    v_accvgpr_write_b32 a14, v14
    v_mfma_f32_16x16x32_bf16 v[212:215], a[240:243], a[196:199], v[212:215]
    buffer_load_dwordx4 a[184:187], v2, s[52:55], s6 offen offset:2048
    v_accvgpr_write_b32 a18, v15
    v_mfma_f32_16x16x32_bf16 v[212:215], a[244:247], a[220:223], v[212:215]
    v_accvgpr_write_b32 a22, v16
    v_mfma_f32_16x16x32_bf16 v[208:211], a[244:247], a[216:219], v[208:211]
    v_mfma_f32_16x16x32_bf16 v[208:211], a[240:243], a[192:195], v[208:211]
    s_waitcnt lgkmcnt(0)
    s_barrier
    v_mfma_f32_16x16x32_bf16 v[232:235], a[248:251], a[192:195], v[232:235]
    buffer_load_dwordx4 a[188:191], v2, s[52:55], s6 offen offset:3072
    v_mfma_f32_16x16x32_bf16 v[232:235], a[252:255], a[216:219], v[232:235]
    ds_read_b64_tr_b16 a[240:241], v3 offset:0
    v_mfma_f32_16x16x32_bf16 v[236:239], a[252:255], a[220:223], v[236:239]
    v_mfma_f32_16x16x32_bf16 v[236:239], a[248:251], a[196:199], v[236:239]
    ds_read_b64_tr_b16 a[242:243], v3 offset:512
    v_mfma_f32_16x16x32_bf16 v[240:243], a[248:251], a[200:203], v[240:243]
    v_mfma_f32_16x16x32_bf16 v[240:243], a[252:255], a[224:227], v[240:243]
    ds_read_b64_tr_b16 a[244:245], v3 offset:12288
    v_mfma_f32_16x16x32_bf16 v[244:247], a[252:255], a[228:231], v[244:247]
    v_mfma_f32_16x16x32_bf16 v[244:247], a[248:251], a[204:207], v[244:247]
    ds_read_b64_tr_b16 a[246:247], v3 offset:12800
    v_mfma_f32_16x16x32_bf16 v[248:251], a[248:251], a[208:211], v[248:251]
    v_mfma_f32_16x16x32_bf16 v[248:251], a[252:255], a[232:235], v[248:251]
    v_mfma_f32_16x16x32_bf16 v[252:255], a[252:255], a[236:239], v[252:255]
    v_mfma_f32_16x16x32_bf16 v[252:255], a[248:251], a[212:215], v[252:255]
    v_mfma_f32_16x16x32_bf16 a[92:95], v[56:59], a[212:215], a[92:95]
    s_waitcnt vmcnt(28)
    v_lshlrev_b32 v14, 16, v52
    v_and_b32 v15, s36, v52
    v_mfma_f32_16x16x32_bf16 a[92:95], v[60:63], a[236:239], a[92:95]
    ds_read_b64_tr_b16 a[248:249], v3 offset:1024
    v_lshlrev_b32 v16, 16, v53
    v_mfma_f32_16x16x32_bf16 a[88:91], v[60:63], a[232:235], a[88:91]
    v_accvgpr_read_b32 v18, a26
    v_accvgpr_read_b32 v19, a30
    v_mfma_f32_16x16x32_bf16 a[88:91], v[56:59], a[208:211], a[88:91]
    ds_read_b64_tr_b16 a[250:251], v3 offset:1536
    v_accvgpr_read_b32 v20, a34
    v_mfma_f32_16x16x32_bf16 a[84:87], v[56:59], a[204:207], a[84:87]
    v_add_f32 v14, v14, v8
    v_add_f32 v15, v15, v9
    v_mfma_f32_16x16x32_bf16 a[84:87], v[60:63], a[228:231], a[84:87]
    ds_read_b64_tr_b16 a[252:253], v3 offset:13312
    v_add_f32 v16, v16, v10
    v_mfma_f32_16x16x32_bf16 a[80:83], v[60:63], a[224:227], a[80:83]
    v_add_f32 v14, v14, v18
    v_add_f32 v15, v15, v19
    v_mfma_f32_16x16x32_bf16 a[80:83], v[56:59], a[200:203], a[80:83]
    ds_read_b64_tr_b16 a[254:255], v3 offset:13824
    v_add_f32 v16, v16, v20
    v_mfma_f32_16x16x32_bf16 a[76:79], v[56:59], a[196:199], a[76:79]
    v_accvgpr_write_b32 a26, v14
    v_accvgpr_write_b32 a30, v15
    v_mfma_f32_16x16x32_bf16 a[76:79], v[60:63], a[220:223], a[76:79]
    v_accvgpr_write_b32 a34, v16
    v_and_b32 v14, s36, v53
    v_mfma_f32_16x16x32_bf16 a[72:75], v[60:63], a[216:219], a[72:75]
    v_lshlrev_b32 v15, 16, v54
    v_and_b32 v16, s36, v54
    v_mfma_f32_16x16x32_bf16 a[72:75], v[56:59], a[192:195], a[72:75]
    v_accvgpr_read_b32 v18, a38
    v_accvgpr_read_b32 v19, a42
    s_waitcnt vmcnt(22)
    s_waitcnt lgkmcnt(4)
    v_mfma_f32_16x16x32_bf16 v[64:67], a[240:243], a[96:99], v[64:67]
    v_accvgpr_read_b32 v20, a46
    v_add_f32 v14, v14, v11
    v_mfma_f32_16x16x32_bf16 v[64:67], a[244:247], a[120:123], v[64:67]
    ds_read_b64_tr_b16 v[56:57], v3 offset:2048
    v_add_f32 v15, v15, v12
    v_mfma_f32_16x16x32_bf16 v[68:71], a[244:247], a[124:127], v[68:71]
    s_add_u32 s4, s4, 36864
    v_add_f32 v16, v16, v13
    v_add_f32 v14, v14, v18
    v_mfma_f32_16x16x32_bf16 v[68:71], a[240:243], a[100:103], v[68:71]
    ds_read_b64_tr_b16 v[58:59], v3 offset:2560
    s_add_u32 s29, s29, 12288
    s_add_u32 s5, s4, 4096
    s_add_u32 m0, s32, 49152
    v_add_f32 v15, v15, v19
    v_mfma_f32_16x16x32_bf16 v[72:75], a[240:243], a[104:107], v[72:75]
    buffer_load_dwordx4 v1, s[8:11], s4 offen offset:0 nt lds
    v_add_f32 v16, v16, v20
    v_mfma_f32_16x16x32_bf16 v[72:75], a[244:247], a[128:131], v[72:75]
    ds_read_b64_tr_b16 v[60:61], v3 offset:14336
    v_accvgpr_write_b32 a38, v14
    v_mfma_f32_16x16x32_bf16 v[76:79], a[244:247], a[132:135], v[76:79]
    v_accvgpr_write_b32 a42, v15
    v_accvgpr_write_b32 a46, v16
    v_mfma_f32_16x16x32_bf16 v[76:79], a[240:243], a[108:111], v[76:79]
    ds_read_b64_tr_b16 v[62:63], v3 offset:14848
    s_add_u32 m0, s32, 49152
    v_mfma_f32_16x16x32_bf16 v[80:83], a[240:243], a[112:115], v[80:83]
    buffer_load_dwordx4 v1, s[8:11], s4 offen offset:1024 nt lds
    v_mfma_f32_16x16x32_bf16 v[80:83], a[244:247], a[136:139], v[80:83]
    v_mfma_f32_16x16x32_bf16 v[84:87], a[244:247], a[140:143], v[84:87]
    v_mfma_f32_16x16x32_bf16 v[84:87], a[240:243], a[116:119], v[84:87]
    s_add_u32 m0, s32, 49152
    s_waitcnt lgkmcnt(4)
    v_mfma_f32_16x16x32_bf16 v[108:111], a[248:251], a[116:119], v[108:111]
    buffer_load_dwordx4 v1, s[8:11], s4 offen offset:2048 nt lds
    v_mfma_f32_16x16x32_bf16 v[108:111], a[252:255], a[140:143], v[108:111]
    ds_read_b64_tr_b16 a[240:241], v3 offset:3072
    v_mfma_f32_16x16x32_bf16 v[104:107], a[252:255], a[136:139], v[104:107]
    v_mfma_f32_16x16x32_bf16 v[104:107], a[248:251], a[112:115], v[104:107]
    ds_read_b64_tr_b16 a[242:243], v3 offset:3584
    s_add_u32 m0, s32, 49152
    v_mfma_f32_16x16x32_bf16 v[100:103], a[248:251], a[108:111], v[100:103]
    buffer_load_dwordx4 v1, s[8:11], s4 offen offset:3072 nt lds
    v_mfma_f32_16x16x32_bf16 v[100:103], a[252:255], a[132:135], v[100:103]
    ds_read_b64_tr_b16 a[244:245], v3 offset:15360
    v_mfma_f32_16x16x32_bf16 v[96:99], a[252:255], a[128:131], v[96:99]
    v_mfma_f32_16x16x32_bf16 v[96:99], a[248:251], a[104:107], v[96:99]
    ds_read_b64_tr_b16 a[246:247], v3 offset:15872
    s_add_u32 m0, s32, 53248
    v_mfma_f32_16x16x32_bf16 v[92:95], a[248:251], a[100:103], v[92:95]
    buffer_load_dwordx4 v1, s[8:11], s5 offen offset:0 nt lds
    v_mfma_f32_16x16x32_bf16 v[92:95], a[252:255], a[124:127], v[92:95]
    v_mfma_f32_16x16x32_bf16 v[88:91], a[252:255], a[120:123], v[88:91]
    v_mfma_f32_16x16x32_bf16 v[88:91], a[248:251], a[96:99], v[88:91]
    s_add_u32 m0, s32, 53248
    s_waitcnt lgkmcnt(4)
    v_mfma_f32_16x16x32_bf16 a[0:3], v[56:59], a[96:99], a[0:3]
    buffer_load_dwordx4 v1, s[8:11], s5 offen offset:1024 nt lds
    v_mfma_f32_16x16x32_bf16 a[0:3], v[60:63], a[120:123], a[0:3]
    ds_read_b64_tr_b16 a[248:249], v3 offset:4096
    v_mfma_f32_16x16x32_bf16 a[4:7], v[60:63], a[124:127], a[4:7]
    s_waitcnt vmcnt(15)
    v_lshlrev_b32 v14, 16, v24
    v_mfma_f32_16x16x32_bf16 a[4:7], v[56:59], a[100:103], a[4:7]
    ds_read_b64_tr_b16 a[250:251], v3 offset:4608
    v_mfma_f32_16x16x32_bf16 a[8:11], v[56:59], a[104:107], a[8:11]
    v_and_b32 v15, s36, v24
    v_mfma_f32_16x16x32_bf16 a[8:11], v[60:63], a[128:131], a[8:11]
    ds_read_b64_tr_b16 a[252:253], v3 offset:16384
    v_mfma_f32_16x16x32_bf16 a[12:15], v[60:63], a[132:135], a[12:15]
    v_lshlrev_b32 v16, 16, v25
    v_mfma_f32_16x16x32_bf16 a[12:15], v[56:59], a[108:111], a[12:15]
    ds_read_b64_tr_b16 a[254:255], v3 offset:16896
    v_mfma_f32_16x16x32_bf16 a[16:19], v[56:59], a[112:115], a[16:19]
    v_add_f32 v14, v14, v8
    v_mfma_f32_16x16x32_bf16 a[16:19], v[60:63], a[136:139], a[16:19]
    v_add_f32 v15, v15, v9
    v_mfma_f32_16x16x32_bf16 a[20:23], v[60:63], a[140:143], a[20:23]
    v_add_f32 v16, v16, v10
    v_mfma_f32_16x16x32_bf16 a[20:23], v[56:59], a[116:119], a[20:23]
    v_add_f32 v163, v14, v163
    s_waitcnt lgkmcnt(4)
    v_mfma_f32_16x16x32_bf16 v[132:135], a[240:243], a[116:119], v[132:135]
    v_add_f32 v167, v15, v167
    v_mfma_f32_16x16x32_bf16 v[132:135], a[244:247], a[140:143], v[132:135]
    ds_read_b64_tr_b16 v[56:57], v3 offset:5120
    v_mfma_f32_16x16x32_bf16 v[128:131], a[244:247], a[136:139], v[128:131]
    v_add_f32 v171, v16, v171
    v_mfma_f32_16x16x32_bf16 v[128:131], a[240:243], a[112:115], v[128:131]
    ds_read_b64_tr_b16 v[58:59], v3 offset:5632
    v_mfma_f32_16x16x32_bf16 v[124:127], a[240:243], a[108:111], v[124:127]
    v_and_b32 v14, s36, v25
    v_mfma_f32_16x16x32_bf16 v[124:127], a[244:247], a[132:135], v[124:127]
    ds_read_b64_tr_b16 v[60:61], v3 offset:17408
    v_mfma_f32_16x16x32_bf16 v[120:123], a[244:247], a[128:131], v[120:123]
    v_lshlrev_b32 v15, 16, v26
    v_mfma_f32_16x16x32_bf16 v[120:123], a[240:243], a[104:107], v[120:123]
    ds_read_b64_tr_b16 v[62:63], v3 offset:17920
    v_mfma_f32_16x16x32_bf16 v[116:119], a[240:243], a[100:103], v[116:119]
    v_and_b32 v16, s36, v26
    v_mfma_f32_16x16x32_bf16 v[116:119], a[244:247], a[124:127], v[116:119]
    v_add_f32 v14, v14, v11
    v_mfma_f32_16x16x32_bf16 v[112:115], a[244:247], a[120:123], v[112:115]
    v_add_f32 v15, v15, v12
    v_mfma_f32_16x16x32_bf16 v[112:115], a[240:243], a[96:99], v[112:115]
    v_add_f32 v16, v16, v13
    s_waitcnt lgkmcnt(4)
    v_mfma_f32_16x16x32_bf16 v[136:139], a[248:251], a[96:99], v[136:139]
    v_add_f32 v175, v14, v175
    v_mfma_f32_16x16x32_bf16 v[136:139], a[252:255], a[120:123], v[136:139]
    ds_read_b64_tr_b16 a[240:241], v3 offset:6144
    v_mfma_f32_16x16x32_bf16 v[140:143], a[252:255], a[124:127], v[140:143]
    v_add_f32 v179, v15, v179
    v_mfma_f32_16x16x32_bf16 v[140:143], a[248:251], a[100:103], v[140:143]
    ds_read_b64_tr_b16 a[242:243], v3 offset:6656
    s_mov_b32 s6, 983040
    v_mfma_f32_16x16x32_bf16 v[144:147], a[248:251], a[104:107], v[144:147]
    buffer_load_dwordx4 a[192:195], v2, s[52:55], s6 offen offset:0
    v_mfma_f32_16x16x32_bf16 v[144:147], a[252:255], a[128:131], v[144:147]
    ds_read_b64_tr_b16 a[244:245], v3 offset:18432
    v_mfma_f32_16x16x32_bf16 v[148:151], a[252:255], a[132:135], v[148:151]
    v_add_f32 v183, v16, v183
    v_mfma_f32_16x16x32_bf16 v[148:151], a[248:251], a[108:111], v[148:151]
    ds_read_b64_tr_b16 a[246:247], v3 offset:18944
    v_mfma_f32_16x16x32_bf16 v[152:155], a[248:251], a[112:115], v[152:155]
    buffer_load_dwordx4 a[196:199], v2, s[52:55], s6 offen offset:1024
    v_mfma_f32_16x16x32_bf16 v[152:155], a[252:255], a[136:139], v[152:155]
    v_mfma_f32_16x16x32_bf16 v[156:159], a[252:255], a[140:143], v[156:159]
    v_mfma_f32_16x16x32_bf16 v[156:159], a[248:251], a[116:119], v[156:159]
    s_waitcnt lgkmcnt(4)
    v_mfma_f32_16x16x32_bf16 a[44:47], v[56:59], a[116:119], a[44:47]
    buffer_load_dwordx4 a[200:203], v2, s[52:55], s6 offen offset:2048
    v_mfma_f32_16x16x32_bf16 a[44:47], v[60:63], a[140:143], a[44:47]
    ds_read_b64_tr_b16 a[248:249], v3 offset:7168
    v_mfma_f32_16x16x32_bf16 a[40:43], v[60:63], a[136:139], a[40:43]
    s_waitcnt vmcnt(17)
    v_lshlrev_b32 v14, 16, v28
    v_mfma_f32_16x16x32_bf16 a[40:43], v[56:59], a[112:115], a[40:43]
    ds_read_b64_tr_b16 a[250:251], v3 offset:7680
    v_mfma_f32_16x16x32_bf16 a[36:39], v[56:59], a[108:111], a[36:39]
    buffer_load_dwordx4 a[204:207], v2, s[52:55], s6 offen offset:3072
    v_mfma_f32_16x16x32_bf16 a[36:39], v[60:63], a[132:135], a[36:39]
    ds_read_b64_tr_b16 a[252:253], v3 offset:19456
    v_mfma_f32_16x16x32_bf16 a[32:35], v[60:63], a[128:131], a[32:35]
    v_and_b32 v15, s36, v28
    v_mfma_f32_16x16x32_bf16 a[32:35], v[56:59], a[104:107], a[32:35]
    ds_read_b64_tr_b16 a[254:255], v3 offset:19968
    s_mov_b32 s6, 987136
    v_mfma_f32_16x16x32_bf16 a[28:31], v[56:59], a[100:103], a[28:31]
    buffer_load_dwordx4 a[208:211], v2, s[52:55], s6 offen offset:0
    v_mfma_f32_16x16x32_bf16 a[28:31], v[60:63], a[124:127], a[28:31]
    v_lshlrev_b32 v16, 16, v29
    v_mfma_f32_16x16x32_bf16 a[24:27], v[60:63], a[120:123], a[24:27]
    v_add_f32 v14, v14, v8
    v_mfma_f32_16x16x32_bf16 a[24:27], v[56:59], a[96:99], a[24:27]
    v_add_f32 v15, v15, v9
    s_waitcnt lgkmcnt(4)
    v_mfma_f32_16x16x32_bf16 v[160:163], a[240:243], a[96:99], v[160:163]
    buffer_load_dwordx4 a[212:215], v2, s[52:55], s6 offen offset:1024
    v_mfma_f32_16x16x32_bf16 v[160:163], a[244:247], a[120:123], v[160:163]
    ds_read_b64_tr_b16 v[56:57], v3 offset:8192
    v_mfma_f32_16x16x32_bf16 v[164:167], a[244:247], a[124:127], v[164:167]
    v_add_f32 v16, v16, v10
    v_mfma_f32_16x16x32_bf16 v[164:167], a[240:243], a[100:103], v[164:167]
    ds_read_b64_tr_b16 v[58:59], v3 offset:8704
    v_mfma_f32_16x16x32_bf16 v[168:171], a[240:243], a[104:107], v[168:171]
    v_add_f32 v211, v14, v211
    s_add_u32 s43, s40, 76800
    buffer_load_dwordx3 v[40:42], v0, s[12:15], s43 offen offset:2304
    v_mfma_f32_16x16x32_bf16 v[168:171], a[244:247], a[128:131], v[168:171]
    ds_read_b64_tr_b16 v[60:61], v3 offset:20480
    v_mfma_f32_16x16x32_bf16 v[172:175], a[244:247], a[132:135], v[172:175]
    v_add_f32 v215, v15, v215
    v_mfma_f32_16x16x32_bf16 v[172:175], a[240:243], a[108:111], v[172:175]
    ds_read_b64_tr_b16 v[62:63], v3 offset:20992
    v_mfma_f32_16x16x32_bf16 v[176:179], a[240:243], a[112:115], v[176:179]
    v_add_f32 v219, v16, v219
    s_add_u32 s43, s40, 86016
    buffer_load_dwordx3 v[44:46], v0, s[12:15], s43 offen offset:2304
    v_mfma_f32_16x16x32_bf16 v[176:179], a[244:247], a[136:139], v[176:179]
    v_and_b32 v14, s36, v29
    v_mfma_f32_16x16x32_bf16 v[180:183], a[244:247], a[140:143], v[180:183]
    v_lshlrev_b32 v15, 16, v30
    v_mfma_f32_16x16x32_bf16 v[180:183], a[240:243], a[116:119], v[180:183]
    v_and_b32 v16, s36, v30
    s_waitcnt lgkmcnt(4)
    v_mfma_f32_16x16x32_bf16 v[204:207], a[248:251], a[116:119], v[204:207]
    v_add_f32 v14, v14, v11
    s_add_u32 s43, s40, 3072
    buffer_load_dwordx3 v[48:50], v0, s[12:15], s43 offen offset:2304
    v_mfma_f32_16x16x32_bf16 v[204:207], a[252:255], a[140:143], v[204:207]
    ds_read_b64_tr_b16 a[240:241], v3 offset:9216
    v_mfma_f32_16x16x32_bf16 v[200:203], a[252:255], a[136:139], v[200:203]
    v_add_f32 v15, v15, v12
    v_mfma_f32_16x16x32_bf16 v[200:203], a[248:251], a[112:115], v[200:203]
    ds_read_b64_tr_b16 a[242:243], v3 offset:9728
    v_mfma_f32_16x16x32_bf16 v[196:199], a[248:251], a[108:111], v[196:199]
    v_add_f32 v16, v16, v13
    s_add_u32 s43, s40, 12288
    buffer_load_dwordx3 v[52:54], v0, s[12:15], s43 offen offset:2304
    v_mfma_f32_16x16x32_bf16 v[196:199], a[252:255], a[132:135], v[196:199]
    ds_read_b64_tr_b16 a[244:245], v3 offset:21504
    v_mfma_f32_16x16x32_bf16 v[192:195], a[252:255], a[128:131], v[192:195]
    v_add_f32 v223, v14, v223
    v_mfma_f32_16x16x32_bf16 v[192:195], a[248:251], a[104:107], v[192:195]
    ds_read_b64_tr_b16 a[246:247], v3 offset:22016
    v_mfma_f32_16x16x32_bf16 v[188:191], a[248:251], a[100:103], v[188:191]
    v_add_f32 v227, v15, v227
    v_mfma_f32_16x16x32_bf16 v[188:191], a[252:255], a[124:127], v[188:191]
    v_add_f32 v231, v16, v231
    v_mfma_f32_16x16x32_bf16 v[184:187], a[252:255], a[120:123], v[184:187]
    v_mfma_f32_16x16x32_bf16 v[184:187], a[248:251], a[96:99], v[184:187]
    s_waitcnt lgkmcnt(4)
    v_mfma_f32_16x16x32_bf16 a[48:51], v[56:59], a[96:99], a[48:51]
    s_waitcnt vmcnt(23)
    v_lshlrev_b32 v14, 16, v32
    v_mfma_f32_16x16x32_bf16 a[48:51], v[60:63], a[120:123], a[48:51]
    ds_read_b64_tr_b16 a[248:249], v3 offset:10240
    v_mfma_f32_16x16x32_bf16 a[52:55], v[60:63], a[124:127], a[52:55]
    v_and_b32 v15, s36, v32
    v_mfma_f32_16x16x32_bf16 a[52:55], v[56:59], a[100:103], a[52:55]
    ds_read_b64_tr_b16 a[250:251], v3 offset:10752
    v_mfma_f32_16x16x32_bf16 a[56:59], v[56:59], a[104:107], a[56:59]
    buffer_load_dwordx4 a[216:219], v2, s[52:55], s6 offen offset:2048
    v_mfma_f32_16x16x32_bf16 a[56:59], v[60:63], a[128:131], a[56:59]
    ds_read_b64_tr_b16 a[252:253], v3 offset:22528
    v_mfma_f32_16x16x32_bf16 a[60:63], v[60:63], a[132:135], a[60:63]
    v_lshlrev_b32 v16, 16, v33
    v_mfma_f32_16x16x32_bf16 a[60:63], v[56:59], a[108:111], a[60:63]
    ds_read_b64_tr_b16 a[254:255], v3 offset:23040
    v_mfma_f32_16x16x32_bf16 a[64:67], v[56:59], a[112:115], a[64:67]
    buffer_load_dwordx4 a[220:223], v2, s[52:55], s6 offen offset:3072
    v_mfma_f32_16x16x32_bf16 a[64:67], v[60:63], a[136:139], a[64:67]
    v_add_f32 v14, v14, v8
    v_mfma_f32_16x16x32_bf16 a[68:71], v[60:63], a[140:143], a[68:71]
    v_add_f32 v15, v15, v9
    v_mfma_f32_16x16x32_bf16 a[68:71], v[56:59], a[116:119], a[68:71]
    s_mov_b32 s6, 991232
    v_add_f32 v16, v16, v10
    s_waitcnt lgkmcnt(4)
    v_mfma_f32_16x16x32_bf16 v[228:231], a[240:243], a[116:119], v[228:231]
    buffer_load_dwordx4 a[224:227], v2, s[52:55], s6 offen offset:0
    v_mfma_f32_16x16x32_bf16 v[228:231], a[244:247], a[140:143], v[228:231]
    ds_read_b64_tr_b16 v[56:57], v3 offset:11264
    v_mfma_f32_16x16x32_bf16 v[224:227], a[244:247], a[136:139], v[224:227]
    v_add_f32 v67, v14, v67
    v_mfma_f32_16x16x32_bf16 v[224:227], a[240:243], a[112:115], v[224:227]
    ds_read_b64_tr_b16 v[58:59], v3 offset:11776
    v_mfma_f32_16x16x32_bf16 v[220:223], a[240:243], a[108:111], v[220:223]
    buffer_load_dwordx4 a[228:231], v2, s[52:55], s6 offen offset:1024
    v_mfma_f32_16x16x32_bf16 v[220:223], a[244:247], a[132:135], v[220:223]
    ds_read_b64_tr_b16 v[60:61], v3 offset:23552
    v_mfma_f32_16x16x32_bf16 v[216:219], a[244:247], a[128:131], v[216:219]
    v_add_f32 v71, v15, v71
    v_mfma_f32_16x16x32_bf16 v[216:219], a[240:243], a[104:107], v[216:219]
    ds_read_b64_tr_b16 v[62:63], v3 offset:24064
    v_mfma_f32_16x16x32_bf16 v[212:215], a[240:243], a[100:103], v[212:215]
    buffer_load_dwordx4 a[232:235], v2, s[52:55], s6 offen offset:2048
    v_mfma_f32_16x16x32_bf16 v[212:215], a[244:247], a[124:127], v[212:215]
    v_add_f32 v75, v16, v75
    v_mfma_f32_16x16x32_bf16 v[208:211], a[244:247], a[120:123], v[208:211]
    v_and_b32 v14, s36, v33
    v_mfma_f32_16x16x32_bf16 v[208:211], a[240:243], a[96:99], v[208:211]
    v_lshlrev_b32 v15, 16, v34
    s_waitcnt lgkmcnt(0)
    s_barrier
    v_mfma_f32_16x16x32_bf16 v[232:235], a[248:251], a[96:99], v[232:235]
    buffer_load_dwordx4 a[236:239], v2, s[52:55], s6 offen offset:3072
    v_mfma_f32_16x16x32_bf16 v[232:235], a[252:255], a[120:123], v[232:235]
    ds_read_b64_tr_b16 a[240:241], v3 offset:24576
    v_mfma_f32_16x16x32_bf16 v[236:239], a[252:255], a[124:127], v[236:239]
    v_and_b32 v16, s36, v34
    v_mfma_f32_16x16x32_bf16 v[236:239], a[248:251], a[100:103], v[236:239]
    ds_read_b64_tr_b16 a[242:243], v3 offset:25088
    v_mfma_f32_16x16x32_bf16 v[240:243], a[248:251], a[104:107], v[240:243]
    v_add_f32 v14, v14, v11
    v_mfma_f32_16x16x32_bf16 v[240:243], a[252:255], a[128:131], v[240:243]
    ds_read_b64_tr_b16 a[244:245], v3 offset:36864
    v_mfma_f32_16x16x32_bf16 v[244:247], a[252:255], a[132:135], v[244:247]
    v_add_f32 v15, v15, v12
    v_mfma_f32_16x16x32_bf16 v[244:247], a[248:251], a[108:111], v[244:247]
    ds_read_b64_tr_b16 a[246:247], v3 offset:37376
    v_mfma_f32_16x16x32_bf16 v[248:251], a[248:251], a[112:115], v[248:251]
    v_add_f32 v16, v16, v13
    v_mfma_f32_16x16x32_bf16 v[248:251], a[252:255], a[136:139], v[248:251]
    v_add_f32 v79, v14, v79
    v_mfma_f32_16x16x32_bf16 v[252:255], a[252:255], a[140:143], v[252:255]
    v_add_f32 v83, v15, v83
    v_mfma_f32_16x16x32_bf16 v[252:255], a[248:251], a[116:119], v[252:255]
    v_add_f32 v87, v16, v87
    v_mfma_f32_16x16x32_bf16 a[92:95], v[56:59], a[116:119], a[92:95]
    s_waitcnt vmcnt(28)
    v_lshlrev_b32 v14, 16, v36
    v_mfma_f32_16x16x32_bf16 a[92:95], v[60:63], a[140:143], a[92:95]
    ds_read_b64_tr_b16 a[248:249], v3 offset:25600
    v_mfma_f32_16x16x32_bf16 a[88:91], v[60:63], a[136:139], a[88:91]
    v_and_b32 v15, s36, v36
    v_mfma_f32_16x16x32_bf16 a[88:91], v[56:59], a[112:115], a[88:91]
    ds_read_b64_tr_b16 a[250:251], v3 offset:26112
    v_mfma_f32_16x16x32_bf16 a[84:87], v[56:59], a[108:111], a[84:87]
    v_lshlrev_b32 v16, 16, v37
    v_mfma_f32_16x16x32_bf16 a[84:87], v[60:63], a[132:135], a[84:87]
    ds_read_b64_tr_b16 a[252:253], v3 offset:37888
    v_mfma_f32_16x16x32_bf16 a[80:83], v[60:63], a[128:131], a[80:83]
    v_add_f32 v14, v14, v8
    v_mfma_f32_16x16x32_bf16 a[80:83], v[56:59], a[104:107], a[80:83]
    ds_read_b64_tr_b16 a[254:255], v3 offset:38400
    v_mfma_f32_16x16x32_bf16 a[76:79], v[56:59], a[100:103], a[76:79]
    v_add_f32 v15, v15, v9
    v_mfma_f32_16x16x32_bf16 a[76:79], v[60:63], a[124:127], a[76:79]
    v_add_f32 v16, v16, v10
    v_mfma_f32_16x16x32_bf16 a[72:75], v[60:63], a[120:123], a[72:75]
    v_add_f32 v115, v14, v115
    v_mfma_f32_16x16x32_bf16 a[72:75], v[56:59], a[96:99], a[72:75]
    v_add_f32 v119, v15, v119
    s_waitcnt vmcnt(22)
    s_waitcnt lgkmcnt(4)
    v_mfma_f32_16x16x32_bf16 v[64:67], a[240:243], a[144:147], v[64:67]
    v_add_f32 v123, v16, v123
    v_mfma_f32_16x16x32_bf16 v[64:67], a[244:247], a[168:171], v[64:67]
    ds_read_b64_tr_b16 v[56:57], v3 offset:26624
    v_mfma_f32_16x16x32_bf16 v[68:71], a[244:247], a[172:175], v[68:71]
    v_and_b32 v14, s36, v37
    v_mfma_f32_16x16x32_bf16 v[68:71], a[240:243], a[148:151], v[68:71]
    ds_read_b64_tr_b16 v[58:59], v3 offset:27136
    s_add_u32 m0, s39, 0
    v_mfma_f32_16x16x32_bf16 v[72:75], a[240:243], a[152:155], v[72:75]
    buffer_load_dwordx4 v1, s[56:59], s4 offen offset:0 nt lds
    v_mfma_f32_16x16x32_bf16 v[72:75], a[244:247], a[176:179], v[72:75]
    ds_read_b64_tr_b16 v[60:61], v3 offset:38912
    v_mfma_f32_16x16x32_bf16 v[76:79], a[244:247], a[180:183], v[76:79]
    v_lshlrev_b32 v15, 16, v38
    v_mfma_f32_16x16x32_bf16 v[76:79], a[240:243], a[156:159], v[76:79]
    ds_read_b64_tr_b16 v[62:63], v3 offset:39424
    s_add_u32 m0, s39, 0
    v_mfma_f32_16x16x32_bf16 v[80:83], a[240:243], a[160:163], v[80:83]
    buffer_load_dwordx4 v1, s[56:59], s4 offen offset:1024 nt lds
    v_mfma_f32_16x16x32_bf16 v[80:83], a[244:247], a[184:187], v[80:83]
    v_and_b32 v16, s36, v38
    v_mfma_f32_16x16x32_bf16 v[84:87], a[244:247], a[188:191], v[84:87]
    v_add_f32 v14, v14, v11
    v_mfma_f32_16x16x32_bf16 v[84:87], a[240:243], a[164:167], v[84:87]
    s_add_u32 m0, s39, 0
    v_add_f32 v15, v15, v12
    s_waitcnt lgkmcnt(4)
    v_mfma_f32_16x16x32_bf16 v[108:111], a[248:251], a[164:167], v[108:111]
    buffer_load_dwordx4 v1, s[56:59], s4 offen offset:2048 nt lds
    v_mfma_f32_16x16x32_bf16 v[108:111], a[252:255], a[188:191], v[108:111]
    ds_read_b64_tr_b16 a[240:241], v3 offset:27648
    v_mfma_f32_16x16x32_bf16 v[104:107], a[252:255], a[184:187], v[104:107]
    v_add_f32 v16, v16, v13
    v_mfma_f32_16x16x32_bf16 v[104:107], a[248:251], a[160:163], v[104:107]
    ds_read_b64_tr_b16 a[242:243], v3 offset:28160
    s_add_u32 m0, s39, 12288
    v_mfma_f32_16x16x32_bf16 v[100:103], a[248:251], a[156:159], v[100:103]
    buffer_load_dwordx4 v1, s[60:63], s29 offen offset:0 nt lds
    v_mfma_f32_16x16x32_bf16 v[100:103], a[252:255], a[180:183], v[100:103]
    ds_read_b64_tr_b16 a[244:245], v3 offset:39936
    v_mfma_f32_16x16x32_bf16 v[96:99], a[252:255], a[176:179], v[96:99]
    v_add_f32 v127, v14, v127
    v_mfma_f32_16x16x32_bf16 v[96:99], a[248:251], a[152:155], v[96:99]
    ds_read_b64_tr_b16 a[246:247], v3 offset:40448
    s_add_u32 m0, s39, 12288
    v_mfma_f32_16x16x32_bf16 v[92:95], a[248:251], a[148:151], v[92:95]
    buffer_load_dwordx4 v1, s[60:63], s29 offen offset:1024 nt lds
    v_mfma_f32_16x16x32_bf16 v[92:95], a[252:255], a[172:175], v[92:95]
    v_add_f32 v131, v15, v131
    v_mfma_f32_16x16x32_bf16 v[88:91], a[252:255], a[168:171], v[88:91]
    v_add_f32 v135, v16, v135
    v_mfma_f32_16x16x32_bf16 v[88:91], a[248:251], a[144:147], v[88:91]
    s_add_u32 m0, s39, 12288
    s_waitcnt lgkmcnt(4)
    v_mfma_f32_16x16x32_bf16 a[0:3], v[56:59], a[144:147], a[0:3]
    buffer_load_dwordx4 v1, s[60:63], s29 offen offset:2048 nt lds
    v_mfma_f32_16x16x32_bf16 a[0:3], v[60:63], a[168:171], a[0:3]
    ds_read_b64_tr_b16 a[248:249], v3 offset:28672
    v_mfma_f32_16x16x32_bf16 a[4:7], v[60:63], a[172:175], a[4:7]
    s_waitcnt vmcnt(15)
    v_lshlrev_b32 v14, 16, v40
    v_mfma_f32_16x16x32_bf16 a[4:7], v[56:59], a[148:151], a[4:7]
    ds_read_b64_tr_b16 a[250:251], v3 offset:29184
    v_mfma_f32_16x16x32_bf16 a[8:11], v[56:59], a[152:155], a[8:11]
    v_and_b32 v15, s36, v40
    v_mfma_f32_16x16x32_bf16 a[8:11], v[60:63], a[176:179], a[8:11]
    ds_read_b64_tr_b16 a[252:253], v3 offset:40960
    v_mfma_f32_16x16x32_bf16 a[12:15], v[60:63], a[180:183], a[12:15]
    v_lshlrev_b32 v16, 16, v41
    v_mfma_f32_16x16x32_bf16 a[12:15], v[56:59], a[156:159], a[12:15]
    ds_read_b64_tr_b16 a[254:255], v3 offset:41472
    v_mfma_f32_16x16x32_bf16 a[16:19], v[56:59], a[160:163], a[16:19]
    v_add_f32 v14, v14, v8
    v_mfma_f32_16x16x32_bf16 a[16:19], v[60:63], a[184:187], a[16:19]
    v_add_f32 v15, v15, v9
    v_mfma_f32_16x16x32_bf16 a[20:23], v[60:63], a[188:191], a[20:23]
    v_add_f32 v16, v16, v10
    v_mfma_f32_16x16x32_bf16 a[20:23], v[56:59], a[164:167], a[20:23]
    v_add_f32 v187, v14, v187
    s_waitcnt lgkmcnt(4)
    v_mfma_f32_16x16x32_bf16 v[132:135], a[240:243], a[164:167], v[132:135]
    v_add_f32 v191, v15, v191
    v_mfma_f32_16x16x32_bf16 v[132:135], a[244:247], a[188:191], v[132:135]
    ds_read_b64_tr_b16 v[56:57], v3 offset:29696
    v_mfma_f32_16x16x32_bf16 v[128:131], a[244:247], a[184:187], v[128:131]
    v_add_f32 v195, v16, v195
    v_mfma_f32_16x16x32_bf16 v[128:131], a[240:243], a[160:163], v[128:131]
    ds_read_b64_tr_b16 v[58:59], v3 offset:30208
    v_mfma_f32_16x16x32_bf16 v[124:127], a[240:243], a[156:159], v[124:127]
    v_and_b32 v14, s36, v41
    v_mfma_f32_16x16x32_bf16 v[124:127], a[244:247], a[180:183], v[124:127]
    ds_read_b64_tr_b16 v[60:61], v3 offset:41984
    v_mfma_f32_16x16x32_bf16 v[120:123], a[244:247], a[176:179], v[120:123]
    v_lshlrev_b32 v15, 16, v42
    v_mfma_f32_16x16x32_bf16 v[120:123], a[240:243], a[152:155], v[120:123]
    ds_read_b64_tr_b16 v[62:63], v3 offset:42496
    v_mfma_f32_16x16x32_bf16 v[116:119], a[240:243], a[148:151], v[116:119]
    v_and_b32 v16, s36, v42
    v_mfma_f32_16x16x32_bf16 v[116:119], a[244:247], a[172:175], v[116:119]
    v_add_f32 v14, v14, v11
    v_mfma_f32_16x16x32_bf16 v[112:115], a[244:247], a[168:171], v[112:115]
    v_add_f32 v15, v15, v12
    v_mfma_f32_16x16x32_bf16 v[112:115], a[240:243], a[144:147], v[112:115]
    v_add_f32 v16, v16, v13
    s_waitcnt lgkmcnt(4)
    v_mfma_f32_16x16x32_bf16 v[136:139], a[248:251], a[144:147], v[136:139]
    v_add_f32 v199, v14, v199
    v_mfma_f32_16x16x32_bf16 v[136:139], a[252:255], a[168:171], v[136:139]
    ds_read_b64_tr_b16 a[240:241], v3 offset:30720
    v_mfma_f32_16x16x32_bf16 v[140:143], a[252:255], a[172:175], v[140:143]
    v_add_f32 v203, v15, v203
    v_mfma_f32_16x16x32_bf16 v[140:143], a[248:251], a[148:151], v[140:143]
    ds_read_b64_tr_b16 a[242:243], v3 offset:31232
    s_mov_b32 s6, 1032192
    v_mfma_f32_16x16x32_bf16 v[144:147], a[248:251], a[152:155], v[144:147]
    buffer_load_dwordx4 a[96:99], v2, s[52:55], s6 offen offset:0
    v_mfma_f32_16x16x32_bf16 v[144:147], a[252:255], a[176:179], v[144:147]
    ds_read_b64_tr_b16 a[244:245], v3 offset:43008
    v_mfma_f32_16x16x32_bf16 v[148:151], a[252:255], a[180:183], v[148:151]
    v_add_f32 v207, v16, v207
    v_mfma_f32_16x16x32_bf16 v[148:151], a[248:251], a[156:159], v[148:151]
    ds_read_b64_tr_b16 a[246:247], v3 offset:43520
    v_mfma_f32_16x16x32_bf16 v[152:155], a[248:251], a[160:163], v[152:155]
    buffer_load_dwordx4 a[100:103], v2, s[52:55], s6 offen offset:1024
    v_mfma_f32_16x16x32_bf16 v[152:155], a[252:255], a[184:187], v[152:155]
    v_mfma_f32_16x16x32_bf16 v[156:159], a[252:255], a[188:191], v[156:159]
    v_mfma_f32_16x16x32_bf16 v[156:159], a[248:251], a[164:167], v[156:159]
    s_waitcnt lgkmcnt(4)
    v_mfma_f32_16x16x32_bf16 a[44:47], v[56:59], a[164:167], a[44:47]
    buffer_load_dwordx4 a[104:107], v2, s[52:55], s6 offen offset:2048
    v_mfma_f32_16x16x32_bf16 a[44:47], v[60:63], a[188:191], a[44:47]
    ds_read_b64_tr_b16 a[248:249], v3 offset:31744
    v_mfma_f32_16x16x32_bf16 a[40:43], v[60:63], a[184:187], a[40:43]
    s_waitcnt vmcnt(17)
    v_lshlrev_b32 v14, 16, v44
    v_mfma_f32_16x16x32_bf16 a[40:43], v[56:59], a[160:163], a[40:43]
    ds_read_b64_tr_b16 a[250:251], v3 offset:32256
    v_mfma_f32_16x16x32_bf16 a[36:39], v[56:59], a[156:159], a[36:39]
    buffer_load_dwordx4 a[108:111], v2, s[52:55], s6 offen offset:3072
    v_mfma_f32_16x16x32_bf16 a[36:39], v[60:63], a[180:183], a[36:39]
    ds_read_b64_tr_b16 a[252:253], v3 offset:44032
    v_mfma_f32_16x16x32_bf16 a[32:35], v[60:63], a[176:179], a[32:35]
    v_and_b32 v15, s36, v44
    v_mfma_f32_16x16x32_bf16 a[32:35], v[56:59], a[152:155], a[32:35]
    ds_read_b64_tr_b16 a[254:255], v3 offset:44544
    s_mov_b32 s6, 1036288
    v_mfma_f32_16x16x32_bf16 a[28:31], v[56:59], a[148:151], a[28:31]
    buffer_load_dwordx4 a[112:115], v2, s[52:55], s6 offen offset:0
    v_mfma_f32_16x16x32_bf16 a[28:31], v[60:63], a[172:175], a[28:31]
    v_lshlrev_b32 v16, 16, v45
    v_mfma_f32_16x16x32_bf16 a[24:27], v[60:63], a[168:171], a[24:27]
    v_add_f32 v14, v14, v8
    v_mfma_f32_16x16x32_bf16 a[24:27], v[56:59], a[144:147], a[24:27]
    v_add_f32 v15, v15, v9
    s_waitcnt lgkmcnt(4)
    v_mfma_f32_16x16x32_bf16 v[160:163], a[240:243], a[144:147], v[160:163]
    buffer_load_dwordx4 a[116:119], v2, s[52:55], s6 offen offset:1024
    v_mfma_f32_16x16x32_bf16 v[160:163], a[244:247], a[168:171], v[160:163]
    ds_read_b64_tr_b16 v[56:57], v3 offset:32768
    v_mfma_f32_16x16x32_bf16 v[164:167], a[244:247], a[172:175], v[164:167]
    v_add_f32 v16, v16, v10
    v_mfma_f32_16x16x32_bf16 v[164:167], a[240:243], a[148:151], v[164:167]
    ds_read_b64_tr_b16 v[58:59], v3 offset:33280
    v_mfma_f32_16x16x32_bf16 v[168:171], a[240:243], a[152:155], v[168:171]
    v_add_f32 v235, v14, v235
    s_add_u32 s43, s40, 79872
    buffer_load_dwordx3 v[24:26], v0, s[12:15], s43 offen offset:2304
    v_mfma_f32_16x16x32_bf16 v[168:171], a[244:247], a[176:179], v[168:171]
    ds_read_b64_tr_b16 v[60:61], v3 offset:45056
    v_mfma_f32_16x16x32_bf16 v[172:175], a[244:247], a[180:183], v[172:175]
    v_add_f32 v239, v15, v239
    v_mfma_f32_16x16x32_bf16 v[172:175], a[240:243], a[156:159], v[172:175]
    ds_read_b64_tr_b16 v[62:63], v3 offset:45568
    v_mfma_f32_16x16x32_bf16 v[176:179], a[240:243], a[160:163], v[176:179]
    v_add_f32 v243, v16, v243
    s_add_u32 s43, s40, 89088
    buffer_load_dwordx3 v[28:30], v0, s[12:15], s43 offen offset:2304
    v_mfma_f32_16x16x32_bf16 v[176:179], a[244:247], a[184:187], v[176:179]
    v_and_b32 v14, s36, v45
    v_mfma_f32_16x16x32_bf16 v[180:183], a[244:247], a[188:191], v[180:183]
    v_lshlrev_b32 v15, 16, v46
    v_mfma_f32_16x16x32_bf16 v[180:183], a[240:243], a[164:167], v[180:183]
    v_and_b32 v16, s36, v46
    s_waitcnt lgkmcnt(4)
    v_mfma_f32_16x16x32_bf16 v[204:207], a[248:251], a[164:167], v[204:207]
    v_add_f32 v14, v14, v11
    s_add_u32 s43, s40, 6144
    buffer_load_dwordx3 v[32:34], v0, s[12:15], s43 offen offset:2304
    v_mfma_f32_16x16x32_bf16 v[204:207], a[252:255], a[188:191], v[204:207]
    ds_read_b64_tr_b16 a[240:241], v3 offset:33792
    v_mfma_f32_16x16x32_bf16 v[200:203], a[252:255], a[184:187], v[200:203]
    v_add_f32 v15, v15, v12
    v_mfma_f32_16x16x32_bf16 v[200:203], a[248:251], a[160:163], v[200:203]
    ds_read_b64_tr_b16 a[242:243], v3 offset:34304
    v_mfma_f32_16x16x32_bf16 v[196:199], a[248:251], a[156:159], v[196:199]
    v_add_f32 v16, v16, v13
    s_add_u32 s43, s40, 15360
    buffer_load_dwordx3 v[36:38], v0, s[12:15], s43 offen offset:2304
    v_mfma_f32_16x16x32_bf16 v[196:199], a[252:255], a[180:183], v[196:199]
    ds_read_b64_tr_b16 a[244:245], v3 offset:46080
    v_mfma_f32_16x16x32_bf16 v[192:195], a[252:255], a[176:179], v[192:195]
    v_add_f32 v247, v14, v247
    v_mfma_f32_16x16x32_bf16 v[192:195], a[248:251], a[152:155], v[192:195]
    ds_read_b64_tr_b16 a[246:247], v3 offset:46592
    v_mfma_f32_16x16x32_bf16 v[188:191], a[248:251], a[148:151], v[188:191]
    v_add_f32 v251, v15, v251
    v_mfma_f32_16x16x32_bf16 v[188:191], a[252:255], a[172:175], v[188:191]
    v_add_f32 v255, v16, v255
    v_mfma_f32_16x16x32_bf16 v[184:187], a[252:255], a[168:171], v[184:187]
    v_mfma_f32_16x16x32_bf16 v[184:187], a[248:251], a[144:147], v[184:187]
    s_waitcnt lgkmcnt(4)
    v_mfma_f32_16x16x32_bf16 a[48:51], v[56:59], a[144:147], a[48:51]
    s_waitcnt vmcnt(23)
    v_lshlrev_b32 v14, 16, v48
    v_mfma_f32_16x16x32_bf16 a[48:51], v[60:63], a[168:171], a[48:51]
    ds_read_b64_tr_b16 a[248:249], v3 offset:34816
    v_mfma_f32_16x16x32_bf16 a[52:55], v[60:63], a[172:175], a[52:55]
    v_and_b32 v15, s36, v48
    v_mfma_f32_16x16x32_bf16 a[52:55], v[56:59], a[148:151], a[52:55]
    ds_read_b64_tr_b16 a[250:251], v3 offset:35328
    v_mfma_f32_16x16x32_bf16 a[56:59], v[56:59], a[152:155], a[56:59]
    buffer_load_dwordx4 a[120:123], v2, s[52:55], s6 offen offset:2048
    v_mfma_f32_16x16x32_bf16 a[56:59], v[60:63], a[176:179], a[56:59]
    ds_read_b64_tr_b16 a[252:253], v3 offset:47104
    v_mfma_f32_16x16x32_bf16 a[60:63], v[60:63], a[180:183], a[60:63]
    v_lshlrev_b32 v16, 16, v49
    v_mfma_f32_16x16x32_bf16 a[60:63], v[56:59], a[156:159], a[60:63]
    ds_read_b64_tr_b16 a[254:255], v3 offset:47616
    v_mfma_f32_16x16x32_bf16 a[64:67], v[56:59], a[160:163], a[64:67]
    buffer_load_dwordx4 a[124:127], v2, s[52:55], s6 offen offset:3072
    v_mfma_f32_16x16x32_bf16 a[64:67], v[60:63], a[184:187], a[64:67]
    v_add_f32 v14, v14, v8
    v_mfma_f32_16x16x32_bf16 a[68:71], v[60:63], a[188:191], a[68:71]
    v_add_f32 v15, v15, v9
    v_mfma_f32_16x16x32_bf16 a[68:71], v[56:59], a[164:167], a[68:71]
    s_mov_b32 s6, 1040384
    v_add_f32 v16, v16, v10
    s_waitcnt lgkmcnt(4)
    v_mfma_f32_16x16x32_bf16 v[228:231], a[240:243], a[164:167], v[228:231]
    buffer_load_dwordx4 a[128:131], v2, s[52:55], s6 offen offset:0
    v_mfma_f32_16x16x32_bf16 v[228:231], a[244:247], a[188:191], v[228:231]
    ds_read_b64_tr_b16 v[56:57], v3 offset:35840
    v_mfma_f32_16x16x32_bf16 v[224:227], a[244:247], a[184:187], v[224:227]
    v_add_f32 v91, v14, v91
    v_mfma_f32_16x16x32_bf16 v[224:227], a[240:243], a[160:163], v[224:227]
    ds_read_b64_tr_b16 v[58:59], v3 offset:36352
    v_mfma_f32_16x16x32_bf16 v[220:223], a[240:243], a[156:159], v[220:223]
    buffer_load_dwordx4 a[132:135], v2, s[52:55], s6 offen offset:1024
    v_mfma_f32_16x16x32_bf16 v[220:223], a[244:247], a[180:183], v[220:223]
    ds_read_b64_tr_b16 v[60:61], v3 offset:48128
    v_mfma_f32_16x16x32_bf16 v[216:219], a[244:247], a[176:179], v[216:219]
    v_add_f32 v95, v15, v95
    v_mfma_f32_16x16x32_bf16 v[216:219], a[240:243], a[152:155], v[216:219]
    ds_read_b64_tr_b16 v[62:63], v3 offset:48640
    v_mfma_f32_16x16x32_bf16 v[212:215], a[240:243], a[148:151], v[212:215]
    buffer_load_dwordx4 a[136:139], v2, s[52:55], s6 offen offset:2048
    v_mfma_f32_16x16x32_bf16 v[212:215], a[244:247], a[172:175], v[212:215]
    v_add_f32 v99, v16, v99
    v_mfma_f32_16x16x32_bf16 v[208:211], a[244:247], a[168:171], v[208:211]
    v_and_b32 v14, s36, v49
    v_mfma_f32_16x16x32_bf16 v[208:211], a[240:243], a[144:147], v[208:211]
    v_lshlrev_b32 v15, 16, v50
    s_waitcnt lgkmcnt(0)
    s_barrier
    v_mfma_f32_16x16x32_bf16 v[232:235], a[248:251], a[144:147], v[232:235]
    buffer_load_dwordx4 a[140:143], v2, s[52:55], s6 offen offset:3072
    v_mfma_f32_16x16x32_bf16 v[232:235], a[252:255], a[168:171], v[232:235]
    ds_read_b64_tr_b16 a[240:241], v4 offset:0
    v_mfma_f32_16x16x32_bf16 v[236:239], a[252:255], a[172:175], v[236:239]
    v_and_b32 v16, s36, v50
    v_mfma_f32_16x16x32_bf16 v[236:239], a[248:251], a[148:151], v[236:239]
    ds_read_b64_tr_b16 a[242:243], v4 offset:512
    v_mfma_f32_16x16x32_bf16 v[240:243], a[248:251], a[152:155], v[240:243]
    v_add_f32 v14, v14, v11
    v_mfma_f32_16x16x32_bf16 v[240:243], a[252:255], a[176:179], v[240:243]
    ds_read_b64_tr_b16 a[244:245], v4 offset:12288
    v_mfma_f32_16x16x32_bf16 v[244:247], a[252:255], a[180:183], v[244:247]
    v_add_f32 v15, v15, v12
    v_mfma_f32_16x16x32_bf16 v[244:247], a[248:251], a[156:159], v[244:247]
    ds_read_b64_tr_b16 a[246:247], v4 offset:12800
    v_mfma_f32_16x16x32_bf16 v[248:251], a[248:251], a[160:163], v[248:251]
    v_add_f32 v16, v16, v13
    v_mfma_f32_16x16x32_bf16 v[248:251], a[252:255], a[184:187], v[248:251]
    v_add_f32 v103, v14, v103
    v_mfma_f32_16x16x32_bf16 v[252:255], a[252:255], a[188:191], v[252:255]
    v_add_f32 v107, v15, v107
    v_mfma_f32_16x16x32_bf16 v[252:255], a[248:251], a[164:167], v[252:255]
    v_add_f32 v111, v16, v111
    v_mfma_f32_16x16x32_bf16 a[92:95], v[56:59], a[164:167], a[92:95]
    s_waitcnt vmcnt(28)
    v_lshlrev_b32 v14, 16, v52
    v_mfma_f32_16x16x32_bf16 a[92:95], v[60:63], a[188:191], a[92:95]
    ds_read_b64_tr_b16 a[248:249], v4 offset:1024
    v_mfma_f32_16x16x32_bf16 a[88:91], v[60:63], a[184:187], a[88:91]
    v_and_b32 v15, s36, v52
    v_mfma_f32_16x16x32_bf16 a[88:91], v[56:59], a[160:163], a[88:91]
    ds_read_b64_tr_b16 a[250:251], v4 offset:1536
    v_mfma_f32_16x16x32_bf16 a[84:87], v[56:59], a[156:159], a[84:87]
    v_lshlrev_b32 v16, 16, v53
    v_mfma_f32_16x16x32_bf16 a[84:87], v[60:63], a[180:183], a[84:87]
    ds_read_b64_tr_b16 a[252:253], v4 offset:13312
    v_mfma_f32_16x16x32_bf16 a[80:83], v[60:63], a[176:179], a[80:83]
    v_add_f32 v14, v14, v8
    v_mfma_f32_16x16x32_bf16 a[80:83], v[56:59], a[152:155], a[80:83]
    ds_read_b64_tr_b16 a[254:255], v4 offset:13824
    v_mfma_f32_16x16x32_bf16 a[76:79], v[56:59], a[148:151], a[76:79]
    v_add_f32 v15, v15, v9
    v_mfma_f32_16x16x32_bf16 a[76:79], v[60:63], a[172:175], a[76:79]
    v_add_f32 v16, v16, v10
    v_mfma_f32_16x16x32_bf16 a[72:75], v[60:63], a[168:171], a[72:75]
    v_add_f32 v139, v14, v139
    v_mfma_f32_16x16x32_bf16 a[72:75], v[56:59], a[144:147], a[72:75]
    v_add_f32 v143, v15, v143
    s_waitcnt vmcnt(22)
    s_waitcnt lgkmcnt(4)
    v_mfma_f32_16x16x32_bf16 v[64:67], a[240:243], a[192:195], v[64:67]
    v_add_f32 v147, v16, v147
    v_mfma_f32_16x16x32_bf16 v[64:67], a[244:247], a[216:219], v[64:67]
    ds_read_b64_tr_b16 v[56:57], v4 offset:2048
    v_mfma_f32_16x16x32_bf16 v[68:71], a[244:247], a[220:223], v[68:71]
    s_add_u32 s4, s4, 36864
    v_and_b32 v14, s36, v53
    v_mfma_f32_16x16x32_bf16 v[68:71], a[240:243], a[196:199], v[68:71]
    ds_read_b64_tr_b16 v[58:59], v4 offset:2560
    s_add_u32 s29, s29, 12288
    s_add_u32 s5, s4, 4096
    s_add_u32 m0, s32, 24576
    v_mfma_f32_16x16x32_bf16 v[72:75], a[240:243], a[200:203], v[72:75]
    buffer_load_dwordx4 v1, s[8:11], s4 offen offset:0 nt lds
    v_mfma_f32_16x16x32_bf16 v[72:75], a[244:247], a[224:227], v[72:75]
    ds_read_b64_tr_b16 v[60:61], v4 offset:14336
    v_mfma_f32_16x16x32_bf16 v[76:79], a[244:247], a[228:231], v[76:79]
    v_lshlrev_b32 v15, 16, v54
    v_mfma_f32_16x16x32_bf16 v[76:79], a[240:243], a[204:207], v[76:79]
    ds_read_b64_tr_b16 v[62:63], v4 offset:14848
    s_add_u32 m0, s32, 24576
    v_mfma_f32_16x16x32_bf16 v[80:83], a[240:243], a[208:211], v[80:83]
    buffer_load_dwordx4 v1, s[8:11], s4 offen offset:1024 nt lds
    v_mfma_f32_16x16x32_bf16 v[80:83], a[244:247], a[232:235], v[80:83]
    v_and_b32 v16, s36, v54
    v_mfma_f32_16x16x32_bf16 v[84:87], a[244:247], a[236:239], v[84:87]
    v_add_f32 v14, v14, v11
    v_mfma_f32_16x16x32_bf16 v[84:87], a[240:243], a[212:215], v[84:87]
    s_add_u32 m0, s32, 24576
    v_add_f32 v15, v15, v12
    s_waitcnt lgkmcnt(4)
    v_mfma_f32_16x16x32_bf16 v[108:111], a[248:251], a[212:215], v[108:111]
    buffer_load_dwordx4 v1, s[8:11], s4 offen offset:2048 nt lds
    v_mfma_f32_16x16x32_bf16 v[108:111], a[252:255], a[236:239], v[108:111]
    ds_read_b64_tr_b16 a[240:241], v4 offset:3072
    v_mfma_f32_16x16x32_bf16 v[104:107], a[252:255], a[232:235], v[104:107]
    v_add_f32 v16, v16, v13
    v_mfma_f32_16x16x32_bf16 v[104:107], a[248:251], a[208:211], v[104:107]
    ds_read_b64_tr_b16 a[242:243], v4 offset:3584
    s_add_u32 m0, s32, 24576
    v_mfma_f32_16x16x32_bf16 v[100:103], a[248:251], a[204:207], v[100:103]
    buffer_load_dwordx4 v1, s[8:11], s4 offen offset:3072 nt lds
    v_mfma_f32_16x16x32_bf16 v[100:103], a[252:255], a[228:231], v[100:103]
    ds_read_b64_tr_b16 a[244:245], v4 offset:15360
    v_mfma_f32_16x16x32_bf16 v[96:99], a[252:255], a[224:227], v[96:99]
    v_add_f32 v151, v14, v151
    v_mfma_f32_16x16x32_bf16 v[96:99], a[248:251], a[200:203], v[96:99]
    ds_read_b64_tr_b16 a[246:247], v4 offset:15872
    s_add_u32 m0, s32, 28672
    v_mfma_f32_16x16x32_bf16 v[92:95], a[248:251], a[196:199], v[92:95]
    buffer_load_dwordx4 v1, s[8:11], s5 offen offset:0 nt lds
    v_mfma_f32_16x16x32_bf16 v[92:95], a[252:255], a[220:223], v[92:95]
    v_add_f32 v155, v15, v155
    v_mfma_f32_16x16x32_bf16 v[88:91], a[252:255], a[216:219], v[88:91]
    v_add_f32 v159, v16, v159
    v_mfma_f32_16x16x32_bf16 v[88:91], a[248:251], a[192:195], v[88:91]
    s_add_u32 m0, s32, 28672
    s_waitcnt lgkmcnt(4)
    v_mfma_f32_16x16x32_bf16 a[0:3], v[56:59], a[192:195], a[0:3]
    buffer_load_dwordx4 v1, s[8:11], s5 offen offset:1024 nt lds
    s_waitcnt vmcnt(15)
    v_lshlrev_b32 v14, 16, v24
    v_mfma_f32_16x16x32_bf16 a[0:3], v[60:63], a[216:219], a[0:3]
    ds_read_b64_tr_b16 a[248:249], v4 offset:4096
    v_and_b32 v15, s36, v24
    v_mfma_f32_16x16x32_bf16 a[4:7], v[60:63], a[220:223], a[4:7]
    v_lshlrev_b32 v16, 16, v25
    v_accvgpr_read_b32 v18, a51
    v_mfma_f32_16x16x32_bf16 a[4:7], v[56:59], a[196:199], a[4:7]
    ds_read_b64_tr_b16 a[250:251], v4 offset:4608
    v_accvgpr_read_b32 v19, a55
    v_mfma_f32_16x16x32_bf16 a[8:11], v[56:59], a[200:203], a[8:11]
    v_accvgpr_read_b32 v20, a59
    v_add_f32 v14, v14, v8
    v_mfma_f32_16x16x32_bf16 a[8:11], v[60:63], a[224:227], a[8:11]
    ds_read_b64_tr_b16 a[252:253], v4 offset:16384
    v_add_f32 v15, v15, v9
    v_mfma_f32_16x16x32_bf16 a[12:15], v[60:63], a[228:231], a[12:15]
    v_add_f32 v16, v16, v10
    v_add_f32 v14, v14, v18
    global_load_dword v22, v23, s[24:25]
    v_mfma_f32_16x16x32_bf16 a[12:15], v[56:59], a[204:207], a[12:15]
    ds_read_b64_tr_b16 a[254:255], v4 offset:16896
    v_add_f32 v15, v15, v19
    v_mfma_f32_16x16x32_bf16 a[16:19], v[56:59], a[208:211], a[16:19]
    v_add_f32 v16, v16, v20
    v_accvgpr_write_b32 a51, v14
    v_mfma_f32_16x16x32_bf16 a[16:19], v[60:63], a[232:235], a[16:19]
    v_accvgpr_write_b32 a55, v15
    v_accvgpr_write_b32 a59, v16
    v_mfma_f32_16x16x32_bf16 a[20:23], v[60:63], a[236:239], a[20:23]
    v_and_b32 v14, s36, v25
    v_lshlrev_b32 v15, 16, v26
    v_mfma_f32_16x16x32_bf16 a[20:23], v[56:59], a[212:215], a[20:23]
    v_and_b32 v16, s36, v26
    v_accvgpr_read_b32 v18, a63
    s_waitcnt lgkmcnt(4)
    v_mfma_f32_16x16x32_bf16 v[132:135], a[240:243], a[212:215], v[132:135]
    v_accvgpr_read_b32 v19, a67
    v_accvgpr_read_b32 v20, a71
    v_mfma_f32_16x16x32_bf16 v[132:135], a[244:247], a[236:239], v[132:135]
    ds_read_b64_tr_b16 v[56:57], v4 offset:5120
    v_add_f32 v14, v14, v11
    v_mfma_f32_16x16x32_bf16 v[128:131], a[244:247], a[232:235], v[128:131]
    v_add_f32 v15, v15, v12
    v_add_f32 v16, v16, v13
    v_mfma_f32_16x16x32_bf16 v[128:131], a[240:243], a[208:211], v[128:131]
    ds_read_b64_tr_b16 v[58:59], v4 offset:5632
    v_add_f32 v14, v14, v18
    v_mfma_f32_16x16x32_bf16 v[124:127], a[240:243], a[204:207], v[124:127]
    v_add_f32 v15, v15, v19
    v_add_f32 v16, v16, v20
    v_mfma_f32_16x16x32_bf16 v[124:127], a[244:247], a[228:231], v[124:127]
    ds_read_b64_tr_b16 v[60:61], v4 offset:17408
    v_accvgpr_write_b32 a63, v14
    v_mfma_f32_16x16x32_bf16 v[120:123], a[244:247], a[224:227], v[120:123]
    v_accvgpr_write_b32 a67, v15
    v_accvgpr_write_b32 a71, v16
    v_mfma_f32_16x16x32_bf16 v[120:123], a[240:243], a[200:203], v[120:123]
    ds_read_b64_tr_b16 v[62:63], v4 offset:17920
    v_mfma_f32_16x16x32_bf16 v[116:119], a[240:243], a[196:199], v[116:119]
    v_mfma_f32_16x16x32_bf16 v[116:119], a[244:247], a[220:223], v[116:119]
    v_mfma_f32_16x16x32_bf16 v[112:115], a[244:247], a[216:219], v[112:115]
    v_mfma_f32_16x16x32_bf16 v[112:115], a[240:243], a[192:195], v[112:115]
    s_waitcnt lgkmcnt(4)
    v_mfma_f32_16x16x32_bf16 v[136:139], a[248:251], a[192:195], v[136:139]
    v_mfma_f32_16x16x32_bf16 v[136:139], a[252:255], a[216:219], v[136:139]
    ds_read_b64_tr_b16 a[240:241], v4 offset:6144
    v_mfma_f32_16x16x32_bf16 v[140:143], a[252:255], a[220:223], v[140:143]
    v_mfma_f32_16x16x32_bf16 v[140:143], a[248:251], a[196:199], v[140:143]
    ds_read_b64_tr_b16 a[242:243], v4 offset:6656
    s_mov_b32 s6, 1081344
    v_mfma_f32_16x16x32_bf16 v[144:147], a[248:251], a[200:203], v[144:147]
    buffer_load_dwordx4 a[144:147], v2, s[52:55], s6 offen offset:0
    v_mfma_f32_16x16x32_bf16 v[144:147], a[252:255], a[224:227], v[144:147]
    ds_read_b64_tr_b16 a[244:245], v4 offset:18432
    v_mfma_f32_16x16x32_bf16 v[148:151], a[252:255], a[228:231], v[148:151]
    v_mfma_f32_16x16x32_bf16 v[148:151], a[248:251], a[204:207], v[148:151]
    ds_read_b64_tr_b16 a[246:247], v4 offset:18944
    v_mfma_f32_16x16x32_bf16 v[152:155], a[248:251], a[208:211], v[152:155]
    buffer_load_dwordx4 a[148:151], v2, s[52:55], s6 offen offset:1024
    v_mfma_f32_16x16x32_bf16 v[152:155], a[252:255], a[232:235], v[152:155]
    v_mfma_f32_16x16x32_bf16 v[156:159], a[252:255], a[236:239], v[156:159]
    v_mfma_f32_16x16x32_bf16 v[156:159], a[248:251], a[212:215], v[156:159]
    s_waitcnt lgkmcnt(4)
    v_mfma_f32_16x16x32_bf16 a[44:47], v[56:59], a[212:215], a[44:47]
    buffer_load_dwordx4 a[152:155], v2, s[52:55], s6 offen offset:2048
    s_waitcnt vmcnt(18)
    v_lshlrev_b32 v14, 16, v28
    v_mfma_f32_16x16x32_bf16 a[44:47], v[60:63], a[236:239], a[44:47]
    ds_read_b64_tr_b16 a[248:249], v4 offset:7168
    v_and_b32 v15, s36, v28
    v_mfma_f32_16x16x32_bf16 a[40:43], v[60:63], a[232:235], a[40:43]
    v_lshlrev_b32 v16, 16, v29
    v_accvgpr_read_b32 v18, a75
    v_mfma_f32_16x16x32_bf16 a[40:43], v[56:59], a[208:211], a[40:43]
    ds_read_b64_tr_b16 a[250:251], v4 offset:7680
    v_accvgpr_read_b32 v19, a79
    v_mfma_f32_16x16x32_bf16 a[36:39], v[56:59], a[204:207], a[36:39]
    buffer_load_dwordx4 a[156:159], v2, s[52:55], s6 offen offset:3072
    v_accvgpr_read_b32 v20, a83
    v_mfma_f32_16x16x32_bf16 a[36:39], v[60:63], a[228:231], a[36:39]
    ds_read_b64_tr_b16 a[252:253], v4 offset:19456
    v_add_f32 v14, v14, v8
    v_mfma_f32_16x16x32_bf16 a[32:35], v[60:63], a[224:227], a[32:35]
    v_add_f32 v15, v15, v9
    v_add_f32 v16, v16, v10
    v_mfma_f32_16x16x32_bf16 a[32:35], v[56:59], a[200:203], a[32:35]
    ds_read_b64_tr_b16 a[254:255], v4 offset:19968
    s_mov_b32 s6, 1085440
    v_add_f32 v14, v14, v18
    v_mfma_f32_16x16x32_bf16 a[28:31], v[56:59], a[196:199], a[28:31]
    buffer_load_dwordx4 a[160:163], v2, s[52:55], s6 offen offset:0
    v_add_f32 v15, v15, v19
    v_mfma_f32_16x16x32_bf16 a[28:31], v[60:63], a[220:223], a[28:31]
    v_add_f32 v16, v16, v20
    v_accvgpr_write_b32 a75, v14
    v_mfma_f32_16x16x32_bf16 a[24:27], v[60:63], a[216:219], a[24:27]
    v_accvgpr_write_b32 a79, v15
    v_accvgpr_write_b32 a83, v16
    v_mfma_f32_16x16x32_bf16 a[24:27], v[56:59], a[192:195], a[24:27]
    v_and_b32 v14, s36, v29
    v_lshlrev_b32 v15, 16, v30
    s_waitcnt lgkmcnt(4)
    v_mfma_f32_16x16x32_bf16 v[160:163], a[240:243], a[192:195], v[160:163]
    buffer_load_dwordx4 a[164:167], v2, s[52:55], s6 offen offset:1024
    v_and_b32 v16, s36, v30
    v_mfma_f32_16x16x32_bf16 v[160:163], a[244:247], a[216:219], v[160:163]
    ds_read_b64_tr_b16 v[56:57], v4 offset:8192
    v_accvgpr_read_b32 v18, a87
    v_mfma_f32_16x16x32_bf16 v[164:167], a[244:247], a[220:223], v[164:167]
    v_accvgpr_read_b32 v19, a91
    v_accvgpr_read_b32 v20, a95
    v_mfma_f32_16x16x32_bf16 v[164:167], a[240:243], a[196:199], v[164:167]
    ds_read_b64_tr_b16 v[58:59], v4 offset:8704
    v_add_f32 v14, v14, v11
    v_mfma_f32_16x16x32_bf16 v[168:171], a[240:243], a[200:203], v[168:171]
    v_add_f32 v15, v15, v12
    v_add_f32 v16, v16, v13
    v_mfma_f32_16x16x32_bf16 v[168:171], a[244:247], a[224:227], v[168:171]
    ds_read_b64_tr_b16 v[60:61], v4 offset:20480
    v_add_f32 v14, v14, v18
    v_mfma_f32_16x16x32_bf16 v[172:175], a[244:247], a[228:231], v[172:175]
    v_add_f32 v15, v15, v19
    v_add_f32 v16, v16, v20
    v_mfma_f32_16x16x32_bf16 v[172:175], a[240:243], a[204:207], v[172:175]
    ds_read_b64_tr_b16 v[62:63], v4 offset:20992
    v_accvgpr_write_b32 a87, v14
    v_mfma_f32_16x16x32_bf16 v[176:179], a[240:243], a[208:211], v[176:179]
    v_accvgpr_write_b32 a91, v15
    v_accvgpr_write_b32 a95, v16
    v_mfma_f32_16x16x32_bf16 v[176:179], a[244:247], a[232:235], v[176:179]
    v_mfma_f32_16x16x32_bf16 v[180:183], a[244:247], a[236:239], v[180:183]
    v_mfma_f32_16x16x32_bf16 v[180:183], a[240:243], a[212:215], v[180:183]
    s_waitcnt lgkmcnt(4)
    v_mfma_f32_16x16x32_bf16 v[204:207], a[248:251], a[212:215], v[204:207]
    v_mfma_f32_16x16x32_bf16 v[204:207], a[252:255], a[236:239], v[204:207]
    ds_read_b64_tr_b16 a[240:241], v4 offset:9216
    v_mfma_f32_16x16x32_bf16 v[200:203], a[252:255], a[232:235], v[200:203]
    v_mfma_f32_16x16x32_bf16 v[200:203], a[248:251], a[208:211], v[200:203]
    ds_read_b64_tr_b16 a[242:243], v4 offset:9728
    v_mfma_f32_16x16x32_bf16 v[196:199], a[248:251], a[204:207], v[196:199]
    v_mfma_f32_16x16x32_bf16 v[196:199], a[252:255], a[228:231], v[196:199]
    ds_read_b64_tr_b16 a[244:245], v4 offset:21504
    v_mfma_f32_16x16x32_bf16 v[192:195], a[252:255], a[224:227], v[192:195]
    v_mfma_f32_16x16x32_bf16 v[192:195], a[248:251], a[200:203], v[192:195]
    ds_read_b64_tr_b16 a[246:247], v4 offset:22016
    v_mfma_f32_16x16x32_bf16 v[188:191], a[248:251], a[196:199], v[188:191]
    v_mfma_f32_16x16x32_bf16 v[188:191], a[252:255], a[220:223], v[188:191]
    v_mfma_f32_16x16x32_bf16 v[184:187], a[252:255], a[216:219], v[184:187]
    v_mfma_f32_16x16x32_bf16 v[184:187], a[248:251], a[192:195], v[184:187]
    s_waitcnt lgkmcnt(4)
    v_mfma_f32_16x16x32_bf16 a[48:51], v[56:59], a[192:195], a[48:51]
    s_waitcnt vmcnt(20)
    v_lshlrev_b32 v14, 16, v32
    v_and_b32 v15, s36, v32
    v_mfma_f32_16x16x32_bf16 a[48:51], v[60:63], a[216:219], a[48:51]
    ds_read_b64_tr_b16 a[248:249], v4 offset:10240
    v_lshlrev_b32 v16, 16, v33
    v_mfma_f32_16x16x32_bf16 a[52:55], v[60:63], a[220:223], a[52:55]
    v_accvgpr_read_b32 v18, a3
    v_accvgpr_read_b32 v19, a7
    v_mfma_f32_16x16x32_bf16 a[52:55], v[56:59], a[196:199], a[52:55]
    ds_read_b64_tr_b16 a[250:251], v4 offset:10752
    v_accvgpr_read_b32 v20, a11
    v_mfma_f32_16x16x32_bf16 a[56:59], v[56:59], a[200:203], a[56:59]
    buffer_load_dwordx4 a[168:171], v2, s[52:55], s6 offen offset:2048
    v_add_f32 v14, v14, v8
    v_mfma_f32_16x16x32_bf16 a[56:59], v[60:63], a[224:227], a[56:59]
    ds_read_b64_tr_b16 a[252:253], v4 offset:22528
    v_add_f32 v15, v15, v9
    v_mfma_f32_16x16x32_bf16 a[60:63], v[60:63], a[228:231], a[60:63]
    v_add_f32 v16, v16, v10
    v_add_f32 v14, v14, v18
    v_mfma_f32_16x16x32_bf16 a[60:63], v[56:59], a[204:207], a[60:63]
    ds_read_b64_tr_b16 a[254:255], v4 offset:23040
    v_add_f32 v15, v15, v19
    v_mfma_f32_16x16x32_bf16 a[64:67], v[56:59], a[208:211], a[64:67]
    buffer_load_dwordx4 a[172:175], v2, s[52:55], s6 offen offset:3072
    v_add_f32 v16, v16, v20
    v_mfma_f32_16x16x32_bf16 a[64:67], v[60:63], a[232:235], a[64:67]
    v_accvgpr_write_b32 a3, v14
    v_accvgpr_write_b32 a7, v15
    v_mfma_f32_16x16x32_bf16 a[68:71], v[60:63], a[236:239], a[68:71]
    v_accvgpr_write_b32 a11, v16
    v_and_b32 v14, s36, v33
    v_mfma_f32_16x16x32_bf16 a[68:71], v[56:59], a[212:215], a[68:71]
    s_mov_b32 s6, 1089536
    v_lshlrev_b32 v15, 16, v34
    v_and_b32 v16, s36, v34
    s_waitcnt lgkmcnt(4)
    v_mfma_f32_16x16x32_bf16 v[228:231], a[240:243], a[212:215], v[228:231]
    buffer_load_dwordx4 a[176:179], v2, s[52:55], s6 offen offset:0
    v_accvgpr_read_b32 v18, a15
    v_mfma_f32_16x16x32_bf16 v[228:231], a[244:247], a[236:239], v[228:231]
    ds_read_b64_tr_b16 v[56:57], v4 offset:11264
    v_accvgpr_read_b32 v19, a19
    v_mfma_f32_16x16x32_bf16 v[224:227], a[244:247], a[232:235], v[224:227]
    v_accvgpr_read_b32 v20, a23
    v_add_f32 v14, v14, v11
    v_mfma_f32_16x16x32_bf16 v[224:227], a[240:243], a[208:211], v[224:227]
    ds_read_b64_tr_b16 v[58:59], v4 offset:11776
    v_add_f32 v15, v15, v12
    v_mfma_f32_16x16x32_bf16 v[220:223], a[240:243], a[204:207], v[220:223]
    buffer_load_dwordx4 a[180:183], v2, s[52:55], s6 offen offset:1024
    v_add_f32 v16, v16, v13
    v_mfma_f32_16x16x32_bf16 v[220:223], a[244:247], a[228:231], v[220:223]
    ds_read_b64_tr_b16 v[60:61], v4 offset:23552
    v_add_f32 v14, v14, v18
    v_mfma_f32_16x16x32_bf16 v[216:219], a[244:247], a[224:227], v[216:219]
    v_add_f32 v15, v15, v19
    v_add_f32 v16, v16, v20
    v_mfma_f32_16x16x32_bf16 v[216:219], a[240:243], a[200:203], v[216:219]
    ds_read_b64_tr_b16 v[62:63], v4 offset:24064
    v_accvgpr_write_b32 a15, v14
    v_mfma_f32_16x16x32_bf16 v[212:215], a[240:243], a[196:199], v[212:215]
    buffer_load_dwordx4 a[184:187], v2, s[52:55], s6 offen offset:2048
    v_accvgpr_write_b32 a19, v15
    v_mfma_f32_16x16x32_bf16 v[212:215], a[244:247], a[220:223], v[212:215]
    v_accvgpr_write_b32 a23, v16
    v_mfma_f32_16x16x32_bf16 v[208:211], a[244:247], a[216:219], v[208:211]
    v_mfma_f32_16x16x32_bf16 v[208:211], a[240:243], a[192:195], v[208:211]
    s_waitcnt lgkmcnt(0)
    s_barrier
    v_mfma_f32_16x16x32_bf16 v[232:235], a[248:251], a[192:195], v[232:235]
    buffer_load_dwordx4 a[188:191], v2, s[52:55], s6 offen offset:3072
    v_mfma_f32_16x16x32_bf16 v[232:235], a[252:255], a[216:219], v[232:235]
    ds_read_b64_tr_b16 a[240:241], v3 offset:0
    v_mfma_f32_16x16x32_bf16 v[236:239], a[252:255], a[220:223], v[236:239]
    v_mfma_f32_16x16x32_bf16 v[236:239], a[248:251], a[196:199], v[236:239]
    ds_read_b64_tr_b16 a[242:243], v3 offset:512
    v_mfma_f32_16x16x32_bf16 v[240:243], a[248:251], a[200:203], v[240:243]
    v_mfma_f32_16x16x32_bf16 v[240:243], a[252:255], a[224:227], v[240:243]
    ds_read_b64_tr_b16 a[244:245], v3 offset:12288
    v_mfma_f32_16x16x32_bf16 v[244:247], a[252:255], a[228:231], v[244:247]
    v_mfma_f32_16x16x32_bf16 v[244:247], a[248:251], a[204:207], v[244:247]
    ds_read_b64_tr_b16 a[246:247], v3 offset:12800
    v_mfma_f32_16x16x32_bf16 v[248:251], a[248:251], a[208:211], v[248:251]
    v_mfma_f32_16x16x32_bf16 v[248:251], a[252:255], a[232:235], v[248:251]
    v_mfma_f32_16x16x32_bf16 v[252:255], a[252:255], a[236:239], v[252:255]
    v_mfma_f32_16x16x32_bf16 v[252:255], a[248:251], a[212:215], v[252:255]
    v_mfma_f32_16x16x32_bf16 a[92:95], v[56:59], a[212:215], a[92:95]
    s_waitcnt vmcnt(25)
    v_lshlrev_b32 v14, 16, v36
    v_and_b32 v15, s36, v36
    v_mfma_f32_16x16x32_bf16 a[92:95], v[60:63], a[236:239], a[92:95]
    ds_read_b64_tr_b16 a[248:249], v3 offset:1024
    v_lshlrev_b32 v16, 16, v37
    v_mfma_f32_16x16x32_bf16 a[88:91], v[60:63], a[232:235], a[88:91]
    v_accvgpr_read_b32 v18, a27
    v_accvgpr_read_b32 v19, a31
    v_mfma_f32_16x16x32_bf16 a[88:91], v[56:59], a[208:211], a[88:91]
    ds_read_b64_tr_b16 a[250:251], v3 offset:1536
    v_accvgpr_read_b32 v20, a35
    v_mfma_f32_16x16x32_bf16 a[84:87], v[56:59], a[204:207], a[84:87]
    v_add_f32 v14, v14, v8
    v_add_f32 v15, v15, v9
    v_mfma_f32_16x16x32_bf16 a[84:87], v[60:63], a[228:231], a[84:87]
    ds_read_b64_tr_b16 a[252:253], v3 offset:13312
    v_add_f32 v16, v16, v10
    v_mfma_f32_16x16x32_bf16 a[80:83], v[60:63], a[224:227], a[80:83]
    v_add_f32 v14, v14, v18
    v_add_f32 v15, v15, v19
    v_mfma_f32_16x16x32_bf16 a[80:83], v[56:59], a[200:203], a[80:83]
    ds_read_b64_tr_b16 a[254:255], v3 offset:13824
    v_add_f32 v16, v16, v20
    v_mfma_f32_16x16x32_bf16 a[76:79], v[56:59], a[196:199], a[76:79]
    v_accvgpr_write_b32 a27, v14
    v_accvgpr_write_b32 a31, v15
    v_mfma_f32_16x16x32_bf16 a[76:79], v[60:63], a[220:223], a[76:79]
    v_accvgpr_write_b32 a35, v16
    v_and_b32 v14, s36, v37
    v_mfma_f32_16x16x32_bf16 a[72:75], v[60:63], a[216:219], a[72:75]
    v_lshlrev_b32 v15, 16, v38
    v_and_b32 v16, s36, v38
    v_mfma_f32_16x16x32_bf16 a[72:75], v[56:59], a[192:195], a[72:75]
    v_accvgpr_read_b32 v18, a39
    v_accvgpr_read_b32 v19, a43
    s_waitcnt vmcnt(19)
    s_waitcnt lgkmcnt(4)
    v_mfma_f32_16x16x32_bf16 v[64:67], a[240:243], a[96:99], v[64:67]
    v_accvgpr_read_b32 v20, a47
    v_add_f32 v14, v14, v11
    v_mfma_f32_16x16x32_bf16 v[64:67], a[244:247], a[120:123], v[64:67]
    ds_read_b64_tr_b16 v[56:57], v3 offset:2048
    v_add_f32 v15, v15, v12
    v_mfma_f32_16x16x32_bf16 v[68:71], a[244:247], a[124:127], v[68:71]
    v_add_f32 v16, v16, v13
    v_add_f32 v14, v14, v18
    v_mfma_f32_16x16x32_bf16 v[68:71], a[240:243], a[100:103], v[68:71]
    ds_read_b64_tr_b16 v[58:59], v3 offset:2560
    s_add_u32 m0, s39, 49152
    v_add_f32 v15, v15, v19
    v_mfma_f32_16x16x32_bf16 v[72:75], a[240:243], a[104:107], v[72:75]
    buffer_load_dwordx4 v1, s[56:59], s4 offen offset:0 nt lds
    v_add_f32 v16, v16, v20
    v_mfma_f32_16x16x32_bf16 v[72:75], a[244:247], a[128:131], v[72:75]
    ds_read_b64_tr_b16 v[60:61], v3 offset:14336
    v_accvgpr_write_b32 a39, v14
    v_mfma_f32_16x16x32_bf16 v[76:79], a[244:247], a[132:135], v[76:79]
    v_accvgpr_write_b32 a43, v15
    v_accvgpr_write_b32 a47, v16
    v_mfma_f32_16x16x32_bf16 v[76:79], a[240:243], a[108:111], v[76:79]
    ds_read_b64_tr_b16 v[62:63], v3 offset:14848
    s_add_u32 m0, s39, 49152
    v_mfma_f32_16x16x32_bf16 v[80:83], a[240:243], a[112:115], v[80:83]
    buffer_load_dwordx4 v1, s[56:59], s4 offen offset:1024 nt lds
    v_mfma_f32_16x16x32_bf16 v[80:83], a[244:247], a[136:139], v[80:83]
    v_mfma_f32_16x16x32_bf16 v[84:87], a[244:247], a[140:143], v[84:87]
    v_mfma_f32_16x16x32_bf16 v[84:87], a[240:243], a[116:119], v[84:87]
    s_add_u32 m0, s39, 49152
    s_waitcnt lgkmcnt(4)
    v_mfma_f32_16x16x32_bf16 v[108:111], a[248:251], a[116:119], v[108:111]
    buffer_load_dwordx4 v1, s[56:59], s4 offen offset:2048 nt lds
    v_mfma_f32_16x16x32_bf16 v[108:111], a[252:255], a[140:143], v[108:111]
    ds_read_b64_tr_b16 a[240:241], v3 offset:3072
    v_mfma_f32_16x16x32_bf16 v[104:107], a[252:255], a[136:139], v[104:107]
    v_mfma_f32_16x16x32_bf16 v[104:107], a[248:251], a[112:115], v[104:107]
    ds_read_b64_tr_b16 a[242:243], v3 offset:3584
    s_add_u32 m0, s39, 61440
    v_mfma_f32_16x16x32_bf16 v[100:103], a[248:251], a[108:111], v[100:103]
    buffer_load_dwordx4 v1, s[60:63], s29 offen offset:0 nt lds
    v_mfma_f32_16x16x32_bf16 v[100:103], a[252:255], a[132:135], v[100:103]
    ds_read_b64_tr_b16 a[244:245], v3 offset:15360
    v_mfma_f32_16x16x32_bf16 v[96:99], a[252:255], a[128:131], v[96:99]
    v_mfma_f32_16x16x32_bf16 v[96:99], a[248:251], a[104:107], v[96:99]
    ds_read_b64_tr_b16 a[246:247], v3 offset:15872
    s_add_u32 m0, s39, 61440
    v_mfma_f32_16x16x32_bf16 v[92:95], a[248:251], a[100:103], v[92:95]
    buffer_load_dwordx4 v1, s[60:63], s29 offen offset:1024 nt lds
    v_mfma_f32_16x16x32_bf16 v[92:95], a[252:255], a[124:127], v[92:95]
    v_mfma_f32_16x16x32_bf16 v[88:91], a[252:255], a[120:123], v[88:91]
    v_mfma_f32_16x16x32_bf16 v[88:91], a[248:251], a[96:99], v[88:91]
    s_add_u32 m0, s39, 61440
    s_waitcnt lgkmcnt(4)
    v_mfma_f32_16x16x32_bf16 a[0:3], v[56:59], a[96:99], a[0:3]
    buffer_load_dwordx4 v1, s[60:63], s29 offen offset:2048 nt lds
    v_mfma_f32_16x16x32_bf16 a[0:3], v[60:63], a[120:123], a[0:3]
    ds_read_b64_tr_b16 a[248:249], v3 offset:4096
    v_mfma_f32_16x16x32_bf16 a[4:7], v[60:63], a[124:127], a[4:7]
    v_mfma_f32_16x16x32_bf16 a[4:7], v[56:59], a[100:103], a[4:7]
    ds_read_b64_tr_b16 a[250:251], v3 offset:4608
    v_mfma_f32_16x16x32_bf16 a[8:11], v[56:59], a[104:107], a[8:11]
    v_mfma_f32_16x16x32_bf16 a[8:11], v[60:63], a[128:131], a[8:11]
    ds_read_b64_tr_b16 a[252:253], v3 offset:16384
    v_mfma_f32_16x16x32_bf16 a[12:15], v[60:63], a[132:135], a[12:15]
    v_mfma_f32_16x16x32_bf16 a[12:15], v[56:59], a[108:111], a[12:15]
    ds_read_b64_tr_b16 a[254:255], v3 offset:16896
    v_mfma_f32_16x16x32_bf16 a[16:19], v[56:59], a[112:115], a[16:19]
    v_mfma_f32_16x16x32_bf16 a[16:19], v[60:63], a[136:139], a[16:19]
    v_mfma_f32_16x16x32_bf16 a[20:23], v[60:63], a[140:143], a[20:23]
    v_mfma_f32_16x16x32_bf16 a[20:23], v[56:59], a[116:119], a[20:23]
    s_waitcnt lgkmcnt(4)
    v_mfma_f32_16x16x32_bf16 v[132:135], a[240:243], a[116:119], v[132:135]
    v_mfma_f32_16x16x32_bf16 v[132:135], a[244:247], a[140:143], v[132:135]
    ds_read_b64_tr_b16 v[56:57], v3 offset:5120
    v_mfma_f32_16x16x32_bf16 v[128:131], a[244:247], a[136:139], v[128:131]
    v_mfma_f32_16x16x32_bf16 v[128:131], a[240:243], a[112:115], v[128:131]
    ds_read_b64_tr_b16 v[58:59], v3 offset:5632
    v_mfma_f32_16x16x32_bf16 v[124:127], a[240:243], a[108:111], v[124:127]
    v_mfma_f32_16x16x32_bf16 v[124:127], a[244:247], a[132:135], v[124:127]
    ds_read_b64_tr_b16 v[60:61], v3 offset:17408
    v_mfma_f32_16x16x32_bf16 v[120:123], a[244:247], a[128:131], v[120:123]
    v_mfma_f32_16x16x32_bf16 v[120:123], a[240:243], a[104:107], v[120:123]
    ds_read_b64_tr_b16 v[62:63], v3 offset:17920
    v_mfma_f32_16x16x32_bf16 v[116:119], a[240:243], a[100:103], v[116:119]
    v_mfma_f32_16x16x32_bf16 v[116:119], a[244:247], a[124:127], v[116:119]
    v_mfma_f32_16x16x32_bf16 v[112:115], a[244:247], a[120:123], v[112:115]
    v_mfma_f32_16x16x32_bf16 v[112:115], a[240:243], a[96:99], v[112:115]
    s_waitcnt lgkmcnt(4)
    v_mfma_f32_16x16x32_bf16 v[136:139], a[248:251], a[96:99], v[136:139]
    v_mfma_f32_16x16x32_bf16 v[136:139], a[252:255], a[120:123], v[136:139]
    ds_read_b64_tr_b16 a[240:241], v3 offset:6144
    v_mfma_f32_16x16x32_bf16 v[140:143], a[252:255], a[124:127], v[140:143]
    v_mfma_f32_16x16x32_bf16 v[140:143], a[248:251], a[100:103], v[140:143]
    ds_read_b64_tr_b16 a[242:243], v3 offset:6656
    s_mov_b32 s6, 1130496
    v_mfma_f32_16x16x32_bf16 v[144:147], a[248:251], a[104:107], v[144:147]
    buffer_load_dwordx4 a[192:195], v2, s[52:55], s6 offen offset:0
    v_mfma_f32_16x16x32_bf16 v[144:147], a[252:255], a[128:131], v[144:147]
    ds_read_b64_tr_b16 a[244:245], v3 offset:18432
    v_mfma_f32_16x16x32_bf16 v[148:151], a[252:255], a[132:135], v[148:151]
    v_mfma_f32_16x16x32_bf16 v[148:151], a[248:251], a[108:111], v[148:151]
    ds_read_b64_tr_b16 a[246:247], v3 offset:18944
    v_mfma_f32_16x16x32_bf16 v[152:155], a[248:251], a[112:115], v[152:155]
    buffer_load_dwordx4 a[196:199], v2, s[52:55], s6 offen offset:1024
    v_mfma_f32_16x16x32_bf16 v[152:155], a[252:255], a[136:139], v[152:155]
    v_mfma_f32_16x16x32_bf16 v[156:159], a[252:255], a[140:143], v[156:159]
    v_mfma_f32_16x16x32_bf16 v[156:159], a[248:251], a[116:119], v[156:159]
    s_waitcnt lgkmcnt(4)
    v_mfma_f32_16x16x32_bf16 a[44:47], v[56:59], a[116:119], a[44:47]
    buffer_load_dwordx4 a[200:203], v2, s[52:55], s6 offen offset:2048
    v_mfma_f32_16x16x32_bf16 a[44:47], v[60:63], a[140:143], a[44:47]
    ds_read_b64_tr_b16 a[248:249], v3 offset:7168
    v_mfma_f32_16x16x32_bf16 a[40:43], v[60:63], a[136:139], a[40:43]
    v_mfma_f32_16x16x32_bf16 a[40:43], v[56:59], a[112:115], a[40:43]
    ds_read_b64_tr_b16 a[250:251], v3 offset:7680
    v_mfma_f32_16x16x32_bf16 a[36:39], v[56:59], a[108:111], a[36:39]
    buffer_load_dwordx4 a[204:207], v2, s[52:55], s6 offen offset:3072
    v_mfma_f32_16x16x32_bf16 a[36:39], v[60:63], a[132:135], a[36:39]
    ds_read_b64_tr_b16 a[252:253], v3 offset:19456
    v_mfma_f32_16x16x32_bf16 a[32:35], v[60:63], a[128:131], a[32:35]
    v_mfma_f32_16x16x32_bf16 a[32:35], v[56:59], a[104:107], a[32:35]
    ds_read_b64_tr_b16 a[254:255], v3 offset:19968
    s_mov_b32 s6, 1134592
    v_mfma_f32_16x16x32_bf16 a[28:31], v[56:59], a[100:103], a[28:31]
    buffer_load_dwordx4 a[208:211], v2, s[52:55], s6 offen offset:0
    v_mfma_f32_16x16x32_bf16 a[28:31], v[60:63], a[124:127], a[28:31]
    v_mfma_f32_16x16x32_bf16 a[24:27], v[60:63], a[120:123], a[24:27]
    v_mfma_f32_16x16x32_bf16 a[24:27], v[56:59], a[96:99], a[24:27]
    s_waitcnt lgkmcnt(4)
    v_mfma_f32_16x16x32_bf16 v[160:163], a[240:243], a[96:99], v[160:163]
    buffer_load_dwordx4 a[212:215], v2, s[52:55], s6 offen offset:1024
    v_mfma_f32_16x16x32_bf16 v[160:163], a[244:247], a[120:123], v[160:163]
    ds_read_b64_tr_b16 v[56:57], v3 offset:8192
    v_mfma_f32_16x16x32_bf16 v[164:167], a[244:247], a[124:127], v[164:167]
    v_mfma_f32_16x16x32_bf16 v[164:167], a[240:243], a[100:103], v[164:167]
    ds_read_b64_tr_b16 v[58:59], v3 offset:8704
    v_mfma_f32_16x16x32_bf16 v[168:171], a[240:243], a[104:107], v[168:171]
    v_mfma_f32_16x16x32_bf16 v[168:171], a[244:247], a[128:131], v[168:171]
    ds_read_b64_tr_b16 v[60:61], v3 offset:20480
    v_mfma_f32_16x16x32_bf16 v[172:175], a[244:247], a[132:135], v[172:175]
    v_mfma_f32_16x16x32_bf16 v[172:175], a[240:243], a[108:111], v[172:175]
    ds_read_b64_tr_b16 v[62:63], v3 offset:20992
    v_mfma_f32_16x16x32_bf16 v[176:179], a[240:243], a[112:115], v[176:179]
    v_mfma_f32_16x16x32_bf16 v[176:179], a[244:247], a[136:139], v[176:179]
    v_mfma_f32_16x16x32_bf16 v[180:183], a[244:247], a[140:143], v[180:183]
    v_mfma_f32_16x16x32_bf16 v[180:183], a[240:243], a[116:119], v[180:183]
    s_waitcnt lgkmcnt(4)
    v_mfma_f32_16x16x32_bf16 v[204:207], a[248:251], a[116:119], v[204:207]
    v_mfma_f32_16x16x32_bf16 v[204:207], a[252:255], a[140:143], v[204:207]
    ds_read_b64_tr_b16 a[240:241], v3 offset:9216
    v_mfma_f32_16x16x32_bf16 v[200:203], a[252:255], a[136:139], v[200:203]
    v_mfma_f32_16x16x32_bf16 v[200:203], a[248:251], a[112:115], v[200:203]
    ds_read_b64_tr_b16 a[242:243], v3 offset:9728
    v_mfma_f32_16x16x32_bf16 v[196:199], a[248:251], a[108:111], v[196:199]
    v_mfma_f32_16x16x32_bf16 v[196:199], a[252:255], a[132:135], v[196:199]
    ds_read_b64_tr_b16 a[244:245], v3 offset:21504
    v_mfma_f32_16x16x32_bf16 v[192:195], a[252:255], a[128:131], v[192:195]
    v_mfma_f32_16x16x32_bf16 v[192:195], a[248:251], a[104:107], v[192:195]
    ds_read_b64_tr_b16 a[246:247], v3 offset:22016
    v_mfma_f32_16x16x32_bf16 v[188:191], a[248:251], a[100:103], v[188:191]
    v_mfma_f32_16x16x32_bf16 v[188:191], a[252:255], a[124:127], v[188:191]
    v_mfma_f32_16x16x32_bf16 v[184:187], a[252:255], a[120:123], v[184:187]
    v_mfma_f32_16x16x32_bf16 v[184:187], a[248:251], a[96:99], v[184:187]
    s_waitcnt lgkmcnt(4)
    v_mfma_f32_16x16x32_bf16 a[48:51], v[56:59], a[96:99], a[48:51]
    v_mfma_f32_16x16x32_bf16 a[48:51], v[60:63], a[120:123], a[48:51]
    ds_read_b64_tr_b16 a[248:249], v3 offset:10240
    v_mfma_f32_16x16x32_bf16 a[52:55], v[60:63], a[124:127], a[52:55]
    v_mfma_f32_16x16x32_bf16 a[52:55], v[56:59], a[100:103], a[52:55]
    ds_read_b64_tr_b16 a[250:251], v3 offset:10752
    v_mfma_f32_16x16x32_bf16 a[56:59], v[56:59], a[104:107], a[56:59]
    buffer_load_dwordx4 a[216:219], v2, s[52:55], s6 offen offset:2048
    v_mfma_f32_16x16x32_bf16 a[56:59], v[60:63], a[128:131], a[56:59]
    ds_read_b64_tr_b16 a[252:253], v3 offset:22528
    v_mfma_f32_16x16x32_bf16 a[60:63], v[60:63], a[132:135], a[60:63]
    v_mfma_f32_16x16x32_bf16 a[60:63], v[56:59], a[108:111], a[60:63]
    ds_read_b64_tr_b16 a[254:255], v3 offset:23040
    v_mfma_f32_16x16x32_bf16 a[64:67], v[56:59], a[112:115], a[64:67]
    buffer_load_dwordx4 a[220:223], v2, s[52:55], s6 offen offset:3072
    v_mfma_f32_16x16x32_bf16 a[64:67], v[60:63], a[136:139], a[64:67]
    v_mfma_f32_16x16x32_bf16 a[68:71], v[60:63], a[140:143], a[68:71]
    v_mfma_f32_16x16x32_bf16 a[68:71], v[56:59], a[116:119], a[68:71]
    s_mov_b32 s6, 1138688
    s_waitcnt lgkmcnt(4)
    v_mfma_f32_16x16x32_bf16 v[228:231], a[240:243], a[116:119], v[228:231]
    buffer_load_dwordx4 a[224:227], v2, s[52:55], s6 offen offset:0
    v_mfma_f32_16x16x32_bf16 v[228:231], a[244:247], a[140:143], v[228:231]
    ds_read_b64_tr_b16 v[56:57], v3 offset:11264
    v_mfma_f32_16x16x32_bf16 v[224:227], a[244:247], a[136:139], v[224:227]
    v_mfma_f32_16x16x32_bf16 v[224:227], a[240:243], a[112:115], v[224:227]
    ds_read_b64_tr_b16 v[58:59], v3 offset:11776
    v_mfma_f32_16x16x32_bf16 v[220:223], a[240:243], a[108:111], v[220:223]
    buffer_load_dwordx4 a[228:231], v2, s[52:55], s6 offen offset:1024
    v_mfma_f32_16x16x32_bf16 v[220:223], a[244:247], a[132:135], v[220:223]
    ds_read_b64_tr_b16 v[60:61], v3 offset:23552
    v_mfma_f32_16x16x32_bf16 v[216:219], a[244:247], a[128:131], v[216:219]
    v_mfma_f32_16x16x32_bf16 v[216:219], a[240:243], a[104:107], v[216:219]
    ds_read_b64_tr_b16 v[62:63], v3 offset:24064
    v_mfma_f32_16x16x32_bf16 v[212:215], a[240:243], a[100:103], v[212:215]
    buffer_load_dwordx4 a[232:235], v2, s[52:55], s6 offen offset:2048
    v_mfma_f32_16x16x32_bf16 v[212:215], a[244:247], a[124:127], v[212:215]
    v_mfma_f32_16x16x32_bf16 v[208:211], a[244:247], a[120:123], v[208:211]
    v_mfma_f32_16x16x32_bf16 v[208:211], a[240:243], a[96:99], v[208:211]
    s_waitcnt vmcnt(30) lgkmcnt(0)
    s_barrier
    v_mfma_f32_16x16x32_bf16 v[232:235], a[248:251], a[96:99], v[232:235]
    buffer_load_dwordx4 a[236:239], v2, s[52:55], s6 offen offset:3072
    v_mfma_f32_16x16x32_bf16 v[232:235], a[252:255], a[120:123], v[232:235]
    ds_read_b64_tr_b16 a[240:241], v3 offset:24576
    v_mfma_f32_16x16x32_bf16 v[236:239], a[252:255], a[124:127], v[236:239]
    v_mfma_f32_16x16x32_bf16 v[236:239], a[248:251], a[100:103], v[236:239]
    ds_read_b64_tr_b16 a[242:243], v3 offset:25088
    v_mfma_f32_16x16x32_bf16 v[240:243], a[248:251], a[104:107], v[240:243]
    v_mfma_f32_16x16x32_bf16 v[240:243], a[252:255], a[128:131], v[240:243]
    ds_read_b64_tr_b16 a[244:245], v3 offset:36864
    v_mfma_f32_16x16x32_bf16 v[244:247], a[252:255], a[132:135], v[244:247]
    v_mfma_f32_16x16x32_bf16 v[244:247], a[248:251], a[108:111], v[244:247]
    ds_read_b64_tr_b16 a[246:247], v3 offset:37376
    v_mfma_f32_16x16x32_bf16 v[248:251], a[248:251], a[112:115], v[248:251]
    v_mfma_f32_16x16x32_bf16 v[248:251], a[252:255], a[136:139], v[248:251]
    v_mfma_f32_16x16x32_bf16 v[252:255], a[252:255], a[140:143], v[252:255]
    v_mfma_f32_16x16x32_bf16 v[252:255], a[248:251], a[116:119], v[252:255]
    v_mfma_f32_16x16x32_bf16 a[92:95], v[56:59], a[116:119], a[92:95]
    v_mfma_f32_16x16x32_bf16 a[92:95], v[60:63], a[140:143], a[92:95]
    ds_read_b64_tr_b16 a[248:249], v3 offset:25600
    v_mfma_f32_16x16x32_bf16 a[88:91], v[60:63], a[136:139], a[88:91]
    v_mfma_f32_16x16x32_bf16 a[88:91], v[56:59], a[112:115], a[88:91]
    ds_read_b64_tr_b16 a[250:251], v3 offset:26112
    v_mfma_f32_16x16x32_bf16 a[84:87], v[56:59], a[108:111], a[84:87]
    v_mfma_f32_16x16x32_bf16 a[84:87], v[60:63], a[132:135], a[84:87]
    ds_read_b64_tr_b16 a[252:253], v3 offset:37888
    v_mfma_f32_16x16x32_bf16 a[80:83], v[60:63], a[128:131], a[80:83]
    v_mfma_f32_16x16x32_bf16 a[80:83], v[56:59], a[104:107], a[80:83]
    ds_read_b64_tr_b16 a[254:255], v3 offset:38400
    v_mfma_f32_16x16x32_bf16 a[76:79], v[56:59], a[100:103], a[76:79]
    v_mfma_f32_16x16x32_bf16 a[76:79], v[60:63], a[124:127], a[76:79]
    v_mfma_f32_16x16x32_bf16 a[72:75], v[60:63], a[120:123], a[72:75]
    v_mfma_f32_16x16x32_bf16 a[72:75], v[56:59], a[96:99], a[72:75]
    s_cmp_eq_u32 s28, 2
    s_cbranch_scc1 L_k2_last
    s_waitcnt vmcnt(18)
    s_waitcnt lgkmcnt(4)
    v_mfma_f32_16x16x32_bf16 v[64:67], a[240:243], a[144:147], v[64:67]
    v_mfma_f32_16x16x32_bf16 v[64:67], a[244:247], a[168:171], v[64:67]
    ds_read_b64_tr_b16 v[56:57], v3 offset:26624
    v_mfma_f32_16x16x32_bf16 v[68:71], a[244:247], a[172:175], v[68:71]
    s_add_u32 s27, s26, 256
    s_mul_i32 s4, s27, 442368
    v_mfma_f32_16x16x32_bf16 v[68:71], a[240:243], a[148:151], v[68:71]
    ds_read_b64_tr_b16 v[58:59], v3 offset:27136
    s_mul_i32 s29, s27, 147456
    s_add_u32 s5, s4, 4096
    s_add_u32 m0, s32, 0
    v_mfma_f32_16x16x32_bf16 v[72:75], a[240:243], a[152:155], v[72:75]
    buffer_load_dwordx4 v1, s[8:11], s4 offen offset:0 nt lds
    v_mfma_f32_16x16x32_bf16 v[72:75], a[244:247], a[176:179], v[72:75]
    ds_read_b64_tr_b16 v[60:61], v3 offset:38912
    v_mfma_f32_16x16x32_bf16 v[76:79], a[244:247], a[180:183], v[76:79]
    v_mfma_f32_16x16x32_bf16 v[76:79], a[240:243], a[156:159], v[76:79]
    ds_read_b64_tr_b16 v[62:63], v3 offset:39424
    s_add_u32 m0, s32, 0
    v_mfma_f32_16x16x32_bf16 v[80:83], a[240:243], a[160:163], v[80:83]
    buffer_load_dwordx4 v1, s[8:11], s4 offen offset:1024 nt lds
    v_mfma_f32_16x16x32_bf16 v[80:83], a[244:247], a[184:187], v[80:83]
    v_mfma_f32_16x16x32_bf16 v[84:87], a[244:247], a[188:191], v[84:87]
    v_mfma_f32_16x16x32_bf16 v[84:87], a[240:243], a[164:167], v[84:87]
    s_add_u32 m0, s32, 0
    s_waitcnt lgkmcnt(4)
    v_mfma_f32_16x16x32_bf16 v[108:111], a[248:251], a[164:167], v[108:111]
    buffer_load_dwordx4 v1, s[8:11], s4 offen offset:2048 nt lds
    v_mfma_f32_16x16x32_bf16 v[108:111], a[252:255], a[188:191], v[108:111]
    ds_read_b64_tr_b16 a[240:241], v3 offset:27648
    v_mfma_f32_16x16x32_bf16 v[104:107], a[252:255], a[184:187], v[104:107]
    v_mfma_f32_16x16x32_bf16 v[104:107], a[248:251], a[160:163], v[104:107]
    ds_read_b64_tr_b16 a[242:243], v3 offset:28160
    s_add_u32 m0, s32, 0
    v_mfma_f32_16x16x32_bf16 v[100:103], a[248:251], a[156:159], v[100:103]
    buffer_load_dwordx4 v1, s[8:11], s4 offen offset:3072 nt lds
    v_mfma_f32_16x16x32_bf16 v[100:103], a[252:255], a[180:183], v[100:103]
    ds_read_b64_tr_b16 a[244:245], v3 offset:39936
    v_mfma_f32_16x16x32_bf16 v[96:99], a[252:255], a[176:179], v[96:99]
    v_mfma_f32_16x16x32_bf16 v[96:99], a[248:251], a[152:155], v[96:99]
    ds_read_b64_tr_b16 a[246:247], v3 offset:40448
    s_add_u32 m0, s32, 4096
    v_mfma_f32_16x16x32_bf16 v[92:95], a[248:251], a[148:151], v[92:95]
    buffer_load_dwordx4 v1, s[8:11], s5 offen offset:0 nt lds
    v_mfma_f32_16x16x32_bf16 v[92:95], a[252:255], a[172:175], v[92:95]
    v_mfma_f32_16x16x32_bf16 v[88:91], a[252:255], a[168:171], v[88:91]
    v_mfma_f32_16x16x32_bf16 v[88:91], a[248:251], a[144:147], v[88:91]
    s_add_u32 m0, s32, 4096
    s_waitcnt lgkmcnt(4)
    v_mfma_f32_16x16x32_bf16 a[0:3], v[56:59], a[144:147], a[0:3]
    buffer_load_dwordx4 v1, s[8:11], s5 offen offset:1024 nt lds
    v_mfma_f32_16x16x32_bf16 a[0:3], v[60:63], a[168:171], a[0:3]
    ds_read_b64_tr_b16 a[248:249], v3 offset:28672
    v_mfma_f32_16x16x32_bf16 a[4:7], v[60:63], a[172:175], a[4:7]
    v_mfma_f32_16x16x32_bf16 a[4:7], v[56:59], a[148:151], a[4:7]
    ds_read_b64_tr_b16 a[250:251], v3 offset:29184
    v_mfma_f32_16x16x32_bf16 a[8:11], v[56:59], a[152:155], a[8:11]
    v_mfma_f32_16x16x32_bf16 a[8:11], v[60:63], a[176:179], a[8:11]
    ds_read_b64_tr_b16 a[252:253], v3 offset:40960
    v_mfma_f32_16x16x32_bf16 a[12:15], v[60:63], a[180:183], a[12:15]
    v_mfma_f32_16x16x32_bf16 a[12:15], v[56:59], a[156:159], a[12:15]
    ds_read_b64_tr_b16 a[254:255], v3 offset:41472
    v_mfma_f32_16x16x32_bf16 a[16:19], v[56:59], a[160:163], a[16:19]
    v_mfma_f32_16x16x32_bf16 a[16:19], v[60:63], a[184:187], a[16:19]
    v_mfma_f32_16x16x32_bf16 a[20:23], v[60:63], a[188:191], a[20:23]
    v_mfma_f32_16x16x32_bf16 a[20:23], v[56:59], a[164:167], a[20:23]
    s_waitcnt lgkmcnt(4)
    v_mfma_f32_16x16x32_bf16 v[132:135], a[240:243], a[164:167], v[132:135]
    v_mfma_f32_16x16x32_bf16 v[132:135], a[244:247], a[188:191], v[132:135]
    ds_read_b64_tr_b16 v[56:57], v3 offset:29696
    v_mfma_f32_16x16x32_bf16 v[128:131], a[244:247], a[184:187], v[128:131]
    v_mfma_f32_16x16x32_bf16 v[128:131], a[240:243], a[160:163], v[128:131]
    ds_read_b64_tr_b16 v[58:59], v3 offset:30208
    v_mfma_f32_16x16x32_bf16 v[124:127], a[240:243], a[156:159], v[124:127]
    v_mfma_f32_16x16x32_bf16 v[124:127], a[244:247], a[180:183], v[124:127]
    ds_read_b64_tr_b16 v[60:61], v3 offset:41984
    v_mfma_f32_16x16x32_bf16 v[120:123], a[244:247], a[176:179], v[120:123]
    v_mfma_f32_16x16x32_bf16 v[120:123], a[240:243], a[152:155], v[120:123]
    ds_read_b64_tr_b16 v[62:63], v3 offset:42496
    v_mfma_f32_16x16x32_bf16 v[116:119], a[240:243], a[148:151], v[116:119]
    v_mfma_f32_16x16x32_bf16 v[116:119], a[244:247], a[172:175], v[116:119]
    v_mfma_f32_16x16x32_bf16 v[112:115], a[244:247], a[168:171], v[112:115]
    v_mfma_f32_16x16x32_bf16 v[112:115], a[240:243], a[144:147], v[112:115]
    s_waitcnt lgkmcnt(4)
    v_mfma_f32_16x16x32_bf16 v[136:139], a[248:251], a[144:147], v[136:139]
    v_mfma_f32_16x16x32_bf16 v[136:139], a[252:255], a[168:171], v[136:139]
    ds_read_b64_tr_b16 a[240:241], v3 offset:30720
    v_mfma_f32_16x16x32_bf16 v[140:143], a[252:255], a[172:175], v[140:143]
    v_mfma_f32_16x16x32_bf16 v[140:143], a[248:251], a[148:151], v[140:143]
    ds_read_b64_tr_b16 a[242:243], v3 offset:31232
    s_mov_b32 s6, 0
    v_mfma_f32_16x16x32_bf16 v[144:147], a[248:251], a[152:155], v[144:147]
    buffer_load_dwordx4 a[96:99], v2, s[52:55], s6 offen offset:0
    v_mfma_f32_16x16x32_bf16 v[144:147], a[252:255], a[176:179], v[144:147]
    ds_read_b64_tr_b16 a[244:245], v3 offset:43008
    v_mfma_f32_16x16x32_bf16 v[148:151], a[252:255], a[180:183], v[148:151]
    v_mfma_f32_16x16x32_bf16 v[148:151], a[248:251], a[156:159], v[148:151]
    ds_read_b64_tr_b16 a[246:247], v3 offset:43520
    v_mfma_f32_16x16x32_bf16 v[152:155], a[248:251], a[160:163], v[152:155]
    buffer_load_dwordx4 a[100:103], v2, s[52:55], s6 offen offset:1024
    v_mfma_f32_16x16x32_bf16 v[152:155], a[252:255], a[184:187], v[152:155]
    v_mfma_f32_16x16x32_bf16 v[156:159], a[252:255], a[188:191], v[156:159]
    v_mfma_f32_16x16x32_bf16 v[156:159], a[248:251], a[164:167], v[156:159]
    s_waitcnt lgkmcnt(4)
    v_mfma_f32_16x16x32_bf16 a[44:47], v[56:59], a[164:167], a[44:47]
    buffer_load_dwordx4 a[104:107], v2, s[52:55], s6 offen offset:2048
    v_mfma_f32_16x16x32_bf16 a[44:47], v[60:63], a[188:191], a[44:47]
    ds_read_b64_tr_b16 a[248:249], v3 offset:31744
    v_mfma_f32_16x16x32_bf16 a[40:43], v[60:63], a[184:187], a[40:43]
    v_mfma_f32_16x16x32_bf16 a[40:43], v[56:59], a[160:163], a[40:43]
    ds_read_b64_tr_b16 a[250:251], v3 offset:32256
    v_mfma_f32_16x16x32_bf16 a[36:39], v[56:59], a[156:159], a[36:39]
    buffer_load_dwordx4 a[108:111], v2, s[52:55], s6 offen offset:3072
    v_mfma_f32_16x16x32_bf16 a[36:39], v[60:63], a[180:183], a[36:39]
    ds_read_b64_tr_b16 a[252:253], v3 offset:44032
    v_mfma_f32_16x16x32_bf16 a[32:35], v[60:63], a[176:179], a[32:35]
    v_mfma_f32_16x16x32_bf16 a[32:35], v[56:59], a[152:155], a[32:35]
    ds_read_b64_tr_b16 a[254:255], v3 offset:44544
    s_mov_b32 s6, 4096
    v_mfma_f32_16x16x32_bf16 a[28:31], v[56:59], a[148:151], a[28:31]
    buffer_load_dwordx4 a[112:115], v2, s[52:55], s6 offen offset:0
    v_mfma_f32_16x16x32_bf16 a[28:31], v[60:63], a[172:175], a[28:31]
    v_mfma_f32_16x16x32_bf16 a[24:27], v[60:63], a[168:171], a[24:27]
    v_mfma_f32_16x16x32_bf16 a[24:27], v[56:59], a[144:147], a[24:27]
    s_waitcnt lgkmcnt(4)
    v_mfma_f32_16x16x32_bf16 v[160:163], a[240:243], a[144:147], v[160:163]
    buffer_load_dwordx4 a[116:119], v2, s[52:55], s6 offen offset:1024
    v_mfma_f32_16x16x32_bf16 v[160:163], a[244:247], a[168:171], v[160:163]
    ds_read_b64_tr_b16 v[56:57], v3 offset:32768
    v_mfma_f32_16x16x32_bf16 v[164:167], a[244:247], a[172:175], v[164:167]
    v_mfma_f32_16x16x32_bf16 v[164:167], a[240:243], a[148:151], v[164:167]
    ds_read_b64_tr_b16 v[58:59], v3 offset:33280
    v_mfma_f32_16x16x32_bf16 v[168:171], a[240:243], a[152:155], v[168:171]
    v_mfma_f32_16x16x32_bf16 v[168:171], a[244:247], a[176:179], v[168:171]
    ds_read_b64_tr_b16 v[60:61], v3 offset:45056
    v_mfma_f32_16x16x32_bf16 v[172:175], a[244:247], a[180:183], v[172:175]
    v_mfma_f32_16x16x32_bf16 v[172:175], a[240:243], a[156:159], v[172:175]
    ds_read_b64_tr_b16 v[62:63], v3 offset:45568
    v_mfma_f32_16x16x32_bf16 v[176:179], a[240:243], a[160:163], v[176:179]
    v_mfma_f32_16x16x32_bf16 v[176:179], a[244:247], a[184:187], v[176:179]
    v_mfma_f32_16x16x32_bf16 v[180:183], a[244:247], a[188:191], v[180:183]
    v_mfma_f32_16x16x32_bf16 v[180:183], a[240:243], a[164:167], v[180:183]
    s_waitcnt lgkmcnt(4)
    v_mfma_f32_16x16x32_bf16 v[204:207], a[248:251], a[164:167], v[204:207]
    v_mfma_f32_16x16x32_bf16 v[204:207], a[252:255], a[188:191], v[204:207]
    ds_read_b64_tr_b16 a[240:241], v3 offset:33792
    v_mfma_f32_16x16x32_bf16 v[200:203], a[252:255], a[184:187], v[200:203]
    v_mfma_f32_16x16x32_bf16 v[200:203], a[248:251], a[160:163], v[200:203]
    ds_read_b64_tr_b16 a[242:243], v3 offset:34304
    v_mfma_f32_16x16x32_bf16 v[196:199], a[248:251], a[156:159], v[196:199]
    v_mfma_f32_16x16x32_bf16 v[196:199], a[252:255], a[180:183], v[196:199]
    ds_read_b64_tr_b16 a[244:245], v3 offset:46080
    v_mfma_f32_16x16x32_bf16 v[192:195], a[252:255], a[176:179], v[192:195]
    v_mfma_f32_16x16x32_bf16 v[192:195], a[248:251], a[152:155], v[192:195]
    ds_read_b64_tr_b16 a[246:247], v3 offset:46592
    v_mfma_f32_16x16x32_bf16 v[188:191], a[248:251], a[148:151], v[188:191]
    v_mfma_f32_16x16x32_bf16 v[188:191], a[252:255], a[172:175], v[188:191]
    v_mfma_f32_16x16x32_bf16 v[184:187], a[252:255], a[168:171], v[184:187]
    v_mfma_f32_16x16x32_bf16 v[184:187], a[248:251], a[144:147], v[184:187]
    s_waitcnt lgkmcnt(4)
    v_mfma_f32_16x16x32_bf16 a[48:51], v[56:59], a[144:147], a[48:51]
    v_mfma_f32_16x16x32_bf16 a[48:51], v[60:63], a[168:171], a[48:51]
    ds_read_b64_tr_b16 a[248:249], v3 offset:34816
    v_mfma_f32_16x16x32_bf16 a[52:55], v[60:63], a[172:175], a[52:55]
    v_mfma_f32_16x16x32_bf16 a[52:55], v[56:59], a[148:151], a[52:55]
    ds_read_b64_tr_b16 a[250:251], v3 offset:35328
    v_mfma_f32_16x16x32_bf16 a[56:59], v[56:59], a[152:155], a[56:59]
    buffer_load_dwordx4 a[120:123], v2, s[52:55], s6 offen offset:2048
    v_mfma_f32_16x16x32_bf16 a[56:59], v[60:63], a[176:179], a[56:59]
    ds_read_b64_tr_b16 a[252:253], v3 offset:47104
    v_mfma_f32_16x16x32_bf16 a[60:63], v[60:63], a[180:183], a[60:63]
    v_mfma_f32_16x16x32_bf16 a[60:63], v[56:59], a[156:159], a[60:63]
    ds_read_b64_tr_b16 a[254:255], v3 offset:47616
    v_mfma_f32_16x16x32_bf16 a[64:67], v[56:59], a[160:163], a[64:67]
    buffer_load_dwordx4 a[124:127], v2, s[52:55], s6 offen offset:3072
    v_mfma_f32_16x16x32_bf16 a[64:67], v[60:63], a[184:187], a[64:67]
    v_mfma_f32_16x16x32_bf16 a[68:71], v[60:63], a[188:191], a[68:71]
    v_mfma_f32_16x16x32_bf16 a[68:71], v[56:59], a[164:167], a[68:71]
    s_mov_b32 s6, 8192
    s_waitcnt lgkmcnt(4)
    v_mfma_f32_16x16x32_bf16 v[228:231], a[240:243], a[164:167], v[228:231]
    buffer_load_dwordx4 a[128:131], v2, s[52:55], s6 offen offset:0
    v_mfma_f32_16x16x32_bf16 v[228:231], a[244:247], a[188:191], v[228:231]
    ds_read_b64_tr_b16 v[56:57], v3 offset:35840
    v_mfma_f32_16x16x32_bf16 v[224:227], a[244:247], a[184:187], v[224:227]
    v_mfma_f32_16x16x32_bf16 v[224:227], a[240:243], a[160:163], v[224:227]
    ds_read_b64_tr_b16 v[58:59], v3 offset:36352
    v_mfma_f32_16x16x32_bf16 v[220:223], a[240:243], a[156:159], v[220:223]
    buffer_load_dwordx4 a[132:135], v2, s[52:55], s6 offen offset:1024
    v_mfma_f32_16x16x32_bf16 v[220:223], a[244:247], a[180:183], v[220:223]
    ds_read_b64_tr_b16 v[60:61], v3 offset:48128
    v_mfma_f32_16x16x32_bf16 v[216:219], a[244:247], a[176:179], v[216:219]
    v_mfma_f32_16x16x32_bf16 v[216:219], a[240:243], a[152:155], v[216:219]
    ds_read_b64_tr_b16 v[62:63], v3 offset:48640
    v_mfma_f32_16x16x32_bf16 v[212:215], a[240:243], a[148:151], v[212:215]
    buffer_load_dwordx4 a[136:139], v2, s[52:55], s6 offen offset:2048
    v_mfma_f32_16x16x32_bf16 v[212:215], a[244:247], a[172:175], v[212:215]
    v_mfma_f32_16x16x32_bf16 v[208:211], a[244:247], a[168:171], v[208:211]
    v_mfma_f32_16x16x32_bf16 v[208:211], a[240:243], a[144:147], v[208:211]
    s_waitcnt vmcnt(29) lgkmcnt(0)
    s_barrier
    v_mfma_f32_16x16x32_bf16 v[232:235], a[248:251], a[144:147], v[232:235]
    buffer_load_dwordx4 a[140:143], v2, s[52:55], s6 offen offset:3072
    v_mfma_f32_16x16x32_bf16 v[232:235], a[252:255], a[168:171], v[232:235]
    ds_read_b64_tr_b16 a[240:241], v4 offset:0
    v_mfma_f32_16x16x32_bf16 v[236:239], a[252:255], a[172:175], v[236:239]
    v_mfma_f32_16x16x32_bf16 v[236:239], a[248:251], a[148:151], v[236:239]
    ds_read_b64_tr_b16 a[242:243], v4 offset:512
    v_mfma_f32_16x16x32_bf16 v[240:243], a[248:251], a[152:155], v[240:243]
    v_mfma_f32_16x16x32_bf16 v[240:243], a[252:255], a[176:179], v[240:243]
    ds_read_b64_tr_b16 a[244:245], v4 offset:12288
    v_mfma_f32_16x16x32_bf16 v[244:247], a[252:255], a[180:183], v[244:247]
    v_mfma_f32_16x16x32_bf16 v[244:247], a[248:251], a[156:159], v[244:247]
    ds_read_b64_tr_b16 a[246:247], v4 offset:12800
    v_mfma_f32_16x16x32_bf16 v[248:251], a[248:251], a[160:163], v[248:251]
    v_mfma_f32_16x16x32_bf16 v[248:251], a[252:255], a[184:187], v[248:251]
    v_mfma_f32_16x16x32_bf16 v[252:255], a[252:255], a[188:191], v[252:255]
    v_mfma_f32_16x16x32_bf16 v[252:255], a[248:251], a[164:167], v[252:255]
    v_mfma_f32_16x16x32_bf16 a[92:95], v[56:59], a[164:167], a[92:95]
    v_mfma_f32_16x16x32_bf16 a[92:95], v[60:63], a[188:191], a[92:95]
    ds_read_b64_tr_b16 a[248:249], v4 offset:1024
    v_mfma_f32_16x16x32_bf16 a[88:91], v[60:63], a[184:187], a[88:91]
    v_mfma_f32_16x16x32_bf16 a[88:91], v[56:59], a[160:163], a[88:91]
    ds_read_b64_tr_b16 a[250:251], v4 offset:1536
    v_mfma_f32_16x16x32_bf16 a[84:87], v[56:59], a[156:159], a[84:87]
    v_mfma_f32_16x16x32_bf16 a[84:87], v[60:63], a[180:183], a[84:87]
    ds_read_b64_tr_b16 a[252:253], v4 offset:13312
    v_mfma_f32_16x16x32_bf16 a[80:83], v[60:63], a[176:179], a[80:83]
    v_mfma_f32_16x16x32_bf16 a[80:83], v[56:59], a[152:155], a[80:83]
    ds_read_b64_tr_b16 a[254:255], v4 offset:13824
    v_mfma_f32_16x16x32_bf16 a[76:79], v[56:59], a[148:151], a[76:79]
    v_mfma_f32_16x16x32_bf16 a[76:79], v[60:63], a[172:175], a[76:79]
    v_mfma_f32_16x16x32_bf16 a[72:75], v[60:63], a[168:171], a[72:75]
    v_mfma_f32_16x16x32_bf16 a[72:75], v[56:59], a[144:147], a[72:75]
    s_waitcnt vmcnt(18)
    s_waitcnt lgkmcnt(4)
    v_mfma_f32_16x16x32_bf16 v[64:67], a[240:243], a[192:195], v[64:67]
    v_mfma_f32_16x16x32_bf16 v[64:67], a[244:247], a[216:219], v[64:67]
    ds_read_b64_tr_b16 v[56:57], v4 offset:2048
    v_mfma_f32_16x16x32_bf16 v[68:71], a[244:247], a[220:223], v[68:71]
    v_mfma_f32_16x16x32_bf16 v[68:71], a[240:243], a[196:199], v[68:71]
    ds_read_b64_tr_b16 v[58:59], v4 offset:2560
    s_add_u32 m0, s39, 24576
    v_mfma_f32_16x16x32_bf16 v[72:75], a[240:243], a[200:203], v[72:75]
    buffer_load_dwordx4 v1, s[56:59], s4 offen offset:0 nt lds
    v_mfma_f32_16x16x32_bf16 v[72:75], a[244:247], a[224:227], v[72:75]
    ds_read_b64_tr_b16 v[60:61], v4 offset:14336
    v_mfma_f32_16x16x32_bf16 v[76:79], a[244:247], a[228:231], v[76:79]
    v_mfma_f32_16x16x32_bf16 v[76:79], a[240:243], a[204:207], v[76:79]
    ds_read_b64_tr_b16 v[62:63], v4 offset:14848
    s_add_u32 m0, s39, 24576
    v_mfma_f32_16x16x32_bf16 v[80:83], a[240:243], a[208:211], v[80:83]
    buffer_load_dwordx4 v1, s[56:59], s4 offen offset:1024 nt lds
    v_mfma_f32_16x16x32_bf16 v[80:83], a[244:247], a[232:235], v[80:83]
    v_mfma_f32_16x16x32_bf16 v[84:87], a[244:247], a[236:239], v[84:87]
    s_mov_b32 s41, s40
    s_add_u32 s44, s40, s35
    v_mfma_f32_16x16x32_bf16 v[84:87], a[240:243], a[212:215], v[84:87]
    s_add_u32 m0, s39, 24576
    s_waitcnt lgkmcnt(4)
    v_mfma_f32_16x16x32_bf16 v[108:111], a[248:251], a[212:215], v[108:111]
    buffer_load_dwordx4 v1, s[56:59], s4 offen offset:2048 nt lds
    v_mfma_f32_16x16x32_bf16 v[108:111], a[252:255], a[236:239], v[108:111]
    ds_read_b64_tr_b16 a[240:241], v4 offset:3072
    v_mfma_f32_16x16x32_bf16 v[104:107], a[252:255], a[232:235], v[104:107]
    v_mfma_f32_16x16x32_bf16 v[104:107], a[248:251], a[208:211], v[104:107]
    ds_read_b64_tr_b16 a[242:243], v4 offset:3584
    s_add_u32 m0, s39, 36864
    v_mfma_f32_16x16x32_bf16 v[100:103], a[248:251], a[204:207], v[100:103]
    buffer_load_dwordx4 v1, s[60:63], s29 offen offset:0 nt lds
    v_mfma_f32_16x16x32_bf16 v[100:103], a[252:255], a[228:231], v[100:103]
    ds_read_b64_tr_b16 a[244:245], v4 offset:15360
    v_mfma_f32_16x16x32_bf16 v[96:99], a[252:255], a[224:227], v[96:99]
    v_mfma_f32_16x16x32_bf16 v[96:99], a[248:251], a[200:203], v[96:99]
    ds_read_b64_tr_b16 a[246:247], v4 offset:15872
    s_add_u32 m0, s39, 36864
    v_mfma_f32_16x16x32_bf16 v[92:95], a[248:251], a[196:199], v[92:95]
    buffer_load_dwordx4 v1, s[60:63], s29 offen offset:1024 nt lds
    v_cvt_pk_bf16_f32 v24, v64, v68
    v_mfma_f32_16x16x32_bf16 v[92:95], a[252:255], a[220:223], v[92:95]
    v_cvt_pk_bf16_f32 v25, v72, v76
    v_cvt_pk_bf16_f32 v26, v80, v84
    v_mfma_f32_16x16x32_bf16 v[88:91], a[252:255], a[216:219], v[88:91]
    ds_write_b32 v5, v24 offset:0
    ds_write_b32 v5, v25 offset:4
    v_mfma_f32_16x16x32_bf16 v[88:91], a[248:251], a[192:195], v[88:91]
    s_add_u32 m0, s39, 36864
    ds_write_b32 v5, v26 offset:8
    v_cvt_pk_bf16_f32 v28, v65, v69
    s_waitcnt lgkmcnt(7)
    v_mfma_f32_16x16x32_bf16 a[0:3], v[56:59], a[192:195], a[0:3]
    buffer_load_dwordx4 v1, s[60:63], s29 offen offset:2048 nt lds
    v_cvt_pk_bf16_f32 v29, v73, v77
    v_mfma_f32_16x16x32_bf16 a[0:3], v[60:63], a[216:219], a[0:3]
    ds_read_b64_tr_b16 a[248:249], v4 offset:4096
    v_cvt_pk_bf16_f32 v30, v81, v85
    v_mfma_f32_16x16x32_bf16 a[4:7], v[60:63], a[220:223], a[4:7]
    ds_write_b32 v5, v28 offset:768
    ds_write_b32 v5, v29 offset:772
    v_mfma_f32_16x16x32_bf16 a[4:7], v[56:59], a[196:199], a[4:7]
    ds_read_b64_tr_b16 a[250:251], v4 offset:4608
    ds_write_b32 v5, v30 offset:776
    v_mfma_f32_16x16x32_bf16 a[8:11], v[56:59], a[200:203], a[8:11]
    v_cvt_pk_bf16_f32 v24, v66, v70
    v_cvt_pk_bf16_f32 v25, v74, v78
    v_mfma_f32_16x16x32_bf16 a[8:11], v[60:63], a[224:227], a[8:11]
    ds_read_b64_tr_b16 a[252:253], v4 offset:16384
    v_cvt_pk_bf16_f32 v26, v82, v86
    v_mfma_f32_16x16x32_bf16 a[12:15], v[60:63], a[228:231], a[12:15]
    ds_write_b32 v5, v24 offset:1536
    ds_write_b32 v5, v25 offset:1540
    v_mfma_f32_16x16x32_bf16 a[12:15], v[56:59], a[204:207], a[12:15]
    ds_read_b64_tr_b16 a[254:255], v4 offset:16896
    ds_write_b32 v5, v26 offset:1544
    v_mfma_f32_16x16x32_bf16 a[16:19], v[56:59], a[208:211], a[16:19]
    v_cvt_pk_bf16_f32 v28, v67, v71
    v_cvt_pk_bf16_f32 v29, v75, v79
    v_mfma_f32_16x16x32_bf16 a[16:19], v[60:63], a[232:235], a[16:19]
    v_cvt_pk_bf16_f32 v30, v83, v87
    ds_write_b32 v5, v28 offset:2304
    v_mfma_f32_16x16x32_bf16 a[20:23], v[60:63], a[236:239], a[20:23]
    ds_write_b32 v5, v29 offset:2308
    ds_write_b32 v5, v30 offset:2312
    v_mfma_f32_16x16x32_bf16 a[20:23], v[56:59], a[212:215], a[20:23]
    v_cvt_pk_bf16_f32 v32, v88, v92
    v_cvt_pk_bf16_f32 v33, v96, v100
    s_waitcnt lgkmcnt(14)
    v_mfma_f32_16x16x32_bf16 v[132:135], a[240:243], a[212:215], v[132:135]
    v_cvt_pk_bf16_f32 v34, v104, v108
    v_cvt_pk_bf16_f32 v36, v89, v93
    v_mfma_f32_16x16x32_bf16 v[132:135], a[244:247], a[236:239], v[132:135]
    ds_read_b64_tr_b16 v[56:57], v4 offset:5120
    v_cvt_pk_bf16_f32 v37, v97, v101
    v_mfma_f32_16x16x32_bf16 v[128:131], a[244:247], a[232:235], v[128:131]
    v_cvt_pk_bf16_f32 v38, v105, v109
    v_cvt_pk_bf16_f32 v40, v90, v94
    v_mfma_f32_16x16x32_bf16 v[128:131], a[240:243], a[208:211], v[128:131]
    ds_read_b64_tr_b16 v[58:59], v4 offset:5632
    v_cvt_pk_bf16_f32 v41, v98, v102
    v_mfma_f32_16x16x32_bf16 v[124:127], a[240:243], a[204:207], v[124:127]
    v_cvt_pk_bf16_f32 v42, v106, v110
    v_cvt_pk_bf16_f32 v44, v91, v95
    v_mfma_f32_16x16x32_bf16 v[124:127], a[244:247], a[228:231], v[124:127]
    ds_read_b64_tr_b16 v[60:61], v4 offset:17408
    v_cvt_pk_bf16_f32 v45, v99, v103
    v_mfma_f32_16x16x32_bf16 v[120:123], a[244:247], a[224:227], v[120:123]
    v_cvt_pk_bf16_f32 v46, v107, v111
    v_mfma_f32_16x16x32_bf16 v[120:123], a[240:243], a[200:203], v[120:123]
    ds_read_b64_tr_b16 v[62:63], v4 offset:17920
    v_mfma_f32_16x16x32_bf16 v[116:119], a[240:243], a[196:199], v[116:119]
    v_accvgpr_read_b32 v14, a0
    v_accvgpr_read_b32 v15, a4
    v_mfma_f32_16x16x32_bf16 v[116:119], a[244:247], a[220:223], v[116:119]
    v_accvgpr_read_b32 v16, a8
    v_accvgpr_read_b32 v17, a12
    v_mfma_f32_16x16x32_bf16 v[112:115], a[244:247], a[216:219], v[112:115]
    v_accvgpr_read_b32 v18, a16
    v_accvgpr_read_b32 v19, a20
    v_mfma_f32_16x16x32_bf16 v[112:115], a[240:243], a[192:195], v[112:115]
    v_cvt_pk_bf16_f32 v24, v14, v15
    v_cvt_pk_bf16_f32 v25, v16, v17
    s_waitcnt lgkmcnt(4)
    v_mfma_f32_16x16x32_bf16 v[136:139], a[248:251], a[192:195], v[136:139]
    v_cvt_pk_bf16_f32 v26, v18, v19
    ds_write_b32 v5, v24 offset:12288
    v_mfma_f32_16x16x32_bf16 v[136:139], a[252:255], a[216:219], v[136:139]
    ds_read_b64_tr_b16 a[240:241], v4 offset:6144
    ds_write_b32 v5, v25 offset:12292
    v_mfma_f32_16x16x32_bf16 v[140:143], a[252:255], a[220:223], v[140:143]
    ds_write_b32 v5, v26 offset:12296
    v_accvgpr_read_b32 v14, a1
    v_mfma_f32_16x16x32_bf16 v[140:143], a[248:251], a[196:199], v[140:143]
    ds_read_b64_tr_b16 a[242:243], v4 offset:6656
    s_mov_b32 s6, 49152
    v_accvgpr_read_b32 v15, a5
    v_mfma_f32_16x16x32_bf16 v[144:147], a[248:251], a[200:203], v[144:147]
    buffer_load_dwordx4 a[144:147], v2, s[52:55], s6 offen offset:0
    v_accvgpr_read_b32 v16, a9
    v_mfma_f32_16x16x32_bf16 v[144:147], a[252:255], a[224:227], v[144:147]
    ds_read_b64_tr_b16 a[244:245], v4 offset:18432
    v_accvgpr_read_b32 v17, a13
    v_mfma_f32_16x16x32_bf16 v[148:151], a[252:255], a[228:231], v[148:151]
    v_accvgpr_read_b32 v18, a17
    v_accvgpr_read_b32 v19, a21
    v_mfma_f32_16x16x32_bf16 v[148:151], a[248:251], a[204:207], v[148:151]
    ds_read_b64_tr_b16 a[246:247], v4 offset:18944
    v_cvt_pk_bf16_f32 v28, v14, v15
    v_mfma_f32_16x16x32_bf16 v[152:155], a[248:251], a[208:211], v[152:155]
    buffer_load_dwordx4 a[148:151], v2, s[52:55], s6 offen offset:1024
    v_cvt_pk_bf16_f32 v29, v16, v17
    v_mfma_f32_16x16x32_bf16 v[152:155], a[252:255], a[232:235], v[152:155]
    v_cvt_pk_bf16_f32 v30, v18, v19
    ds_write_b32 v5, v28 offset:13056
    v_mfma_f32_16x16x32_bf16 v[156:159], a[252:255], a[236:239], v[156:159]
    ds_write_b32 v5, v29 offset:13060
    ds_write_b32 v5, v30 offset:13064
    v_mfma_f32_16x16x32_bf16 v[156:159], a[248:251], a[212:215], v[156:159]
    v_accvgpr_read_b32 v14, a2
    v_accvgpr_read_b32 v15, a6
    s_waitcnt lgkmcnt(10)
    v_mfma_f32_16x16x32_bf16 a[44:47], v[56:59], a[212:215], a[44:47]
    buffer_load_dwordx4 a[152:155], v2, s[52:55], s6 offen offset:2048
    v_accvgpr_read_b32 v16, a10
    v_mfma_f32_16x16x32_bf16 a[44:47], v[60:63], a[236:239], a[44:47]
    ds_read_b64_tr_b16 a[248:249], v4 offset:7168
    v_accvgpr_read_b32 v17, a14
    v_mfma_f32_16x16x32_bf16 a[40:43], v[60:63], a[232:235], a[40:43]
    s_add_u32 s42, s41, 3072
    buffer_store_dwordx3 v[32:34], v0, s[16:19], s42 offen offset:0
    v_accvgpr_read_b32 v18, a18
    v_mfma_f32_16x16x32_bf16 a[40:43], v[56:59], a[208:211], a[40:43]
    ds_read_b64_tr_b16 a[250:251], v4 offset:7680
    v_accvgpr_read_b32 v19, a22
    v_mfma_f32_16x16x32_bf16 a[36:39], v[56:59], a[204:207], a[36:39]
    buffer_load_dwordx4 a[156:159], v2, s[52:55], s6 offen offset:3072
    v_cvt_pk_bf16_f32 v24, v14, v15
    v_mfma_f32_16x16x32_bf16 a[36:39], v[60:63], a[228:231], a[36:39]
    ds_read_b64_tr_b16 a[252:253], v4 offset:19456
    v_cvt_pk_bf16_f32 v25, v16, v17
    v_mfma_f32_16x16x32_bf16 a[32:35], v[60:63], a[224:227], a[32:35]
    v_cvt_pk_bf16_f32 v26, v18, v19
    ds_write_b32 v5, v24 offset:13824
    v_mfma_f32_16x16x32_bf16 a[32:35], v[56:59], a[200:203], a[32:35]
    ds_read_b64_tr_b16 a[254:255], v4 offset:19968
    s_mov_b32 s6, 53248
    ds_write_b32 v5, v25 offset:13828
    v_mfma_f32_16x16x32_bf16 a[28:31], v[56:59], a[196:199], a[28:31]
    buffer_load_dwordx4 a[160:163], v2, s[52:55], s6 offen offset:0
    ds_write_b32 v5, v26 offset:13832
    v_mfma_f32_16x16x32_bf16 a[28:31], v[60:63], a[220:223], a[28:31]
    v_accvgpr_read_b32 v14, a3
    v_accvgpr_read_b32 v15, a7
    v_mfma_f32_16x16x32_bf16 a[24:27], v[60:63], a[216:219], a[24:27]
    v_accvgpr_read_b32 v16, a11
    v_accvgpr_read_b32 v17, a15
    v_mfma_f32_16x16x32_bf16 a[24:27], v[56:59], a[192:195], a[24:27]
    v_accvgpr_read_b32 v18, a19
    v_accvgpr_read_b32 v19, a23
    s_waitcnt lgkmcnt(7)
    v_mfma_f32_16x16x32_bf16 v[160:163], a[240:243], a[192:195], v[160:163]
    buffer_load_dwordx4 a[164:167], v2, s[52:55], s6 offen offset:1024
    v_cvt_pk_bf16_f32 v28, v14, v15
    v_mfma_f32_16x16x32_bf16 v[160:163], a[244:247], a[216:219], v[160:163]
    ds_read_b64_tr_b16 v[56:57], v4 offset:8192
    v_cvt_pk_bf16_f32 v29, v16, v17
    v_mfma_f32_16x16x32_bf16 v[164:167], a[244:247], a[220:223], v[164:167]
    s_add_u32 s42, s41, 3072
    buffer_store_dwordx3 v[36:38], v0, s[16:19], s42 offen offset:768
    v_cvt_pk_bf16_f32 v30, v18, v19
    v_mfma_f32_16x16x32_bf16 v[164:167], a[240:243], a[196:199], v[164:167]
    ds_read_b64_tr_b16 v[58:59], v4 offset:8704
    ds_write_b32 v5, v28 offset:14592
    v_mfma_f32_16x16x32_bf16 v[168:171], a[240:243], a[200:203], v[168:171]
    ds_write_b32 v5, v29 offset:14596
    ds_write_b32 v5, v30 offset:14600
    v_mfma_f32_16x16x32_bf16 v[168:171], a[244:247], a[224:227], v[168:171]
    ds_read_b64_tr_b16 v[60:61], v4 offset:20480
    v_cvt_pk_bf16_f32 v24, v112, v116
    v_mfma_f32_16x16x32_bf16 v[172:175], a[244:247], a[228:231], v[172:175]
    v_cvt_pk_bf16_f32 v25, v120, v124
    v_cvt_pk_bf16_f32 v26, v128, v132
    v_mfma_f32_16x16x32_bf16 v[172:175], a[240:243], a[204:207], v[172:175]
    ds_read_b64_tr_b16 v[62:63], v4 offset:20992
    ds_write_b32 v5, v24 offset:24576
    v_mfma_f32_16x16x32_bf16 v[176:179], a[240:243], a[208:211], v[176:179]
    ds_write_b32 v5, v25 offset:24580
    ds_write_b32 v5, v26 offset:24584
    v_mfma_f32_16x16x32_bf16 v[176:179], a[244:247], a[232:235], v[176:179]
    v_cvt_pk_bf16_f32 v28, v113, v117
    v_cvt_pk_bf16_f32 v29, v121, v125
    v_mfma_f32_16x16x32_bf16 v[180:183], a[244:247], a[236:239], v[180:183]
    v_cvt_pk_bf16_f32 v30, v129, v133
    ds_write_b32 v5, v28 offset:25344
    v_mfma_f32_16x16x32_bf16 v[180:183], a[240:243], a[212:215], v[180:183]
    ds_write_b32 v5, v29 offset:25348
    ds_write_b32 v5, v30 offset:25352
    s_waitcnt lgkmcnt(13)
    v_mfma_f32_16x16x32_bf16 v[204:207], a[248:251], a[212:215], v[204:207]
    v_cvt_pk_bf16_f32 v24, v114, v118
    v_cvt_pk_bf16_f32 v25, v122, v126
    v_mfma_f32_16x16x32_bf16 v[204:207], a[252:255], a[236:239], v[204:207]
    ds_read_b64_tr_b16 a[240:241], v4 offset:9216
    v_cvt_pk_bf16_f32 v26, v130, v134
    v_mfma_f32_16x16x32_bf16 v[200:203], a[252:255], a[232:235], v[200:203]
    ds_write_b32 v5, v24 offset:26112
    ds_write_b32 v5, v25 offset:26116
    v_mfma_f32_16x16x32_bf16 v[200:203], a[248:251], a[208:211], v[200:203]
    ds_read_b64_tr_b16 a[242:243], v4 offset:9728
    ds_write_b32 v5, v26 offset:26120
    v_mfma_f32_16x16x32_bf16 v[196:199], a[248:251], a[204:207], v[196:199]
    s_add_u32 s42, s41, 3072
    buffer_store_dwordx3 v[40:42], v0, s[16:19], s42 offen offset:1536
    v_cvt_pk_bf16_f32 v28, v115, v119
    v_mfma_f32_16x16x32_bf16 v[196:199], a[252:255], a[228:231], v[196:199]
    ds_read_b64_tr_b16 a[244:245], v4 offset:21504
    v_cvt_pk_bf16_f32 v29, v123, v127
    v_mfma_f32_16x16x32_bf16 v[192:195], a[252:255], a[224:227], v[192:195]
    v_cvt_pk_bf16_f32 v30, v131, v135
    ds_write_b32 v5, v28 offset:26880
    v_mfma_f32_16x16x32_bf16 v[192:195], a[248:251], a[200:203], v[192:195]
    ds_read_b64_tr_b16 a[246:247], v4 offset:22016
    ds_write_b32 v5, v29 offset:26884
    v_mfma_f32_16x16x32_bf16 v[188:191], a[248:251], a[196:199], v[188:191]
    ds_write_b32 v5, v30 offset:26888
    v_cvt_pk_bf16_f32 v48, v136, v140
    v_mfma_f32_16x16x32_bf16 v[188:191], a[252:255], a[220:223], v[188:191]
    v_cvt_pk_bf16_f32 v49, v144, v148
    v_cvt_pk_bf16_f32 v50, v152, v156
    v_mfma_f32_16x16x32_bf16 v[184:187], a[252:255], a[216:219], v[184:187]
    v_cvt_pk_bf16_f32 v52, v137, v141
    v_cvt_pk_bf16_f32 v53, v145, v149
    v_mfma_f32_16x16x32_bf16 v[184:187], a[248:251], a[192:195], v[184:187]
    v_cvt_pk_bf16_f32 v54, v153, v157
    v_cvt_pk_bf16_f32 v32, v138, v142
    s_waitcnt lgkmcnt(12)
    v_mfma_f32_16x16x32_bf16 a[48:51], v[56:59], a[192:195], a[48:51]
    v_cvt_pk_bf16_f32 v33, v146, v150
    v_cvt_pk_bf16_f32 v34, v154, v158
    v_mfma_f32_16x16x32_bf16 a[48:51], v[60:63], a[216:219], a[48:51]
    ds_read_b64_tr_b16 a[248:249], v4 offset:10240
    v_cvt_pk_bf16_f32 v36, v139, v143
    v_mfma_f32_16x16x32_bf16 a[52:55], v[60:63], a[220:223], a[52:55]
    v_cvt_pk_bf16_f32 v37, v147, v151
    v_cvt_pk_bf16_f32 v38, v155, v159
    v_mfma_f32_16x16x32_bf16 a[52:55], v[56:59], a[196:199], a[52:55]
    ds_read_b64_tr_b16 a[250:251], v4 offset:10752
    v_accvgpr_read_b32 v14, a24
    v_mfma_f32_16x16x32_bf16 a[56:59], v[56:59], a[200:203], a[56:59]
    buffer_load_dwordx4 a[168:171], v2, s[52:55], s6 offen offset:2048
    v_accvgpr_read_b32 v15, a28
    v_mfma_f32_16x16x32_bf16 a[56:59], v[60:63], a[224:227], a[56:59]
    ds_read_b64_tr_b16 a[252:253], v4 offset:22528
    v_accvgpr_read_b32 v16, a32
    v_mfma_f32_16x16x32_bf16 a[60:63], v[60:63], a[228:231], a[60:63]
    s_add_u32 s42, s41, 3072
    buffer_store_dwordx3 v[44:46], v0, s[16:19], s42 offen offset:2304
    v_accvgpr_read_b32 v17, a36
    v_mfma_f32_16x16x32_bf16 a[60:63], v[56:59], a[204:207], a[60:63]
    ds_read_b64_tr_b16 a[254:255], v4 offset:23040
    v_accvgpr_read_b32 v18, a40
    v_mfma_f32_16x16x32_bf16 a[64:67], v[56:59], a[208:211], a[64:67]
    buffer_load_dwordx4 a[172:175], v2, s[52:55], s6 offen offset:3072
    v_accvgpr_read_b32 v19, a44
    v_mfma_f32_16x16x32_bf16 a[64:67], v[60:63], a[232:235], a[64:67]
    v_cvt_pk_bf16_f32 v24, v14, v15
    v_cvt_pk_bf16_f32 v25, v16, v17
    v_mfma_f32_16x16x32_bf16 a[68:71], v[60:63], a[236:239], a[68:71]
    v_cvt_pk_bf16_f32 v26, v18, v19
    ds_write_b32 v5, v24 offset:36864
    v_mfma_f32_16x16x32_bf16 a[68:71], v[56:59], a[212:215], a[68:71]
    s_mov_b32 s6, 57344
    ds_write_b32 v5, v25 offset:36868
    ds_write_b32 v5, v26 offset:36872
    s_waitcnt lgkmcnt(7)
    v_mfma_f32_16x16x32_bf16 v[228:231], a[240:243], a[212:215], v[228:231]
    buffer_load_dwordx4 a[176:179], v2, s[52:55], s6 offen offset:0
    v_accvgpr_read_b32 v14, a25
    v_mfma_f32_16x16x32_bf16 v[228:231], a[244:247], a[236:239], v[228:231]
    ds_read_b64_tr_b16 v[56:57], v4 offset:11264
    v_accvgpr_read_b32 v15, a29
    v_mfma_f32_16x16x32_bf16 v[224:227], a[244:247], a[232:235], v[224:227]
    v_accvgpr_read_b32 v16, a33
    v_accvgpr_read_b32 v17, a37
    v_mfma_f32_16x16x32_bf16 v[224:227], a[240:243], a[208:211], v[224:227]
    ds_read_b64_tr_b16 v[58:59], v4 offset:11776
    v_accvgpr_read_b32 v18, a41
    v_mfma_f32_16x16x32_bf16 v[220:223], a[240:243], a[204:207], v[220:223]
    buffer_load_dwordx4 a[180:183], v2, s[52:55], s6 offen offset:1024
    v_accvgpr_read_b32 v19, a45
    v_mfma_f32_16x16x32_bf16 v[220:223], a[244:247], a[228:231], v[220:223]
    ds_read_b64_tr_b16 v[60:61], v4 offset:23552
    v_cvt_pk_bf16_f32 v28, v14, v15
    v_mfma_f32_16x16x32_bf16 v[216:219], a[244:247], a[224:227], v[216:219]
    v_cvt_pk_bf16_f32 v29, v16, v17
    v_cvt_pk_bf16_f32 v30, v18, v19
    v_mfma_f32_16x16x32_bf16 v[216:219], a[240:243], a[200:203], v[216:219]
    ds_read_b64_tr_b16 v[62:63], v4 offset:24064
    ds_write_b32 v5, v28 offset:37632
    v_mfma_f32_16x16x32_bf16 v[212:215], a[240:243], a[196:199], v[212:215]
    buffer_load_dwordx4 a[184:187], v2, s[52:55], s6 offen offset:2048
    ds_write_b32 v5, v29 offset:37636
    v_mfma_f32_16x16x32_bf16 v[212:215], a[244:247], a[220:223], v[212:215]
    s_add_u32 s42, s41, 12288
    buffer_store_dwordx3 v[48:50], v0, s[16:19], s42 offen offset:0
    ds_write_b32 v5, v30 offset:37640
    v_mfma_f32_16x16x32_bf16 v[208:211], a[244:247], a[216:219], v[208:211]
    v_accvgpr_read_b32 v14, a26
    v_accvgpr_read_b32 v15, a30
    v_mfma_f32_16x16x32_bf16 v[208:211], a[240:243], a[192:195], v[208:211]
    v_accvgpr_read_b32 v16, a34
    v_accvgpr_read_b32 v17, a38
    s_waitcnt vmcnt(34) lgkmcnt(0)
    s_barrier
    v_mfma_f32_16x16x32_bf16 v[232:235], a[248:251], a[192:195], v[232:235]
    buffer_load_dwordx4 a[188:191], v2, s[52:55], s6 offen offset:3072
    v_accvgpr_read_b32 v18, a42
    v_mfma_f32_16x16x32_bf16 v[232:235], a[252:255], a[216:219], v[232:235]
    ds_read_b64_tr_b16 a[240:241], v3 offset:0
    v_accvgpr_read_b32 v19, a46
    v_mfma_f32_16x16x32_bf16 v[236:239], a[252:255], a[220:223], v[236:239]
    v_cvt_pk_bf16_f32 v24, v14, v15
    v_cvt_pk_bf16_f32 v25, v16, v17
    v_mfma_f32_16x16x32_bf16 v[236:239], a[248:251], a[196:199], v[236:239]
    ds_read_b64_tr_b16 a[242:243], v3 offset:512
    v_cvt_pk_bf16_f32 v26, v18, v19
    v_mfma_f32_16x16x32_bf16 v[240:243], a[248:251], a[200:203], v[240:243]
    ds_write_b32 v5, v24 offset:38400
    ds_write_b32 v5, v25 offset:38404
    v_mfma_f32_16x16x32_bf16 v[240:243], a[252:255], a[224:227], v[240:243]
    ds_read_b64_tr_b16 a[244:245], v3 offset:12288
    ds_write_b32 v5, v26 offset:38408
    v_mfma_f32_16x16x32_bf16 v[244:247], a[252:255], a[228:231], v[244:247]
    v_accvgpr_read_b32 v14, a27
    v_accvgpr_read_b32 v15, a31
    v_mfma_f32_16x16x32_bf16 v[244:247], a[248:251], a[204:207], v[244:247]
    ds_read_b64_tr_b16 a[246:247], v3 offset:12800
    v_accvgpr_read_b32 v16, a35
    v_mfma_f32_16x16x32_bf16 v[248:251], a[248:251], a[208:211], v[248:251]
    v_accvgpr_read_b32 v17, a39
    v_accvgpr_read_b32 v18, a43
    v_mfma_f32_16x16x32_bf16 v[248:251], a[252:255], a[232:235], v[248:251]
    v_accvgpr_read_b32 v19, a47
    v_cvt_pk_bf16_f32 v28, v14, v15
    v_mfma_f32_16x16x32_bf16 v[252:255], a[252:255], a[236:239], v[252:255]
    s_add_u32 s42, s41, 12288
    buffer_store_dwordx3 v[52:54], v0, s[16:19], s42 offen offset:768
    v_cvt_pk_bf16_f32 v29, v16, v17
    v_mfma_f32_16x16x32_bf16 v[252:255], a[248:251], a[212:215], v[252:255]
    v_cvt_pk_bf16_f32 v30, v18, v19
    ds_write_b32 v5, v28 offset:39168
    v_mfma_f32_16x16x32_bf16 a[92:95], v[56:59], a[212:215], a[92:95]
    ds_write_b32 v5, v29 offset:39172
    ds_write_b32 v5, v30 offset:39176
    v_mfma_f32_16x16x32_bf16 a[92:95], v[60:63], a[236:239], a[92:95]
    ds_read_b64_tr_b16 a[248:249], v3 offset:1024
    v_cvt_pk_bf16_f32 v24, v160, v164
    v_mfma_f32_16x16x32_bf16 a[88:91], v[60:63], a[232:235], a[88:91]
    v_cvt_pk_bf16_f32 v25, v168, v172
    v_cvt_pk_bf16_f32 v26, v176, v180
    v_mfma_f32_16x16x32_bf16 a[88:91], v[56:59], a[208:211], a[88:91]
    ds_read_b64_tr_b16 a[250:251], v3 offset:1536
    ds_write_b32 v6, v24 offset:0
    v_mfma_f32_16x16x32_bf16 a[84:87], v[56:59], a[204:207], a[84:87]
    ds_write_b32 v6, v25 offset:4
    ds_write_b32 v6, v26 offset:8
    v_mfma_f32_16x16x32_bf16 a[84:87], v[60:63], a[228:231], a[84:87]
    ds_read_b64_tr_b16 a[252:253], v3 offset:13312
    v_cvt_pk_bf16_f32 v28, v161, v165
    v_mfma_f32_16x16x32_bf16 a[80:83], v[60:63], a[224:227], a[80:83]
    v_cvt_pk_bf16_f32 v29, v169, v173
    v_cvt_pk_bf16_f32 v30, v177, v181
    v_mfma_f32_16x16x32_bf16 a[80:83], v[56:59], a[200:203], a[80:83]
    ds_read_b64_tr_b16 a[254:255], v3 offset:13824
    ds_write_b32 v6, v28 offset:768
    v_mfma_f32_16x16x32_bf16 a[76:79], v[56:59], a[196:199], a[76:79]
    ds_write_b32 v6, v29 offset:772
    ds_write_b32 v6, v30 offset:776
    v_mfma_f32_16x16x32_bf16 a[76:79], v[60:63], a[220:223], a[76:79]
    v_cvt_pk_bf16_f32 v24, v162, v166
    v_cvt_pk_bf16_f32 v25, v170, v174
    v_mfma_f32_16x16x32_bf16 a[72:75], v[60:63], a[216:219], a[72:75]
    v_cvt_pk_bf16_f32 v26, v178, v182
    ds_write_b32 v6, v24 offset:1536
    v_mfma_f32_16x16x32_bf16 a[72:75], v[56:59], a[192:195], a[72:75]
    ds_write_b32 v6, v25 offset:1540
    ds_write_b32 v6, v26 offset:1544
    s_add_u32 s28, s28, 1
    s_add_u32 s26, s26, 256
    s_branch L_k2_cycle
L_k2_last:
    s_waitcnt vmcnt(12)
    s_barrier
    s_waitcnt lgkmcnt(4)
    v_mfma_f32_16x16x32_bf16 v[64:67], a[240:243], a[144:147], v[64:67]
    v_mfma_f32_16x16x32_bf16 v[64:67], a[244:247], a[168:171], v[64:67]
    ds_read_b64_tr_b16 v[56:57], v4 offset:0
    v_mfma_f32_16x16x32_bf16 v[68:71], a[244:247], a[172:175], v[68:71]
    v_mfma_f32_16x16x32_bf16 v[68:71], a[240:243], a[148:151], v[68:71]
    ds_read_b64_tr_b16 v[58:59], v4 offset:512
    v_mfma_f32_16x16x32_bf16 v[72:75], a[240:243], a[152:155], v[72:75]
    s_mov_b32 s41, s40
    v_mfma_f32_16x16x32_bf16 v[72:75], a[244:247], a[176:179], v[72:75]
    ds_read_b64_tr_b16 v[60:61], v4 offset:12288
    v_mfma_f32_16x16x32_bf16 v[76:79], a[244:247], a[180:183], v[76:79]
    v_mfma_f32_16x16x32_bf16 v[76:79], a[240:243], a[156:159], v[76:79]
    ds_read_b64_tr_b16 v[62:63], v4 offset:12800
    v_mfma_f32_16x16x32_bf16 v[80:83], a[240:243], a[160:163], v[80:83]
    v_mfma_f32_16x16x32_bf16 v[80:83], a[244:247], a[184:187], v[80:83]
    v_mfma_f32_16x16x32_bf16 v[84:87], a[244:247], a[188:191], v[84:87]
    v_mfma_f32_16x16x32_bf16 v[84:87], a[240:243], a[164:167], v[84:87]
    s_waitcnt lgkmcnt(4)
    v_mfma_f32_16x16x32_bf16 v[108:111], a[248:251], a[164:167], v[108:111]
    v_mfma_f32_16x16x32_bf16 v[108:111], a[252:255], a[188:191], v[108:111]
    ds_read_b64_tr_b16 a[240:241], v4 offset:1024
    v_mfma_f32_16x16x32_bf16 v[104:107], a[252:255], a[184:187], v[104:107]
    v_mfma_f32_16x16x32_bf16 v[104:107], a[248:251], a[160:163], v[104:107]
    ds_read_b64_tr_b16 a[242:243], v4 offset:1536
    v_mfma_f32_16x16x32_bf16 v[100:103], a[248:251], a[156:159], v[100:103]
    v_mfma_f32_16x16x32_bf16 v[100:103], a[252:255], a[180:183], v[100:103]
    ds_read_b64_tr_b16 a[244:245], v4 offset:13312
    v_mfma_f32_16x16x32_bf16 v[96:99], a[252:255], a[176:179], v[96:99]
    v_mfma_f32_16x16x32_bf16 v[96:99], a[248:251], a[152:155], v[96:99]
    ds_read_b64_tr_b16 a[246:247], v4 offset:13824
    v_mfma_f32_16x16x32_bf16 v[92:95], a[248:251], a[148:151], v[92:95]
    v_mfma_f32_16x16x32_bf16 v[92:95], a[252:255], a[172:175], v[92:95]
    v_mfma_f32_16x16x32_bf16 v[88:91], a[252:255], a[168:171], v[88:91]
    v_mfma_f32_16x16x32_bf16 v[88:91], a[248:251], a[144:147], v[88:91]
    s_waitcnt vmcnt(11)
    s_waitcnt lgkmcnt(4)
    v_mfma_f32_16x16x32_bf16 v[64:67], v[56:59], a[192:195], v[64:67]
    s_waitcnt vmcnt(5)
    v_mfma_f32_16x16x32_bf16 v[64:67], v[60:63], a[216:219], v[64:67]
    ds_read_b64_tr_b16 a[248:249], v3 offset:26624
    s_waitcnt vmcnt(4)
    v_mfma_f32_16x16x32_bf16 v[68:71], v[60:63], a[220:223], v[68:71]
    v_mfma_f32_16x16x32_bf16 v[68:71], v[56:59], a[196:199], v[68:71]
    ds_read_b64_tr_b16 a[250:251], v3 offset:27136
    v_mfma_f32_16x16x32_bf16 v[72:75], v[56:59], a[200:203], v[72:75]
    s_waitcnt vmcnt(3)
    v_mfma_f32_16x16x32_bf16 v[72:75], v[60:63], a[224:227], v[72:75]
    ds_read_b64_tr_b16 a[252:253], v3 offset:38912
    s_waitcnt vmcnt(2)
    v_mfma_f32_16x16x32_bf16 v[76:79], v[60:63], a[228:231], v[76:79]
    v_mfma_f32_16x16x32_bf16 v[76:79], v[56:59], a[204:207], v[76:79]
    ds_read_b64_tr_b16 a[254:255], v3 offset:39424
    v_mfma_f32_16x16x32_bf16 v[80:83], v[56:59], a[208:211], v[80:83]
    s_waitcnt vmcnt(1)
    v_mfma_f32_16x16x32_bf16 v[80:83], v[60:63], a[232:235], v[80:83]
    s_waitcnt vmcnt(0)
    v_mfma_f32_16x16x32_bf16 v[84:87], v[60:63], a[236:239], v[84:87]
    v_mfma_f32_16x16x32_bf16 v[84:87], v[56:59], a[212:215], v[84:87]
    s_waitcnt lgkmcnt(4)
    v_mfma_f32_16x16x32_bf16 v[108:111], a[240:243], a[212:215], v[108:111]
    v_mfma_f32_16x16x32_bf16 v[108:111], a[244:247], a[236:239], v[108:111]
    ds_read_b64_tr_b16 v[56:57], v4 offset:2048
    v_mfma_f32_16x16x32_bf16 v[104:107], a[244:247], a[232:235], v[104:107]
    v_mfma_f32_16x16x32_bf16 v[104:107], a[240:243], a[208:211], v[104:107]
    ds_read_b64_tr_b16 v[58:59], v4 offset:2560
    v_mfma_f32_16x16x32_bf16 v[100:103], a[240:243], a[204:207], v[100:103]
    v_mfma_f32_16x16x32_bf16 v[100:103], a[244:247], a[228:231], v[100:103]
    ds_read_b64_tr_b16 v[60:61], v4 offset:14336
    v_mfma_f32_16x16x32_bf16 v[96:99], a[244:247], a[224:227], v[96:99]
    v_mfma_f32_16x16x32_bf16 v[96:99], a[240:243], a[200:203], v[96:99]
    ds_read_b64_tr_b16 v[62:63], v4 offset:14848
    v_mfma_f32_16x16x32_bf16 v[92:95], a[240:243], a[196:199], v[92:95]
    v_cvt_pk_bf16_f32 v24, v64, v68
    v_cvt_pk_bf16_f32 v25, v72, v76
    v_cvt_pk_bf16_f32 v26, v80, v84
    s_add_u32 s42, s41, 0
    buffer_store_dwordx3 v[24:26], v0, s[16:19], s42 offen offset:0
    v_cvt_pk_bf16_f32 v28, v65, v69
    v_mfma_f32_16x16x32_bf16 v[92:95], a[244:247], a[220:223], v[92:95]
    v_cvt_pk_bf16_f32 v29, v73, v77
    v_cvt_pk_bf16_f32 v30, v81, v85
    s_add_u32 s42, s41, 0
    buffer_store_dwordx3 v[28:30], v0, s[16:19], s42 offen offset:768
    v_cvt_pk_bf16_f32 v32, v66, v70
    v_cvt_pk_bf16_f32 v33, v74, v78
    v_mfma_f32_16x16x32_bf16 v[88:91], a[244:247], a[216:219], v[88:91]
    v_cvt_pk_bf16_f32 v34, v82, v86
    s_add_u32 s42, s41, 0
    buffer_store_dwordx3 v[32:34], v0, s[16:19], s42 offen offset:1536
    v_cvt_pk_bf16_f32 v36, v67, v71
    v_cvt_pk_bf16_f32 v37, v75, v79
    v_cvt_pk_bf16_f32 v38, v83, v87
    v_mfma_f32_16x16x32_bf16 v[88:91], a[240:243], a[192:195], v[88:91]
    s_add_u32 s42, s41, 0
    buffer_store_dwordx3 v[36:38], v0, s[16:19], s42 offen offset:2304
    s_waitcnt lgkmcnt(4)
    v_mfma_f32_16x16x32_bf16 a[0:3], a[248:251], a[144:147], a[0:3]
    v_mfma_f32_16x16x32_bf16 a[0:3], a[252:255], a[168:171], a[0:3]
    ds_read_b64_tr_b16 a[240:241], v3 offset:27648
    v_mfma_f32_16x16x32_bf16 a[4:7], a[252:255], a[172:175], a[4:7]
    v_mfma_f32_16x16x32_bf16 a[4:7], a[248:251], a[148:151], a[4:7]
    ds_read_b64_tr_b16 a[242:243], v3 offset:28160
    v_mfma_f32_16x16x32_bf16 a[8:11], a[248:251], a[152:155], a[8:11]
    v_mfma_f32_16x16x32_bf16 a[8:11], a[252:255], a[176:179], a[8:11]
    ds_read_b64_tr_b16 a[244:245], v3 offset:39936
    v_mfma_f32_16x16x32_bf16 a[12:15], a[252:255], a[180:183], a[12:15]
    v_mfma_f32_16x16x32_bf16 a[12:15], a[248:251], a[156:159], a[12:15]
    ds_read_b64_tr_b16 a[246:247], v3 offset:40448
    v_mfma_f32_16x16x32_bf16 a[16:19], a[248:251], a[160:163], a[16:19]
    v_cvt_pk_bf16_f32 v40, v88, v92
    v_cvt_pk_bf16_f32 v41, v96, v100
    v_cvt_pk_bf16_f32 v42, v104, v108
    s_add_u32 s42, s41, 3072
    buffer_store_dwordx3 v[40:42], v0, s[16:19], s42 offen offset:0
    v_cvt_pk_bf16_f32 v44, v89, v93
    v_mfma_f32_16x16x32_bf16 a[16:19], a[252:255], a[184:187], a[16:19]
    v_cvt_pk_bf16_f32 v45, v97, v101
    v_cvt_pk_bf16_f32 v46, v105, v109
    s_add_u32 s42, s41, 3072
    buffer_store_dwordx3 v[44:46], v0, s[16:19], s42 offen offset:768
    v_cvt_pk_bf16_f32 v48, v90, v94
    v_cvt_pk_bf16_f32 v49, v98, v102
    v_mfma_f32_16x16x32_bf16 a[20:23], a[252:255], a[188:191], a[20:23]
    v_cvt_pk_bf16_f32 v50, v106, v110
    s_add_u32 s42, s41, 3072
    buffer_store_dwordx3 v[48:50], v0, s[16:19], s42 offen offset:1536
    v_cvt_pk_bf16_f32 v52, v91, v95
    v_cvt_pk_bf16_f32 v53, v99, v103
    v_cvt_pk_bf16_f32 v54, v107, v111
    v_mfma_f32_16x16x32_bf16 a[20:23], a[248:251], a[164:167], a[20:23]
    s_add_u32 s42, s41, 3072
    buffer_store_dwordx3 v[52:54], v0, s[16:19], s42 offen offset:2304
    s_waitcnt lgkmcnt(4)
    v_mfma_f32_16x16x32_bf16 a[20:23], v[56:59], a[212:215], a[20:23]
    v_mfma_f32_16x16x32_bf16 a[20:23], v[60:63], a[236:239], a[20:23]
    ds_read_b64_tr_b16 a[248:249], v4 offset:3072
    v_mfma_f32_16x16x32_bf16 a[16:19], v[60:63], a[232:235], a[16:19]
    v_mfma_f32_16x16x32_bf16 a[16:19], v[56:59], a[208:211], a[16:19]
    ds_read_b64_tr_b16 a[250:251], v4 offset:3584
    v_mfma_f32_16x16x32_bf16 a[12:15], v[56:59], a[204:207], a[12:15]
    v_mfma_f32_16x16x32_bf16 a[12:15], v[60:63], a[228:231], a[12:15]
    ds_read_b64_tr_b16 a[252:253], v4 offset:15360
    v_mfma_f32_16x16x32_bf16 a[8:11], v[60:63], a[224:227], a[8:11]
    v_mfma_f32_16x16x32_bf16 a[8:11], v[56:59], a[200:203], a[8:11]
    ds_read_b64_tr_b16 a[254:255], v4 offset:15872
    v_mfma_f32_16x16x32_bf16 a[4:7], v[56:59], a[196:199], a[4:7]
    v_mfma_f32_16x16x32_bf16 a[4:7], v[60:63], a[220:223], a[4:7]
    v_mfma_f32_16x16x32_bf16 a[0:3], v[60:63], a[216:219], a[0:3]
    v_mfma_f32_16x16x32_bf16 a[0:3], v[56:59], a[192:195], a[0:3]
    s_waitcnt lgkmcnt(4)
    v_mfma_f32_16x16x32_bf16 v[112:115], a[240:243], a[144:147], v[112:115]
    v_mfma_f32_16x16x32_bf16 v[112:115], a[244:247], a[168:171], v[112:115]
    ds_read_b64_tr_b16 v[56:57], v3 offset:28672
    v_mfma_f32_16x16x32_bf16 v[116:119], a[244:247], a[172:175], v[116:119]
    v_mfma_f32_16x16x32_bf16 v[116:119], a[240:243], a[148:151], v[116:119]
    ds_read_b64_tr_b16 v[58:59], v3 offset:29184
    v_mfma_f32_16x16x32_bf16 v[120:123], a[240:243], a[152:155], v[120:123]
    v_mfma_f32_16x16x32_bf16 v[120:123], a[244:247], a[176:179], v[120:123]
    ds_read_b64_tr_b16 v[60:61], v3 offset:40960
    v_mfma_f32_16x16x32_bf16 v[124:127], a[244:247], a[180:183], v[124:127]
    v_mfma_f32_16x16x32_bf16 v[124:127], a[240:243], a[156:159], v[124:127]
    ds_read_b64_tr_b16 v[62:63], v3 offset:41472
    v_mfma_f32_16x16x32_bf16 v[128:131], a[240:243], a[160:163], v[128:131]
    v_accvgpr_read_b32 v14, a0
    v_accvgpr_read_b32 v15, a4
    v_accvgpr_read_b32 v16, a8
    v_accvgpr_read_b32 v17, a12
    v_accvgpr_read_b32 v18, a16
    v_mfma_f32_16x16x32_bf16 v[128:131], a[244:247], a[184:187], v[128:131]
    v_accvgpr_read_b32 v19, a20
    v_cvt_pk_bf16_f32 v24, v14, v15
    v_cvt_pk_bf16_f32 v25, v16, v17
    v_cvt_pk_bf16_f32 v26, v18, v19
    s_add_u32 s42, s41, 6144
    buffer_store_dwordx3 v[24:26], v0, s[16:19], s42 offen offset:0
    v_mfma_f32_16x16x32_bf16 v[132:135], a[244:247], a[188:191], v[132:135]
    v_accvgpr_read_b32 v14, a1
    v_accvgpr_read_b32 v15, a5
    v_accvgpr_read_b32 v16, a9
    v_accvgpr_read_b32 v17, a13
    v_accvgpr_read_b32 v18, a17
    v_mfma_f32_16x16x32_bf16 v[132:135], a[240:243], a[164:167], v[132:135]
    v_accvgpr_read_b32 v19, a21
    v_cvt_pk_bf16_f32 v28, v14, v15
    v_cvt_pk_bf16_f32 v29, v16, v17
    v_cvt_pk_bf16_f32 v30, v18, v19
    s_add_u32 s42, s41, 6144
    buffer_store_dwordx3 v[28:30], v0, s[16:19], s42 offen offset:768
    s_waitcnt lgkmcnt(4)
    v_mfma_f32_16x16x32_bf16 v[132:135], a[248:251], a[212:215], v[132:135]
    v_accvgpr_read_b32 v14, a2
    v_accvgpr_read_b32 v15, a6
    v_accvgpr_read_b32 v16, a10
    v_accvgpr_read_b32 v17, a14
    v_accvgpr_read_b32 v18, a18
    v_mfma_f32_16x16x32_bf16 v[132:135], a[252:255], a[236:239], v[132:135]
    ds_read_b64_tr_b16 a[240:241], v4 offset:4096
    v_accvgpr_read_b32 v19, a22
    v_cvt_pk_bf16_f32 v32, v14, v15
    v_cvt_pk_bf16_f32 v33, v16, v17
    v_cvt_pk_bf16_f32 v34, v18, v19
    v_mfma_f32_16x16x32_bf16 v[128:131], a[252:255], a[232:235], v[128:131]
    s_add_u32 s42, s41, 6144
    buffer_store_dwordx3 v[32:34], v0, s[16:19], s42 offen offset:1536
    v_accvgpr_read_b32 v14, a3
    v_accvgpr_read_b32 v15, a7
    v_accvgpr_read_b32 v16, a11
    v_accvgpr_read_b32 v17, a15
    v_mfma_f32_16x16x32_bf16 v[128:131], a[248:251], a[208:211], v[128:131]
    ds_read_b64_tr_b16 a[242:243], v4 offset:4608
    v_accvgpr_read_b32 v18, a19
    v_accvgpr_read_b32 v19, a23
    v_cvt_pk_bf16_f32 v36, v14, v15
    v_cvt_pk_bf16_f32 v37, v16, v17
    v_mfma_f32_16x16x32_bf16 v[124:127], a[248:251], a[204:207], v[124:127]
    v_cvt_pk_bf16_f32 v38, v18, v19
    s_add_u32 s42, s41, 6144
    buffer_store_dwordx3 v[36:38], v0, s[16:19], s42 offen offset:2304
    v_mfma_f32_16x16x32_bf16 v[124:127], a[252:255], a[228:231], v[124:127]
    ds_read_b64_tr_b16 a[244:245], v4 offset:16384
    v_mfma_f32_16x16x32_bf16 v[120:123], a[252:255], a[224:227], v[120:123]
    v_mfma_f32_16x16x32_bf16 v[120:123], a[248:251], a[200:203], v[120:123]
    ds_read_b64_tr_b16 a[246:247], v4 offset:16896
    v_mfma_f32_16x16x32_bf16 v[116:119], a[248:251], a[196:199], v[116:119]
    v_mfma_f32_16x16x32_bf16 v[116:119], a[252:255], a[220:223], v[116:119]
    v_mfma_f32_16x16x32_bf16 v[112:115], a[252:255], a[216:219], v[112:115]
    v_mfma_f32_16x16x32_bf16 v[112:115], a[248:251], a[192:195], v[112:115]
    s_waitcnt lgkmcnt(4)
    v_mfma_f32_16x16x32_bf16 v[136:139], v[56:59], a[144:147], v[136:139]
    v_mfma_f32_16x16x32_bf16 v[136:139], v[60:63], a[168:171], v[136:139]
    ds_read_b64_tr_b16 a[248:249], v3 offset:29696
    v_mfma_f32_16x16x32_bf16 v[140:143], v[60:63], a[172:175], v[140:143]
    v_mfma_f32_16x16x32_bf16 v[140:143], v[56:59], a[148:151], v[140:143]
    ds_read_b64_tr_b16 a[250:251], v3 offset:30208
    v_mfma_f32_16x16x32_bf16 v[144:147], v[56:59], a[152:155], v[144:147]
    v_mfma_f32_16x16x32_bf16 v[144:147], v[60:63], a[176:179], v[144:147]
    ds_read_b64_tr_b16 a[252:253], v3 offset:41984
    v_mfma_f32_16x16x32_bf16 v[148:151], v[60:63], a[180:183], v[148:151]
    v_mfma_f32_16x16x32_bf16 v[148:151], v[56:59], a[156:159], v[148:151]
    ds_read_b64_tr_b16 a[254:255], v3 offset:42496
    v_mfma_f32_16x16x32_bf16 v[152:155], v[56:59], a[160:163], v[152:155]
    v_cvt_pk_bf16_f32 v40, v112, v116
    v_cvt_pk_bf16_f32 v41, v120, v124
    v_cvt_pk_bf16_f32 v42, v128, v132
    s_add_u32 s42, s41, 9216
    buffer_store_dwordx3 v[40:42], v0, s[16:19], s42 offen offset:0
    v_cvt_pk_bf16_f32 v44, v113, v117
    v_mfma_f32_16x16x32_bf16 v[152:155], v[60:63], a[184:187], v[152:155]
    v_cvt_pk_bf16_f32 v45, v121, v125
    v_cvt_pk_bf16_f32 v46, v129, v133
    s_add_u32 s42, s41, 9216
    buffer_store_dwordx3 v[44:46], v0, s[16:19], s42 offen offset:768
    v_cvt_pk_bf16_f32 v48, v114, v118
    v_cvt_pk_bf16_f32 v49, v122, v126
    v_mfma_f32_16x16x32_bf16 v[156:159], v[60:63], a[188:191], v[156:159]
    v_cvt_pk_bf16_f32 v50, v130, v134
    s_add_u32 s42, s41, 9216
    buffer_store_dwordx3 v[48:50], v0, s[16:19], s42 offen offset:1536
    v_cvt_pk_bf16_f32 v52, v115, v119
    v_cvt_pk_bf16_f32 v53, v123, v127
    v_cvt_pk_bf16_f32 v54, v131, v135
    v_mfma_f32_16x16x32_bf16 v[156:159], v[56:59], a[164:167], v[156:159]
    s_add_u32 s42, s41, 9216
    buffer_store_dwordx3 v[52:54], v0, s[16:19], s42 offen offset:2304
    s_waitcnt lgkmcnt(4)
    v_mfma_f32_16x16x32_bf16 v[156:159], a[240:243], a[212:215], v[156:159]
    v_mfma_f32_16x16x32_bf16 v[156:159], a[244:247], a[236:239], v[156:159]
    ds_read_b64_tr_b16 v[56:57], v4 offset:5120
    v_mfma_f32_16x16x32_bf16 v[152:155], a[244:247], a[232:235], v[152:155]
    v_mfma_f32_16x16x32_bf16 v[152:155], a[240:243], a[208:211], v[152:155]
    ds_read_b64_tr_b16 v[58:59], v4 offset:5632
    v_mfma_f32_16x16x32_bf16 v[148:151], a[240:243], a[204:207], v[148:151]
    v_mfma_f32_16x16x32_bf16 v[148:151], a[244:247], a[228:231], v[148:151]
    ds_read_b64_tr_b16 v[60:61], v4 offset:17408
    v_mfma_f32_16x16x32_bf16 v[144:147], a[244:247], a[224:227], v[144:147]
    v_mfma_f32_16x16x32_bf16 v[144:147], a[240:243], a[200:203], v[144:147]
    ds_read_b64_tr_b16 v[62:63], v4 offset:17920
    v_mfma_f32_16x16x32_bf16 v[140:143], a[240:243], a[196:199], v[140:143]
    v_mfma_f32_16x16x32_bf16 v[140:143], a[244:247], a[220:223], v[140:143]
    v_mfma_f32_16x16x32_bf16 v[136:139], a[244:247], a[216:219], v[136:139]
    v_mfma_f32_16x16x32_bf16 v[136:139], a[240:243], a[192:195], v[136:139]
    s_waitcnt lgkmcnt(4)
    v_mfma_f32_16x16x32_bf16 a[24:27], a[248:251], a[144:147], a[24:27]
    v_mfma_f32_16x16x32_bf16 a[24:27], a[252:255], a[168:171], a[24:27]
    ds_read_b64_tr_b16 a[240:241], v3 offset:30720
    v_mfma_f32_16x16x32_bf16 a[28:31], a[252:255], a[172:175], a[28:31]
    v_mfma_f32_16x16x32_bf16 a[28:31], a[248:251], a[148:151], a[28:31]
    ds_read_b64_tr_b16 a[242:243], v3 offset:31232
    v_mfma_f32_16x16x32_bf16 a[32:35], a[248:251], a[152:155], a[32:35]
    v_mfma_f32_16x16x32_bf16 a[32:35], a[252:255], a[176:179], a[32:35]
    ds_read_b64_tr_b16 a[244:245], v3 offset:43008
    v_mfma_f32_16x16x32_bf16 a[36:39], a[252:255], a[180:183], a[36:39]
    v_mfma_f32_16x16x32_bf16 a[36:39], a[248:251], a[156:159], a[36:39]
    ds_read_b64_tr_b16 a[246:247], v3 offset:43520
    v_mfma_f32_16x16x32_bf16 a[40:43], a[248:251], a[160:163], a[40:43]
    v_cvt_pk_bf16_f32 v24, v136, v140
    v_cvt_pk_bf16_f32 v25, v144, v148
    v_cvt_pk_bf16_f32 v26, v152, v156
    s_add_u32 s42, s41, 12288
    buffer_store_dwordx3 v[24:26], v0, s[16:19], s42 offen offset:0
    v_cvt_pk_bf16_f32 v28, v137, v141
    v_mfma_f32_16x16x32_bf16 a[40:43], a[252:255], a[184:187], a[40:43]
    v_cvt_pk_bf16_f32 v29, v145, v149
    v_cvt_pk_bf16_f32 v30, v153, v157
    s_add_u32 s42, s41, 12288
    buffer_store_dwordx3 v[28:30], v0, s[16:19], s42 offen offset:768
    v_cvt_pk_bf16_f32 v32, v138, v142
    v_cvt_pk_bf16_f32 v33, v146, v150
    v_mfma_f32_16x16x32_bf16 a[44:47], a[252:255], a[188:191], a[44:47]
    v_cvt_pk_bf16_f32 v34, v154, v158
    s_add_u32 s42, s41, 12288
    buffer_store_dwordx3 v[32:34], v0, s[16:19], s42 offen offset:1536
    v_cvt_pk_bf16_f32 v36, v139, v143
    v_cvt_pk_bf16_f32 v37, v147, v151
    v_cvt_pk_bf16_f32 v38, v155, v159
    v_mfma_f32_16x16x32_bf16 a[44:47], a[248:251], a[164:167], a[44:47]
    s_add_u32 s42, s41, 12288
    buffer_store_dwordx3 v[36:38], v0, s[16:19], s42 offen offset:2304
    s_waitcnt lgkmcnt(4)
    v_mfma_f32_16x16x32_bf16 a[44:47], v[56:59], a[212:215], a[44:47]
    v_mfma_f32_16x16x32_bf16 a[44:47], v[60:63], a[236:239], a[44:47]
    ds_read_b64_tr_b16 a[248:249], v4 offset:6144
    v_mfma_f32_16x16x32_bf16 a[40:43], v[60:63], a[232:235], a[40:43]
    v_mfma_f32_16x16x32_bf16 a[40:43], v[56:59], a[208:211], a[40:43]
    ds_read_b64_tr_b16 a[250:251], v4 offset:6656
    v_mfma_f32_16x16x32_bf16 a[36:39], v[56:59], a[204:207], a[36:39]
    v_mfma_f32_16x16x32_bf16 a[36:39], v[60:63], a[228:231], a[36:39]
    ds_read_b64_tr_b16 a[252:253], v4 offset:18432
    v_mfma_f32_16x16x32_bf16 a[32:35], v[60:63], a[224:227], a[32:35]
    v_mfma_f32_16x16x32_bf16 a[32:35], v[56:59], a[200:203], a[32:35]
    ds_read_b64_tr_b16 a[254:255], v4 offset:18944
    v_mfma_f32_16x16x32_bf16 a[28:31], v[56:59], a[196:199], a[28:31]
    v_mfma_f32_16x16x32_bf16 a[28:31], v[60:63], a[220:223], a[28:31]
    v_mfma_f32_16x16x32_bf16 a[24:27], v[60:63], a[216:219], a[24:27]
    v_mfma_f32_16x16x32_bf16 a[24:27], v[56:59], a[192:195], a[24:27]
    s_waitcnt lgkmcnt(4)
    v_mfma_f32_16x16x32_bf16 v[160:163], a[240:243], a[144:147], v[160:163]
    v_mfma_f32_16x16x32_bf16 v[160:163], a[244:247], a[168:171], v[160:163]
    ds_read_b64_tr_b16 v[56:57], v3 offset:31744
    v_mfma_f32_16x16x32_bf16 v[164:167], a[244:247], a[172:175], v[164:167]
    v_mfma_f32_16x16x32_bf16 v[164:167], a[240:243], a[148:151], v[164:167]
    ds_read_b64_tr_b16 v[58:59], v3 offset:32256
    v_mfma_f32_16x16x32_bf16 v[168:171], a[240:243], a[152:155], v[168:171]
    v_mfma_f32_16x16x32_bf16 v[168:171], a[244:247], a[176:179], v[168:171]
    ds_read_b64_tr_b16 v[60:61], v3 offset:44032
    v_mfma_f32_16x16x32_bf16 v[172:175], a[244:247], a[180:183], v[172:175]
    v_mfma_f32_16x16x32_bf16 v[172:175], a[240:243], a[156:159], v[172:175]
    ds_read_b64_tr_b16 v[62:63], v3 offset:44544
    v_mfma_f32_16x16x32_bf16 v[176:179], a[240:243], a[160:163], v[176:179]
    v_accvgpr_read_b32 v14, a24
    v_accvgpr_read_b32 v15, a28
    v_accvgpr_read_b32 v16, a32
    v_accvgpr_read_b32 v17, a36
    v_accvgpr_read_b32 v18, a40
    v_mfma_f32_16x16x32_bf16 v[176:179], a[244:247], a[184:187], v[176:179]
    v_accvgpr_read_b32 v19, a44
    v_cvt_pk_bf16_f32 v40, v14, v15
    v_cvt_pk_bf16_f32 v41, v16, v17
    v_cvt_pk_bf16_f32 v42, v18, v19
    s_add_u32 s42, s41, 15360
    buffer_store_dwordx3 v[40:42], v0, s[16:19], s42 offen offset:0
    v_mfma_f32_16x16x32_bf16 v[180:183], a[244:247], a[188:191], v[180:183]
    v_accvgpr_read_b32 v14, a25
    v_accvgpr_read_b32 v15, a29
    v_accvgpr_read_b32 v16, a33
    v_accvgpr_read_b32 v17, a37
    v_accvgpr_read_b32 v18, a41
    v_mfma_f32_16x16x32_bf16 v[180:183], a[240:243], a[164:167], v[180:183]
    v_accvgpr_read_b32 v19, a45
    v_cvt_pk_bf16_f32 v44, v14, v15
    v_cvt_pk_bf16_f32 v45, v16, v17
    v_cvt_pk_bf16_f32 v46, v18, v19
    s_add_u32 s42, s41, 15360
    buffer_store_dwordx3 v[44:46], v0, s[16:19], s42 offen offset:768
    s_waitcnt lgkmcnt(4)
    v_mfma_f32_16x16x32_bf16 v[180:183], a[248:251], a[212:215], v[180:183]
    v_accvgpr_read_b32 v14, a26
    v_accvgpr_read_b32 v15, a30
    v_accvgpr_read_b32 v16, a34
    v_accvgpr_read_b32 v17, a38
    v_accvgpr_read_b32 v18, a42
    v_mfma_f32_16x16x32_bf16 v[180:183], a[252:255], a[236:239], v[180:183]
    ds_read_b64_tr_b16 a[240:241], v4 offset:7168
    v_accvgpr_read_b32 v19, a46
    v_cvt_pk_bf16_f32 v48, v14, v15
    v_cvt_pk_bf16_f32 v49, v16, v17
    v_cvt_pk_bf16_f32 v50, v18, v19
    v_mfma_f32_16x16x32_bf16 v[176:179], a[252:255], a[232:235], v[176:179]
    s_add_u32 s42, s41, 15360
    buffer_store_dwordx3 v[48:50], v0, s[16:19], s42 offen offset:1536
    v_accvgpr_read_b32 v14, a27
    v_accvgpr_read_b32 v15, a31
    v_accvgpr_read_b32 v16, a35
    v_accvgpr_read_b32 v17, a39
    v_mfma_f32_16x16x32_bf16 v[176:179], a[248:251], a[208:211], v[176:179]
    ds_read_b64_tr_b16 a[242:243], v4 offset:7680
    v_accvgpr_read_b32 v18, a43
    v_accvgpr_read_b32 v19, a47
    v_cvt_pk_bf16_f32 v52, v14, v15
    v_cvt_pk_bf16_f32 v53, v16, v17
    v_mfma_f32_16x16x32_bf16 v[172:175], a[248:251], a[204:207], v[172:175]
    v_cvt_pk_bf16_f32 v54, v18, v19
    s_add_u32 s42, s41, 15360
    buffer_store_dwordx3 v[52:54], v0, s[16:19], s42 offen offset:2304
    v_mfma_f32_16x16x32_bf16 v[172:175], a[252:255], a[228:231], v[172:175]
    ds_read_b64_tr_b16 a[244:245], v4 offset:19456
    v_mfma_f32_16x16x32_bf16 v[168:171], a[252:255], a[224:227], v[168:171]
    v_mfma_f32_16x16x32_bf16 v[168:171], a[248:251], a[200:203], v[168:171]
    ds_read_b64_tr_b16 a[246:247], v4 offset:19968
    v_mfma_f32_16x16x32_bf16 v[164:167], a[248:251], a[196:199], v[164:167]
    v_mfma_f32_16x16x32_bf16 v[164:167], a[252:255], a[220:223], v[164:167]
    v_mfma_f32_16x16x32_bf16 v[160:163], a[252:255], a[216:219], v[160:163]
    v_mfma_f32_16x16x32_bf16 v[160:163], a[248:251], a[192:195], v[160:163]
    s_waitcnt lgkmcnt(4)
    v_mfma_f32_16x16x32_bf16 v[184:187], v[56:59], a[144:147], v[184:187]
    v_mfma_f32_16x16x32_bf16 v[184:187], v[60:63], a[168:171], v[184:187]
    ds_read_b64_tr_b16 a[248:249], v3 offset:32768
    v_mfma_f32_16x16x32_bf16 v[188:191], v[60:63], a[172:175], v[188:191]
    v_mfma_f32_16x16x32_bf16 v[188:191], v[56:59], a[148:151], v[188:191]
    ds_read_b64_tr_b16 a[250:251], v3 offset:33280
    v_mfma_f32_16x16x32_bf16 v[192:195], v[56:59], a[152:155], v[192:195]
    v_mfma_f32_16x16x32_bf16 v[192:195], v[60:63], a[176:179], v[192:195]
    ds_read_b64_tr_b16 a[252:253], v3 offset:45056
    v_mfma_f32_16x16x32_bf16 v[196:199], v[60:63], a[180:183], v[196:199]
    v_mfma_f32_16x16x32_bf16 v[196:199], v[56:59], a[156:159], v[196:199]
    ds_read_b64_tr_b16 a[254:255], v3 offset:45568
    v_mfma_f32_16x16x32_bf16 v[200:203], v[56:59], a[160:163], v[200:203]
    v_cvt_pk_bf16_f32 v24, v160, v164
    v_cvt_pk_bf16_f32 v25, v168, v172
    v_cvt_pk_bf16_f32 v26, v176, v180
    s_add_u32 s42, s41, 73728
    buffer_store_dwordx3 v[24:26], v0, s[16:19], s42 offen offset:0
    v_cvt_pk_bf16_f32 v28, v161, v165
    v_mfma_f32_16x16x32_bf16 v[200:203], v[60:63], a[184:187], v[200:203]
    v_cvt_pk_bf16_f32 v29, v169, v173
    v_cvt_pk_bf16_f32 v30, v177, v181
    s_add_u32 s42, s41, 73728
    buffer_store_dwordx3 v[28:30], v0, s[16:19], s42 offen offset:768
    v_cvt_pk_bf16_f32 v32, v162, v166
    v_cvt_pk_bf16_f32 v33, v170, v174
    v_mfma_f32_16x16x32_bf16 v[204:207], v[60:63], a[188:191], v[204:207]
    v_cvt_pk_bf16_f32 v34, v178, v182
    s_add_u32 s42, s41, 73728
    buffer_store_dwordx3 v[32:34], v0, s[16:19], s42 offen offset:1536
    v_cvt_pk_bf16_f32 v36, v163, v167
    v_cvt_pk_bf16_f32 v37, v171, v175
    v_cvt_pk_bf16_f32 v38, v179, v183
    v_mfma_f32_16x16x32_bf16 v[204:207], v[56:59], a[164:167], v[204:207]
    s_add_u32 s42, s41, 73728
    buffer_store_dwordx3 v[36:38], v0, s[16:19], s42 offen offset:2304
    s_waitcnt lgkmcnt(4)
    v_mfma_f32_16x16x32_bf16 v[204:207], a[240:243], a[212:215], v[204:207]
    v_mfma_f32_16x16x32_bf16 v[204:207], a[244:247], a[236:239], v[204:207]
    ds_read_b64_tr_b16 v[56:57], v4 offset:8192
    v_mfma_f32_16x16x32_bf16 v[200:203], a[244:247], a[232:235], v[200:203]
    v_mfma_f32_16x16x32_bf16 v[200:203], a[240:243], a[208:211], v[200:203]
    ds_read_b64_tr_b16 v[58:59], v4 offset:8704
    v_mfma_f32_16x16x32_bf16 v[196:199], a[240:243], a[204:207], v[196:199]
    v_mfma_f32_16x16x32_bf16 v[196:199], a[244:247], a[228:231], v[196:199]
    ds_read_b64_tr_b16 v[60:61], v4 offset:20480
    v_mfma_f32_16x16x32_bf16 v[192:195], a[244:247], a[224:227], v[192:195]
    v_mfma_f32_16x16x32_bf16 v[192:195], a[240:243], a[200:203], v[192:195]
    ds_read_b64_tr_b16 v[62:63], v4 offset:20992
    v_mfma_f32_16x16x32_bf16 v[188:191], a[240:243], a[196:199], v[188:191]
    v_mfma_f32_16x16x32_bf16 v[188:191], a[244:247], a[220:223], v[188:191]
    v_mfma_f32_16x16x32_bf16 v[184:187], a[244:247], a[216:219], v[184:187]
    v_mfma_f32_16x16x32_bf16 v[184:187], a[240:243], a[192:195], v[184:187]
    s_waitcnt lgkmcnt(4)
    v_mfma_f32_16x16x32_bf16 a[48:51], a[248:251], a[144:147], a[48:51]
    v_mfma_f32_16x16x32_bf16 a[48:51], a[252:255], a[168:171], a[48:51]
    ds_read_b64_tr_b16 a[240:241], v3 offset:33792
    v_mfma_f32_16x16x32_bf16 a[52:55], a[252:255], a[172:175], a[52:55]
    v_mfma_f32_16x16x32_bf16 a[52:55], a[248:251], a[148:151], a[52:55]
    ds_read_b64_tr_b16 a[242:243], v3 offset:34304
    v_mfma_f32_16x16x32_bf16 a[56:59], a[248:251], a[152:155], a[56:59]
    v_mfma_f32_16x16x32_bf16 a[56:59], a[252:255], a[176:179], a[56:59]
    ds_read_b64_tr_b16 a[244:245], v3 offset:46080
    v_mfma_f32_16x16x32_bf16 a[60:63], a[252:255], a[180:183], a[60:63]
    v_mfma_f32_16x16x32_bf16 a[60:63], a[248:251], a[156:159], a[60:63]
    ds_read_b64_tr_b16 a[246:247], v3 offset:46592
    v_mfma_f32_16x16x32_bf16 a[64:67], a[248:251], a[160:163], a[64:67]
    v_cvt_pk_bf16_f32 v40, v184, v188
    v_cvt_pk_bf16_f32 v41, v192, v196
    v_cvt_pk_bf16_f32 v42, v200, v204
    s_add_u32 s42, s41, 76800
    buffer_store_dwordx3 v[40:42], v0, s[16:19], s42 offen offset:0
    v_cvt_pk_bf16_f32 v44, v185, v189
    v_mfma_f32_16x16x32_bf16 a[64:67], a[252:255], a[184:187], a[64:67]
    v_cvt_pk_bf16_f32 v45, v193, v197
    v_cvt_pk_bf16_f32 v46, v201, v205
    s_add_u32 s42, s41, 76800
    buffer_store_dwordx3 v[44:46], v0, s[16:19], s42 offen offset:768
    v_cvt_pk_bf16_f32 v48, v186, v190
    v_cvt_pk_bf16_f32 v49, v194, v198
    v_mfma_f32_16x16x32_bf16 a[68:71], a[252:255], a[188:191], a[68:71]
    v_cvt_pk_bf16_f32 v50, v202, v206
    s_add_u32 s42, s41, 76800
    buffer_store_dwordx3 v[48:50], v0, s[16:19], s42 offen offset:1536
    v_cvt_pk_bf16_f32 v52, v187, v191
    v_cvt_pk_bf16_f32 v53, v195, v199
    v_cvt_pk_bf16_f32 v54, v203, v207
    v_mfma_f32_16x16x32_bf16 a[68:71], a[248:251], a[164:167], a[68:71]
    s_add_u32 s42, s41, 76800
    buffer_store_dwordx3 v[52:54], v0, s[16:19], s42 offen offset:2304
    s_waitcnt lgkmcnt(4)
    v_mfma_f32_16x16x32_bf16 a[68:71], v[56:59], a[212:215], a[68:71]
    v_mfma_f32_16x16x32_bf16 a[68:71], v[60:63], a[236:239], a[68:71]
    ds_read_b64_tr_b16 a[248:249], v4 offset:9216
    v_mfma_f32_16x16x32_bf16 a[64:67], v[60:63], a[232:235], a[64:67]
    v_mfma_f32_16x16x32_bf16 a[64:67], v[56:59], a[208:211], a[64:67]
    ds_read_b64_tr_b16 a[250:251], v4 offset:9728
    v_mfma_f32_16x16x32_bf16 a[60:63], v[56:59], a[204:207], a[60:63]
    v_mfma_f32_16x16x32_bf16 a[60:63], v[60:63], a[228:231], a[60:63]
    ds_read_b64_tr_b16 a[252:253], v4 offset:21504
    v_mfma_f32_16x16x32_bf16 a[56:59], v[60:63], a[224:227], a[56:59]
    v_mfma_f32_16x16x32_bf16 a[56:59], v[56:59], a[200:203], a[56:59]
    ds_read_b64_tr_b16 a[254:255], v4 offset:22016
    v_mfma_f32_16x16x32_bf16 a[52:55], v[56:59], a[196:199], a[52:55]
    v_mfma_f32_16x16x32_bf16 a[52:55], v[60:63], a[220:223], a[52:55]
    v_mfma_f32_16x16x32_bf16 a[48:51], v[60:63], a[216:219], a[48:51]
    v_mfma_f32_16x16x32_bf16 a[48:51], v[56:59], a[192:195], a[48:51]
    s_waitcnt lgkmcnt(4)
    v_mfma_f32_16x16x32_bf16 v[208:211], a[240:243], a[144:147], v[208:211]
    v_mfma_f32_16x16x32_bf16 v[208:211], a[244:247], a[168:171], v[208:211]
    ds_read_b64_tr_b16 v[56:57], v3 offset:34816
    v_mfma_f32_16x16x32_bf16 v[212:215], a[244:247], a[172:175], v[212:215]
    v_mfma_f32_16x16x32_bf16 v[212:215], a[240:243], a[148:151], v[212:215]
    ds_read_b64_tr_b16 v[58:59], v3 offset:35328
    v_mfma_f32_16x16x32_bf16 v[216:219], a[240:243], a[152:155], v[216:219]
    v_mfma_f32_16x16x32_bf16 v[216:219], a[244:247], a[176:179], v[216:219]
    ds_read_b64_tr_b16 v[60:61], v3 offset:47104
    v_mfma_f32_16x16x32_bf16 v[220:223], a[244:247], a[180:183], v[220:223]
    v_mfma_f32_16x16x32_bf16 v[220:223], a[240:243], a[156:159], v[220:223]
    ds_read_b64_tr_b16 v[62:63], v3 offset:47616
    v_mfma_f32_16x16x32_bf16 v[224:227], a[240:243], a[160:163], v[224:227]
    v_accvgpr_read_b32 v14, a48
    v_accvgpr_read_b32 v15, a52
    v_accvgpr_read_b32 v16, a56
    v_accvgpr_read_b32 v17, a60
    v_accvgpr_read_b32 v18, a64
    v_mfma_f32_16x16x32_bf16 v[224:227], a[244:247], a[184:187], v[224:227]
    v_accvgpr_read_b32 v19, a68
    v_cvt_pk_bf16_f32 v24, v14, v15
    v_cvt_pk_bf16_f32 v25, v16, v17
    v_cvt_pk_bf16_f32 v26, v18, v19
    s_add_u32 s42, s41, 79872
    buffer_store_dwordx3 v[24:26], v0, s[16:19], s42 offen offset:0
    v_mfma_f32_16x16x32_bf16 v[228:231], a[244:247], a[188:191], v[228:231]
    v_accvgpr_read_b32 v14, a49
    v_accvgpr_read_b32 v15, a53
    v_accvgpr_read_b32 v16, a57
    v_accvgpr_read_b32 v17, a61
    v_accvgpr_read_b32 v18, a65
    v_mfma_f32_16x16x32_bf16 v[228:231], a[240:243], a[164:167], v[228:231]
    v_accvgpr_read_b32 v19, a69
    v_cvt_pk_bf16_f32 v28, v14, v15
    v_cvt_pk_bf16_f32 v29, v16, v17
    v_cvt_pk_bf16_f32 v30, v18, v19
    s_add_u32 s42, s41, 79872
    buffer_store_dwordx3 v[28:30], v0, s[16:19], s42 offen offset:768
    s_waitcnt lgkmcnt(4)
    v_mfma_f32_16x16x32_bf16 v[228:231], a[248:251], a[212:215], v[228:231]
    v_accvgpr_read_b32 v14, a50
    v_accvgpr_read_b32 v15, a54
    v_accvgpr_read_b32 v16, a58
    v_accvgpr_read_b32 v17, a62
    v_accvgpr_read_b32 v18, a66
    v_mfma_f32_16x16x32_bf16 v[228:231], a[252:255], a[236:239], v[228:231]
    ds_read_b64_tr_b16 a[240:241], v4 offset:10240
    v_accvgpr_read_b32 v19, a70
    v_cvt_pk_bf16_f32 v32, v14, v15
    v_cvt_pk_bf16_f32 v33, v16, v17
    v_cvt_pk_bf16_f32 v34, v18, v19
    v_mfma_f32_16x16x32_bf16 v[224:227], a[252:255], a[232:235], v[224:227]
    s_add_u32 s42, s41, 79872
    buffer_store_dwordx3 v[32:34], v0, s[16:19], s42 offen offset:1536
    v_accvgpr_read_b32 v14, a51
    v_accvgpr_read_b32 v15, a55
    v_accvgpr_read_b32 v16, a59
    v_accvgpr_read_b32 v17, a63
    v_mfma_f32_16x16x32_bf16 v[224:227], a[248:251], a[208:211], v[224:227]
    ds_read_b64_tr_b16 a[242:243], v4 offset:10752
    v_accvgpr_read_b32 v18, a67
    v_accvgpr_read_b32 v19, a71
    v_cvt_pk_bf16_f32 v36, v14, v15
    v_cvt_pk_bf16_f32 v37, v16, v17
    v_mfma_f32_16x16x32_bf16 v[220:223], a[248:251], a[204:207], v[220:223]
    v_cvt_pk_bf16_f32 v38, v18, v19
    s_add_u32 s42, s41, 79872
    buffer_store_dwordx3 v[36:38], v0, s[16:19], s42 offen offset:2304
    v_mfma_f32_16x16x32_bf16 v[220:223], a[252:255], a[228:231], v[220:223]
    ds_read_b64_tr_b16 a[244:245], v4 offset:22528
    v_mfma_f32_16x16x32_bf16 v[216:219], a[252:255], a[224:227], v[216:219]
    v_mfma_f32_16x16x32_bf16 v[216:219], a[248:251], a[200:203], v[216:219]
    ds_read_b64_tr_b16 a[246:247], v4 offset:23040
    v_mfma_f32_16x16x32_bf16 v[212:215], a[248:251], a[196:199], v[212:215]
    v_mfma_f32_16x16x32_bf16 v[212:215], a[252:255], a[220:223], v[212:215]
    v_mfma_f32_16x16x32_bf16 v[208:211], a[252:255], a[216:219], v[208:211]
    v_mfma_f32_16x16x32_bf16 v[208:211], a[248:251], a[192:195], v[208:211]
    s_waitcnt lgkmcnt(4)
    v_mfma_f32_16x16x32_bf16 v[232:235], v[56:59], a[144:147], v[232:235]
    v_mfma_f32_16x16x32_bf16 v[232:235], v[60:63], a[168:171], v[232:235]
    ds_read_b64_tr_b16 a[248:249], v3 offset:35840
    v_mfma_f32_16x16x32_bf16 v[236:239], v[60:63], a[172:175], v[236:239]
    v_mfma_f32_16x16x32_bf16 v[236:239], v[56:59], a[148:151], v[236:239]
    ds_read_b64_tr_b16 a[250:251], v3 offset:36352
    v_mfma_f32_16x16x32_bf16 v[240:243], v[56:59], a[152:155], v[240:243]
    v_mfma_f32_16x16x32_bf16 v[240:243], v[60:63], a[176:179], v[240:243]
    ds_read_b64_tr_b16 a[252:253], v3 offset:48128
    v_mfma_f32_16x16x32_bf16 v[244:247], v[60:63], a[180:183], v[244:247]
    v_mfma_f32_16x16x32_bf16 v[244:247], v[56:59], a[156:159], v[244:247]
    ds_read_b64_tr_b16 a[254:255], v3 offset:48640
    v_mfma_f32_16x16x32_bf16 v[248:251], v[56:59], a[160:163], v[248:251]
    v_cvt_pk_bf16_f32 v40, v208, v212
    v_cvt_pk_bf16_f32 v41, v216, v220
    v_cvt_pk_bf16_f32 v42, v224, v228
    s_add_u32 s42, s41, 82944
    buffer_store_dwordx3 v[40:42], v0, s[16:19], s42 offen offset:0
    v_cvt_pk_bf16_f32 v44, v209, v213
    v_mfma_f32_16x16x32_bf16 v[248:251], v[60:63], a[184:187], v[248:251]
    v_cvt_pk_bf16_f32 v45, v217, v221
    v_cvt_pk_bf16_f32 v46, v225, v229
    s_add_u32 s42, s41, 82944
    buffer_store_dwordx3 v[44:46], v0, s[16:19], s42 offen offset:768
    v_cvt_pk_bf16_f32 v48, v210, v214
    v_cvt_pk_bf16_f32 v49, v218, v222
    v_mfma_f32_16x16x32_bf16 v[252:255], v[60:63], a[188:191], v[252:255]
    v_cvt_pk_bf16_f32 v50, v226, v230
    s_add_u32 s42, s41, 82944
    buffer_store_dwordx3 v[48:50], v0, s[16:19], s42 offen offset:1536
    v_cvt_pk_bf16_f32 v52, v211, v215
    v_cvt_pk_bf16_f32 v53, v219, v223
    v_cvt_pk_bf16_f32 v54, v227, v231
    v_mfma_f32_16x16x32_bf16 v[252:255], v[56:59], a[164:167], v[252:255]
    s_add_u32 s42, s41, 82944
    buffer_store_dwordx3 v[52:54], v0, s[16:19], s42 offen offset:2304
    s_waitcnt lgkmcnt(4)
    v_mfma_f32_16x16x32_bf16 v[252:255], a[240:243], a[212:215], v[252:255]
    v_mfma_f32_16x16x32_bf16 v[252:255], a[244:247], a[236:239], v[252:255]
    ds_read_b64_tr_b16 v[56:57], v4 offset:11264
    v_mfma_f32_16x16x32_bf16 v[248:251], a[244:247], a[232:235], v[248:251]
    v_mfma_f32_16x16x32_bf16 v[248:251], a[240:243], a[208:211], v[248:251]
    ds_read_b64_tr_b16 v[58:59], v4 offset:11776
    v_mfma_f32_16x16x32_bf16 v[244:247], a[240:243], a[204:207], v[244:247]
    v_mfma_f32_16x16x32_bf16 v[244:247], a[244:247], a[228:231], v[244:247]
    ds_read_b64_tr_b16 v[60:61], v4 offset:23552
    v_mfma_f32_16x16x32_bf16 v[240:243], a[244:247], a[224:227], v[240:243]
    v_mfma_f32_16x16x32_bf16 v[240:243], a[240:243], a[200:203], v[240:243]
    ds_read_b64_tr_b16 v[62:63], v4 offset:24064
    v_mfma_f32_16x16x32_bf16 v[236:239], a[240:243], a[196:199], v[236:239]
    v_mfma_f32_16x16x32_bf16 v[236:239], a[244:247], a[220:223], v[236:239]
    v_mfma_f32_16x16x32_bf16 v[232:235], a[244:247], a[216:219], v[232:235]
    v_mfma_f32_16x16x32_bf16 v[232:235], a[240:243], a[192:195], v[232:235]
    s_waitcnt lgkmcnt(4)
    v_mfma_f32_16x16x32_bf16 a[72:75], a[248:251], a[144:147], a[72:75]
    v_mfma_f32_16x16x32_bf16 a[72:75], a[252:255], a[168:171], a[72:75]
    v_mfma_f32_16x16x32_bf16 a[76:79], a[252:255], a[172:175], a[76:79]
    v_mfma_f32_16x16x32_bf16 a[76:79], a[248:251], a[148:151], a[76:79]
    v_mfma_f32_16x16x32_bf16 a[80:83], a[248:251], a[152:155], a[80:83]
    v_mfma_f32_16x16x32_bf16 a[80:83], a[252:255], a[176:179], a[80:83]
    v_mfma_f32_16x16x32_bf16 a[84:87], a[252:255], a[180:183], a[84:87]
    v_mfma_f32_16x16x32_bf16 a[84:87], a[248:251], a[156:159], a[84:87]
    v_mfma_f32_16x16x32_bf16 a[88:91], a[248:251], a[160:163], a[88:91]
    v_cvt_pk_bf16_f32 v24, v232, v236
    v_cvt_pk_bf16_f32 v25, v240, v244
    v_cvt_pk_bf16_f32 v26, v248, v252
    s_add_u32 s42, s41, 86016
    buffer_store_dwordx3 v[24:26], v0, s[16:19], s42 offen offset:0
    v_cvt_pk_bf16_f32 v28, v233, v237
    v_mfma_f32_16x16x32_bf16 a[88:91], a[252:255], a[184:187], a[88:91]
    v_cvt_pk_bf16_f32 v29, v241, v245
    v_cvt_pk_bf16_f32 v30, v249, v253
    s_add_u32 s42, s41, 86016
    buffer_store_dwordx3 v[28:30], v0, s[16:19], s42 offen offset:768
    v_cvt_pk_bf16_f32 v32, v234, v238
    v_cvt_pk_bf16_f32 v33, v242, v246
    v_mfma_f32_16x16x32_bf16 a[92:95], a[252:255], a[188:191], a[92:95]
    v_cvt_pk_bf16_f32 v34, v250, v254
    s_add_u32 s42, s41, 86016
    buffer_store_dwordx3 v[32:34], v0, s[16:19], s42 offen offset:1536
    v_cvt_pk_bf16_f32 v36, v235, v239
    v_cvt_pk_bf16_f32 v37, v243, v247
    v_cvt_pk_bf16_f32 v38, v251, v255
    v_mfma_f32_16x16x32_bf16 a[92:95], a[248:251], a[164:167], a[92:95]
    s_add_u32 s42, s41, 86016
    buffer_store_dwordx3 v[36:38], v0, s[16:19], s42 offen offset:2304
    s_waitcnt lgkmcnt(0)
    v_mfma_f32_16x16x32_bf16 a[92:95], v[56:59], a[212:215], a[92:95]
    v_mfma_f32_16x16x32_bf16 a[92:95], v[60:63], a[236:239], a[92:95]
    v_mfma_f32_16x16x32_bf16 a[88:91], v[60:63], a[232:235], a[88:91]
    v_mfma_f32_16x16x32_bf16 a[88:91], v[56:59], a[208:211], a[88:91]
    v_mfma_f32_16x16x32_bf16 a[84:87], v[56:59], a[204:207], a[84:87]
    v_mfma_f32_16x16x32_bf16 a[84:87], v[60:63], a[228:231], a[84:87]
    v_mfma_f32_16x16x32_bf16 a[80:83], v[60:63], a[224:227], a[80:83]
    v_mfma_f32_16x16x32_bf16 a[80:83], v[56:59], a[200:203], a[80:83]
    v_mfma_f32_16x16x32_bf16 a[76:79], v[56:59], a[196:199], a[76:79]
    v_mfma_f32_16x16x32_bf16 a[76:79], v[60:63], a[220:223], a[76:79]
    v_mfma_f32_16x16x32_bf16 a[72:75], v[60:63], a[216:219], a[72:75]
    v_mfma_f32_16x16x32_bf16 a[72:75], v[56:59], a[192:195], a[72:75]
    s_nop 7
    v_accvgpr_read_b32 v14, a72
    v_accvgpr_read_b32 v15, a76
    v_accvgpr_read_b32 v16, a80
    v_accvgpr_read_b32 v17, a84
    v_accvgpr_read_b32 v18, a88
    v_accvgpr_read_b32 v19, a92
    v_cvt_pk_bf16_f32 v40, v14, v15
    v_cvt_pk_bf16_f32 v41, v16, v17
    v_cvt_pk_bf16_f32 v42, v18, v19
    s_add_u32 s42, s41, 89088
    buffer_store_dwordx3 v[40:42], v0, s[16:19], s42 offen offset:0
    v_accvgpr_read_b32 v14, a73
    v_accvgpr_read_b32 v15, a77
    v_accvgpr_read_b32 v16, a81
    v_accvgpr_read_b32 v17, a85
    v_accvgpr_read_b32 v18, a89
    v_accvgpr_read_b32 v19, a93
    v_cvt_pk_bf16_f32 v44, v14, v15
    v_cvt_pk_bf16_f32 v45, v16, v17
    v_cvt_pk_bf16_f32 v46, v18, v19
    s_add_u32 s42, s41, 89088
    buffer_store_dwordx3 v[44:46], v0, s[16:19], s42 offen offset:768
    v_accvgpr_read_b32 v14, a74
    v_accvgpr_read_b32 v15, a78
    v_accvgpr_read_b32 v16, a82
    v_accvgpr_read_b32 v17, a86
    v_accvgpr_read_b32 v18, a90
    v_accvgpr_read_b32 v19, a94
    v_cvt_pk_bf16_f32 v48, v14, v15
    v_cvt_pk_bf16_f32 v49, v16, v17
    v_cvt_pk_bf16_f32 v50, v18, v19
    s_add_u32 s42, s41, 89088
    buffer_store_dwordx3 v[48:50], v0, s[16:19], s42 offen offset:1536
    v_accvgpr_read_b32 v14, a75
    v_accvgpr_read_b32 v15, a79
    v_accvgpr_read_b32 v16, a83
    v_accvgpr_read_b32 v17, a87
    v_accvgpr_read_b32 v18, a91
    v_accvgpr_read_b32 v19, a95
    v_cvt_pk_bf16_f32 v52, v14, v15
    v_cvt_pk_bf16_f32 v53, v16, v17
    v_cvt_pk_bf16_f32 v54, v18, v19
    s_add_u32 s42, s41, 89088
    buffer_store_dwordx3 v[52:54], v0, s[16:19], s42 offen offset:2304
L_k2_end:
    s_endpgm
.section .rodata,"a"
.p2align 6
.amdhsa_kernel prep_kernel
  .amdhsa_next_free_vgpr 48
  .amdhsa_next_free_sgpr 102
  .amdhsa_accum_offset 48
  .amdhsa_group_segment_fixed_size 0
  .amdhsa_kernarg_size 72
  .amdhsa_user_sgpr_count 2
  .amdhsa_user_sgpr_kernarg_segment_ptr 1
  .amdhsa_system_sgpr_workgroup_id_x 1
.end_amdhsa_kernel
.p2align 6
.amdhsa_kernel ln_gemm1_kernel
  .amdhsa_next_free_vgpr 256
  .amdhsa_next_free_sgpr 102
  .amdhsa_accum_offset 256
  .amdhsa_group_segment_fixed_size 0
  .amdhsa_kernarg_size 72
  .amdhsa_user_sgpr_count 2
  .amdhsa_user_sgpr_kernarg_segment_ptr 1
  .amdhsa_system_sgpr_workgroup_id_x 1
.end_amdhsa_kernel
.p2align 6
.amdhsa_kernel grn_kernel
  .amdhsa_next_free_vgpr 64
  .amdhsa_next_free_sgpr 102
  .amdhsa_accum_offset 64
  .amdhsa_group_segment_fixed_size 0
  .amdhsa_kernarg_size 72
  .amdhsa_user_sgpr_count 2
  .amdhsa_user_sgpr_kernarg_segment_ptr 1
  .amdhsa_system_sgpr_workgroup_id_x 1
.end_amdhsa_kernel
.p2align 6
.amdhsa_kernel gemm2_kernel
  .amdhsa_next_free_vgpr 512
  .amdhsa_next_free_sgpr 102
  .amdhsa_accum_offset 256
  .amdhsa_group_segment_fixed_size 0
  .amdhsa_kernarg_size 72
  .amdhsa_user_sgpr_count 2
  .amdhsa_user_sgpr_kernarg_segment_ptr 1
  .amdhsa_system_sgpr_workgroup_id_x 1
.end_amdhsa_kernel
```
